```python
import torch

def _softmax(x, axis=-1):
    return torch.softmax(x, dim=axis)
def _gelu(x):
    return torch.nn.functional.gelu(x, approximate="tanh")
def _silu(x):
    return torch.nn.functional.silu(x)
def _sigmoid(x):
    return torch.sigmoid(x)
def _layernorm(x, axis=-1, eps=1e-5):
    m = x.mean(dim=axis, keepdim=True)
    v = x.var(dim=axis, keepdim=True, unbiased=False)
    return (x - m) / torch.sqrt(v + eps)
def _scatter_add(tgt, idx, src, axis=0):
    return tgt.clone().index_add_(axis, idx, src)
def _segment_sum(src, seg, n):
    out = torch.zeros((n,) + src.shape[1:], dtype=src.dtype)
    return out.index_add_(0, seg, src)
def _pad(x, pw):
    flat = tuple(v for pair in reversed(pw) for v in pair)
    return torch.nn.functional.pad(x, flat)

kernel_name = 'concat_heads__mha_block_cached__gqa_block_cached__near_ridge'

def setup_inputs():

    _w = (lambda a: (lambda t: t.to(torch.bfloat16) if t.is_floating_point() else t)(torch.as_tensor(a)))
    def _A_setup():
        B, Sq, D = 16, 192, 640
        H, Sk, Dh = 32, 512, 128
        return {
            "x": _w((lambda *s: torch.randn(*s, dtype=torch.bfloat16) * 0.8)(B, Sq, D)),
            "k_cache": _w((lambda *s: torch.randn(*s, dtype=torch.bfloat16) * 0.8)(B, H, Sk, Dh)),
            "v_cache": _w((lambda *s: torch.randn(*s, dtype=torch.bfloat16) * 0.05)(B, H, Sk, Dh)),
            "wq": _w((lambda *s: torch.randn(*s, dtype=torch.bfloat16) * 0.8)(D, H * Dh) * (D ** -0.5)),
            "wo": _w((lambda *s: torch.randn(*s, dtype=torch.bfloat16) * 0.05)(H * Dh, D) * ((H * Dh) ** -0.5)),
        }
    _A_in = _A_setup()

    def _B_setup():
        B, Sq, D = 16, 192, 640
        Hq, Hkv, Sk, Dh = 32, 32, 512, 128
        assert Hq % Hkv == 0, (Hq, Hkv)
        return {
            "x": _w((lambda *s: torch.randn(*s, dtype=torch.bfloat16) * 0.8)(B, Sq, D)),
            "k_cache": _w((lambda *s: torch.randn(*s, dtype=torch.bfloat16) * 0.8)(B, Hkv, Sk, Dh)),
            "v_cache": _w((lambda *s: torch.randn(*s, dtype=torch.bfloat16) * 0.05)(B, Hkv, Sk, Dh)),
            "wq": _w((lambda *s: torch.randn(*s, dtype=torch.bfloat16) * 0.8)(D, Hq * Dh) * (D ** -0.5)),
            "wo": _w((lambda *s: torch.randn(*s, dtype=torch.bfloat16) * 0.05)(Hq * Dh, D) * ((Hq * Dh) ** -0.5)),
        }
    _B_in = _B_setup()

    return {
        "A_x": _A_in["x"],
        "A_k_cache": _A_in["k_cache"],
        "A_v_cache": _A_in["v_cache"],
        "A_wq": _A_in["wq"],
        "A_wo": _A_in["wo"],
        "B_x": _B_in["x"],
        "B_k_cache": _B_in["k_cache"],
        "B_v_cache": _B_in["v_cache"],
        "B_wq": _B_in["wq"],
        "B_wo": _B_in["wo"],
    }

def reference(A_x, A_k_cache, A_v_cache, A_wq, A_wo, B_x, B_k_cache, B_v_cache, B_wq, B_wo):
    def _A_ref(x, k_cache, v_cache, wq, wo):
        B, Sq, D = x.shape
        H, Dh = 32, 128
        q = (lambda x, *d: x.permute(*d))((x @ wq).reshape(B, Sq, H, Dh), 0, 2, 1, 3)
        scores = torch.einsum("bhqd,bhkd->bhqk", q, k_cache) * (Dh ** -0.5)
        p = _softmax(scores, axis=-1)
        o = torch.einsum("bhqk,bhkd->bhqd", p, v_cache)
        return (lambda x, *d: x.permute(*d))(o, 0, 2, 1, 3).reshape(B, Sq, H * Dh) @ wo

    def _B_ref(x, k_cache, v_cache, wq, wo):
        B, Sq, D = x.shape
        Hq, Dh = 32, 128
        Hkv = k_cache.shape[1]
        rep = Hq // Hkv
        q = (lambda x, *d: x.permute(*d))((x @ wq).reshape(B, Sq, Hq, Dh), 0, 2, 1, 3)
        k = (lambda x, n, axis: torch.repeat_interleave(x, n, dim=axis))(k_cache, rep, axis=1)
        v = (lambda x, n, axis: torch.repeat_interleave(x, n, dim=axis))(v_cache, rep, axis=1)
        scores = torch.einsum("bhqd,bhkd->bhqk", q, k) * (Dh ** -0.5)
        p = _softmax(scores, axis=-1)
        o = torch.einsum("bhqk,bhkd->bhqd", p, v)
        return (lambda x, *d: x.permute(*d))(o, 0, 2, 1, 3).reshape(B, Sq, Hq * Dh) @ wo

    a = _A_ref(A_x, A_k_cache, A_v_cache, A_wq, A_wo)
    b = _B_ref(B_x, B_k_cache, B_v_cache, B_wq, B_wo)
    return torch.concatenate([a, b], axis=-1)
```

```asm
; @launch grid=(256,1,1) block=(256,1,1) lds=159744
.amdgcn_target "amdgcn-amd-amdhsa--gfx950"
.text
.globl concat_heads__mha_block_cached__gqa_block_cached__near_ridge_kernel
.p2align 8
.type concat_heads__mha_block_cached__gqa_block_cached__near_ridge_kernel,@function
concat_heads__mha_block_cached__gqa_block_cached__near_ridge_kernel:
    s_cmp_ge_u32 s2, 256
    s_cbranch_scc1 L_end
    s_load_dwordx16 s[4:19], s[0:1], 0
    s_load_dwordx4 s[20:23], s[0:1], 64
    s_load_dwordx2 s[28:29], s[0:1], 96
    s_bfe_u32 s73, s2, 0x10002
    s_and_b32 s71, s2, 3
    s_lshl_b32 s71, s71, 2
    s_bfe_u32 s66, s2, 0x20003
    s_add_u32 s71, s71, s66
    s_lshr_b32 s72, s2, 5
    s_lshl_b32 s74, s73, 4
    s_add_u32 s74, s74, s71
    s_and_b32 s31, s2, 1
    v_lshrrev_b32 v7, 6, v0
    v_and_b32 v0, 63, v0
    v_readfirstlane_b32 s60, v7
    v_and_b32 v8, 15, v0
    v_lshrrev_b32 v9, 4, v0
    v_and_b32 v10, 1, v9
    v_lshlrev_b32 v10, 4, v10
    v_lshrrev_b32 v11, 1, v9
    v_lshl_add_u32 v10, v11, 2, v10
    v_lshrrev_b32 v11, 1, v7
    v_lshl_add_u32 v10, v11, 3, v10
    v_and_b32 v11, 1, v7
    v_lshl_add_u32 v10, v11, 1, v10
    v_lshlrev_b32 v10, 13, v10
    v_lshl_add_u32 v6, v8, 4, v10
    v_mul_u32_u24 v10, 48, v7
    v_lshrrev_b32 v11, 3, v0
    v_add_u32 v10, v10, v11
    v_mul_u32_u24 v10, 1280, v10
    v_and_b32 v11, 7, v0
    v_xor_b32 v11, v11, v9
    v_lshl_add_u32 v156, v11, 4, v10
    v_xor_b32 v11, 4, v11
    v_add_u32 v10, 10240, v10
    v_lshl_add_u32 v157, v11, 4, v10
    s_mul_i32 s61, s60, 2112
    s_mul_i32 s63, s60, 6144
    s_add_u32 s63, s63, 135168
    s_mov_b32 s68, 0
    s_mov_b32 s75, 0
    s_mov_b32 s26, 0
    s_waitcnt lgkmcnt(0)
    s_cmp_eq_u32 s73, 0
    s_cselect_b64 s[4:5], s[4:5], s[14:15]
    s_cselect_b64 s[6:7], s[6:7], s[16:17]
    s_cselect_b64 s[8:9], s[8:9], s[18:19]
    s_cselect_b64 s[10:11], s[10:11], s[20:21]
    s_cselect_b64 s[12:13], s[12:13], s[22:23]
    s_load_dwordx4 s[16:19], s[0:1], 80
    s_mul_i32 s66, s71, 245760
    s_add_u32 s32, s4, s66
    s_addc_u32 s33, s5, 0
    s_and_b32 s33, s33, 0xffff
    s_mov_b32 s34, 245760
    s_mov_b32 s35, 0x20000
    s_lshl_b32 s66, s72, 10
    s_add_u32 s36, s10, s66
    s_addc_u32 s37, s11, 0
    s_and_b32 s37, s37, 0xffff
    s_mov_b32 s38, 5235712
    s_mov_b32 s39, 0x20000
    s_xor_b32 s21, s71, s72
    s_and_b32 s21, s21, 3
    s_and_b32 s25, s72, 3
    s_lshl_b32 s26, s21, 18
    s_lshl_b32 s66, s25, 8
    s_or_b32 s26, s26, s66
    s_add_u32 s20, s26, 1048576
    s_lshr_b32 s75, s21, 1
    s_lshl_b32 s75, s75, 7
    s_cmp_lg_u32 s31, 0
    s_cselect_b32 s69, 67584, 0
    s_cselect_b32 s70, 0, 512
    s_sub_u32 s69, s63, s69
    s_xor_b32 s70, s26, s70
    s_xor_b32 s64, s70, 256
    s_add_u32 m0, s61, 33792
    s_nop 0
    buffer_load_dwordx4 v6, s[36:39], s64 offen lds
    s_xor_b32 s64, s70, 8448
    s_add_u32 m0, s61, 34824
    s_nop 0
    buffer_load_dwordx4 v6, s[36:39], s64 offen lds
    s_add_u32 s65, s75, 0
    s_add_u32 m0, s69, 0
    s_nop 0
    buffer_load_dwordx4 v156, s[32:35], s65 offen lds
    s_add_u32 m0, s69, 1024
    s_nop 0
    buffer_load_dwordx4 v157, s[32:35], s65 offen lds
    s_add_u32 s65, s75, 20480
    s_add_u32 m0, s69, 2048
    s_nop 0
    buffer_load_dwordx4 v156, s[32:35], s65 offen lds
    s_add_u32 m0, s69, 3072
    s_nop 0
    buffer_load_dwordx4 v157, s[32:35], s65 offen lds
    s_add_u32 s65, s75, 40960
    s_add_u32 m0, s69, 4096
    s_nop 0
    buffer_load_dwordx4 v156, s[32:35], s65 offen lds
    s_add_u32 m0, s69, 5120
    s_nop 0
    buffer_load_dwordx4 v157, s[32:35], s65 offen lds
    s_xor_b32 s64, s70, 262400
    s_add_u32 m0, s61, 101376
    s_nop 0
    buffer_load_dwordx4 v6, s[36:39], s64 offen lds
    s_xor_b32 s64, s70, 270592
    s_add_u32 m0, s61, 102408
    s_nop 0
    buffer_load_dwordx4 v6, s[36:39], s64 offen lds
    s_bfe_u32 s22, s2, 0x40001
    s_lshl_b32 s22, s22, 13
    s_lshl_b32 s66, s25, 17
    s_or_b32 s22, s22, s66
    s_mov_b32 s56, s22
    s_add_u32 s3, s61, 67584
    v_bfe_u32 v10, v0, 2, 3
    v_lshrrev_b32 v11, 1, v10
    v_lshlrev_b32 v11, 6, v11
    v_lshl_add_u32 v4, v10, 10, v11
    v_and_b32 v11, 1, v10
    v_lshl_add_u32 v4, v11, 3, v4
    v_lshrrev_b32 v11, 5, v0
    v_lshl_add_u32 v4, v11, 8, v4
    v_mul_u32_u24 v10, 1056, v10
    v_lshl_add_u32 v10, v11, 8, v10
    v_and_b32 v11, 3, v0
    v_lshl_add_u32 v4, v11, 4, v4
    v_lshl_add_u32 v10, v11, 3, v10
    v_add_u32 v3, 67584, v10
    v_add_u32 v5, 67584, v4
    v_and_b32 v10, 7, v8
    v_mul_u32_u24 v10, 1056, v10
    v_lshrrev_b32 v11, 3, v8
    v_lshl_add_u32 v10, v11, 8, v10
    v_lshl_add_u32 v2, v9, 4, v10
    v_lshlrev_b32 v10, 4, v0
    v_lshl_add_u32 v1, v7, 11, v10
    v_lshlrev_b32 v10, 7, v8
    v_add_u32 v10, s63, v10
    v_lshrrev_b32 v11, 1, v8
    v_xor_b32 v11, v11, v9
    s_and_b32 s66, s21, 1
    s_lshl_b32 s66, s66, 2
    v_xor_b32 v11, s66, v11
    v_lshl_add_u32 v158, v11, 4, v10
    v_xor_b32 v11, 4, v11
    v_lshl_add_u32 v159, v11, 4, v10
    s_lshl_b32 s66, s71, 3
    s_add_u32 s66, s66, s72
    s_lshl_b32 s66, s66, 19
    s_add_u32 s40, s6, s66
    s_addc_u32 s41, s7, 0
    s_and_b32 s41, s41, 0xffff
    s_mov_b32 s42, 524288
    s_mov_b32 s43, 0x20000
    s_add_u32 s44, s8, s66
    s_addc_u32 s45, s9, 0
    s_and_b32 s45, s45, 0xffff
    s_mov_b32 s46, 524288
    s_mov_b32 s47, 0x20000
    s_mul_i32 s66, s72, 655360
    s_add_u32 s48, s12, s66
    s_addc_u32 s49, s13, 0
    s_and_b32 s49, s49, 0xffff
    s_mov_b32 s50, 655360
    s_mov_b32 s51, 0x20000
    s_xor_b32 s4, s25, 0
    s_mul_i32 s4, s4, 163840
    s_xor_b32 s5, s25, 1
    s_mul_i32 s5, s5, 163840
    s_xor_b32 s6, s25, 2
    s_mul_i32 s6, s6, 163840
    s_xor_b32 s7, s25, 3
    s_mul_i32 s7, s7, 163840
    s_mov_b32 s23, 0
    s_mov_b32 s76, 24576
    s_cmp_lt_u32 s72, 4
    s_cselect_b32 s66, 128, 0
    s_mov_b32 s12, 128
    s_cselect_b32 s12, -128, s12
    s_sub_u32 s13, 256, s12
    s_add_u32 s4, s4, s66
    s_add_u32 s5, s5, s66
    s_add_u32 s6, s6, s66
    s_add_u32 s7, s7, s66
    s_lshl_b32 s66, s74, 12
    s_add_u32 s66, s66, 125829120
    s_add_u32 s8, s28, s66
    s_addc_u32 s9, s29, 0
    s_and_b32 s9, s9, 0xffff
    s_mov_b32 s10, 4096
    s_mov_b32 s11, 0x20000
    s_cmp_eq_u32 s31, 0
    s_cbranch_scc1 L_p0
L_split:
L_p1:
    s_xor_b32 s77, s75, 128
    s_mov_b32 s30, 1
    s_getpc_b64 s[14:15]
L_pc_12:
    s_add_u32 s14, s14, L_q2-L_pc_12
    s_addc_u32 s15, s15, 0
    s_lshr_b32 s69, s2, 3
    s_lshl_b32 s69, s69, 2
    s_add_u32 s69, s69, s60
    s_lshl_b32 s69, s69, 7
    v_and_b32 v10, 3, v0
    v_lshlrev_b32 v10, 14, v10
    v_add_u32 v10, s69, v10
    v_min_u32 v10, L_enter-L_q2-4, v10
    global_load_dword v11, v10, s[14:15]
    s_mov_b32 s67, 0
    v_and_b32 v9, 56, v0
    s_lshl_b32 s66, s60, 1
    v_add_u32 v9, s66, v9
    v_mul_u32_u24 v9, 1280, v9
    v_and_b32 v8, 7, v0
    s_xor_b32 s66, s72, 7
    s_and_b32 s66, s66, 3
    s_lshl_b32 s66, s66, 1
    v_xor_b32 v8, s66, v8
    v_lshl_add_u32 v155, v8, 4, v9
    v_subrev_u32 v12, 67584, v158
    v_subrev_u32 v13, 67584, v159
    s_add_u32 s65, s77, 0
    s_add_u32 m0, s63, 0
    s_nop 0
    buffer_load_dwordx4 v156, s[32:35], s65 offen lds
    s_add_u32 m0, s63, 1024
    s_nop 0
    buffer_load_dwordx4 v157, s[32:35], s65 offen lds
    s_xor_b32 s64, s26, 0
    s_add_u32 m0, s61, 42240
    s_nop 0
    buffer_load_dwordx4 v6, s[36:39], s64 offen lds
    s_xor_b32 s64, s26, 8192
    s_add_u32 m0, s61, 43272
    s_nop 0
    buffer_load_dwordx4 v6, s[36:39], s64 offen lds
    s_add_u32 s65, s77, 20480
    s_add_u32 m0, s63, 2048
    s_nop 0
    buffer_load_dwordx4 v156, s[32:35], s65 offen lds
    s_add_u32 m0, s63, 3072
    s_nop 0
    buffer_load_dwordx4 v157, s[32:35], s65 offen lds
    s_xor_b32 s64, s26, 262144
    s_add_u32 m0, s61, 109824
    s_nop 0
    buffer_load_dwordx4 v6, s[36:39], s64 offen lds
    s_xor_b32 s64, s26, 270336
    s_add_u32 m0, s61, 110856
    s_nop 0
    buffer_load_dwordx4 v6, s[36:39], s64 offen lds
    s_add_u32 s65, s77, 40960
    s_add_u32 m0, s63, 4096
    s_nop 0
    buffer_load_dwordx4 v156, s[32:35], s65 offen lds
    s_add_u32 m0, s63, 5120
    s_nop 0
    buffer_load_dwordx4 v157, s[32:35], s65 offen lds
    s_xor_b32 s64, s26, 524544
    s_add_u32 m0, s61, 50688
    s_nop 0
    buffer_load_dwordx4 v6, s[36:39], s64 offen lds
    s_xor_b32 s64, s26, 532736
    s_add_u32 m0, s61, 51720
    s_nop 0
    buffer_load_dwordx4 v6, s[36:39], s64 offen lds
    s_waitcnt vmcnt(10) lgkmcnt(0)
    ds_read_b128 a[0:3], v12 offset:0
    ds_read_b128 a[4:7], v13 offset:0
    ds_read_b128 a[8:11], v12 offset:2048
    ds_read_b128 a[12:15], v13 offset:2048
    ds_read_b128 a[16:19], v12 offset:4096
    ds_read_b128 a[20:23], v13 offset:4096
L_q2go:
    s_barrier
    ds_read_b64_tr_b16 a[192:193], v4 offset:33792
    ds_read_b64_tr_b16 a[194:195], v4 offset:34304
    ds_read_b64_tr_b16 a[196:197], v5 offset:33792
    ds_read_b64_tr_b16 a[198:199], v5 offset:34304
    ds_read_b64_tr_b16 a[200:201], v4 offset:33800
    ds_read_b64_tr_b16 a[202:203], v4 offset:34312
    ds_read_b64_tr_b16 a[204:205], v5 offset:33800
    ds_read_b64_tr_b16 a[206:207], v5 offset:34312
    ds_read_b64_tr_b16 a[208:209], v4 offset:33856
    ds_read_b64_tr_b16 a[210:211], v4 offset:34368
    ds_read_b64_tr_b16 a[212:213], v5 offset:33856
    ds_read_b64_tr_b16 a[214:215], v5 offset:34368
    ds_read_b64_tr_b16 a[216:217], v4 offset:33864
    ds_read_b64_tr_b16 a[218:219], v4 offset:34376
    ds_read_b64_tr_b16 a[220:221], v5 offset:33864
    ds_read_b64_tr_b16 a[222:223], v5 offset:34376
    s_waitcnt lgkmcnt(0)
L_q2:
    v_mfma_f32_16x16x32_bf16 v[56:59], a[192:195], a[0:3], 0
    ds_read_b128 a[24:27], v158 offset:0
    v_mfma_f32_16x16x32_bf16 v[56:59], a[196:199], a[4:7], v[56:59]
    ds_read_b128 a[28:31], v159 offset:0
    v_mfma_f32_16x16x32_bf16 v[60:63], a[196:199], a[12:15], 0
    s_xor_b32 s64, s26, 786688
    ds_read_b64_tr_b16 a[224:225], v4 offset:33920
    v_mfma_f32_16x16x32_bf16 v[60:63], a[192:195], a[8:11], v[60:63]
    s_add_u32 m0, s61, 118272
    ds_read_b64_tr_b16 a[226:227], v4 offset:34432
    v_mfma_f32_16x16x32_bf16 v[64:67], a[192:195], a[16:19], 0
    buffer_load_dwordx4 v6, s[36:39], s64 offen lds
    v_mfma_f32_16x16x32_bf16 v[64:67], a[196:199], a[20:23], v[64:67]
    s_xor_b32 s64, s26, 794880
    ds_read_b64_tr_b16 a[228:229], v5 offset:33920
    v_mfma_f32_16x16x32_bf16 v[76:79], a[204:207], a[20:23], 0
    s_add_u32 m0, s61, 119304
    ds_read_b64_tr_b16 a[230:231], v5 offset:34432
    v_mfma_f32_16x16x32_bf16 v[76:79], a[200:203], a[16:19], v[76:79]
    s_waitcnt lgkmcnt(4)
    buffer_load_dwordx4 v6, s[36:39], s64 offen lds
    v_mfma_f32_16x16x32_bf16 v[72:75], a[200:203], a[8:11], 0
    s_add_u32 s65, s75, 256
    ds_read_b64_tr_b16 a[232:233], v4 offset:33928
    v_mfma_f32_16x16x32_bf16 v[72:75], a[204:207], a[12:15], v[72:75]
    s_add_u32 m0, s63, 0
    ds_read_b64_tr_b16 a[234:235], v4 offset:34440
    v_mfma_f32_16x16x32_bf16 v[68:71], a[204:207], a[4:7], 0
    buffer_load_dwordx4 v156, s[32:35], s65 offen lds
    v_mfma_f32_16x16x32_bf16 v[68:71], a[200:203], a[0:3], v[68:71]
    ds_read_b64_tr_b16 a[236:237], v5 offset:33928
    v_mfma_f32_16x16x32_bf16 v[80:83], a[208:211], a[0:3], 0
    s_add_u32 m0, s63, 1024
    ds_read_b64_tr_b16 a[238:239], v5 offset:34440
    v_mfma_f32_16x16x32_bf16 v[80:83], a[212:215], a[4:7], v[80:83]
    buffer_load_dwordx4 v157, s[32:35], s65 offen lds
    v_mfma_f32_16x16x32_bf16 v[84:87], a[212:215], a[12:15], 0
    ds_read_b64_tr_b16 a[240:241], v4 offset:33984
    v_mfma_f32_16x16x32_bf16 v[84:87], a[208:211], a[8:11], v[84:87]
    ds_read_b64_tr_b16 a[242:243], v4 offset:34496
    v_mfma_f32_16x16x32_bf16 v[88:91], a[208:211], a[16:19], 0
    ds_read_b64_tr_b16 a[244:245], v5 offset:33984
    v_mfma_f32_16x16x32_bf16 v[88:91], a[212:215], a[20:23], v[88:91]
    ds_read_b64_tr_b16 a[246:247], v5 offset:34496
    v_mfma_f32_16x16x32_bf16 v[100:103], a[220:223], a[20:23], 0
    ds_read_b64_tr_b16 a[248:249], v4 offset:33992
    v_mfma_f32_16x16x32_bf16 v[100:103], a[216:219], a[16:19], v[100:103]
    ds_read_b64_tr_b16 a[250:251], v4 offset:34504
    v_mfma_f32_16x16x32_bf16 v[96:99], a[216:219], a[8:11], 0
    ds_read_b64_tr_b16 a[252:253], v5 offset:33992
    v_mfma_f32_16x16x32_bf16 v[96:99], a[220:223], a[12:15], v[96:99]
    ds_read_b64_tr_b16 a[254:255], v5 offset:34504
    v_mfma_f32_16x16x32_bf16 v[92:95], a[220:223], a[4:7], 0
    s_waitcnt vmcnt(8) lgkmcnt(5)
    v_mfma_f32_16x16x32_bf16 v[92:95], a[216:219], a[0:3], v[92:95]
    s_barrier
    v_mfma_f32_16x16x32_bf16 v[104:107], a[224:227], a[0:3], 0
    ds_read_b128 a[32:35], v158 offset:2048
    v_mfma_f32_16x16x32_bf16 v[104:107], a[228:231], a[4:7], v[104:107]
    ds_read_b128 a[36:39], v159 offset:2048
    v_mfma_f32_16x16x32_bf16 v[108:111], a[228:231], a[12:15], 0
    s_xor_b32 s64, s26, 524288
    ds_read_b64_tr_b16 a[192:193], v4 offset:42240
    v_mfma_f32_16x16x32_bf16 v[108:111], a[224:227], a[8:11], v[108:111]
    s_add_u32 m0, s61, 59136
    ds_read_b64_tr_b16 a[194:195], v4 offset:42752
    v_mfma_f32_16x16x32_bf16 v[112:115], a[224:227], a[16:19], 0
    buffer_load_dwordx4 v6, s[36:39], s64 offen lds
    v_mfma_f32_16x16x32_bf16 v[112:115], a[228:231], a[20:23], v[112:115]
    s_xor_b32 s64, s26, 532480
    ds_read_b64_tr_b16 a[196:197], v5 offset:42240
    v_mfma_f32_16x16x32_bf16 v[124:127], a[236:239], a[20:23], 0
    s_add_u32 m0, s61, 60168
    ds_read_b64_tr_b16 a[198:199], v5 offset:42752
    v_mfma_f32_16x16x32_bf16 v[124:127], a[232:235], a[16:19], v[124:127]
    s_waitcnt lgkmcnt(4)
    buffer_load_dwordx4 v6, s[36:39], s64 offen lds
    v_mfma_f32_16x16x32_bf16 v[120:123], a[232:235], a[8:11], 0
    s_add_u32 s65, s75, 20736
    ds_read_b64_tr_b16 a[200:201], v4 offset:42248
    v_mfma_f32_16x16x32_bf16 v[120:123], a[236:239], a[12:15], v[120:123]
    s_add_u32 m0, s63, 2048
    ds_read_b64_tr_b16 a[202:203], v4 offset:42760
    v_mfma_f32_16x16x32_bf16 v[116:119], a[236:239], a[4:7], 0
    buffer_load_dwordx4 v156, s[32:35], s65 offen lds
    v_mfma_f32_16x16x32_bf16 v[116:119], a[232:235], a[0:3], v[116:119]
    ds_read_b64_tr_b16 a[204:205], v5 offset:42248
    v_mfma_f32_16x16x32_bf16 v[128:131], a[240:243], a[0:3], 0
    s_add_u32 m0, s63, 3072
    ds_read_b64_tr_b16 a[206:207], v5 offset:42760
    v_mfma_f32_16x16x32_bf16 v[128:131], a[244:247], a[4:7], v[128:131]
    buffer_load_dwordx4 v157, s[32:35], s65 offen lds
    v_mfma_f32_16x16x32_bf16 v[132:135], a[244:247], a[12:15], 0
    ds_read_b64_tr_b16 a[208:209], v4 offset:42304
    v_mfma_f32_16x16x32_bf16 v[132:135], a[240:243], a[8:11], v[132:135]
    ds_read_b64_tr_b16 a[210:211], v4 offset:42816
    v_mfma_f32_16x16x32_bf16 v[136:139], a[240:243], a[16:19], 0
    ds_read_b64_tr_b16 a[212:213], v5 offset:42304
    v_mfma_f32_16x16x32_bf16 v[136:139], a[244:247], a[20:23], v[136:139]
    ds_read_b64_tr_b16 a[214:215], v5 offset:42816
    v_mfma_f32_16x16x32_bf16 v[148:151], a[252:255], a[20:23], 0
    ds_read_b64_tr_b16 a[216:217], v4 offset:42312
    v_mfma_f32_16x16x32_bf16 v[148:151], a[248:251], a[16:19], v[148:151]
    ds_read_b64_tr_b16 a[218:219], v4 offset:42824
    v_mfma_f32_16x16x32_bf16 v[144:147], a[248:251], a[8:11], 0
    ds_read_b64_tr_b16 a[220:221], v5 offset:42312
    v_mfma_f32_16x16x32_bf16 v[144:147], a[252:255], a[12:15], v[144:147]
    ds_read_b64_tr_b16 a[222:223], v5 offset:42824
    v_mfma_f32_16x16x32_bf16 v[140:143], a[252:255], a[4:7], 0
    s_waitcnt vmcnt(10) lgkmcnt(5)
    v_mfma_f32_16x16x32_bf16 v[140:143], a[248:251], a[0:3], v[140:143]
    v_mfma_f32_16x16x32_bf16 v[160:163], a[192:195], a[0:3], 0
    ds_read_b128 a[40:43], v158 offset:4096
    v_mfma_f32_16x16x32_bf16 v[160:163], a[196:199], a[4:7], v[160:163]
    ds_read_b128 a[44:47], v159 offset:4096
    v_mfma_f32_16x16x32_bf16 v[164:167], a[196:199], a[12:15], 0
    s_xor_b32 s64, s26, 786432
    ds_read_b64_tr_b16 a[224:225], v4 offset:42368
    v_mfma_f32_16x16x32_bf16 v[164:167], a[192:195], a[8:11], v[164:167]
    s_add_u32 m0, s61, 126720
    ds_read_b64_tr_b16 a[226:227], v4 offset:42880
    v_mfma_f32_16x16x32_bf16 v[168:171], a[192:195], a[16:19], 0
    buffer_load_dwordx4 v6, s[36:39], s64 offen lds
    v_mfma_f32_16x16x32_bf16 v[168:171], a[196:199], a[20:23], v[168:171]
    s_xor_b32 s64, s26, 794624
    ds_read_b64_tr_b16 a[228:229], v5 offset:42368
    v_mfma_f32_16x16x32_bf16 v[180:183], a[204:207], a[20:23], 0
    s_add_u32 m0, s61, 127752
    ds_read_b64_tr_b16 a[230:231], v5 offset:42880
    v_mfma_f32_16x16x32_bf16 v[180:183], a[200:203], a[16:19], v[180:183]
    s_waitcnt lgkmcnt(4)
    buffer_load_dwordx4 v6, s[36:39], s64 offen lds
    v_mfma_f32_16x16x32_bf16 v[176:179], a[200:203], a[8:11], 0
    s_add_u32 s65, s75, 41216
    ds_read_b64_tr_b16 a[232:233], v4 offset:42376
    v_mfma_f32_16x16x32_bf16 v[176:179], a[204:207], a[12:15], v[176:179]
    s_add_u32 m0, s63, 4096
    ds_read_b64_tr_b16 a[234:235], v4 offset:42888
    v_mfma_f32_16x16x32_bf16 v[172:175], a[204:207], a[4:7], 0
    buffer_load_dwordx4 v156, s[32:35], s65 offen lds
    v_mfma_f32_16x16x32_bf16 v[172:175], a[200:203], a[0:3], v[172:175]
    ds_read_b64_tr_b16 a[236:237], v5 offset:42376
    v_mfma_f32_16x16x32_bf16 v[184:187], a[208:211], a[0:3], 0
    s_add_u32 m0, s63, 5120
    ds_read_b64_tr_b16 a[238:239], v5 offset:42888
    v_mfma_f32_16x16x32_bf16 v[184:187], a[212:215], a[4:7], v[184:187]
    buffer_load_dwordx4 v157, s[32:35], s65 offen lds
    v_mfma_f32_16x16x32_bf16 v[188:191], a[212:215], a[12:15], 0
    ds_read_b64_tr_b16 a[240:241], v4 offset:42432
    v_mfma_f32_16x16x32_bf16 v[188:191], a[208:211], a[8:11], v[188:191]
    ds_read_b64_tr_b16 a[242:243], v4 offset:42944
    v_mfma_f32_16x16x32_bf16 v[192:195], a[208:211], a[16:19], 0
    ds_read_b64_tr_b16 a[244:245], v5 offset:42432
    v_mfma_f32_16x16x32_bf16 v[192:195], a[212:215], a[20:23], v[192:195]
    ds_read_b64_tr_b16 a[246:247], v5 offset:42944
    v_mfma_f32_16x16x32_bf16 v[204:207], a[220:223], a[20:23], 0
    ds_read_b64_tr_b16 a[248:249], v4 offset:42440
    v_mfma_f32_16x16x32_bf16 v[204:207], a[216:219], a[16:19], v[204:207]
    ds_read_b64_tr_b16 a[250:251], v4 offset:42952
    v_mfma_f32_16x16x32_bf16 v[200:203], a[216:219], a[8:11], 0
    ds_read_b64_tr_b16 a[252:253], v5 offset:42440
    v_mfma_f32_16x16x32_bf16 v[200:203], a[220:223], a[12:15], v[200:203]
    ds_read_b64_tr_b16 a[254:255], v5 offset:42952
    v_mfma_f32_16x16x32_bf16 v[196:199], a[220:223], a[4:7], 0
    s_waitcnt vmcnt(10) lgkmcnt(5)
    v_mfma_f32_16x16x32_bf16 v[196:199], a[216:219], a[0:3], v[196:199]
    s_barrier
    v_mfma_f32_16x16x32_bf16 v[208:211], a[224:227], a[0:3], 0
    v_mfma_f32_16x16x32_bf16 v[208:211], a[228:231], a[4:7], v[208:211]
    v_mfma_f32_16x16x32_bf16 v[212:215], a[228:231], a[12:15], 0
    s_xor_b32 s64, s20, 256
    ds_read_b64_tr_b16 a[192:193], v4 offset:50688
    v_mfma_f32_16x16x32_bf16 v[212:215], a[224:227], a[8:11], v[212:215]
    s_add_u32 m0, s61, 33792
    ds_read_b64_tr_b16 a[194:195], v4 offset:51200
    v_mfma_f32_16x16x32_bf16 v[216:219], a[224:227], a[16:19], 0
    buffer_load_dwordx4 v6, s[36:39], s64 offen lds
    v_mfma_f32_16x16x32_bf16 v[216:219], a[228:231], a[20:23], v[216:219]
    s_xor_b32 s64, s20, 8448
    ds_read_b64_tr_b16 a[196:197], v5 offset:50688
    v_mfma_f32_16x16x32_bf16 v[228:231], a[236:239], a[20:23], 0
    s_add_u32 m0, s61, 34824
    ds_read_b64_tr_b16 a[198:199], v5 offset:51200
    v_mfma_f32_16x16x32_bf16 v[228:231], a[232:235], a[16:19], v[228:231]
    buffer_load_dwordx4 v6, s[36:39], s64 offen lds
    v_mfma_f32_16x16x32_bf16 v[224:227], a[232:235], a[8:11], 0
    ds_read_b64_tr_b16 a[200:201], v4 offset:50696
    v_mfma_f32_16x16x32_bf16 v[224:227], a[236:239], a[12:15], v[224:227]
    ds_read_b64_tr_b16 a[202:203], v4 offset:51208
    v_mfma_f32_16x16x32_bf16 v[220:223], a[236:239], a[4:7], 0
    v_mfma_f32_16x16x32_bf16 v[220:223], a[232:235], a[0:3], v[220:223]
    ds_read_b64_tr_b16 a[204:205], v5 offset:50696
    v_mfma_f32_16x16x32_bf16 v[232:235], a[240:243], a[0:3], 0
    s_waitcnt lgkmcnt(11)
    ds_read_b64_tr_b16 a[206:207], v5 offset:51208
    v_mfma_f32_16x16x32_bf16 v[232:235], a[244:247], a[4:7], v[232:235]
    v_mfma_f32_16x16x32_bf16 v[236:239], a[244:247], a[12:15], 0
    ds_read_b64_tr_b16 a[208:209], v4 offset:50752
    v_mfma_f32_16x16x32_bf16 v[236:239], a[240:243], a[8:11], v[236:239]
    ds_read_b64_tr_b16 a[210:211], v4 offset:51264
    v_mfma_f32_16x16x32_bf16 v[240:243], a[240:243], a[16:19], 0
    ds_read_b64_tr_b16 a[212:213], v5 offset:50752
    v_mfma_f32_16x16x32_bf16 v[240:243], a[244:247], a[20:23], v[240:243]
    s_waitcnt lgkmcnt(11)
    ds_read_b64_tr_b16 a[214:215], v5 offset:51264
    v_mfma_f32_16x16x32_bf16 v[252:255], a[252:255], a[20:23], 0
    ds_read_b64_tr_b16 a[216:217], v4 offset:50760
    v_mfma_f32_16x16x32_bf16 v[252:255], a[248:251], a[16:19], v[252:255]
    ds_read_b64_tr_b16 a[218:219], v4 offset:51272
    v_mfma_f32_16x16x32_bf16 v[248:251], a[248:251], a[8:11], 0
    ds_read_b64_tr_b16 a[220:221], v5 offset:50760
    v_mfma_f32_16x16x32_bf16 v[248:251], a[252:255], a[12:15], v[248:251]
    ds_read_b64_tr_b16 a[222:223], v5 offset:51272
    v_mfma_f32_16x16x32_bf16 v[244:247], a[252:255], a[4:7], 0
    s_waitcnt vmcnt(10) lgkmcnt(5)
    v_mfma_f32_16x16x32_bf16 v[244:247], a[248:251], a[0:3], v[244:247]
    v_mfma_f32_16x16x32_bf16 v[56:59], a[192:195], a[24:27], v[56:59]
    ds_read_b128 a[0:3], v158 offset:0
    v_mfma_f32_16x16x32_bf16 v[56:59], a[196:199], a[28:31], v[56:59]
    ds_read_b128 a[4:7], v159 offset:0
    v_mfma_f32_16x16x32_bf16 v[60:63], a[196:199], a[36:39], v[60:63]
    s_xor_b32 s64, s20, 262400
    ds_read_b64_tr_b16 a[224:225], v4 offset:50816
    v_mfma_f32_16x16x32_bf16 v[60:63], a[192:195], a[32:35], v[60:63]
    s_add_u32 m0, s61, 101376
    ds_read_b64_tr_b16 a[226:227], v4 offset:51328
    v_mfma_f32_16x16x32_bf16 v[64:67], a[192:195], a[40:43], v[64:67]
    buffer_load_dwordx4 v6, s[36:39], s64 offen lds
    v_mfma_f32_16x16x32_bf16 v[64:67], a[196:199], a[44:47], v[64:67]
    s_xor_b32 s64, s20, 270592
    ds_read_b64_tr_b16 a[228:229], v5 offset:50816
    v_mfma_f32_16x16x32_bf16 v[76:79], a[204:207], a[44:47], v[76:79]
    s_add_u32 m0, s61, 102408
    ds_read_b64_tr_b16 a[230:231], v5 offset:51328
    v_mfma_f32_16x16x32_bf16 v[76:79], a[200:203], a[40:43], v[76:79]
    s_waitcnt lgkmcnt(4)
    buffer_load_dwordx4 v6, s[36:39], s64 offen lds
    v_mfma_f32_16x16x32_bf16 v[72:75], a[200:203], a[32:35], v[72:75]
    s_add_u32 s65, s77, 256
    ds_read_b64_tr_b16 a[232:233], v4 offset:50824
    v_mfma_f32_16x16x32_bf16 v[72:75], a[204:207], a[36:39], v[72:75]
    s_add_u32 m0, s63, 0
    ds_read_b64_tr_b16 a[234:235], v4 offset:51336
    v_mfma_f32_16x16x32_bf16 v[68:71], a[204:207], a[28:31], v[68:71]
    buffer_load_dwordx4 v156, s[32:35], s65 offen lds
    v_mfma_f32_16x16x32_bf16 v[68:71], a[200:203], a[24:27], v[68:71]
    ds_read_b64_tr_b16 a[236:237], v5 offset:50824
    v_mfma_f32_16x16x32_bf16 v[80:83], a[208:211], a[24:27], v[80:83]
    s_add_u32 m0, s63, 1024
    ds_read_b64_tr_b16 a[238:239], v5 offset:51336
    v_mfma_f32_16x16x32_bf16 v[80:83], a[212:215], a[28:31], v[80:83]
    buffer_load_dwordx4 v157, s[32:35], s65 offen lds
    v_mfma_f32_16x16x32_bf16 v[84:87], a[212:215], a[36:39], v[84:87]
    ds_read_b64_tr_b16 a[240:241], v4 offset:50880
    v_mfma_f32_16x16x32_bf16 v[84:87], a[208:211], a[32:35], v[84:87]
    ds_read_b64_tr_b16 a[242:243], v4 offset:51392
    v_mfma_f32_16x16x32_bf16 v[88:91], a[208:211], a[40:43], v[88:91]
    ds_read_b64_tr_b16 a[244:245], v5 offset:50880
    v_mfma_f32_16x16x32_bf16 v[88:91], a[212:215], a[44:47], v[88:91]
    ds_read_b64_tr_b16 a[246:247], v5 offset:51392
    v_mfma_f32_16x16x32_bf16 v[100:103], a[220:223], a[44:47], v[100:103]
    ds_read_b64_tr_b16 a[248:249], v4 offset:50888
    v_mfma_f32_16x16x32_bf16 v[100:103], a[216:219], a[40:43], v[100:103]
    ds_read_b64_tr_b16 a[250:251], v4 offset:51400
    v_mfma_f32_16x16x32_bf16 v[96:99], a[216:219], a[32:35], v[96:99]
    ds_read_b64_tr_b16 a[252:253], v5 offset:50888
    v_mfma_f32_16x16x32_bf16 v[96:99], a[220:223], a[36:39], v[96:99]
    ds_read_b64_tr_b16 a[254:255], v5 offset:51400
    v_mfma_f32_16x16x32_bf16 v[92:95], a[220:223], a[28:31], v[92:95]
    s_waitcnt vmcnt(8) lgkmcnt(5)
    v_mfma_f32_16x16x32_bf16 v[92:95], a[216:219], a[24:27], v[92:95]
    s_barrier
    v_mfma_f32_16x16x32_bf16 v[104:107], a[224:227], a[24:27], v[104:107]
    ds_read_b128 a[8:11], v158 offset:2048
    v_mfma_f32_16x16x32_bf16 v[104:107], a[228:231], a[28:31], v[104:107]
    ds_read_b128 a[12:15], v159 offset:2048
    v_mfma_f32_16x16x32_bf16 v[108:111], a[228:231], a[36:39], v[108:111]
    s_xor_b32 s64, s20, 0
    ds_read_b64_tr_b16 a[192:193], v4 offset:59136
    v_mfma_f32_16x16x32_bf16 v[108:111], a[224:227], a[32:35], v[108:111]
    s_add_u32 m0, s61, 42240
    ds_read_b64_tr_b16 a[194:195], v4 offset:59648
    v_mfma_f32_16x16x32_bf16 v[112:115], a[224:227], a[40:43], v[112:115]
    buffer_load_dwordx4 v6, s[36:39], s64 offen lds
    v_mfma_f32_16x16x32_bf16 v[112:115], a[228:231], a[44:47], v[112:115]
    s_xor_b32 s64, s20, 8192
    ds_read_b64_tr_b16 a[196:197], v5 offset:59136
    v_mfma_f32_16x16x32_bf16 v[124:127], a[236:239], a[44:47], v[124:127]
    s_add_u32 m0, s61, 43272
    ds_read_b64_tr_b16 a[198:199], v5 offset:59648
    v_mfma_f32_16x16x32_bf16 v[124:127], a[232:235], a[40:43], v[124:127]
    s_waitcnt lgkmcnt(4)
    buffer_load_dwordx4 v6, s[36:39], s64 offen lds
    v_mfma_f32_16x16x32_bf16 v[120:123], a[232:235], a[32:35], v[120:123]
    s_add_u32 s65, s77, 20736
    ds_read_b64_tr_b16 a[200:201], v4 offset:59144
    v_mfma_f32_16x16x32_bf16 v[120:123], a[236:239], a[36:39], v[120:123]
    s_add_u32 m0, s63, 2048
    ds_read_b64_tr_b16 a[202:203], v4 offset:59656
    v_mfma_f32_16x16x32_bf16 v[116:119], a[236:239], a[28:31], v[116:119]
    buffer_load_dwordx4 v156, s[32:35], s65 offen lds
    v_mfma_f32_16x16x32_bf16 v[116:119], a[232:235], a[24:27], v[116:119]
    ds_read_b64_tr_b16 a[204:205], v5 offset:59144
    v_mfma_f32_16x16x32_bf16 v[128:131], a[240:243], a[24:27], v[128:131]
    s_add_u32 m0, s63, 3072
    ds_read_b64_tr_b16 a[206:207], v5 offset:59656
    v_mfma_f32_16x16x32_bf16 v[128:131], a[244:247], a[28:31], v[128:131]
    buffer_load_dwordx4 v157, s[32:35], s65 offen lds
    v_mfma_f32_16x16x32_bf16 v[132:135], a[244:247], a[36:39], v[132:135]
    ds_read_b64_tr_b16 a[208:209], v4 offset:59200
    v_mfma_f32_16x16x32_bf16 v[132:135], a[240:243], a[32:35], v[132:135]
    ds_read_b64_tr_b16 a[210:211], v4 offset:59712
    v_mfma_f32_16x16x32_bf16 v[136:139], a[240:243], a[40:43], v[136:139]
    ds_read_b64_tr_b16 a[212:213], v5 offset:59200
    v_mfma_f32_16x16x32_bf16 v[136:139], a[244:247], a[44:47], v[136:139]
    ds_read_b64_tr_b16 a[214:215], v5 offset:59712
    v_mfma_f32_16x16x32_bf16 v[148:151], a[252:255], a[44:47], v[148:151]
    ds_read_b64_tr_b16 a[216:217], v4 offset:59208
    v_mfma_f32_16x16x32_bf16 v[148:151], a[248:251], a[40:43], v[148:151]
    ds_read_b64_tr_b16 a[218:219], v4 offset:59720
    v_mfma_f32_16x16x32_bf16 v[144:147], a[248:251], a[32:35], v[144:147]
    ds_read_b64_tr_b16 a[220:221], v5 offset:59208
    v_mfma_f32_16x16x32_bf16 v[144:147], a[252:255], a[36:39], v[144:147]
    ds_read_b64_tr_b16 a[222:223], v5 offset:59720
    v_mfma_f32_16x16x32_bf16 v[140:143], a[252:255], a[28:31], v[140:143]
    s_waitcnt vmcnt(10) lgkmcnt(5)
    v_mfma_f32_16x16x32_bf16 v[140:143], a[248:251], a[24:27], v[140:143]
    v_mfma_f32_16x16x32_bf16 v[160:163], a[192:195], a[24:27], v[160:163]
    ds_read_b128 a[16:19], v158 offset:4096
    v_mfma_f32_16x16x32_bf16 v[160:163], a[196:199], a[28:31], v[160:163]
    ds_read_b128 a[20:23], v159 offset:4096
    v_mfma_f32_16x16x32_bf16 v[164:167], a[196:199], a[36:39], v[164:167]
    s_xor_b32 s64, s20, 262144
    ds_read_b64_tr_b16 a[224:225], v4 offset:59264
    v_mfma_f32_16x16x32_bf16 v[164:167], a[192:195], a[32:35], v[164:167]
    s_add_u32 m0, s61, 109824
    ds_read_b64_tr_b16 a[226:227], v4 offset:59776
    v_mfma_f32_16x16x32_bf16 v[168:171], a[192:195], a[40:43], v[168:171]
    buffer_load_dwordx4 v6, s[36:39], s64 offen lds
    v_mfma_f32_16x16x32_bf16 v[168:171], a[196:199], a[44:47], v[168:171]
    s_xor_b32 s64, s20, 270336
    ds_read_b64_tr_b16 a[228:229], v5 offset:59264
    v_mfma_f32_16x16x32_bf16 v[180:183], a[204:207], a[44:47], v[180:183]
    s_add_u32 m0, s61, 110856
    ds_read_b64_tr_b16 a[230:231], v5 offset:59776
    v_mfma_f32_16x16x32_bf16 v[180:183], a[200:203], a[40:43], v[180:183]
    s_waitcnt lgkmcnt(4)
    buffer_load_dwordx4 v6, s[36:39], s64 offen lds
    v_mfma_f32_16x16x32_bf16 v[176:179], a[200:203], a[32:35], v[176:179]
    s_add_u32 s65, s77, 41216
    ds_read_b64_tr_b16 a[232:233], v4 offset:59272
    v_mfma_f32_16x16x32_bf16 v[176:179], a[204:207], a[36:39], v[176:179]
    s_add_u32 m0, s63, 4096
    ds_read_b64_tr_b16 a[234:235], v4 offset:59784
    v_mfma_f32_16x16x32_bf16 v[172:175], a[204:207], a[28:31], v[172:175]
    buffer_load_dwordx4 v156, s[32:35], s65 offen lds
    v_mfma_f32_16x16x32_bf16 v[172:175], a[200:203], a[24:27], v[172:175]
    ds_read_b64_tr_b16 a[236:237], v5 offset:59272
    v_mfma_f32_16x16x32_bf16 v[184:187], a[208:211], a[24:27], v[184:187]
    s_add_u32 m0, s63, 5120
    ds_read_b64_tr_b16 a[238:239], v5 offset:59784
    v_mfma_f32_16x16x32_bf16 v[184:187], a[212:215], a[28:31], v[184:187]
    buffer_load_dwordx4 v157, s[32:35], s65 offen lds
    v_mfma_f32_16x16x32_bf16 v[188:191], a[212:215], a[36:39], v[188:191]
    ds_read_b64_tr_b16 a[240:241], v4 offset:59328
    v_mfma_f32_16x16x32_bf16 v[188:191], a[208:211], a[32:35], v[188:191]
    ds_read_b64_tr_b16 a[242:243], v4 offset:59840
    v_mfma_f32_16x16x32_bf16 v[192:195], a[208:211], a[40:43], v[192:195]
    ds_read_b64_tr_b16 a[244:245], v5 offset:59328
    v_mfma_f32_16x16x32_bf16 v[192:195], a[212:215], a[44:47], v[192:195]
    ds_read_b64_tr_b16 a[246:247], v5 offset:59840
    v_mfma_f32_16x16x32_bf16 v[204:207], a[220:223], a[44:47], v[204:207]
    ds_read_b64_tr_b16 a[248:249], v4 offset:59336
    v_mfma_f32_16x16x32_bf16 v[204:207], a[216:219], a[40:43], v[204:207]
    ds_read_b64_tr_b16 a[250:251], v4 offset:59848
    v_mfma_f32_16x16x32_bf16 v[200:203], a[216:219], a[32:35], v[200:203]
    ds_read_b64_tr_b16 a[252:253], v5 offset:59336
    v_mfma_f32_16x16x32_bf16 v[200:203], a[220:223], a[36:39], v[200:203]
    ds_read_b64_tr_b16 a[254:255], v5 offset:59848
    v_mfma_f32_16x16x32_bf16 v[196:199], a[220:223], a[28:31], v[196:199]
    s_waitcnt vmcnt(10) lgkmcnt(5)
    v_mfma_f32_16x16x32_bf16 v[196:199], a[216:219], a[24:27], v[196:199]
    s_barrier
    v_mfma_f32_16x16x32_bf16 v[208:211], a[224:227], a[24:27], v[208:211]
    v_mfma_f32_16x16x32_bf16 v[208:211], a[228:231], a[28:31], v[208:211]
    v_mfma_f32_16x16x32_bf16 v[212:215], a[228:231], a[36:39], v[212:215]
    s_xor_b32 s64, s20, 524544
    ds_read_b64_tr_b16 a[192:193], v4 offset:33792
    v_mfma_f32_16x16x32_bf16 v[212:215], a[224:227], a[32:35], v[212:215]
    s_add_u32 m0, s61, 50688
    ds_read_b64_tr_b16 a[194:195], v4 offset:34304
    v_mfma_f32_16x16x32_bf16 v[216:219], a[224:227], a[40:43], v[216:219]
    buffer_load_dwordx4 v6, s[36:39], s64 offen lds
    v_mfma_f32_16x16x32_bf16 v[216:219], a[228:231], a[44:47], v[216:219]
    s_xor_b32 s64, s20, 532736
    ds_read_b64_tr_b16 a[196:197], v5 offset:33792
    v_mfma_f32_16x16x32_bf16 v[228:231], a[236:239], a[44:47], v[228:231]
    s_add_u32 m0, s61, 51720
    ds_read_b64_tr_b16 a[198:199], v5 offset:34304
    v_mfma_f32_16x16x32_bf16 v[228:231], a[232:235], a[40:43], v[228:231]
    buffer_load_dwordx4 v6, s[36:39], s64 offen lds
    v_mfma_f32_16x16x32_bf16 v[224:227], a[232:235], a[32:35], v[224:227]
    ds_read_b64_tr_b16 a[200:201], v4 offset:33800
    v_mfma_f32_16x16x32_bf16 v[224:227], a[236:239], a[36:39], v[224:227]
    ds_read_b64_tr_b16 a[202:203], v4 offset:34312
    v_mfma_f32_16x16x32_bf16 v[220:223], a[236:239], a[28:31], v[220:223]
    v_mfma_f32_16x16x32_bf16 v[220:223], a[232:235], a[24:27], v[220:223]
    ds_read_b64_tr_b16 a[204:205], v5 offset:33800
    v_mfma_f32_16x16x32_bf16 v[232:235], a[240:243], a[24:27], v[232:235]
    s_waitcnt lgkmcnt(11)
    ds_read_b64_tr_b16 a[206:207], v5 offset:34312
    v_mfma_f32_16x16x32_bf16 v[232:235], a[244:247], a[28:31], v[232:235]
    v_mfma_f32_16x16x32_bf16 v[236:239], a[244:247], a[36:39], v[236:239]
    ds_read_b64_tr_b16 a[208:209], v4 offset:33856
    v_mfma_f32_16x16x32_bf16 v[236:239], a[240:243], a[32:35], v[236:239]
    ds_read_b64_tr_b16 a[210:211], v4 offset:34368
    v_mfma_f32_16x16x32_bf16 v[240:243], a[240:243], a[40:43], v[240:243]
    s_mov_b32 s26, s20
    ds_read_b64_tr_b16 a[212:213], v5 offset:33856
    v_mfma_f32_16x16x32_bf16 v[240:243], a[244:247], a[44:47], v[240:243]
    s_waitcnt lgkmcnt(11)
    s_add_u32 s20, s20, 1048576
    ds_read_b64_tr_b16 a[214:215], v5 offset:34368
    v_mfma_f32_16x16x32_bf16 v[252:255], a[252:255], a[44:47], v[252:255]
    s_add_u32 s77, s77, 256
    ds_read_b64_tr_b16 a[216:217], v4 offset:33864
    v_mfma_f32_16x16x32_bf16 v[252:255], a[248:251], a[40:43], v[252:255]
    s_add_u32 s75, s75, 256
    ds_read_b64_tr_b16 a[218:219], v4 offset:34376
    v_mfma_f32_16x16x32_bf16 v[248:251], a[248:251], a[32:35], v[248:251]
    s_cmp_lt_u32 s75, 1024
    ds_read_b64_tr_b16 a[220:221], v5 offset:33864
    v_mfma_f32_16x16x32_bf16 v[248:251], a[252:255], a[36:39], v[248:251]
    ds_read_b64_tr_b16 a[222:223], v5 offset:34376
    v_mfma_f32_16x16x32_bf16 v[244:247], a[252:255], a[28:31], v[244:247]
    s_waitcnt vmcnt(10) lgkmcnt(5)
    v_mfma_f32_16x16x32_bf16 v[244:247], a[248:251], a[24:27], v[244:247]
    s_cmp_lg_u32 s67, 0
    s_cbranch_scc1 L_q2l
    s_lshl_b32 s66, s72, 9
    s_lshl_b32 s69, s60, 7
    s_add_u32 s66, s66, s69
    v_and_b32 v8, 7, v0
    v_lshlrev_b32 v8, 2, v8
    v_mov_b32 v7, 0
    buffer_store_dword v7, v8, s[8:11], s66 offen sc1
    s_xor_b32 s64, s56, 0
    s_add_u32 m0, s61, 0
    s_nop 0
    buffer_load_dwordx4 v1, s[40:43], s64 offen nt lds
    s_add_u32 m0, s61, 32
    s_nop 0
    buffer_load_dwordx4 v1, s[40:43], s64 offen offset:1024 nt lds
.p2align 6
L_q2l:
    v_mfma_f32_16x16x32_bf16 v[56:59], a[192:195], a[0:3], v[56:59]
    ds_read_b128 a[24:27], v158 offset:0
    v_mfma_f32_16x16x32_bf16 v[56:59], a[196:199], a[4:7], v[56:59]
    ds_read_b128 a[28:31], v159 offset:0
    v_mfma_f32_16x16x32_bf16 v[60:63], a[196:199], a[12:15], v[60:63]
    s_xor_b32 s64, s26, 786688
    ds_read_b64_tr_b16 a[224:225], v4 offset:33920
    v_mfma_f32_16x16x32_bf16 v[60:63], a[192:195], a[8:11], v[60:63]
    s_add_u32 m0, s61, 118272
    ds_read_b64_tr_b16 a[226:227], v4 offset:34432
    v_mfma_f32_16x16x32_bf16 v[64:67], a[192:195], a[16:19], v[64:67]
    buffer_load_dwordx4 v6, s[36:39], s64 offen lds
    v_mfma_f32_16x16x32_bf16 v[64:67], a[196:199], a[20:23], v[64:67]
    s_xor_b32 s64, s26, 794880
    ds_read_b64_tr_b16 a[228:229], v5 offset:33920
    v_mfma_f32_16x16x32_bf16 v[76:79], a[204:207], a[20:23], v[76:79]
    s_add_u32 m0, s61, 119304
    ds_read_b64_tr_b16 a[230:231], v5 offset:34432
    v_mfma_f32_16x16x32_bf16 v[76:79], a[200:203], a[16:19], v[76:79]
    s_waitcnt lgkmcnt(4)
    buffer_load_dwordx4 v6, s[36:39], s64 offen lds
    v_mfma_f32_16x16x32_bf16 v[72:75], a[200:203], a[8:11], v[72:75]
    s_add_u32 s65, s75, 256
    ds_read_b64_tr_b16 a[232:233], v4 offset:33928
    v_mfma_f32_16x16x32_bf16 v[72:75], a[204:207], a[12:15], v[72:75]
    s_add_u32 m0, s63, 0
    ds_read_b64_tr_b16 a[234:235], v4 offset:34440
    v_mfma_f32_16x16x32_bf16 v[68:71], a[204:207], a[4:7], v[68:71]
    buffer_load_dwordx4 v156, s[32:35], s65 offen lds
    v_mfma_f32_16x16x32_bf16 v[68:71], a[200:203], a[0:3], v[68:71]
    ds_read_b64_tr_b16 a[236:237], v5 offset:33928
    v_mfma_f32_16x16x32_bf16 v[80:83], a[208:211], a[0:3], v[80:83]
    s_add_u32 m0, s63, 1024
    ds_read_b64_tr_b16 a[238:239], v5 offset:34440
    v_mfma_f32_16x16x32_bf16 v[80:83], a[212:215], a[4:7], v[80:83]
    buffer_load_dwordx4 v157, s[32:35], s65 offen lds
    v_mfma_f32_16x16x32_bf16 v[84:87], a[212:215], a[12:15], v[84:87]
    ds_read_b64_tr_b16 a[240:241], v4 offset:33984
    v_mfma_f32_16x16x32_bf16 v[84:87], a[208:211], a[8:11], v[84:87]
    ds_read_b64_tr_b16 a[242:243], v4 offset:34496
    v_mfma_f32_16x16x32_bf16 v[88:91], a[208:211], a[16:19], v[88:91]
    ds_read_b64_tr_b16 a[244:245], v5 offset:33984
    v_mfma_f32_16x16x32_bf16 v[88:91], a[212:215], a[20:23], v[88:91]
    ds_read_b64_tr_b16 a[246:247], v5 offset:34496
    v_mfma_f32_16x16x32_bf16 v[100:103], a[220:223], a[20:23], v[100:103]
    ds_read_b64_tr_b16 a[248:249], v4 offset:33992
    v_mfma_f32_16x16x32_bf16 v[100:103], a[216:219], a[16:19], v[100:103]
    ds_read_b64_tr_b16 a[250:251], v4 offset:34504
    v_mfma_f32_16x16x32_bf16 v[96:99], a[216:219], a[8:11], v[96:99]
    ds_read_b64_tr_b16 a[252:253], v5 offset:33992
    v_mfma_f32_16x16x32_bf16 v[96:99], a[220:223], a[12:15], v[96:99]
    ds_read_b64_tr_b16 a[254:255], v5 offset:34504
    v_mfma_f32_16x16x32_bf16 v[92:95], a[220:223], a[4:7], v[92:95]
    s_waitcnt vmcnt(8) lgkmcnt(5)
    v_mfma_f32_16x16x32_bf16 v[92:95], a[216:219], a[0:3], v[92:95]
    s_barrier
    v_mfma_f32_16x16x32_bf16 v[104:107], a[224:227], a[0:3], v[104:107]
    ds_read_b128 a[32:35], v158 offset:2048
    v_mfma_f32_16x16x32_bf16 v[104:107], a[228:231], a[4:7], v[104:107]
    ds_read_b128 a[36:39], v159 offset:2048
    v_mfma_f32_16x16x32_bf16 v[108:111], a[228:231], a[12:15], v[108:111]
    s_xor_b32 s64, s26, 524288
    ds_read_b64_tr_b16 a[192:193], v4 offset:42240
    v_mfma_f32_16x16x32_bf16 v[108:111], a[224:227], a[8:11], v[108:111]
    s_add_u32 m0, s61, 59136
    ds_read_b64_tr_b16 a[194:195], v4 offset:42752
    v_mfma_f32_16x16x32_bf16 v[112:115], a[224:227], a[16:19], v[112:115]
    buffer_load_dwordx4 v6, s[36:39], s64 offen lds
    v_mfma_f32_16x16x32_bf16 v[112:115], a[228:231], a[20:23], v[112:115]
    s_xor_b32 s64, s26, 532480
    ds_read_b64_tr_b16 a[196:197], v5 offset:42240
    v_mfma_f32_16x16x32_bf16 v[124:127], a[236:239], a[20:23], v[124:127]
    s_add_u32 m0, s61, 60168
    ds_read_b64_tr_b16 a[198:199], v5 offset:42752
    v_mfma_f32_16x16x32_bf16 v[124:127], a[232:235], a[16:19], v[124:127]
    s_waitcnt lgkmcnt(4)
    buffer_load_dwordx4 v6, s[36:39], s64 offen lds
    v_mfma_f32_16x16x32_bf16 v[120:123], a[232:235], a[8:11], v[120:123]
    s_add_u32 s65, s75, 20736
    ds_read_b64_tr_b16 a[200:201], v4 offset:42248
    v_mfma_f32_16x16x32_bf16 v[120:123], a[236:239], a[12:15], v[120:123]
    s_add_u32 m0, s63, 2048
    ds_read_b64_tr_b16 a[202:203], v4 offset:42760
    v_mfma_f32_16x16x32_bf16 v[116:119], a[236:239], a[4:7], v[116:119]
    buffer_load_dwordx4 v156, s[32:35], s65 offen lds
    v_mfma_f32_16x16x32_bf16 v[116:119], a[232:235], a[0:3], v[116:119]
    ds_read_b64_tr_b16 a[204:205], v5 offset:42248
    v_mfma_f32_16x16x32_bf16 v[128:131], a[240:243], a[0:3], v[128:131]
    s_add_u32 m0, s63, 3072
    ds_read_b64_tr_b16 a[206:207], v5 offset:42760
    v_mfma_f32_16x16x32_bf16 v[128:131], a[244:247], a[4:7], v[128:131]
    buffer_load_dwordx4 v157, s[32:35], s65 offen lds
    v_mfma_f32_16x16x32_bf16 v[132:135], a[244:247], a[12:15], v[132:135]
    ds_read_b64_tr_b16 a[208:209], v4 offset:42304
    v_mfma_f32_16x16x32_bf16 v[132:135], a[240:243], a[8:11], v[132:135]
    ds_read_b64_tr_b16 a[210:211], v4 offset:42816
    v_mfma_f32_16x16x32_bf16 v[136:139], a[240:243], a[16:19], v[136:139]
    ds_read_b64_tr_b16 a[212:213], v5 offset:42304
    v_mfma_f32_16x16x32_bf16 v[136:139], a[244:247], a[20:23], v[136:139]
    ds_read_b64_tr_b16 a[214:215], v5 offset:42816
    v_mfma_f32_16x16x32_bf16 v[148:151], a[252:255], a[20:23], v[148:151]
    ds_read_b64_tr_b16 a[216:217], v4 offset:42312
    v_mfma_f32_16x16x32_bf16 v[148:151], a[248:251], a[16:19], v[148:151]
    ds_read_b64_tr_b16 a[218:219], v4 offset:42824
    v_mfma_f32_16x16x32_bf16 v[144:147], a[248:251], a[8:11], v[144:147]
    ds_read_b64_tr_b16 a[220:221], v5 offset:42312
    v_mfma_f32_16x16x32_bf16 v[144:147], a[252:255], a[12:15], v[144:147]
    ds_read_b64_tr_b16 a[222:223], v5 offset:42824
    v_mfma_f32_16x16x32_bf16 v[140:143], a[252:255], a[4:7], v[140:143]
    s_waitcnt vmcnt(10) lgkmcnt(5)
    v_mfma_f32_16x16x32_bf16 v[140:143], a[248:251], a[0:3], v[140:143]
    v_mfma_f32_16x16x32_bf16 v[160:163], a[192:195], a[0:3], v[160:163]
    ds_read_b128 a[40:43], v158 offset:4096
    v_mfma_f32_16x16x32_bf16 v[160:163], a[196:199], a[4:7], v[160:163]
    ds_read_b128 a[44:47], v159 offset:4096
    v_mfma_f32_16x16x32_bf16 v[164:167], a[196:199], a[12:15], v[164:167]
    s_xor_b32 s64, s26, 786432
    ds_read_b64_tr_b16 a[224:225], v4 offset:42368
    v_mfma_f32_16x16x32_bf16 v[164:167], a[192:195], a[8:11], v[164:167]
    s_add_u32 m0, s61, 126720
    ds_read_b64_tr_b16 a[226:227], v4 offset:42880
    v_mfma_f32_16x16x32_bf16 v[168:171], a[192:195], a[16:19], v[168:171]
    buffer_load_dwordx4 v6, s[36:39], s64 offen lds
    v_mfma_f32_16x16x32_bf16 v[168:171], a[196:199], a[20:23], v[168:171]
    s_xor_b32 s64, s26, 794624
    ds_read_b64_tr_b16 a[228:229], v5 offset:42368
    v_mfma_f32_16x16x32_bf16 v[180:183], a[204:207], a[20:23], v[180:183]
    s_add_u32 m0, s61, 127752
    ds_read_b64_tr_b16 a[230:231], v5 offset:42880
    v_mfma_f32_16x16x32_bf16 v[180:183], a[200:203], a[16:19], v[180:183]
    s_waitcnt lgkmcnt(4)
    buffer_load_dwordx4 v6, s[36:39], s64 offen lds
    v_mfma_f32_16x16x32_bf16 v[176:179], a[200:203], a[8:11], v[176:179]
    s_add_u32 s65, s75, 41216
    ds_read_b64_tr_b16 a[232:233], v4 offset:42376
    v_mfma_f32_16x16x32_bf16 v[176:179], a[204:207], a[12:15], v[176:179]
    s_add_u32 m0, s63, 4096
    ds_read_b64_tr_b16 a[234:235], v4 offset:42888
    v_mfma_f32_16x16x32_bf16 v[172:175], a[204:207], a[4:7], v[172:175]
    buffer_load_dwordx4 v156, s[32:35], s65 offen lds
    v_mfma_f32_16x16x32_bf16 v[172:175], a[200:203], a[0:3], v[172:175]
    ds_read_b64_tr_b16 a[236:237], v5 offset:42376
    v_mfma_f32_16x16x32_bf16 v[184:187], a[208:211], a[0:3], v[184:187]
    s_add_u32 m0, s63, 5120
    ds_read_b64_tr_b16 a[238:239], v5 offset:42888
    v_mfma_f32_16x16x32_bf16 v[184:187], a[212:215], a[4:7], v[184:187]
    buffer_load_dwordx4 v157, s[32:35], s65 offen lds
    v_mfma_f32_16x16x32_bf16 v[188:191], a[212:215], a[12:15], v[188:191]
    ds_read_b64_tr_b16 a[240:241], v4 offset:42432
    v_mfma_f32_16x16x32_bf16 v[188:191], a[208:211], a[8:11], v[188:191]
    ds_read_b64_tr_b16 a[242:243], v4 offset:42944
    v_mfma_f32_16x16x32_bf16 v[192:195], a[208:211], a[16:19], v[192:195]
    ds_read_b64_tr_b16 a[244:245], v5 offset:42432
    v_mfma_f32_16x16x32_bf16 v[192:195], a[212:215], a[20:23], v[192:195]
    ds_read_b64_tr_b16 a[246:247], v5 offset:42944
    v_mfma_f32_16x16x32_bf16 v[204:207], a[220:223], a[20:23], v[204:207]
    ds_read_b64_tr_b16 a[248:249], v4 offset:42440
    v_mfma_f32_16x16x32_bf16 v[204:207], a[216:219], a[16:19], v[204:207]
    ds_read_b64_tr_b16 a[250:251], v4 offset:42952
    v_mfma_f32_16x16x32_bf16 v[200:203], a[216:219], a[8:11], v[200:203]
    ds_read_b64_tr_b16 a[252:253], v5 offset:42440
    v_mfma_f32_16x16x32_bf16 v[200:203], a[220:223], a[12:15], v[200:203]
    ds_read_b64_tr_b16 a[254:255], v5 offset:42952
    v_mfma_f32_16x16x32_bf16 v[196:199], a[220:223], a[4:7], v[196:199]
    s_waitcnt vmcnt(10) lgkmcnt(5)
    v_mfma_f32_16x16x32_bf16 v[196:199], a[216:219], a[0:3], v[196:199]
    s_barrier
    v_mfma_f32_16x16x32_bf16 v[208:211], a[224:227], a[0:3], v[208:211]
    s_cmp_ge_u32 s23, s76
    s_cselect_b64 vcc, -1, 0
    v_mfma_f32_16x16x32_bf16 v[208:211], a[228:231], a[4:7], v[208:211]
    s_cselect_b32 s25, 0, 8192
    s_add_u32 s58, s23, 0
    v_mfma_f32_16x16x32_bf16 v[212:215], a[228:231], a[12:15], v[212:215]
    s_xor_b32 s64, s20, 256
    ds_read_b64_tr_b16 a[192:193], v4 offset:50688
    v_mfma_f32_16x16x32_bf16 v[212:215], a[224:227], a[8:11], v[212:215]
    s_add_u32 m0, s61, 33792
    ds_read_b64_tr_b16 a[194:195], v4 offset:51200
    v_mfma_f32_16x16x32_bf16 v[216:219], a[224:227], a[16:19], v[216:219]
    s_xor_b32 s65, s58, s22
    buffer_load_dwordx4 v6, s[36:39], s64 offen lds
    v_mfma_f32_16x16x32_bf16 v[216:219], a[228:231], a[20:23], v[216:219]
    s_xor_b32 s64, s20, 8448
    ds_read_b64_tr_b16 a[196:197], v5 offset:50688
    v_mfma_f32_16x16x32_bf16 v[228:231], a[236:239], a[20:23], v[228:231]
    s_add_u32 m0, s61, 34824
    ds_read_b64_tr_b16 a[198:199], v5 offset:51200
    v_mfma_f32_16x16x32_bf16 v[228:231], a[232:235], a[16:19], v[228:231]
    s_bfe_u32 s58, s58, 0x3000d
    buffer_load_dwordx4 v6, s[36:39], s64 offen lds
    v_mfma_f32_16x16x32_bf16 v[224:227], a[232:235], a[8:11], v[224:227]
    s_mul_i32 s58, s58, 8448
    ds_read_b64_tr_b16 a[200:201], v4 offset:50696
    v_mfma_f32_16x16x32_bf16 v[224:227], a[236:239], a[12:15], v[224:227]
    s_add_u32 m0, s58, s3
    ds_read_b64_tr_b16 a[202:203], v4 offset:51208
    v_mfma_f32_16x16x32_bf16 v[220:223], a[236:239], a[4:7], v[220:223]
    s_cbranch_vccnz L_sk_13
    buffer_load_dwordx4 v1, s[44:47], s65 offen nt lds
L_sk_13:
    v_mfma_f32_16x16x32_bf16 v[220:223], a[232:235], a[0:3], v[220:223]
    ds_read_b64_tr_b16 a[204:205], v5 offset:50696
    v_mfma_f32_16x16x32_bf16 v[232:235], a[240:243], a[0:3], v[232:235]
    s_waitcnt lgkmcnt(11)
    s_add_u32 m0, m0, 32
    ds_read_b64_tr_b16 a[206:207], v5 offset:51208
    v_mfma_f32_16x16x32_bf16 v[232:235], a[244:247], a[4:7], v[232:235]
    s_cbranch_vccnz L_sk_14
    buffer_load_dwordx4 v1, s[44:47], s65 offen offset:1024 nt lds
L_sk_14:
    v_mfma_f32_16x16x32_bf16 v[236:239], a[244:247], a[12:15], v[236:239]
    ds_read_b64_tr_b16 a[208:209], v4 offset:50752
    v_mfma_f32_16x16x32_bf16 v[236:239], a[240:243], a[8:11], v[236:239]
    ds_read_b64_tr_b16 a[210:211], v4 offset:51264
    v_mfma_f32_16x16x32_bf16 v[240:243], a[240:243], a[16:19], v[240:243]
    ds_read_b64_tr_b16 a[212:213], v5 offset:50752
    v_mfma_f32_16x16x32_bf16 v[240:243], a[244:247], a[20:23], v[240:243]
    s_waitcnt lgkmcnt(11)
    ds_read_b64_tr_b16 a[214:215], v5 offset:51264
    v_mfma_f32_16x16x32_bf16 v[252:255], a[252:255], a[20:23], v[252:255]
    ds_read_b64_tr_b16 a[216:217], v4 offset:50760
    v_mfma_f32_16x16x32_bf16 v[252:255], a[248:251], a[16:19], v[252:255]
    ds_read_b64_tr_b16 a[218:219], v4 offset:51272
    v_mfma_f32_16x16x32_bf16 v[248:251], a[248:251], a[8:11], v[248:251]
    ds_read_b64_tr_b16 a[220:221], v5 offset:50760
    v_mfma_f32_16x16x32_bf16 v[248:251], a[252:255], a[12:15], v[248:251]
    ds_read_b64_tr_b16 a[222:223], v5 offset:51272
    v_mfma_f32_16x16x32_bf16 v[244:247], a[252:255], a[4:7], v[244:247]
    s_waitcnt vmcnt(10) lgkmcnt(5)
    v_mfma_f32_16x16x32_bf16 v[244:247], a[248:251], a[0:3], v[244:247]
    v_mfma_f32_16x16x32_bf16 v[56:59], a[192:195], a[24:27], v[56:59]
    ds_read_b128 a[0:3], v158 offset:0
    v_mfma_f32_16x16x32_bf16 v[56:59], a[196:199], a[28:31], v[56:59]
    ds_read_b128 a[4:7], v159 offset:0
    v_mfma_f32_16x16x32_bf16 v[60:63], a[196:199], a[36:39], v[60:63]
    s_xor_b32 s64, s20, 262400
    ds_read_b64_tr_b16 a[224:225], v4 offset:50816
    v_mfma_f32_16x16x32_bf16 v[60:63], a[192:195], a[32:35], v[60:63]
    s_add_u32 m0, s61, 101376
    ds_read_b64_tr_b16 a[226:227], v4 offset:51328
    v_mfma_f32_16x16x32_bf16 v[64:67], a[192:195], a[40:43], v[64:67]
    buffer_load_dwordx4 v6, s[36:39], s64 offen lds
    v_mfma_f32_16x16x32_bf16 v[64:67], a[196:199], a[44:47], v[64:67]
    s_xor_b32 s64, s20, 270592
    ds_read_b64_tr_b16 a[228:229], v5 offset:50816
    v_mfma_f32_16x16x32_bf16 v[76:79], a[204:207], a[44:47], v[76:79]
    s_add_u32 m0, s61, 102408
    ds_read_b64_tr_b16 a[230:231], v5 offset:51328
    v_mfma_f32_16x16x32_bf16 v[76:79], a[200:203], a[40:43], v[76:79]
    s_waitcnt lgkmcnt(4)
    buffer_load_dwordx4 v6, s[36:39], s64 offen lds
    v_mfma_f32_16x16x32_bf16 v[72:75], a[200:203], a[32:35], v[72:75]
    s_add_u32 s65, s77, 256
    ds_read_b64_tr_b16 a[232:233], v4 offset:50824
    v_mfma_f32_16x16x32_bf16 v[72:75], a[204:207], a[36:39], v[72:75]
    s_add_u32 m0, s63, 0
    ds_read_b64_tr_b16 a[234:235], v4 offset:51336
    v_mfma_f32_16x16x32_bf16 v[68:71], a[204:207], a[28:31], v[68:71]
    buffer_load_dwordx4 v156, s[32:35], s65 offen lds
    v_mfma_f32_16x16x32_bf16 v[68:71], a[200:203], a[24:27], v[68:71]
    ds_read_b64_tr_b16 a[236:237], v5 offset:50824
    v_mfma_f32_16x16x32_bf16 v[80:83], a[208:211], a[24:27], v[80:83]
    s_add_u32 m0, s63, 1024
    ds_read_b64_tr_b16 a[238:239], v5 offset:51336
    v_mfma_f32_16x16x32_bf16 v[80:83], a[212:215], a[28:31], v[80:83]
    buffer_load_dwordx4 v157, s[32:35], s65 offen lds
    v_mfma_f32_16x16x32_bf16 v[84:87], a[212:215], a[36:39], v[84:87]
    ds_read_b64_tr_b16 a[240:241], v4 offset:50880
    v_mfma_f32_16x16x32_bf16 v[84:87], a[208:211], a[32:35], v[84:87]
    ds_read_b64_tr_b16 a[242:243], v4 offset:51392
    v_mfma_f32_16x16x32_bf16 v[88:91], a[208:211], a[40:43], v[88:91]
    ds_read_b64_tr_b16 a[244:245], v5 offset:50880
    v_mfma_f32_16x16x32_bf16 v[88:91], a[212:215], a[44:47], v[88:91]
    ds_read_b64_tr_b16 a[246:247], v5 offset:51392
    v_mfma_f32_16x16x32_bf16 v[100:103], a[220:223], a[44:47], v[100:103]
    ds_read_b64_tr_b16 a[248:249], v4 offset:50888
    v_mfma_f32_16x16x32_bf16 v[100:103], a[216:219], a[40:43], v[100:103]
    ds_read_b64_tr_b16 a[250:251], v4 offset:51400
    v_mfma_f32_16x16x32_bf16 v[96:99], a[216:219], a[32:35], v[96:99]
    ds_read_b64_tr_b16 a[252:253], v5 offset:50888
    v_mfma_f32_16x16x32_bf16 v[96:99], a[220:223], a[36:39], v[96:99]
    ds_read_b64_tr_b16 a[254:255], v5 offset:51400
    v_mfma_f32_16x16x32_bf16 v[92:95], a[220:223], a[28:31], v[92:95]
    s_waitcnt vmcnt(8) lgkmcnt(5)
    v_mfma_f32_16x16x32_bf16 v[92:95], a[216:219], a[24:27], v[92:95]
    s_barrier
    v_mfma_f32_16x16x32_bf16 v[104:107], a[224:227], a[24:27], v[104:107]
    ds_read_b128 a[8:11], v158 offset:2048
    v_mfma_f32_16x16x32_bf16 v[104:107], a[228:231], a[28:31], v[104:107]
    ds_read_b128 a[12:15], v159 offset:2048
    v_mfma_f32_16x16x32_bf16 v[108:111], a[228:231], a[36:39], v[108:111]
    s_xor_b32 s64, s20, 0
    ds_read_b64_tr_b16 a[192:193], v4 offset:59136
    v_mfma_f32_16x16x32_bf16 v[108:111], a[224:227], a[32:35], v[108:111]
    s_add_u32 m0, s61, 42240
    ds_read_b64_tr_b16 a[194:195], v4 offset:59648
    v_mfma_f32_16x16x32_bf16 v[112:115], a[224:227], a[40:43], v[112:115]
    buffer_load_dwordx4 v6, s[36:39], s64 offen lds
    v_mfma_f32_16x16x32_bf16 v[112:115], a[228:231], a[44:47], v[112:115]
    s_xor_b32 s64, s20, 8192
    ds_read_b64_tr_b16 a[196:197], v5 offset:59136
    v_mfma_f32_16x16x32_bf16 v[124:127], a[236:239], a[44:47], v[124:127]
    s_add_u32 m0, s61, 43272
    ds_read_b64_tr_b16 a[198:199], v5 offset:59648
    v_mfma_f32_16x16x32_bf16 v[124:127], a[232:235], a[40:43], v[124:127]
    s_waitcnt lgkmcnt(4)
    buffer_load_dwordx4 v6, s[36:39], s64 offen lds
    v_mfma_f32_16x16x32_bf16 v[120:123], a[232:235], a[32:35], v[120:123]
    s_add_u32 s65, s77, 20736
    ds_read_b64_tr_b16 a[200:201], v4 offset:59144
    v_mfma_f32_16x16x32_bf16 v[120:123], a[236:239], a[36:39], v[120:123]
    s_add_u32 m0, s63, 2048
    ds_read_b64_tr_b16 a[202:203], v4 offset:59656
    v_mfma_f32_16x16x32_bf16 v[116:119], a[236:239], a[28:31], v[116:119]
    buffer_load_dwordx4 v156, s[32:35], s65 offen lds
    v_mfma_f32_16x16x32_bf16 v[116:119], a[232:235], a[24:27], v[116:119]
    ds_read_b64_tr_b16 a[204:205], v5 offset:59144
    v_mfma_f32_16x16x32_bf16 v[128:131], a[240:243], a[24:27], v[128:131]
    s_add_u32 m0, s63, 3072
    ds_read_b64_tr_b16 a[206:207], v5 offset:59656
    v_mfma_f32_16x16x32_bf16 v[128:131], a[244:247], a[28:31], v[128:131]
    buffer_load_dwordx4 v157, s[32:35], s65 offen lds
    v_mfma_f32_16x16x32_bf16 v[132:135], a[244:247], a[36:39], v[132:135]
    ds_read_b64_tr_b16 a[208:209], v4 offset:59200
    v_mfma_f32_16x16x32_bf16 v[132:135], a[240:243], a[32:35], v[132:135]
    ds_read_b64_tr_b16 a[210:211], v4 offset:59712
    v_mfma_f32_16x16x32_bf16 v[136:139], a[240:243], a[40:43], v[136:139]
    ds_read_b64_tr_b16 a[212:213], v5 offset:59200
    v_mfma_f32_16x16x32_bf16 v[136:139], a[244:247], a[44:47], v[136:139]
    ds_read_b64_tr_b16 a[214:215], v5 offset:59712
    v_mfma_f32_16x16x32_bf16 v[148:151], a[252:255], a[44:47], v[148:151]
    ds_read_b64_tr_b16 a[216:217], v4 offset:59208
    v_mfma_f32_16x16x32_bf16 v[148:151], a[248:251], a[40:43], v[148:151]
    ds_read_b64_tr_b16 a[218:219], v4 offset:59720
    v_mfma_f32_16x16x32_bf16 v[144:147], a[248:251], a[32:35], v[144:147]
    ds_read_b64_tr_b16 a[220:221], v5 offset:59208
    v_mfma_f32_16x16x32_bf16 v[144:147], a[252:255], a[36:39], v[144:147]
    ds_read_b64_tr_b16 a[222:223], v5 offset:59720
    v_mfma_f32_16x16x32_bf16 v[140:143], a[252:255], a[28:31], v[140:143]
    s_waitcnt vmcnt(10) lgkmcnt(5)
    v_mfma_f32_16x16x32_bf16 v[140:143], a[248:251], a[24:27], v[140:143]
    v_mfma_f32_16x16x32_bf16 v[160:163], a[192:195], a[24:27], v[160:163]
    ds_read_b128 a[16:19], v158 offset:4096
    v_mfma_f32_16x16x32_bf16 v[160:163], a[196:199], a[28:31], v[160:163]
    ds_read_b128 a[20:23], v159 offset:4096
    v_mfma_f32_16x16x32_bf16 v[164:167], a[196:199], a[36:39], v[164:167]
    s_xor_b32 s64, s20, 262144
    ds_read_b64_tr_b16 a[224:225], v4 offset:59264
    v_mfma_f32_16x16x32_bf16 v[164:167], a[192:195], a[32:35], v[164:167]
    s_add_u32 m0, s61, 109824
    ds_read_b64_tr_b16 a[226:227], v4 offset:59776
    v_mfma_f32_16x16x32_bf16 v[168:171], a[192:195], a[40:43], v[168:171]
    buffer_load_dwordx4 v6, s[36:39], s64 offen lds
    v_mfma_f32_16x16x32_bf16 v[168:171], a[196:199], a[44:47], v[168:171]
    s_xor_b32 s64, s20, 270336
    ds_read_b64_tr_b16 a[228:229], v5 offset:59264
    v_mfma_f32_16x16x32_bf16 v[180:183], a[204:207], a[44:47], v[180:183]
    s_add_u32 m0, s61, 110856
    ds_read_b64_tr_b16 a[230:231], v5 offset:59776
    v_mfma_f32_16x16x32_bf16 v[180:183], a[200:203], a[40:43], v[180:183]
    s_waitcnt lgkmcnt(4)
    buffer_load_dwordx4 v6, s[36:39], s64 offen lds
    v_mfma_f32_16x16x32_bf16 v[176:179], a[200:203], a[32:35], v[176:179]
    s_add_u32 s65, s77, 41216
    ds_read_b64_tr_b16 a[232:233], v4 offset:59272
    v_mfma_f32_16x16x32_bf16 v[176:179], a[204:207], a[36:39], v[176:179]
    s_add_u32 m0, s63, 4096
    ds_read_b64_tr_b16 a[234:235], v4 offset:59784
    v_mfma_f32_16x16x32_bf16 v[172:175], a[204:207], a[28:31], v[172:175]
    buffer_load_dwordx4 v156, s[32:35], s65 offen lds
    v_mfma_f32_16x16x32_bf16 v[172:175], a[200:203], a[24:27], v[172:175]
    ds_read_b64_tr_b16 a[236:237], v5 offset:59272
    v_mfma_f32_16x16x32_bf16 v[184:187], a[208:211], a[24:27], v[184:187]
    s_add_u32 m0, s63, 5120
    ds_read_b64_tr_b16 a[238:239], v5 offset:59784
    v_mfma_f32_16x16x32_bf16 v[184:187], a[212:215], a[28:31], v[184:187]
    buffer_load_dwordx4 v157, s[32:35], s65 offen lds
    v_mfma_f32_16x16x32_bf16 v[188:191], a[212:215], a[36:39], v[188:191]
    ds_read_b64_tr_b16 a[240:241], v4 offset:59328
    v_mfma_f32_16x16x32_bf16 v[188:191], a[208:211], a[32:35], v[188:191]
    ds_read_b64_tr_b16 a[242:243], v4 offset:59840
    v_mfma_f32_16x16x32_bf16 v[192:195], a[208:211], a[40:43], v[192:195]
    ds_read_b64_tr_b16 a[244:245], v5 offset:59328
    v_mfma_f32_16x16x32_bf16 v[192:195], a[212:215], a[44:47], v[192:195]
    ds_read_b64_tr_b16 a[246:247], v5 offset:59840
    v_mfma_f32_16x16x32_bf16 v[204:207], a[220:223], a[44:47], v[204:207]
    ds_read_b64_tr_b16 a[248:249], v4 offset:59336
    v_mfma_f32_16x16x32_bf16 v[204:207], a[216:219], a[40:43], v[204:207]
    ds_read_b64_tr_b16 a[250:251], v4 offset:59848
    v_mfma_f32_16x16x32_bf16 v[200:203], a[216:219], a[32:35], v[200:203]
    ds_read_b64_tr_b16 a[252:253], v5 offset:59336
    v_mfma_f32_16x16x32_bf16 v[200:203], a[220:223], a[36:39], v[200:203]
    ds_read_b64_tr_b16 a[254:255], v5 offset:59848
    v_mfma_f32_16x16x32_bf16 v[196:199], a[220:223], a[28:31], v[196:199]
    s_waitcnt vmcnt(10) lgkmcnt(5)
    v_mfma_f32_16x16x32_bf16 v[196:199], a[216:219], a[24:27], v[196:199]
    s_barrier
    v_mfma_f32_16x16x32_bf16 v[208:211], a[224:227], a[24:27], v[208:211]
    s_add_u32 s59, s23, 8192
    s_xor_b32 s65, s59, s22
    v_mfma_f32_16x16x32_bf16 v[208:211], a[228:231], a[28:31], v[208:211]
    s_bfe_u32 s59, s59, 0x3000d
    s_mul_i32 s59, s59, 8448
    v_mfma_f32_16x16x32_bf16 v[212:215], a[228:231], a[36:39], v[212:215]
    s_xor_b32 s64, s20, 524544
    ds_read_b64_tr_b16 a[192:193], v4 offset:33792
    v_mfma_f32_16x16x32_bf16 v[212:215], a[224:227], a[32:35], v[212:215]
    s_add_u32 m0, s61, 50688
    ds_read_b64_tr_b16 a[194:195], v4 offset:34304
    v_mfma_f32_16x16x32_bf16 v[216:219], a[224:227], a[40:43], v[216:219]
    s_add_u32 s23, s23, s25
    buffer_load_dwordx4 v6, s[36:39], s64 offen lds
    v_mfma_f32_16x16x32_bf16 v[216:219], a[228:231], a[44:47], v[216:219]
    s_xor_b32 s64, s20, 532736
    ds_read_b64_tr_b16 a[196:197], v5 offset:33792
    v_mfma_f32_16x16x32_bf16 v[228:231], a[236:239], a[44:47], v[228:231]
    s_add_u32 m0, s61, 51720
    ds_read_b64_tr_b16 a[198:199], v5 offset:34304
    v_mfma_f32_16x16x32_bf16 v[228:231], a[232:235], a[40:43], v[228:231]
    buffer_load_dwordx4 v6, s[36:39], s64 offen lds
    v_mfma_f32_16x16x32_bf16 v[224:227], a[232:235], a[32:35], v[224:227]
    ds_read_b64_tr_b16 a[200:201], v4 offset:33800
    v_mfma_f32_16x16x32_bf16 v[224:227], a[236:239], a[36:39], v[224:227]
    s_add_u32 m0, s59, s61
    ds_read_b64_tr_b16 a[202:203], v4 offset:34312
    v_mfma_f32_16x16x32_bf16 v[220:223], a[236:239], a[28:31], v[220:223]
    s_cbranch_vccnz L_sk_15
    buffer_load_dwordx4 v1, s[40:43], s65 offen nt lds
L_sk_15:
    v_mfma_f32_16x16x32_bf16 v[220:223], a[232:235], a[24:27], v[220:223]
    ds_read_b64_tr_b16 a[204:205], v5 offset:33800
    v_mfma_f32_16x16x32_bf16 v[232:235], a[240:243], a[24:27], v[232:235]
    s_waitcnt lgkmcnt(11)
    s_add_u32 m0, m0, 32
    ds_read_b64_tr_b16 a[206:207], v5 offset:34312
    v_mfma_f32_16x16x32_bf16 v[232:235], a[244:247], a[28:31], v[232:235]
    s_cbranch_vccnz L_sk_16
    buffer_load_dwordx4 v1, s[40:43], s65 offen offset:1024 nt lds
L_sk_16:
    v_mfma_f32_16x16x32_bf16 v[236:239], a[244:247], a[36:39], v[236:239]
    ds_read_b64_tr_b16 a[208:209], v4 offset:33856
    v_mfma_f32_16x16x32_bf16 v[236:239], a[240:243], a[32:35], v[236:239]
    ds_read_b64_tr_b16 a[210:211], v4 offset:34368
    v_mfma_f32_16x16x32_bf16 v[240:243], a[240:243], a[40:43], v[240:243]
    s_mov_b32 s26, s20
    ds_read_b64_tr_b16 a[212:213], v5 offset:33856
    v_mfma_f32_16x16x32_bf16 v[240:243], a[244:247], a[44:47], v[240:243]
    s_waitcnt lgkmcnt(11)
    s_add_u32 s20, s20, 1048576
    ds_read_b64_tr_b16 a[214:215], v5 offset:34368
    v_mfma_f32_16x16x32_bf16 v[252:255], a[252:255], a[44:47], v[252:255]
    s_add_u32 s77, s77, 256
    ds_read_b64_tr_b16 a[216:217], v4 offset:33864
    v_mfma_f32_16x16x32_bf16 v[252:255], a[248:251], a[40:43], v[252:255]
    s_add_u32 s75, s75, 256
    ds_read_b64_tr_b16 a[218:219], v4 offset:34376
    v_mfma_f32_16x16x32_bf16 v[248:251], a[248:251], a[32:35], v[248:251]
    s_cmp_lt_u32 s75, 1024
    ds_read_b64_tr_b16 a[220:221], v5 offset:33864
    v_mfma_f32_16x16x32_bf16 v[248:251], a[252:255], a[36:39], v[248:251]
    ds_read_b64_tr_b16 a[222:223], v5 offset:34376
    v_mfma_f32_16x16x32_bf16 v[244:247], a[252:255], a[28:31], v[244:247]
    s_waitcnt vmcnt(10) lgkmcnt(5)
    v_mfma_f32_16x16x32_bf16 v[244:247], a[248:251], a[24:27], v[244:247]
    s_cbranch_scc1 L_q2l
    s_getpc_b64 s[14:15]
L_pc_17:
    s_add_u32 s14, s14, L_enter-L_pc_17
    s_addc_u32 s15, s15, 0
    s_lshr_b32 s69, s2, 3
    s_lshl_b32 s69, s69, 2
    s_add_u32 s69, s69, s60
    s_lshl_b32 s69, s69, 7
    v_and_b32 v10, 3, v0
    v_lshlrev_b32 v10, 14, v10
    v_add_u32 v10, s69, v10
    v_min_u32 v10, L_q2b-L_enter-4, v10
    global_load_dword v11, v10, s[14:15]
    v_mfma_f32_16x16x32_bf16 v[56:59], a[192:195], a[0:3], v[56:59]
    ds_read_b128 a[24:27], v158 offset:0
    v_mfma_f32_16x16x32_bf16 v[56:59], a[196:199], a[4:7], v[56:59]
    ds_read_b128 a[28:31], v159 offset:0
    v_mfma_f32_16x16x32_bf16 v[60:63], a[196:199], a[12:15], v[60:63]
    s_xor_b32 s64, s26, 786688
    ds_read_b64_tr_b16 a[224:225], v4 offset:33920
    v_mfma_f32_16x16x32_bf16 v[60:63], a[192:195], a[8:11], v[60:63]
    s_add_u32 m0, s61, 118272
    ds_read_b64_tr_b16 a[226:227], v4 offset:34432
    v_mfma_f32_16x16x32_bf16 v[64:67], a[192:195], a[16:19], v[64:67]
    buffer_load_dwordx4 v6, s[36:39], s64 offen lds
    v_mfma_f32_16x16x32_bf16 v[64:67], a[196:199], a[20:23], v[64:67]
    s_xor_b32 s64, s26, 794880
    ds_read_b64_tr_b16 a[228:229], v5 offset:33920
    v_mfma_f32_16x16x32_bf16 v[76:79], a[204:207], a[20:23], v[76:79]
    s_add_u32 m0, s61, 119304
    ds_read_b64_tr_b16 a[230:231], v5 offset:34432
    v_mfma_f32_16x16x32_bf16 v[76:79], a[200:203], a[16:19], v[76:79]
    buffer_load_dwordx4 v6, s[36:39], s64 offen lds
    v_mfma_f32_16x16x32_bf16 v[72:75], a[200:203], a[8:11], v[72:75]
    ds_read_b64_tr_b16 a[232:233], v4 offset:33928
    v_mfma_f32_16x16x32_bf16 v[72:75], a[204:207], a[12:15], v[72:75]
    ds_read_b64_tr_b16 a[234:235], v4 offset:34440
    v_mfma_f32_16x16x32_bf16 v[68:71], a[204:207], a[4:7], v[68:71]
    v_mfma_f32_16x16x32_bf16 v[68:71], a[200:203], a[0:3], v[68:71]
    ds_read_b64_tr_b16 a[236:237], v5 offset:33928
    v_mfma_f32_16x16x32_bf16 v[80:83], a[208:211], a[0:3], v[80:83]
    s_waitcnt lgkmcnt(13)
    ds_read_b64_tr_b16 a[238:239], v5 offset:34440
    v_mfma_f32_16x16x32_bf16 v[80:83], a[212:215], a[4:7], v[80:83]
    v_mfma_f32_16x16x32_bf16 v[84:87], a[212:215], a[12:15], v[84:87]
    s_mov_b32 s14, 0x3e0293ee
    ds_read_b64_tr_b16 a[240:241], v4 offset:33984
    v_mfma_f32_16x16x32_bf16 v[84:87], a[208:211], a[8:11], v[84:87]
    ds_read_b64_tr_b16 a[242:243], v4 offset:34496
    v_mfma_f32_16x16x32_bf16 v[88:91], a[208:211], a[16:19], v[88:91]
    ds_read_b64_tr_b16 a[244:245], v5 offset:33984
    v_mfma_f32_16x16x32_bf16 v[88:91], a[212:215], a[20:23], v[88:91]
    s_waitcnt lgkmcnt(13)
    ds_read_b64_tr_b16 a[246:247], v5 offset:34496
    v_mfma_f32_16x16x32_bf16 v[100:103], a[220:223], a[20:23], v[100:103]
    ds_read_b64_tr_b16 a[248:249], v4 offset:33992
    v_mfma_f32_16x16x32_bf16 v[100:103], a[216:219], a[16:19], v[100:103]
    ds_read_b64_tr_b16 a[250:251], v4 offset:34504
    v_mfma_f32_16x16x32_bf16 v[96:99], a[216:219], a[8:11], v[96:99]
    ds_read_b64_tr_b16 a[252:253], v5 offset:33992
    v_mfma_f32_16x16x32_bf16 v[96:99], a[220:223], a[12:15], v[96:99]
    ds_read_b64_tr_b16 a[254:255], v5 offset:34504
    v_mfma_f32_16x16x32_bf16 v[92:95], a[220:223], a[4:7], v[92:95]
    s_waitcnt vmcnt(6) lgkmcnt(5)
    v_mfma_f32_16x16x32_bf16 v[92:95], a[216:219], a[0:3], v[92:95]
    s_barrier
    v_mfma_f32_16x16x32_bf16 v[104:107], a[224:227], a[0:3], v[104:107]
    s_add_u32 s58, s23, 0
    ds_read_b128 a[32:35], v158 offset:2048
    v_mfma_f32_16x16x32_bf16 v[104:107], a[228:231], a[4:7], v[104:107]
    s_xor_b32 s65, s58, s22
    ds_read_b128 a[36:39], v159 offset:2048
    v_mfma_f32_16x16x32_bf16 v[108:111], a[228:231], a[12:15], v[108:111]
    s_xor_b32 s64, s26, 524288
    ds_read_b64_tr_b16 a[192:193], v4 offset:42240
    v_mfma_f32_16x16x32_bf16 v[108:111], a[224:227], a[8:11], v[108:111]
    s_add_u32 m0, s61, 59136
    ds_read_b64_tr_b16 a[194:195], v4 offset:42752
    v_mfma_f32_16x16x32_bf16 v[112:115], a[224:227], a[16:19], v[112:115]
    s_bfe_u32 s58, s58, 0x3000d
    buffer_load_dwordx4 v6, s[36:39], s64 offen lds
    v_mfma_f32_16x16x32_bf16 v[112:115], a[228:231], a[20:23], v[112:115]
    s_xor_b32 s64, s26, 532480
    ds_read_b64_tr_b16 a[196:197], v5 offset:42240
    v_mfma_f32_16x16x32_bf16 v[124:127], a[236:239], a[20:23], v[124:127]
    s_add_u32 m0, s61, 60168
    ds_read_b64_tr_b16 a[198:199], v5 offset:42752
    v_mfma_f32_16x16x32_bf16 v[124:127], a[232:235], a[16:19], v[124:127]
    buffer_load_dwordx4 v6, s[36:39], s64 offen lds
    v_mfma_f32_16x16x32_bf16 v[120:123], a[232:235], a[8:11], v[120:123]
    s_mul_i32 s58, s58, 8448
    ds_read_b64_tr_b16 a[200:201], v4 offset:42248
    v_mfma_f32_16x16x32_bf16 v[120:123], a[236:239], a[12:15], v[120:123]
    s_add_u32 m0, s58, s3
    ds_read_b64_tr_b16 a[202:203], v4 offset:42760
    v_mfma_f32_16x16x32_bf16 v[116:119], a[236:239], a[4:7], v[116:119]
    buffer_load_dwordx4 v1, s[44:47], s65 offen nt lds
    v_mfma_f32_16x16x32_bf16 v[116:119], a[232:235], a[0:3], v[116:119]
    ds_read_b64_tr_b16 a[204:205], v5 offset:42248
    v_mfma_f32_16x16x32_bf16 v[128:131], a[240:243], a[0:3], v[128:131]
    s_waitcnt lgkmcnt(13)
    s_add_u32 m0, m0, 32
    ds_read_b64_tr_b16 a[206:207], v5 offset:42760
    v_mfma_f32_16x16x32_bf16 v[128:131], a[244:247], a[4:7], v[128:131]
    buffer_load_dwordx4 v1, s[44:47], s65 offen offset:1024 nt lds
    v_mfma_f32_16x16x32_bf16 v[132:135], a[244:247], a[12:15], v[132:135]
    ds_read_b64_tr_b16 a[208:209], v4 offset:42304
    v_mfma_f32_16x16x32_bf16 v[132:135], a[240:243], a[8:11], v[132:135]
    ds_read_b64_tr_b16 a[210:211], v4 offset:42816
    v_mfma_f32_16x16x32_bf16 v[136:139], a[240:243], a[16:19], v[136:139]
    ds_read_b64_tr_b16 a[212:213], v5 offset:42304
    v_mfma_f32_16x16x32_bf16 v[136:139], a[244:247], a[20:23], v[136:139]
    s_waitcnt lgkmcnt(13)
    ds_read_b64_tr_b16 a[214:215], v5 offset:42816
    v_mfma_f32_16x16x32_bf16 v[148:151], a[252:255], a[20:23], v[148:151]
    ds_read_b64_tr_b16 a[216:217], v4 offset:42312
    v_mfma_f32_16x16x32_bf16 v[148:151], a[248:251], a[16:19], v[148:151]
    ds_read_b64_tr_b16 a[218:219], v4 offset:42824
    v_mfma_f32_16x16x32_bf16 v[144:147], a[248:251], a[8:11], v[144:147]
    ds_read_b64_tr_b16 a[220:221], v5 offset:42312
    v_mfma_f32_16x16x32_bf16 v[144:147], a[252:255], a[12:15], v[144:147]
    ds_read_b64_tr_b16 a[222:223], v5 offset:42824
    v_mfma_f32_16x16x32_bf16 v[140:143], a[252:255], a[4:7], v[140:143]
    s_waitcnt vmcnt(8) lgkmcnt(5)
    v_mfma_f32_16x16x32_bf16 v[140:143], a[248:251], a[0:3], v[140:143]
    v_mfma_f32_16x16x32_bf16 v[160:163], a[192:195], a[0:3], v[160:163]
    ds_read_b128 a[40:43], v158 offset:4096
    v_mfma_f32_16x16x32_bf16 v[160:163], a[196:199], a[4:7], v[160:163]
    ds_read_b128 a[44:47], v159 offset:4096
    v_mfma_f32_16x16x32_bf16 v[164:167], a[196:199], a[12:15], v[164:167]
    s_xor_b32 s64, s26, 786432
    ds_read_b64_tr_b16 a[224:225], v4 offset:42368
    v_mfma_f32_16x16x32_bf16 v[164:167], a[192:195], a[8:11], v[164:167]
    s_add_u32 m0, s61, 126720
    ds_read_b64_tr_b16 a[226:227], v4 offset:42880
    v_mfma_f32_16x16x32_bf16 v[168:171], a[192:195], a[16:19], v[168:171]
    buffer_load_dwordx4 v6, s[36:39], s64 offen lds
    v_mfma_f32_16x16x32_bf16 v[168:171], a[196:199], a[20:23], v[168:171]
    s_xor_b32 s64, s26, 794624
    ds_read_b64_tr_b16 a[228:229], v5 offset:42368
    v_mfma_f32_16x16x32_bf16 v[180:183], a[204:207], a[20:23], v[180:183]
    s_add_u32 m0, s61, 127752
    ds_read_b64_tr_b16 a[230:231], v5 offset:42880
    v_mfma_f32_16x16x32_bf16 v[180:183], a[200:203], a[16:19], v[180:183]
    buffer_load_dwordx4 v6, s[36:39], s64 offen lds
    v_mfma_f32_16x16x32_bf16 v[176:179], a[200:203], a[8:11], v[176:179]
    ds_read_b64_tr_b16 a[232:233], v4 offset:42376
    v_mfma_f32_16x16x32_bf16 v[176:179], a[204:207], a[12:15], v[176:179]
    ds_read_b64_tr_b16 a[234:235], v4 offset:42888
    v_mfma_f32_16x16x32_bf16 v[172:175], a[204:207], a[4:7], v[172:175]
    v_mfma_f32_16x16x32_bf16 v[172:175], a[200:203], a[0:3], v[172:175]
    ds_read_b64_tr_b16 a[236:237], v5 offset:42376
    v_mfma_f32_16x16x32_bf16 v[184:187], a[208:211], a[0:3], v[184:187]
    s_waitcnt lgkmcnt(13)
    ds_read_b64_tr_b16 a[238:239], v5 offset:42888
    v_mfma_f32_16x16x32_bf16 v[184:187], a[212:215], a[4:7], v[184:187]
    v_mfma_f32_16x16x32_bf16 v[188:191], a[212:215], a[12:15], v[188:191]
    ds_read_b64_tr_b16 a[240:241], v4 offset:42432
    v_mfma_f32_16x16x32_bf16 v[188:191], a[208:211], a[8:11], v[188:191]
    ds_read_b64_tr_b16 a[242:243], v4 offset:42944
    v_mfma_f32_16x16x32_bf16 v[192:195], a[208:211], a[16:19], v[192:195]
    ds_read_b64_tr_b16 a[244:245], v5 offset:42432
    v_mfma_f32_16x16x32_bf16 v[192:195], a[212:215], a[20:23], v[192:195]
    s_waitcnt lgkmcnt(13)
    ds_read_b64_tr_b16 a[246:247], v5 offset:42944
    v_mfma_f32_16x16x32_bf16 v[204:207], a[220:223], a[20:23], v[204:207]
    ds_read_b64_tr_b16 a[248:249], v4 offset:42440
    v_mfma_f32_16x16x32_bf16 v[204:207], a[216:219], a[16:19], v[204:207]
    ds_read_b64_tr_b16 a[250:251], v4 offset:42952
    v_mfma_f32_16x16x32_bf16 v[200:203], a[216:219], a[8:11], v[200:203]
    ds_read_b64_tr_b16 a[252:253], v5 offset:42440
    v_mfma_f32_16x16x32_bf16 v[200:203], a[220:223], a[12:15], v[200:203]
    ds_read_b64_tr_b16 a[254:255], v5 offset:42952
    v_mfma_f32_16x16x32_bf16 v[196:199], a[220:223], a[4:7], v[196:199]
    s_waitcnt vmcnt(6) lgkmcnt(5)
    v_mfma_f32_16x16x32_bf16 v[196:199], a[216:219], a[0:3], v[196:199]
    s_barrier
    v_mfma_f32_16x16x32_bf16 v[208:211], a[224:227], a[0:3], v[208:211]
    s_add_u32 s59, s23, 8192
    v_mfma_f32_16x16x32_bf16 v[208:211], a[228:231], a[4:7], v[208:211]
    s_xor_b32 s65, s59, s22
    v_mfma_f32_16x16x32_bf16 v[212:215], a[228:231], a[12:15], v[212:215]
    ds_read_b64_tr_b16 a[192:193], v4 offset:50688
    v_mfma_f32_16x16x32_bf16 v[212:215], a[224:227], a[8:11], v[212:215]
    ds_read_b64_tr_b16 a[194:195], v4 offset:51200
    v_mfma_f32_16x16x32_bf16 v[216:219], a[224:227], a[16:19], v[216:219]
    s_bfe_u32 s59, s59, 0x3000d
    v_mfma_f32_16x16x32_bf16 v[216:219], a[228:231], a[20:23], v[216:219]
    ds_read_b64_tr_b16 a[196:197], v5 offset:50688
    v_mfma_f32_16x16x32_bf16 v[228:231], a[236:239], a[20:23], v[228:231]
    ds_read_b64_tr_b16 a[198:199], v5 offset:51200
    v_mfma_f32_16x16x32_bf16 v[228:231], a[232:235], a[16:19], v[228:231]
    v_mfma_f32_16x16x32_bf16 v[224:227], a[232:235], a[8:11], v[224:227]
    s_mul_i32 s59, s59, 8448
    ds_read_b64_tr_b16 a[200:201], v4 offset:50696
    v_mfma_f32_16x16x32_bf16 v[224:227], a[236:239], a[12:15], v[224:227]
    s_add_u32 m0, s59, s61
    ds_read_b64_tr_b16 a[202:203], v4 offset:51208
    v_mfma_f32_16x16x32_bf16 v[220:223], a[236:239], a[4:7], v[220:223]
    buffer_load_dwordx4 v1, s[40:43], s65 offen nt lds
    v_mfma_f32_16x16x32_bf16 v[220:223], a[232:235], a[0:3], v[220:223]
    ds_read_b64_tr_b16 a[204:205], v5 offset:50696
    v_mfma_f32_16x16x32_bf16 v[232:235], a[240:243], a[0:3], v[232:235]
    s_waitcnt lgkmcnt(11)
    s_add_u32 m0, m0, 32
    ds_read_b64_tr_b16 a[206:207], v5 offset:51208
    v_mfma_f32_16x16x32_bf16 v[232:235], a[244:247], a[4:7], v[232:235]
    buffer_load_dwordx4 v1, s[40:43], s65 offen offset:1024 nt lds
    v_mfma_f32_16x16x32_bf16 v[236:239], a[244:247], a[12:15], v[236:239]
    ds_read_b64_tr_b16 a[208:209], v4 offset:50752
    v_mfma_f32_16x16x32_bf16 v[236:239], a[240:243], a[8:11], v[236:239]
    ds_read_b64_tr_b16 a[210:211], v4 offset:51264
    v_mfma_f32_16x16x32_bf16 v[240:243], a[240:243], a[16:19], v[240:243]
    ds_read_b64_tr_b16 a[212:213], v5 offset:50752
    v_mfma_f32_16x16x32_bf16 v[240:243], a[244:247], a[20:23], v[240:243]
    s_waitcnt lgkmcnt(11)
    ds_read_b64_tr_b16 a[214:215], v5 offset:51264
    v_mfma_f32_16x16x32_bf16 v[252:255], a[252:255], a[20:23], v[252:255]
    ds_read_b64_tr_b16 a[216:217], v4 offset:50760
    v_mfma_f32_16x16x32_bf16 v[252:255], a[248:251], a[16:19], v[252:255]
    ds_read_b64_tr_b16 a[218:219], v4 offset:51272
    v_mfma_f32_16x16x32_bf16 v[248:251], a[248:251], a[8:11], v[248:251]
    ds_read_b64_tr_b16 a[220:221], v5 offset:50760
    v_mfma_f32_16x16x32_bf16 v[248:251], a[252:255], a[12:15], v[248:251]
    ds_read_b64_tr_b16 a[222:223], v5 offset:51272
    v_mfma_f32_16x16x32_bf16 v[244:247], a[252:255], a[4:7], v[244:247]
    s_waitcnt vmcnt(62) lgkmcnt(5)
    v_mfma_f32_16x16x32_bf16 v[244:247], a[248:251], a[0:3], v[244:247]
    v_mfma_f32_16x16x32_bf16 v[56:59], a[192:195], a[24:27], v[56:59]
    s_add_u32 s58, s23, 8192
    v_mfma_f32_16x16x32_bf16 v[56:59], a[196:199], a[28:31], v[56:59]
    s_xor_b32 s65, s58, s22
    v_mfma_f32_16x16x32_bf16 v[60:63], a[196:199], a[36:39], v[60:63]
    ds_read_b64_tr_b16 a[224:225], v4 offset:50816
    v_mfma_f32_16x16x32_bf16 v[60:63], a[192:195], a[32:35], v[60:63]
    ds_read_b64_tr_b16 a[226:227], v4 offset:51328
    v_mfma_f32_16x16x32_bf16 v[64:67], a[192:195], a[40:43], v[64:67]
    s_bfe_u32 s58, s58, 0x3000d
    v_mfma_f32_16x16x32_bf16 v[64:67], a[196:199], a[44:47], v[64:67]
    ds_read_b64_tr_b16 a[228:229], v5 offset:50816
    v_mfma_f32_16x16x32_bf16 v[76:79], a[204:207], a[44:47], v[76:79]
    ds_read_b64_tr_b16 a[230:231], v5 offset:51328
    v_mfma_f32_16x16x32_bf16 v[76:79], a[200:203], a[40:43], v[76:79]
    v_mfma_f32_16x16x32_bf16 v[72:75], a[200:203], a[32:35], v[72:75]
    s_mul_i32 s58, s58, 8448
    ds_read_b64_tr_b16 a[232:233], v4 offset:50824
    v_mfma_f32_16x16x32_bf16 v[72:75], a[204:207], a[36:39], v[72:75]
    s_add_u32 m0, s58, s3
    ds_read_b64_tr_b16 a[234:235], v4 offset:51336
    v_mfma_f32_16x16x32_bf16 v[68:71], a[204:207], a[28:31], v[68:71]
    buffer_load_dwordx4 v1, s[44:47], s65 offen nt lds
    v_mfma_f32_16x16x32_bf16 v[68:71], a[200:203], a[24:27], v[68:71]
    ds_read_b64_tr_b16 a[236:237], v5 offset:50824
    v_mfma_f32_16x16x32_bf16 v[80:83], a[208:211], a[24:27], v[80:83]
    s_waitcnt lgkmcnt(11)
    s_add_u32 m0, m0, 32
    ds_read_b64_tr_b16 a[238:239], v5 offset:51336
    v_mfma_f32_16x16x32_bf16 v[80:83], a[212:215], a[28:31], v[80:83]
    buffer_load_dwordx4 v1, s[44:47], s65 offen offset:1024 nt lds
    v_mfma_f32_16x16x32_bf16 v[84:87], a[212:215], a[36:39], v[84:87]
    ds_read_b64_tr_b16 a[240:241], v4 offset:50880
    v_mfma_f32_16x16x32_bf16 v[84:87], a[208:211], a[32:35], v[84:87]
    ds_read_b64_tr_b16 a[242:243], v4 offset:51392
    v_mfma_f32_16x16x32_bf16 v[88:91], a[208:211], a[40:43], v[88:91]
    ds_read_b64_tr_b16 a[244:245], v5 offset:50880
    v_mfma_f32_16x16x32_bf16 v[88:91], a[212:215], a[44:47], v[88:91]
    s_waitcnt lgkmcnt(11)
    ds_read_b64_tr_b16 a[246:247], v5 offset:51392
    v_mfma_f32_16x16x32_bf16 v[100:103], a[220:223], a[44:47], v[100:103]
    ds_read_b64_tr_b16 a[248:249], v4 offset:50888
    v_mfma_f32_16x16x32_bf16 v[100:103], a[216:219], a[40:43], v[100:103]
    ds_read_b64_tr_b16 a[250:251], v4 offset:51400
    v_mfma_f32_16x16x32_bf16 v[96:99], a[216:219], a[32:35], v[96:99]
    ds_read_b64_tr_b16 a[252:253], v5 offset:50888
    v_mfma_f32_16x16x32_bf16 v[96:99], a[220:223], a[36:39], v[96:99]
    ds_read_b64_tr_b16 a[254:255], v5 offset:51400
    v_mfma_f32_16x16x32_bf16 v[92:95], a[220:223], a[28:31], v[92:95]
    s_waitcnt vmcnt(4) lgkmcnt(5)
    v_mfma_f32_16x16x32_bf16 v[92:95], a[216:219], a[24:27], v[92:95]
    s_barrier
    v_mfma_f32_16x16x32_bf16 v[104:107], a[224:227], a[24:27], v[104:107]
    s_add_u32 s59, s23, 16384
    v_mfma_f32_16x16x32_bf16 v[104:107], a[228:231], a[28:31], v[104:107]
    s_xor_b32 s65, s59, s22
    v_mfma_f32_16x16x32_bf16 v[108:111], a[228:231], a[36:39], v[108:111]
    ds_read_b64_tr_b16 a[192:193], v4 offset:59136
    v_mfma_f32_16x16x32_bf16 v[108:111], a[224:227], a[32:35], v[108:111]
    ds_read_b64_tr_b16 a[194:195], v4 offset:59648
    v_mfma_f32_16x16x32_bf16 v[112:115], a[224:227], a[40:43], v[112:115]
    s_bfe_u32 s59, s59, 0x3000d
    v_mul_f32 v56, s14, v56
    v_mul_f32 v57, s14, v57
    v_mfma_f32_16x16x32_bf16 v[112:115], a[228:231], a[44:47], v[112:115]
    ds_read_b64_tr_b16 a[196:197], v5 offset:59136
    v_mul_f32 v58, s14, v58
    v_mfma_f32_16x16x32_bf16 v[124:127], a[236:239], a[44:47], v[124:127]
    ds_read_b64_tr_b16 a[198:199], v5 offset:59648
    v_mul_f32 v59, s14, v59
    v_mfma_f32_16x16x32_bf16 v[124:127], a[232:235], a[40:43], v[124:127]
    v_mul_f32 v68, s14, v68
    v_mul_f32 v69, s14, v69
    v_mfma_f32_16x16x32_bf16 v[120:123], a[232:235], a[32:35], v[120:123]
    s_mul_i32 s59, s59, 8448
    ds_read_b64_tr_b16 a[200:201], v4 offset:59144
    v_mul_f32 v70, s14, v70
    v_mfma_f32_16x16x32_bf16 v[120:123], a[236:239], a[36:39], v[120:123]
    s_add_u32 m0, s59, s61
    ds_read_b64_tr_b16 a[202:203], v4 offset:59656
    v_mul_f32 v71, s14, v71
    v_mfma_f32_16x16x32_bf16 v[116:119], a[236:239], a[28:31], v[116:119]
    buffer_load_dwordx4 v1, s[40:43], s65 offen nt lds
    v_mfma_f32_16x16x32_bf16 v[116:119], a[232:235], a[24:27], v[116:119]
    ds_read_b64_tr_b16 a[204:205], v5 offset:59144
    v_cvt_pk_bf16_f32 v56, v56, v57
    v_mfma_f32_16x16x32_bf16 v[128:131], a[240:243], a[24:27], v[128:131]
    s_waitcnt lgkmcnt(11)
    s_add_u32 m0, m0, 32
    ds_read_b64_tr_b16 a[206:207], v5 offset:59656
    v_cvt_pk_bf16_f32 v57, v58, v59
    v_mfma_f32_16x16x32_bf16 v[128:131], a[244:247], a[28:31], v[128:131]
    buffer_load_dwordx4 v1, s[40:43], s65 offen offset:1024 nt lds
    v_mfma_f32_16x16x32_bf16 v[132:135], a[244:247], a[36:39], v[132:135]
    ds_read_b64_tr_b16 a[208:209], v4 offset:59200
    v_cvt_pk_bf16_f32 v58, v68, v69
    v_mfma_f32_16x16x32_bf16 v[132:135], a[240:243], a[32:35], v[132:135]
    ds_read_b64_tr_b16 a[210:211], v4 offset:59712
    v_cvt_pk_bf16_f32 v59, v70, v71
    v_mfma_f32_16x16x32_bf16 v[136:139], a[240:243], a[40:43], v[136:139]
    ds_read_b64_tr_b16 a[212:213], v5 offset:59200
    v_mul_f32 v60, s14, v60
    v_mfma_f32_16x16x32_bf16 v[136:139], a[244:247], a[44:47], v[136:139]
    s_waitcnt lgkmcnt(11)
    ds_read_b64_tr_b16 a[214:215], v5 offset:59712
    v_mul_f32 v61, s14, v61
    v_mfma_f32_16x16x32_bf16 v[148:151], a[252:255], a[44:47], v[148:151]
    ds_read_b64_tr_b16 a[216:217], v4 offset:59208
    v_mul_f32 v62, s14, v62
    v_mfma_f32_16x16x32_bf16 v[148:151], a[248:251], a[40:43], v[148:151]
    ds_read_b64_tr_b16 a[218:219], v4 offset:59720
    v_mul_f32 v63, s14, v63
    v_mfma_f32_16x16x32_bf16 v[144:147], a[248:251], a[32:35], v[144:147]
    ds_read_b64_tr_b16 a[220:221], v5 offset:59208
    v_mul_f32 v72, s14, v72
    v_mfma_f32_16x16x32_bf16 v[144:147], a[252:255], a[36:39], v[144:147]
    ds_read_b64_tr_b16 a[222:223], v5 offset:59720
    v_mul_f32 v73, s14, v73
    v_mfma_f32_16x16x32_bf16 v[140:143], a[252:255], a[28:31], v[140:143]
    s_waitcnt vmcnt(62) lgkmcnt(5)
    v_mul_f32 v74, s14, v74
    v_mul_f32 v75, s14, v75
    v_mfma_f32_16x16x32_bf16 v[140:143], a[248:251], a[24:27], v[140:143]
    v_cvt_pk_bf16_f32 v60, v60, v61
    v_mfma_f32_16x16x32_bf16 v[160:163], a[192:195], a[24:27], v[160:163]
    s_add_u32 s58, s23, 16384
    v_mfma_f32_16x16x32_bf16 v[160:163], a[196:199], a[28:31], v[160:163]
    s_xor_b32 s65, s58, s22
    v_mfma_f32_16x16x32_bf16 v[164:167], a[196:199], a[36:39], v[164:167]
    ds_read_b64_tr_b16 a[224:225], v4 offset:59264
    v_mfma_f32_16x16x32_bf16 v[164:167], a[192:195], a[32:35], v[164:167]
    ds_read_b64_tr_b16 a[226:227], v4 offset:59776
    v_mfma_f32_16x16x32_bf16 v[168:171], a[192:195], a[40:43], v[168:171]
    s_bfe_u32 s58, s58, 0x3000d
    v_cvt_pk_bf16_f32 v61, v62, v63
    v_cvt_pk_bf16_f32 v62, v72, v73
    v_mfma_f32_16x16x32_bf16 v[168:171], a[196:199], a[44:47], v[168:171]
    ds_read_b64_tr_b16 a[228:229], v5 offset:59264
    v_cvt_pk_bf16_f32 v63, v74, v75
    v_mfma_f32_16x16x32_bf16 v[180:183], a[204:207], a[44:47], v[180:183]
    ds_read_b64_tr_b16 a[230:231], v5 offset:59776
    v_mul_f32 v64, s14, v64
    v_mfma_f32_16x16x32_bf16 v[180:183], a[200:203], a[40:43], v[180:183]
    v_mul_f32 v65, s14, v65
    v_mul_f32 v66, s14, v66
    v_mfma_f32_16x16x32_bf16 v[176:179], a[200:203], a[32:35], v[176:179]
    s_mul_i32 s58, s58, 8448
    ds_read_b64_tr_b16 a[232:233], v4 offset:59272
    v_mul_f32 v67, s14, v67
    v_mfma_f32_16x16x32_bf16 v[176:179], a[204:207], a[36:39], v[176:179]
    s_add_u32 m0, s58, s3
    ds_read_b64_tr_b16 a[234:235], v4 offset:59784
    v_mul_f32 v76, s14, v76
    v_mfma_f32_16x16x32_bf16 v[172:175], a[204:207], a[28:31], v[172:175]
    buffer_load_dwordx4 v1, s[44:47], s65 offen nt lds
    v_mfma_f32_16x16x32_bf16 v[172:175], a[200:203], a[24:27], v[172:175]
    ds_read_b64_tr_b16 a[236:237], v5 offset:59272
    v_mul_f32 v77, s14, v77
    v_mfma_f32_16x16x32_bf16 v[184:187], a[208:211], a[24:27], v[184:187]
    s_waitcnt lgkmcnt(11)
    s_add_u32 m0, m0, 32
    ds_read_b64_tr_b16 a[238:239], v5 offset:59784
    v_mul_f32 v78, s14, v78
    v_mfma_f32_16x16x32_bf16 v[184:187], a[212:215], a[28:31], v[184:187]
    buffer_load_dwordx4 v1, s[44:47], s65 offen offset:1024 nt lds
    v_mfma_f32_16x16x32_bf16 v[188:191], a[212:215], a[36:39], v[188:191]
    ds_read_b64_tr_b16 a[240:241], v4 offset:59328
    v_mul_f32 v79, s14, v79
    v_mfma_f32_16x16x32_bf16 v[188:191], a[208:211], a[32:35], v[188:191]
    ds_read_b64_tr_b16 a[242:243], v4 offset:59840
    v_cvt_pk_bf16_f32 v64, v64, v65
    v_mfma_f32_16x16x32_bf16 v[192:195], a[208:211], a[40:43], v[192:195]
    ds_read_b64_tr_b16 a[244:245], v5 offset:59328
    v_cvt_pk_bf16_f32 v65, v66, v67
    v_mfma_f32_16x16x32_bf16 v[192:195], a[212:215], a[44:47], v[192:195]
    s_waitcnt lgkmcnt(11)
    ds_read_b64_tr_b16 a[246:247], v5 offset:59840
    v_cvt_pk_bf16_f32 v66, v76, v77
    v_mfma_f32_16x16x32_bf16 v[204:207], a[220:223], a[44:47], v[204:207]
    ds_read_b64_tr_b16 a[248:249], v4 offset:59336
    v_cvt_pk_bf16_f32 v67, v78, v79
    v_mfma_f32_16x16x32_bf16 v[204:207], a[216:219], a[40:43], v[204:207]
    ds_read_b64_tr_b16 a[250:251], v4 offset:59848
    v_mul_f32 v80, s14, v80
    v_mfma_f32_16x16x32_bf16 v[200:203], a[216:219], a[32:35], v[200:203]
    ds_read_b64_tr_b16 a[252:253], v5 offset:59336
    v_mul_f32 v81, s14, v81
    v_mfma_f32_16x16x32_bf16 v[200:203], a[220:223], a[36:39], v[200:203]
    ds_read_b64_tr_b16 a[254:255], v5 offset:59848
    v_mul_f32 v82, s14, v82
    v_mfma_f32_16x16x32_bf16 v[196:199], a[220:223], a[28:31], v[196:199]
    s_waitcnt vmcnt(62) lgkmcnt(5)
    v_mul_f32 v83, s14, v83
    v_mul_f32 v92, s14, v92
    v_mfma_f32_16x16x32_bf16 v[196:199], a[216:219], a[24:27], v[196:199]
    s_barrier
    v_mfma_f32_16x16x32_bf16 v[208:211], a[224:227], a[24:27], v[208:211]
    s_add_u32 s59, s23, 24576
    v_mul_f32 v93, s14, v93
    v_mul_f32 v94, s14, v94
    v_mfma_f32_16x16x32_bf16 v[208:211], a[228:231], a[28:31], v[208:211]
    s_xor_b32 s65, s59, s22
    v_mul_f32 v95, s14, v95
    v_mfma_f32_16x16x32_bf16 v[212:215], a[228:231], a[36:39], v[212:215]
    v_cvt_pk_bf16_f32 v80, v80, v81
    v_cvt_pk_bf16_f32 v81, v82, v83
    v_mfma_f32_16x16x32_bf16 v[212:215], a[224:227], a[32:35], v[212:215]
    v_cvt_pk_bf16_f32 v82, v92, v93
    v_mfma_f32_16x16x32_bf16 v[216:219], a[224:227], a[40:43], v[216:219]
    s_bfe_u32 s59, s59, 0x3000d
    v_cvt_pk_bf16_f32 v83, v94, v95
    v_mul_f32 v84, s14, v84
    v_mfma_f32_16x16x32_bf16 v[216:219], a[228:231], a[44:47], v[216:219]
    v_mul_f32 v85, s14, v85
    v_mfma_f32_16x16x32_bf16 v[228:231], a[236:239], a[44:47], v[228:231]
    v_mul_f32 v86, s14, v86
    v_mul_f32 v87, s14, v87
    v_mfma_f32_16x16x32_bf16 v[228:231], a[232:235], a[40:43], v[228:231]
    v_mul_f32 v96, s14, v96
    v_mfma_f32_16x16x32_bf16 v[224:227], a[232:235], a[32:35], v[224:227]
    s_mul_i32 s59, s59, 8448
    v_mul_f32 v97, s14, v97
    v_mul_f32 v98, s14, v98
    v_mfma_f32_16x16x32_bf16 v[224:227], a[236:239], a[36:39], v[224:227]
    s_add_u32 m0, s59, s61
    v_mul_f32 v99, s14, v99
    v_mfma_f32_16x16x32_bf16 v[220:223], a[236:239], a[28:31], v[220:223]
    buffer_load_dwordx4 v1, s[40:43], s65 offen nt lds
    v_mfma_f32_16x16x32_bf16 v[220:223], a[232:235], a[24:27], v[220:223]
    v_cvt_pk_bf16_f32 v84, v84, v85
    v_cvt_pk_bf16_f32 v85, v86, v87
    v_mfma_f32_16x16x32_bf16 v[232:235], a[240:243], a[24:27], v[232:235]
    s_waitcnt lgkmcnt(4)
    s_add_u32 m0, m0, 32
    v_cvt_pk_bf16_f32 v86, v96, v97
    v_mfma_f32_16x16x32_bf16 v[232:235], a[244:247], a[28:31], v[232:235]
    buffer_load_dwordx4 v1, s[40:43], s65 offen offset:1024 nt lds
    v_mfma_f32_16x16x32_bf16 v[236:239], a[244:247], a[36:39], v[236:239]
    v_cvt_pk_bf16_f32 v87, v98, v99
    v_mul_f32 v88, s14, v88
    v_mfma_f32_16x16x32_bf16 v[236:239], a[240:243], a[32:35], v[236:239]
    v_mul_f32 v89, s14, v89
    v_mfma_f32_16x16x32_bf16 v[240:243], a[240:243], a[40:43], v[240:243]
    v_mul_f32 v90, s14, v90
    v_mul_f32 v91, s14, v91
    v_mfma_f32_16x16x32_bf16 v[240:243], a[244:247], a[44:47], v[240:243]
    s_waitcnt lgkmcnt(0)
    v_mul_f32 v100, s14, v100
    v_mfma_f32_16x16x32_bf16 v[252:255], a[252:255], a[44:47], v[252:255]
    v_mul_f32 v101, s14, v101
    v_mul_f32 v102, s14, v102
    v_mfma_f32_16x16x32_bf16 v[252:255], a[248:251], a[40:43], v[252:255]
    v_mul_f32 v103, s14, v103
    v_mfma_f32_16x16x32_bf16 v[248:251], a[248:251], a[32:35], v[248:251]
    v_cvt_pk_bf16_f32 v88, v88, v89
    v_cvt_pk_bf16_f32 v89, v90, v91
    v_mfma_f32_16x16x32_bf16 v[248:251], a[252:255], a[36:39], v[248:251]
    v_cvt_pk_bf16_f32 v90, v100, v101
    v_mfma_f32_16x16x32_bf16 v[244:247], a[252:255], a[28:31], v[244:247]
    v_cvt_pk_bf16_f32 v91, v102, v103
    v_mul_f32 v104, s14, v104
    v_mfma_f32_16x16x32_bf16 v[244:247], a[248:251], a[24:27], v[244:247]
    v_mul_f32 v105, s14, v105
    v_pk_mul_f32 v[106:107], v[106:107], s[14:15] op_sel:[0,0] op_sel_hi:[1,0]
    v_pk_mul_f32 v[116:117], v[116:117], s[14:15] op_sel:[0,0] op_sel_hi:[1,0]
    v_pk_mul_f32 v[118:119], v[118:119], s[14:15] op_sel:[0,0] op_sel_hi:[1,0]
    v_cvt_pk_bf16_f32 v104, v104, v105
    v_cvt_pk_bf16_f32 v105, v106, v107
    v_cvt_pk_bf16_f32 v106, v116, v117
    v_cvt_pk_bf16_f32 v107, v118, v119
    v_pk_mul_f32 v[108:109], v[108:109], s[14:15] op_sel:[0,0] op_sel_hi:[1,0]
    v_pk_mul_f32 v[110:111], v[110:111], s[14:15] op_sel:[0,0] op_sel_hi:[1,0]
    v_pk_mul_f32 v[120:121], v[120:121], s[14:15] op_sel:[0,0] op_sel_hi:[1,0]
    v_pk_mul_f32 v[122:123], v[122:123], s[14:15] op_sel:[0,0] op_sel_hi:[1,0]
    v_cvt_pk_bf16_f32 v108, v108, v109
    v_cvt_pk_bf16_f32 v109, v110, v111
    v_cvt_pk_bf16_f32 v110, v120, v121
    v_cvt_pk_bf16_f32 v111, v122, v123
    v_pk_mul_f32 v[112:113], v[112:113], s[14:15] op_sel:[0,0] op_sel_hi:[1,0]
    v_pk_mul_f32 v[114:115], v[114:115], s[14:15] op_sel:[0,0] op_sel_hi:[1,0]
    v_pk_mul_f32 v[124:125], v[124:125], s[14:15] op_sel:[0,0] op_sel_hi:[1,0]
    v_pk_mul_f32 v[126:127], v[126:127], s[14:15] op_sel:[0,0] op_sel_hi:[1,0]
    v_cvt_pk_bf16_f32 v112, v112, v113
    v_cvt_pk_bf16_f32 v113, v114, v115
    v_cvt_pk_bf16_f32 v114, v124, v125
    v_cvt_pk_bf16_f32 v115, v126, v127
    v_pk_mul_f32 v[128:129], v[128:129], s[14:15] op_sel:[0,0] op_sel_hi:[1,0]
    v_pk_mul_f32 v[130:131], v[130:131], s[14:15] op_sel:[0,0] op_sel_hi:[1,0]
    v_pk_mul_f32 v[140:141], v[140:141], s[14:15] op_sel:[0,0] op_sel_hi:[1,0]
    v_pk_mul_f32 v[142:143], v[142:143], s[14:15] op_sel:[0,0] op_sel_hi:[1,0]
    v_cvt_pk_bf16_f32 v128, v128, v129
    v_cvt_pk_bf16_f32 v129, v130, v131
    v_cvt_pk_bf16_f32 v130, v140, v141
    v_cvt_pk_bf16_f32 v131, v142, v143
    v_pk_mul_f32 v[132:133], v[132:133], s[14:15] op_sel:[0,0] op_sel_hi:[1,0]
    v_pk_mul_f32 v[134:135], v[134:135], s[14:15] op_sel:[0,0] op_sel_hi:[1,0]
    v_pk_mul_f32 v[144:145], v[144:145], s[14:15] op_sel:[0,0] op_sel_hi:[1,0]
    v_pk_mul_f32 v[146:147], v[146:147], s[14:15] op_sel:[0,0] op_sel_hi:[1,0]
    v_cvt_pk_bf16_f32 v132, v132, v133
    v_cvt_pk_bf16_f32 v133, v134, v135
    v_cvt_pk_bf16_f32 v134, v144, v145
    v_cvt_pk_bf16_f32 v135, v146, v147
    v_pk_mul_f32 v[136:137], v[136:137], s[14:15] op_sel:[0,0] op_sel_hi:[1,0]
    v_pk_mul_f32 v[138:139], v[138:139], s[14:15] op_sel:[0,0] op_sel_hi:[1,0]
    v_pk_mul_f32 v[148:149], v[148:149], s[14:15] op_sel:[0,0] op_sel_hi:[1,0]
    v_pk_mul_f32 v[150:151], v[150:151], s[14:15] op_sel:[0,0] op_sel_hi:[1,0]
    v_cvt_pk_bf16_f32 v136, v136, v137
    v_cvt_pk_bf16_f32 v137, v138, v139
    v_cvt_pk_bf16_f32 v138, v148, v149
    v_cvt_pk_bf16_f32 v139, v150, v151
    s_cmp_lg_u32 s67, 0
    s_cbranch_scc1 L_cv2b
    s_and_b32 s26, s26, 1023
    s_xor_b32 s26, s26, 512
    s_add_u32 s20, s26, 1048576
    s_and_b32 s75, s75, 0
    s_xor_b32 s77, s75, 128
    s_and_b32 s66, s21, 1
    s_lshl_b32 s66, s66, 6
    v_xor_b32 v158, s66, v158
    v_xor_b32 v159, s66, v159
    v_accvgpr_write_b32 a96, v56
    v_accvgpr_write_b32 a97, v57
    v_accvgpr_write_b32 a98, v58
    v_accvgpr_write_b32 a99, v59
    v_accvgpr_write_b32 a100, v60
    v_accvgpr_write_b32 a101, v61
    v_accvgpr_write_b32 a102, v62
    v_accvgpr_write_b32 a103, v63
    v_accvgpr_write_b32 a104, v64
    v_accvgpr_write_b32 a105, v65
    v_accvgpr_write_b32 a106, v66
    v_accvgpr_write_b32 a107, v67
    v_accvgpr_write_b32 a108, v80
    v_accvgpr_write_b32 a109, v81
    v_accvgpr_write_b32 a110, v82
    v_accvgpr_write_b32 a111, v83
    v_accvgpr_write_b32 a112, v84
    v_accvgpr_write_b32 a113, v85
    v_accvgpr_write_b32 a114, v86
    v_accvgpr_write_b32 a115, v87
    v_accvgpr_write_b32 a116, v88
    v_accvgpr_write_b32 a117, v89
    v_accvgpr_write_b32 a118, v90
    v_accvgpr_write_b32 a119, v91
    v_accvgpr_write_b32 a120, v104
    v_accvgpr_write_b32 a121, v105
    v_accvgpr_write_b32 a122, v106
    v_accvgpr_write_b32 a123, v107
    v_accvgpr_write_b32 a124, v108
    v_accvgpr_write_b32 a125, v109
    v_accvgpr_write_b32 a126, v110
    v_accvgpr_write_b32 a127, v111
    v_accvgpr_write_b32 a128, v112
    v_accvgpr_write_b32 a129, v113
    v_accvgpr_write_b32 a130, v114
    v_accvgpr_write_b32 a131, v115
    v_accvgpr_write_b32 a132, v128
    v_accvgpr_write_b32 a133, v129
    v_accvgpr_write_b32 a134, v130
    v_accvgpr_write_b32 a135, v131
    v_accvgpr_write_b32 a136, v132
    v_accvgpr_write_b32 a137, v133
    v_accvgpr_write_b32 a138, v134
    v_accvgpr_write_b32 a139, v135
    v_accvgpr_write_b32 a140, v136
    v_accvgpr_write_b32 a141, v137
    v_accvgpr_write_b32 a142, v138
    v_accvgpr_write_b32 a143, v139
    s_branch L_cv2c
L_cv2b:
    s_nop 7
    v_accvgpr_write_b32 a0, v56
    v_accvgpr_write_b32 a1, v57
    v_accvgpr_write_b32 a2, v58
    v_accvgpr_write_b32 a3, v59
    v_accvgpr_write_b32 a4, v60
    v_accvgpr_write_b32 a5, v61
    v_accvgpr_write_b32 a6, v62
    v_accvgpr_write_b32 a7, v63
    v_accvgpr_write_b32 a8, v64
    v_accvgpr_write_b32 a9, v65
    v_accvgpr_write_b32 a10, v66
    v_accvgpr_write_b32 a11, v67
    v_accvgpr_write_b32 a12, v80
    v_accvgpr_write_b32 a13, v81
    v_accvgpr_write_b32 a14, v82
    v_accvgpr_write_b32 a15, v83
    v_accvgpr_write_b32 a16, v84
    v_accvgpr_write_b32 a17, v85
    v_accvgpr_write_b32 a18, v86
    v_accvgpr_write_b32 a19, v87
    v_accvgpr_write_b32 a20, v88
    v_accvgpr_write_b32 a21, v89
    v_accvgpr_write_b32 a22, v90
    v_accvgpr_write_b32 a23, v91
    v_accvgpr_write_b32 a24, v104
    v_accvgpr_write_b32 a25, v105
    v_accvgpr_write_b32 a26, v106
    v_accvgpr_write_b32 a27, v107
    v_accvgpr_write_b32 a28, v108
    v_accvgpr_write_b32 a29, v109
    v_accvgpr_write_b32 a30, v110
    v_accvgpr_write_b32 a31, v111
    v_accvgpr_write_b32 a32, v112
    v_accvgpr_write_b32 a33, v113
    v_accvgpr_write_b32 a34, v114
    v_accvgpr_write_b32 a35, v115
    v_accvgpr_write_b32 a36, v128
    v_accvgpr_write_b32 a37, v129
    v_accvgpr_write_b32 a38, v130
    v_accvgpr_write_b32 a39, v131
    v_accvgpr_write_b32 a40, v132
    v_accvgpr_write_b32 a41, v133
    v_accvgpr_write_b32 a42, v134
    v_accvgpr_write_b32 a43, v135
    v_accvgpr_write_b32 a44, v136
    v_accvgpr_write_b32 a45, v137
    v_accvgpr_write_b32 a46, v138
    v_accvgpr_write_b32 a47, v139
    s_cmp_lg_u32 s60, 0
    s_cbranch_scc1 L_boot_18
    s_lshl_b32 s66, s74, 2
    s_add_u32 s66, s66, 128
    v_mov_b32 v157, s66
    s_getreg_b32 s69, hwreg(HW_REG_XCC_ID, 0, 4)
    s_mul_i32 s70, s69, s69
    s_lshl_b32 s70, s70, 8
    s_add_u32 s70, s70, s69
    s_lshl_b32 s70, s70, 8
    s_add_u32 s24, s70, 1
    v_mov_b32 v158, s24
    s_mov_b64 exec, 1
    global_atomic_add v157, v158, s[18:19]
    s_mov_b64 exec, -1
L_boot_18:
L_cv2c:
    v_pk_mul_f32 v[160:161], v[160:161], s[14:15] op_sel:[0,0] op_sel_hi:[1,0]
    v_pk_mul_f32 v[162:163], v[162:163], s[14:15] op_sel:[0,0] op_sel_hi:[1,0]
    v_pk_mul_f32 v[172:173], v[172:173], s[14:15] op_sel:[0,0] op_sel_hi:[1,0]
    v_pk_mul_f32 v[174:175], v[174:175], s[14:15] op_sel:[0,0] op_sel_hi:[1,0]
    v_cvt_pk_bf16_f32 v12, v160, v161
    v_cvt_pk_bf16_f32 v13, v162, v163
    v_cvt_pk_bf16_f32 v14, v172, v173
    v_cvt_pk_bf16_f32 v15, v174, v175
    v_pk_mul_f32 v[164:165], v[164:165], s[14:15] op_sel:[0,0] op_sel_hi:[1,0]
    v_pk_mul_f32 v[166:167], v[166:167], s[14:15] op_sel:[0,0] op_sel_hi:[1,0]
    v_pk_mul_f32 v[176:177], v[176:177], s[14:15] op_sel:[0,0] op_sel_hi:[1,0]
    v_pk_mul_f32 v[178:179], v[178:179], s[14:15] op_sel:[0,0] op_sel_hi:[1,0]
    v_cvt_pk_bf16_f32 v28, v164, v165
    v_cvt_pk_bf16_f32 v29, v166, v167
    v_cvt_pk_bf16_f32 v30, v176, v177
    v_cvt_pk_bf16_f32 v31, v178, v179
    v_pk_mul_f32 v[168:169], v[168:169], s[14:15] op_sel:[0,0] op_sel_hi:[1,0]
    v_pk_mul_f32 v[170:171], v[170:171], s[14:15] op_sel:[0,0] op_sel_hi:[1,0]
    v_pk_mul_f32 v[180:181], v[180:181], s[14:15] op_sel:[0,0] op_sel_hi:[1,0]
    v_pk_mul_f32 v[182:183], v[182:183], s[14:15] op_sel:[0,0] op_sel_hi:[1,0]
    v_cvt_pk_bf16_f32 v44, v168, v169
    v_cvt_pk_bf16_f32 v45, v170, v171
    v_cvt_pk_bf16_f32 v46, v180, v181
    v_cvt_pk_bf16_f32 v47, v182, v183
    v_pk_mul_f32 v[184:185], v[184:185], s[14:15] op_sel:[0,0] op_sel_hi:[1,0]
    v_pk_mul_f32 v[186:187], v[186:187], s[14:15] op_sel:[0,0] op_sel_hi:[1,0]
    v_pk_mul_f32 v[196:197], v[196:197], s[14:15] op_sel:[0,0] op_sel_hi:[1,0]
    v_pk_mul_f32 v[198:199], v[198:199], s[14:15] op_sel:[0,0] op_sel_hi:[1,0]
    v_cvt_pk_bf16_f32 v16, v184, v185
    v_cvt_pk_bf16_f32 v17, v186, v187
    v_cvt_pk_bf16_f32 v18, v196, v197
    v_cvt_pk_bf16_f32 v19, v198, v199
    v_pk_mul_f32 v[188:189], v[188:189], s[14:15] op_sel:[0,0] op_sel_hi:[1,0]
    v_pk_mul_f32 v[190:191], v[190:191], s[14:15] op_sel:[0,0] op_sel_hi:[1,0]
    v_pk_mul_f32 v[200:201], v[200:201], s[14:15] op_sel:[0,0] op_sel_hi:[1,0]
    v_pk_mul_f32 v[202:203], v[202:203], s[14:15] op_sel:[0,0] op_sel_hi:[1,0]
    v_cvt_pk_bf16_f32 v32, v188, v189
    v_cvt_pk_bf16_f32 v33, v190, v191
    v_cvt_pk_bf16_f32 v34, v200, v201
    v_cvt_pk_bf16_f32 v35, v202, v203
    v_pk_mul_f32 v[192:193], v[192:193], s[14:15] op_sel:[0,0] op_sel_hi:[1,0]
    v_pk_mul_f32 v[194:195], v[194:195], s[14:15] op_sel:[0,0] op_sel_hi:[1,0]
    v_pk_mul_f32 v[204:205], v[204:205], s[14:15] op_sel:[0,0] op_sel_hi:[1,0]
    v_pk_mul_f32 v[206:207], v[206:207], s[14:15] op_sel:[0,0] op_sel_hi:[1,0]
    v_cvt_pk_bf16_f32 v48, v192, v193
    v_cvt_pk_bf16_f32 v49, v194, v195
    v_cvt_pk_bf16_f32 v50, v204, v205
    v_cvt_pk_bf16_f32 v51, v206, v207
    v_pk_mul_f32 v[208:209], v[208:209], s[14:15] op_sel:[0,0] op_sel_hi:[1,0]
    v_pk_mul_f32 v[210:211], v[210:211], s[14:15] op_sel:[0,0] op_sel_hi:[1,0]
    v_pk_mul_f32 v[220:221], v[220:221], s[14:15] op_sel:[0,0] op_sel_hi:[1,0]
    v_pk_mul_f32 v[222:223], v[222:223], s[14:15] op_sel:[0,0] op_sel_hi:[1,0]
    v_cvt_pk_bf16_f32 v20, v208, v209
    v_cvt_pk_bf16_f32 v21, v210, v211
    v_cvt_pk_bf16_f32 v22, v220, v221
    v_cvt_pk_bf16_f32 v23, v222, v223
    v_pk_mul_f32 v[212:213], v[212:213], s[14:15] op_sel:[0,0] op_sel_hi:[1,0]
    v_pk_mul_f32 v[214:215], v[214:215], s[14:15] op_sel:[0,0] op_sel_hi:[1,0]
    v_pk_mul_f32 v[224:225], v[224:225], s[14:15] op_sel:[0,0] op_sel_hi:[1,0]
    v_pk_mul_f32 v[226:227], v[226:227], s[14:15] op_sel:[0,0] op_sel_hi:[1,0]
    v_cvt_pk_bf16_f32 v36, v212, v213
    v_cvt_pk_bf16_f32 v37, v214, v215
    v_cvt_pk_bf16_f32 v38, v224, v225
    v_cvt_pk_bf16_f32 v39, v226, v227
    v_pk_mul_f32 v[216:217], v[216:217], s[14:15] op_sel:[0,0] op_sel_hi:[1,0]
    v_pk_mul_f32 v[218:219], v[218:219], s[14:15] op_sel:[0,0] op_sel_hi:[1,0]
    v_pk_mul_f32 v[228:229], v[228:229], s[14:15] op_sel:[0,0] op_sel_hi:[1,0]
    v_pk_mul_f32 v[230:231], v[230:231], s[14:15] op_sel:[0,0] op_sel_hi:[1,0]
    v_cvt_pk_bf16_f32 v52, v216, v217
    v_cvt_pk_bf16_f32 v53, v218, v219
    v_cvt_pk_bf16_f32 v54, v228, v229
    v_cvt_pk_bf16_f32 v55, v230, v231
    v_pk_mul_f32 v[232:233], v[232:233], s[14:15] op_sel:[0,0] op_sel_hi:[1,0]
    v_pk_mul_f32 v[234:235], v[234:235], s[14:15] op_sel:[0,0] op_sel_hi:[1,0]
    v_pk_mul_f32 v[244:245], v[244:245], s[14:15] op_sel:[0,0] op_sel_hi:[1,0]
    v_pk_mul_f32 v[246:247], v[246:247], s[14:15] op_sel:[0,0] op_sel_hi:[1,0]
    v_cvt_pk_bf16_f32 v24, v232, v233
    v_cvt_pk_bf16_f32 v25, v234, v235
    v_cvt_pk_bf16_f32 v26, v244, v245
    v_cvt_pk_bf16_f32 v27, v246, v247
    v_pk_mul_f32 v[236:237], v[236:237], s[14:15] op_sel:[0,0] op_sel_hi:[1,0]
    v_pk_mul_f32 v[238:239], v[238:239], s[14:15] op_sel:[0,0] op_sel_hi:[1,0]
    v_pk_mul_f32 v[248:249], v[248:249], s[14:15] op_sel:[0,0] op_sel_hi:[1,0]
    v_pk_mul_f32 v[250:251], v[250:251], s[14:15] op_sel:[0,0] op_sel_hi:[1,0]
    v_cvt_pk_bf16_f32 v40, v236, v237
    v_cvt_pk_bf16_f32 v41, v238, v239
    v_cvt_pk_bf16_f32 v42, v248, v249
    v_cvt_pk_bf16_f32 v43, v250, v251
    v_pk_mul_f32 v[240:241], v[240:241], s[14:15] op_sel:[0,0] op_sel_hi:[1,0]
    v_pk_mul_f32 v[242:243], v[242:243], s[14:15] op_sel:[0,0] op_sel_hi:[1,0]
    v_pk_mul_f32 v[252:253], v[252:253], s[14:15] op_sel:[0,0] op_sel_hi:[1,0]
    v_pk_mul_f32 v[254:255], v[254:255], s[14:15] op_sel:[0,0] op_sel_hi:[1,0]
    v_cvt_pk_bf16_f32 v56, v240, v241
    v_cvt_pk_bf16_f32 v57, v242, v243
    v_cvt_pk_bf16_f32 v58, v252, v253
    v_cvt_pk_bf16_f32 v59, v254, v255
L_enter:
    v_mov_b32 v7, 0x3f803f80
    v_and_b32 v8, 3, v0
    v_cmp_eq_u32 vcc, 0, v8
    s_nop 1
    v_cndmask_b32 v7, 0, v7, vcc
    v_accvgpr_write_b32 a204, v7
    v_accvgpr_write_b32 a205, v7
    v_accvgpr_write_b32 a206, v7
    v_accvgpr_write_b32 a207, v7
    s_add_u32 s57, s23, 32768
    s_mov_b32 s76, 0
    s_cmp_eq_u32 s31, 0
    s_cselect_b32 s56, 0, 5
    s_mov_b32 s62, 5
    s_waitcnt vmcnt(12)
    s_barrier
    ds_read_b128 v[120:123], v2 offset:0
    ds_read_b128 v[124:127], v2 offset:64
    ds_read_b128 v[128:131], v2 offset:128
    ds_read_b128 v[132:135], v2 offset:192
    ds_read_b128 v[136:139], v2 offset:512
    ds_read_b128 v[140:143], v2 offset:576
    ds_read_b128 v[144:147], v2 offset:640
    ds_read_b128 v[148:151], v2 offset:704
    s_add_u32 s58, s23, 24576
    s_xor_b32 s64, s58, s22
    s_bfe_u32 s58, s58, 0x3000d
    s_mul_i32 s58, s58, 8448
    s_add_u32 s59, s23, 32768
    s_xor_b32 s65, s59, s22
    s_bfe_u32 s59, s59, 0x3000d
    s_mul_i32 s59, s59, 8448
    s_waitcnt lgkmcnt(0)
L_head:
    v_mfma_f32_16x16x32_bf16 v[72:75], v[120:123], v[12:15], 0
    v_mfma_f32_16x16x32_bf16 v[72:75], v[124:127], v[16:19], v[72:75]
    v_mfma_f32_16x16x32_bf16 v[72:75], v[128:131], v[20:23], v[72:75]
    s_waitcnt vmcnt(8)
    v_mfma_f32_16x16x32_bf16 v[72:75], v[132:135], v[24:27], v[72:75]
    s_getreg_b32 s25, hwreg(HW_REG_IB_STS, 0, 4)
    v_mfma_f32_16x16x32_bf16 v[76:79], v[120:123], v[28:31], 0
    s_cmp_ge_u32 s25, s56
    v_mfma_f32_16x16x32_bf16 v[76:79], v[124:127], v[32:35], v[76:79]
    v_mfma_f32_16x16x32_bf16 v[76:79], v[128:131], v[36:39], v[76:79]
    v_mfma_f32_16x16x32_bf16 v[76:79], v[132:135], v[40:43], v[76:79]
    v_mfma_f32_16x16x32_bf16 v[80:83], v[120:123], v[44:47], 0
    v_mfma_f32_16x16x32_bf16 v[80:83], v[124:127], v[48:51], v[80:83]
    v_mfma_f32_16x16x32_bf16 v[80:83], v[128:131], v[52:55], v[80:83]
    v_mfma_f32_16x16x32_bf16 v[80:83], v[132:135], v[56:59], v[80:83]
    s_nop 7
.p2align 6
L_head2:
    v_max3_f32 v60, v72, v73, v74
    v_max3_f32 v64, v76, v77, v78
    v_max3_f32 v68, v80, v81, v82
    v_max_f32 v60, v60, v75
    v_max_f32 v64, v64, v79
    v_max_f32 v68, v68, v83
    v_mov_b32 v61, v60
    v_mov_b32 v65, v64
    v_mov_b32 v69, v68
    v_permlane32_swap_b32 v60, v61
    v_permlane32_swap_b32 v64, v65
    v_permlane32_swap_b32 v68, v69
    v_max_f32 v60, v60, v61
    v_max_f32 v64, v64, v65
    v_max_f32 v68, v68, v69
    v_mov_b32 v61, v60
    v_mov_b32 v65, v64
    v_mov_b32 v69, v68
    v_permlane16_swap_b32 v60, v61
    v_permlane16_swap_b32 v64, v65
    v_permlane16_swap_b32 v68, v69
    v_max_f32 v60, v60, v61
    v_max_f32 v64, v64, v65
    v_max_f32 v68, v68, v69
    v_pk_mul_f32 v[62:63], v[60:61], -1.0 op_sel_hi:[0,0]
    v_pk_mul_f32 v[60:61], v[60:61], -1.0 op_sel_hi:[0,0]
    v_pk_mul_f32 v[66:67], v[64:65], -1.0 op_sel_hi:[0,0]
    v_pk_mul_f32 v[64:65], v[64:65], -1.0 op_sel_hi:[0,0]
    v_pk_mul_f32 v[70:71], v[68:69], -1.0 op_sel_hi:[0,0]
    v_pk_mul_f32 v[68:69], v[68:69], -1.0 op_sel_hi:[0,0]
    s_cbranch_scc1 L_df_19
L_df_19i:
    v_mfma_f32_16x16x32_bf16 v[84:87], v[136:139], v[12:15], v[60:63]
    s_barrier
    ds_read_b128 v[120:123], v2 offset:8448
    v_add_f32 v72, v72, v60
    v_mfma_f32_16x16x32_bf16 v[84:87], v[140:143], v[16:19], v[84:87]
    s_add_u32 m0, s58, s3
    v_add_f32 v73, v73, v60
    v_add_f32 v74, v74, v60
    v_mfma_f32_16x16x32_bf16 v[84:87], v[144:147], v[20:23], v[84:87]
    buffer_load_dwordx4 v1, s[44:47], s64 offen nt lds
    v_mfma_f32_16x16x32_bf16 v[84:87], v[148:151], v[24:27], v[84:87]
    ds_read_b128 v[124:127], v2 offset:8512
    v_add_f32 v75, v75, v60
    v_mfma_f32_16x16x32_bf16 v[88:91], v[136:139], v[28:31], v[64:67]
    s_add_u32 m0, m0, 32
    v_add_f32 v76, v76, v64
    v_add_f32 v77, v77, v64
    v_mfma_f32_16x16x32_bf16 v[88:91], v[140:143], v[32:35], v[88:91]
    buffer_load_dwordx4 v1, s[44:47], s64 offen offset:1024 nt lds
    v_mfma_f32_16x16x32_bf16 v[88:91], v[144:147], v[36:39], v[88:91]
    s_mov_b32 s64, s65
    ds_read_b128 v[128:131], v2 offset:8576
    v_add_f32 v78, v78, v64
    v_mfma_f32_16x16x32_bf16 v[88:91], v[148:151], v[40:43], v[88:91]
    s_add_u32 m0, s59, s61
    v_add_f32 v79, v79, v64
    v_add_f32 v80, v80, v68
    v_mfma_f32_16x16x32_bf16 v[92:95], v[136:139], v[44:47], v[68:71]
    s_mov_b32 s58, s59
    buffer_load_dwordx4 v1, s[40:43], s65 offen nt lds
    v_mfma_f32_16x16x32_bf16 v[92:95], v[140:143], v[48:51], v[92:95]
    s_add_u32 s57, s57, 8192
    ds_read_b128 v[132:135], v2 offset:8640
    v_add_f32 v81, v81, v68
    v_mfma_f32_16x16x32_bf16 v[92:95], v[144:147], v[52:55], v[92:95]
    s_add_u32 m0, m0, 32
    v_add_f32 v82, v82, v68
    v_add_f32 v83, v83, v68
    v_mfma_f32_16x16x32_bf16 v[92:95], v[148:151], v[56:59], v[92:95]
    buffer_load_dwordx4 v1, s[40:43], s65 offen offset:1024 nt lds
L_dfb_20:
    v_exp_f32 v72, v72
    v_exp_f32 v73, v73
    v_exp_f32 v74, v74
    v_exp_f32 v75, v75
    v_exp_f32 v76, v76
    v_exp_f32 v77, v77
    v_exp_f32 v78, v78
    v_exp_f32 v79, v79
    v_exp_f32 v80, v80
    v_exp_f32 v81, v81
    v_exp_f32 v82, v82
    v_exp_f32 v83, v83
    v_exp_f32 v84, v84
    v_exp_f32 v85, v85
    v_exp_f32 v86, v86
    v_exp_f32 v87, v87
    v_exp_f32 v88, v88
    v_exp_f32 v89, v89
    v_exp_f32 v90, v90
    v_exp_f32 v91, v91
    v_cvt_pk_bf16_f32 v96, v72, v73
    v_cvt_pk_bf16_f32 v97, v74, v75
    v_cvt_pk_bf16_f32 v100, v76, v77
    v_cvt_pk_bf16_f32 v101, v78, v79
    v_cvt_pk_bf16_f32 v104, v80, v81
    v_cvt_pk_bf16_f32 v105, v82, v83
    s_waitcnt lgkmcnt(0)
    v_mfma_f32_16x16x32_bf16 v[72:75], v[120:123], v[12:15], v[60:63]
    ds_read_b64_tr_b16 v[136:137], v3 offset:0
    v_cvt_pk_bf16_f32 v98, v84, v85
    v_mfma_f32_16x16x32_bf16 v[72:75], v[124:127], v[16:19], v[72:75]
    s_xor_b32 s65, s57, s22
    ds_read_b64_tr_b16 v[138:139], v3 offset:512
    v_cvt_pk_bf16_f32 v99, v86, v87
    v_mfma_f32_16x16x32_bf16 v[72:75], v[128:131], v[20:23], v[72:75]
    s_bfe_u32 s59, s57, 0x3000d
    v_exp_f32 v92, v92
    v_mfma_f32_16x16x32_bf16 v[72:75], v[132:135], v[24:27], v[72:75]
    s_mul_i32 s59, s59, 8448
    v_exp_f32 v93, v93
    v_mfma_f32_16x16x32_bf16 v[76:79], v[132:135], v[40:43], v[64:67]
    ds_read_b64_tr_b16 v[140:141], v3 offset:32
    v_cvt_pk_bf16_f32 v102, v88, v89
    v_mfma_f32_16x16x32_bf16 v[76:79], v[128:131], v[36:39], v[76:79]
    ds_read_b64_tr_b16 v[142:143], v3 offset:544
    v_cvt_pk_bf16_f32 v103, v90, v91
    v_mfma_f32_16x16x32_bf16 v[76:79], v[124:127], v[32:35], v[76:79]
    v_exp_f32 v94, v94
    v_mfma_f32_16x16x32_bf16 v[76:79], v[120:123], v[28:31], v[76:79]
    v_exp_f32 v95, v95
    v_mfma_f32_16x16x32_bf16 v[80:83], v[120:123], v[44:47], v[68:71]
    ds_read_b64_tr_b16 v[144:145], v3 offset:64
    v_cvt_pk_bf16_f32 v106, v92, v93
    v_mfma_f32_16x16x32_bf16 v[80:83], v[124:127], v[48:51], v[80:83]
    ds_read_b64_tr_b16 v[146:147], v3 offset:576
    v_cvt_pk_bf16_f32 v107, v94, v95
    v_mfma_f32_16x16x32_bf16 v[80:83], v[128:131], v[52:55], v[80:83]
    ds_read_b64_tr_b16 v[148:149], v3 offset:96
    v_mfma_f32_16x16x32_bf16 v[80:83], v[132:135], v[56:59], v[80:83]
    s_waitcnt lgkmcnt(5)
    ds_read_b64_tr_b16 v[150:151], v3 offset:608
    v_mfma_f32_16x16x32_bf16 v[160:163], v[136:139], v[96:99], 0
    ds_read_b128 v[120:123], v2 offset:8960
    v_mfma_f32_16x16x32_bf16 v[164:167], v[136:139], v[100:103], 0
    ds_read_b128 v[124:127], v2 offset:9024
    v_mfma_f32_16x16x32_bf16 v[168:171], v[136:139], v[104:107], 0
    s_waitcnt lgkmcnt(6)
    ds_read_b128 v[128:131], v2 offset:9088
    v_mfma_f32_16x16x32_bf16 v[180:183], v[140:143], v[104:107], 0
    ds_read_b128 v[132:135], v2 offset:9152
    v_mfma_f32_16x16x32_bf16 v[176:179], v[140:143], v[100:103], 0
    v_exp_f32 v72, v72
    v_mfma_f32_16x16x32_bf16 v[172:175], v[140:143], v[96:99], 0
    s_waitcnt lgkmcnt(6)
    v_exp_f32 v73, v73
    v_mfma_f32_16x16x32_bf16 v[184:187], v[144:147], v[96:99], 0
    v_exp_f32 v74, v74
    v_mfma_f32_16x16x32_bf16 v[188:191], v[144:147], v[100:103], 0
    v_exp_f32 v75, v75
    v_mfma_f32_16x16x32_bf16 v[192:195], v[144:147], v[104:107], 0
    s_waitcnt lgkmcnt(4)
    v_exp_f32 v76, v76
    v_mfma_f32_16x16x32_bf16 v[204:207], v[148:151], v[104:107], 0
    v_exp_f32 v77, v77
    v_mfma_f32_16x16x32_bf16 v[200:203], v[148:151], v[100:103], 0
    s_waitcnt lgkmcnt(0)
    v_exp_f32 v78, v78
    v_mfma_f32_16x16x32_bf16 v[196:199], v[148:151], v[96:99], 0
    v_exp_f32 v79, v79
    v_mfma_f32_16x16x32_bf16 v[84:87], v[120:123], v[12:15], v[60:63]
    ds_read_b64_tr_b16 v[136:137], v3 offset:128
    v_cvt_pk_bf16_f32 v108, v72, v73
    v_mfma_f32_16x16x32_bf16 v[84:87], v[124:127], v[16:19], v[84:87]
    ds_read_b64_tr_b16 v[138:139], v3 offset:640
    v_cvt_pk_bf16_f32 v109, v74, v75
    v_mfma_f32_16x16x32_bf16 v[84:87], v[128:131], v[20:23], v[84:87]
    v_exp_f32 v80, v80
    v_mfma_f32_16x16x32_bf16 v[84:87], v[132:135], v[24:27], v[84:87]
    v_exp_f32 v81, v81
    v_mfma_f32_16x16x32_bf16 v[88:91], v[132:135], v[40:43], v[64:67]
    ds_read_b64_tr_b16 v[140:141], v3 offset:160
    v_cvt_pk_bf16_f32 v112, v76, v77
    v_mfma_f32_16x16x32_bf16 v[88:91], v[128:131], v[36:39], v[88:91]
    ds_read_b64_tr_b16 v[142:143], v3 offset:672
    v_cvt_pk_bf16_f32 v113, v78, v79
    v_mfma_f32_16x16x32_bf16 v[88:91], v[124:127], v[32:35], v[88:91]
    v_exp_f32 v82, v82
    v_mfma_f32_16x16x32_bf16 v[88:91], v[120:123], v[28:31], v[88:91]
    v_exp_f32 v83, v83
    v_mfma_f32_16x16x32_bf16 v[92:95], v[120:123], v[44:47], v[68:71]
    s_waitcnt vmcnt(8)
    ds_read_b64_tr_b16 v[144:145], v3 offset:192
    v_cvt_pk_bf16_f32 v116, v80, v81
    v_mfma_f32_16x16x32_bf16 v[92:95], v[124:127], v[48:51], v[92:95]
    s_getreg_b32 s25, hwreg(HW_REG_IB_STS, 0, 4)
    ds_read_b64_tr_b16 v[146:147], v3 offset:704
    v_cvt_pk_bf16_f32 v117, v82, v83
    v_mfma_f32_16x16x32_bf16 v[92:95], v[128:131], v[52:55], v[92:95]
    s_cmp_ge_u32 s25, s56
    ds_read_b64_tr_b16 v[148:149], v3 offset:224
    v_mfma_f32_16x16x32_bf16 v[92:95], v[132:135], v[56:59], v[92:95]
    ds_read_b64_tr_b16 v[150:151], v3 offset:736
    s_cbranch_scc1 L_df_21
L_df_21i:
    v_mfma_f32_16x16x32_bf16 a[200:203], a[204:207], v[104:107], 0
    s_barrier
    ds_read_b128 v[120:123], v2 offset:16896
    v_mfma_f32_16x16x32_bf16 a[196:199], a[204:207], v[100:103], 0
    s_waitcnt lgkmcnt(5)
    ds_read_b128 v[124:127], v2 offset:16960
    v_mfma_f32_16x16x32_bf16 a[192:195], a[204:207], v[96:99], 0
    ds_read_b128 v[128:131], v2 offset:17024
    v_mfma_f32_16x16x32_bf16 v[208:211], v[136:139], v[96:99], 0
    s_add_u32 s57, s57, 8192
    ds_read_b128 v[132:135], v2 offset:17088
    v_exp_f32 v84, v84
    v_mfma_f32_16x16x32_bf16 v[212:215], v[136:139], v[100:103], 0
    s_add_u32 m0, s58, s3
    v_exp_f32 v85, v85
    v_mfma_f32_16x16x32_bf16 v[216:219], v[136:139], v[104:107], 0
    buffer_load_dwordx4 v1, s[44:47], s64 offen nt lds
    v_mfma_f32_16x16x32_bf16 v[228:231], v[140:143], v[104:107], 0
    s_waitcnt lgkmcnt(4)
    v_exp_f32 v86, v86
    v_mfma_f32_16x16x32_bf16 v[224:227], v[140:143], v[100:103], 0
    s_add_u32 m0, m0, 32
    v_exp_f32 v87, v87
    v_mfma_f32_16x16x32_bf16 v[220:223], v[140:143], v[96:99], 0
    buffer_load_dwordx4 v1, s[44:47], s64 offen offset:1024 nt lds
    v_mfma_f32_16x16x32_bf16 v[232:235], v[144:147], v[96:99], 0
    s_mov_b32 s64, s65
    v_exp_f32 v88, v88
    v_mfma_f32_16x16x32_bf16 v[236:239], v[144:147], v[100:103], 0
    s_add_u32 m0, s59, s61
    v_exp_f32 v89, v89
    v_mfma_f32_16x16x32_bf16 v[240:243], v[144:147], v[104:107], 0
    s_mov_b32 s58, s59
    buffer_load_dwordx4 v1, s[40:43], s65 offen nt lds
    v_mfma_f32_16x16x32_bf16 v[252:255], v[148:151], v[104:107], 0
    s_waitcnt lgkmcnt(0)
    v_exp_f32 v90, v90
    v_mfma_f32_16x16x32_bf16 v[248:251], v[148:151], v[100:103], 0
    s_add_u32 m0, m0, 32
    v_exp_f32 v91, v91
    v_mfma_f32_16x16x32_bf16 v[244:247], v[148:151], v[96:99], 0
    buffer_load_dwordx4 v1, s[40:43], s65 offen offset:1024 nt lds
L_dfb_22:
    v_mfma_f32_16x16x32_bf16 v[72:75], v[120:123], v[12:15], v[60:63]
    ds_read_b64_tr_b16 v[136:137], v3 offset:8448
    v_cvt_pk_bf16_f32 v110, v84, v85
    v_mfma_f32_16x16x32_bf16 v[72:75], v[124:127], v[16:19], v[72:75]
    s_xor_b32 s65, s57, s22
    ds_read_b64_tr_b16 v[138:139], v3 offset:8960
    v_cvt_pk_bf16_f32 v111, v86, v87
    v_mfma_f32_16x16x32_bf16 v[72:75], v[128:131], v[20:23], v[72:75]
    s_bfe_u32 s59, s57, 0x3000d
    v_exp_f32 v92, v92
    v_mfma_f32_16x16x32_bf16 v[72:75], v[132:135], v[24:27], v[72:75]
    s_mul_i32 s59, s59, 8448
    v_exp_f32 v93, v93
    v_mfma_f32_16x16x32_bf16 v[76:79], v[132:135], v[40:43], v[64:67]
    ds_read_b64_tr_b16 v[140:141], v3 offset:8480
    v_cvt_pk_bf16_f32 v114, v88, v89
    v_mfma_f32_16x16x32_bf16 v[76:79], v[128:131], v[36:39], v[76:79]
    ds_read_b64_tr_b16 v[142:143], v3 offset:8992
    v_cvt_pk_bf16_f32 v115, v90, v91
    v_mfma_f32_16x16x32_bf16 v[76:79], v[124:127], v[32:35], v[76:79]
    v_exp_f32 v94, v94
    v_mfma_f32_16x16x32_bf16 v[76:79], v[120:123], v[28:31], v[76:79]
    v_exp_f32 v95, v95
    v_mfma_f32_16x16x32_bf16 v[80:83], v[120:123], v[44:47], v[68:71]
    ds_read_b64_tr_b16 v[144:145], v3 offset:8512
    v_cvt_pk_bf16_f32 v118, v92, v93
    v_mfma_f32_16x16x32_bf16 v[80:83], v[124:127], v[48:51], v[80:83]
    ds_read_b64_tr_b16 v[146:147], v3 offset:9024
    v_cvt_pk_bf16_f32 v119, v94, v95
    v_mfma_f32_16x16x32_bf16 v[80:83], v[128:131], v[52:55], v[80:83]
    ds_read_b64_tr_b16 v[148:149], v3 offset:8544
    v_mfma_f32_16x16x32_bf16 v[80:83], v[132:135], v[56:59], v[80:83]
    s_waitcnt lgkmcnt(5)
    ds_read_b64_tr_b16 v[150:151], v3 offset:9056
    v_mfma_f32_16x16x32_bf16 v[160:163], v[136:139], v[108:111], v[160:163]
    ds_read_b128 v[120:123], v2 offset:17408
    v_mfma_f32_16x16x32_bf16 v[164:167], v[136:139], v[112:115], v[164:167]
    ds_read_b128 v[124:127], v2 offset:17472
    v_mfma_f32_16x16x32_bf16 v[168:171], v[136:139], v[116:119], v[168:171]
    s_waitcnt lgkmcnt(6)
    ds_read_b128 v[128:131], v2 offset:17536
    v_mfma_f32_16x16x32_bf16 v[180:183], v[140:143], v[116:119], v[180:183]
    ds_read_b128 v[132:135], v2 offset:17600
    v_mfma_f32_16x16x32_bf16 v[176:179], v[140:143], v[112:115], v[176:179]
    v_exp_f32 v72, v72
    v_mfma_f32_16x16x32_bf16 v[172:175], v[140:143], v[108:111], v[172:175]
    s_waitcnt lgkmcnt(6)
    v_exp_f32 v73, v73
    v_mfma_f32_16x16x32_bf16 v[184:187], v[144:147], v[108:111], v[184:187]
    v_exp_f32 v74, v74
    v_mfma_f32_16x16x32_bf16 v[188:191], v[144:147], v[112:115], v[188:191]
    v_exp_f32 v75, v75
    v_mfma_f32_16x16x32_bf16 v[192:195], v[144:147], v[116:119], v[192:195]
    s_waitcnt lgkmcnt(4)
    v_exp_f32 v76, v76
    v_mfma_f32_16x16x32_bf16 v[204:207], v[148:151], v[116:119], v[204:207]
    v_exp_f32 v77, v77
    v_mfma_f32_16x16x32_bf16 v[200:203], v[148:151], v[112:115], v[200:203]
    s_waitcnt lgkmcnt(0)
    v_exp_f32 v78, v78
    v_mfma_f32_16x16x32_bf16 v[196:199], v[148:151], v[108:111], v[196:199]
    v_exp_f32 v79, v79
    v_mfma_f32_16x16x32_bf16 v[84:87], v[120:123], v[12:15], v[60:63]
    ds_read_b64_tr_b16 v[136:137], v3 offset:8576
    v_cvt_pk_bf16_f32 v96, v72, v73
    v_mfma_f32_16x16x32_bf16 v[84:87], v[124:127], v[16:19], v[84:87]
    ds_read_b64_tr_b16 v[138:139], v3 offset:9088
    v_cvt_pk_bf16_f32 v97, v74, v75
    v_mfma_f32_16x16x32_bf16 v[84:87], v[128:131], v[20:23], v[84:87]
    v_exp_f32 v80, v80
    v_mfma_f32_16x16x32_bf16 v[84:87], v[132:135], v[24:27], v[84:87]
    v_exp_f32 v81, v81
    v_mfma_f32_16x16x32_bf16 v[88:91], v[132:135], v[40:43], v[64:67]
    ds_read_b64_tr_b16 v[140:141], v3 offset:8608
    v_cvt_pk_bf16_f32 v100, v76, v77
    v_mfma_f32_16x16x32_bf16 v[88:91], v[128:131], v[36:39], v[88:91]
    ds_read_b64_tr_b16 v[142:143], v3 offset:9120
    v_cvt_pk_bf16_f32 v101, v78, v79
    v_mfma_f32_16x16x32_bf16 v[88:91], v[124:127], v[32:35], v[88:91]
    v_exp_f32 v82, v82
    v_mfma_f32_16x16x32_bf16 v[88:91], v[120:123], v[28:31], v[88:91]
    v_exp_f32 v83, v83
    v_mfma_f32_16x16x32_bf16 v[92:95], v[120:123], v[44:47], v[68:71]
    s_waitcnt vmcnt(8)
    ds_read_b64_tr_b16 v[144:145], v3 offset:8640
    v_cvt_pk_bf16_f32 v104, v80, v81
    v_mfma_f32_16x16x32_bf16 v[92:95], v[124:127], v[48:51], v[92:95]
    s_getreg_b32 s25, hwreg(HW_REG_IB_STS, 0, 4)
    ds_read_b64_tr_b16 v[146:147], v3 offset:9152
    v_cvt_pk_bf16_f32 v105, v82, v83
    v_mfma_f32_16x16x32_bf16 v[92:95], v[128:131], v[52:55], v[92:95]
    s_cmp_ge_u32 s25, s56
    ds_read_b64_tr_b16 v[148:149], v3 offset:8672
    v_mfma_f32_16x16x32_bf16 v[92:95], v[132:135], v[56:59], v[92:95]
    ds_read_b64_tr_b16 v[150:151], v3 offset:9184
    s_cbranch_scc1 L_df_23
L_df_23i:
    v_mfma_f32_16x16x32_bf16 a[200:203], a[204:207], v[116:119], a[200:203]
    s_barrier
    ds_read_b128 v[120:123], v2 offset:25344
    v_mfma_f32_16x16x32_bf16 a[196:199], a[204:207], v[112:115], a[196:199]
    s_waitcnt lgkmcnt(5)
    ds_read_b128 v[124:127], v2 offset:25408
    v_mfma_f32_16x16x32_bf16 a[192:195], a[204:207], v[108:111], a[192:195]
    ds_read_b128 v[128:131], v2 offset:25472
    v_mfma_f32_16x16x32_bf16 v[208:211], v[136:139], v[108:111], v[208:211]
    s_add_u32 s57, s57, 8192
    ds_read_b128 v[132:135], v2 offset:25536
    v_exp_f32 v84, v84
    v_mfma_f32_16x16x32_bf16 v[212:215], v[136:139], v[112:115], v[212:215]
    s_add_u32 m0, s58, s3
    v_exp_f32 v85, v85
    v_mfma_f32_16x16x32_bf16 v[216:219], v[136:139], v[116:119], v[216:219]
    buffer_load_dwordx4 v1, s[44:47], s64 offen nt lds
    v_mfma_f32_16x16x32_bf16 v[228:231], v[140:143], v[116:119], v[228:231]
    s_waitcnt lgkmcnt(4)
    v_exp_f32 v86, v86
    v_mfma_f32_16x16x32_bf16 v[224:227], v[140:143], v[112:115], v[224:227]
    s_add_u32 m0, m0, 32
    v_exp_f32 v87, v87
    v_mfma_f32_16x16x32_bf16 v[220:223], v[140:143], v[108:111], v[220:223]
    buffer_load_dwordx4 v1, s[44:47], s64 offen offset:1024 nt lds
    v_mfma_f32_16x16x32_bf16 v[232:235], v[144:147], v[108:111], v[232:235]
    s_mov_b32 s64, s65
    v_exp_f32 v88, v88
    v_mfma_f32_16x16x32_bf16 v[236:239], v[144:147], v[112:115], v[236:239]
    s_add_u32 m0, s59, s61
    v_exp_f32 v89, v89
    v_mfma_f32_16x16x32_bf16 v[240:243], v[144:147], v[116:119], v[240:243]
    s_mov_b32 s58, s59
    buffer_load_dwordx4 v1, s[40:43], s65 offen nt lds
    v_mfma_f32_16x16x32_bf16 v[252:255], v[148:151], v[116:119], v[252:255]
    s_waitcnt lgkmcnt(0)
    v_exp_f32 v90, v90
    v_mfma_f32_16x16x32_bf16 v[248:251], v[148:151], v[112:115], v[248:251]
    s_add_u32 m0, m0, 32
    v_exp_f32 v91, v91
    v_mfma_f32_16x16x32_bf16 v[244:247], v[148:151], v[108:111], v[244:247]
    buffer_load_dwordx4 v1, s[40:43], s65 offen offset:1024 nt lds
L_dfb_24:
    v_mfma_f32_16x16x32_bf16 v[72:75], v[120:123], v[12:15], v[60:63]
    ds_read_b64_tr_b16 v[136:137], v3 offset:16896
    v_cvt_pk_bf16_f32 v98, v84, v85
    v_mfma_f32_16x16x32_bf16 v[72:75], v[124:127], v[16:19], v[72:75]
    s_xor_b32 s65, s57, s22
    ds_read_b64_tr_b16 v[138:139], v3 offset:17408
    v_cvt_pk_bf16_f32 v99, v86, v87
    v_mfma_f32_16x16x32_bf16 v[72:75], v[128:131], v[20:23], v[72:75]
    s_bfe_u32 s59, s57, 0x3000d
    v_exp_f32 v92, v92
    v_mfma_f32_16x16x32_bf16 v[72:75], v[132:135], v[24:27], v[72:75]
    s_mul_i32 s59, s59, 8448
    v_exp_f32 v93, v93
    v_mfma_f32_16x16x32_bf16 v[76:79], v[132:135], v[40:43], v[64:67]
    ds_read_b64_tr_b16 v[140:141], v3 offset:16928
    v_cvt_pk_bf16_f32 v102, v88, v89
    v_mfma_f32_16x16x32_bf16 v[76:79], v[128:131], v[36:39], v[76:79]
    ds_read_b64_tr_b16 v[142:143], v3 offset:17440
    v_cvt_pk_bf16_f32 v103, v90, v91
    v_mfma_f32_16x16x32_bf16 v[76:79], v[124:127], v[32:35], v[76:79]
    v_exp_f32 v94, v94
    v_mfma_f32_16x16x32_bf16 v[76:79], v[120:123], v[28:31], v[76:79]
    v_exp_f32 v95, v95
    v_mfma_f32_16x16x32_bf16 v[80:83], v[120:123], v[44:47], v[68:71]
    ds_read_b64_tr_b16 v[144:145], v3 offset:16960
    v_cvt_pk_bf16_f32 v106, v92, v93
    v_mfma_f32_16x16x32_bf16 v[80:83], v[124:127], v[48:51], v[80:83]
    ds_read_b64_tr_b16 v[146:147], v3 offset:17472
    v_cvt_pk_bf16_f32 v107, v94, v95
    v_mfma_f32_16x16x32_bf16 v[80:83], v[128:131], v[52:55], v[80:83]
    ds_read_b64_tr_b16 v[148:149], v3 offset:16992
    v_mfma_f32_16x16x32_bf16 v[80:83], v[132:135], v[56:59], v[80:83]
    s_waitcnt lgkmcnt(5)
    ds_read_b64_tr_b16 v[150:151], v3 offset:17504
    v_mfma_f32_16x16x32_bf16 v[160:163], v[136:139], v[96:99], v[160:163]
    ds_read_b128 v[120:123], v2 offset:25856
    v_mfma_f32_16x16x32_bf16 v[164:167], v[136:139], v[100:103], v[164:167]
    ds_read_b128 v[124:127], v2 offset:25920
    v_mfma_f32_16x16x32_bf16 v[168:171], v[136:139], v[104:107], v[168:171]
    s_waitcnt lgkmcnt(6)
    ds_read_b128 v[128:131], v2 offset:25984
    v_mfma_f32_16x16x32_bf16 v[180:183], v[140:143], v[104:107], v[180:183]
    ds_read_b128 v[132:135], v2 offset:26048
    v_mfma_f32_16x16x32_bf16 v[176:179], v[140:143], v[100:103], v[176:179]
    v_exp_f32 v72, v72
    v_mfma_f32_16x16x32_bf16 v[172:175], v[140:143], v[96:99], v[172:175]
    s_waitcnt lgkmcnt(6)
    v_exp_f32 v73, v73
    v_mfma_f32_16x16x32_bf16 v[184:187], v[144:147], v[96:99], v[184:187]
    v_exp_f32 v74, v74
    v_mfma_f32_16x16x32_bf16 v[188:191], v[144:147], v[100:103], v[188:191]
    v_exp_f32 v75, v75
    v_mfma_f32_16x16x32_bf16 v[192:195], v[144:147], v[104:107], v[192:195]
    s_waitcnt lgkmcnt(4)
    v_exp_f32 v76, v76
    v_mfma_f32_16x16x32_bf16 v[204:207], v[148:151], v[104:107], v[204:207]
    v_exp_f32 v77, v77
    v_mfma_f32_16x16x32_bf16 v[200:203], v[148:151], v[100:103], v[200:203]
    s_waitcnt lgkmcnt(0)
    v_exp_f32 v78, v78
    v_mfma_f32_16x16x32_bf16 v[196:199], v[148:151], v[96:99], v[196:199]
    v_exp_f32 v79, v79
    v_mfma_f32_16x16x32_bf16 v[84:87], v[120:123], v[12:15], v[60:63]
    ds_read_b64_tr_b16 v[136:137], v3 offset:17024
    v_cvt_pk_bf16_f32 v108, v72, v73
    v_mfma_f32_16x16x32_bf16 v[84:87], v[124:127], v[16:19], v[84:87]
    ds_read_b64_tr_b16 v[138:139], v3 offset:17536
    v_cvt_pk_bf16_f32 v109, v74, v75
    v_mfma_f32_16x16x32_bf16 v[84:87], v[128:131], v[20:23], v[84:87]
    v_exp_f32 v80, v80
    v_mfma_f32_16x16x32_bf16 v[84:87], v[132:135], v[24:27], v[84:87]
    v_exp_f32 v81, v81
    v_mfma_f32_16x16x32_bf16 v[88:91], v[132:135], v[40:43], v[64:67]
    ds_read_b64_tr_b16 v[140:141], v3 offset:17056
    v_cvt_pk_bf16_f32 v112, v76, v77
    v_mfma_f32_16x16x32_bf16 v[88:91], v[128:131], v[36:39], v[88:91]
    ds_read_b64_tr_b16 v[142:143], v3 offset:17568
    v_cvt_pk_bf16_f32 v113, v78, v79
    v_mfma_f32_16x16x32_bf16 v[88:91], v[124:127], v[32:35], v[88:91]
    v_exp_f32 v82, v82
    v_mfma_f32_16x16x32_bf16 v[88:91], v[120:123], v[28:31], v[88:91]
    v_exp_f32 v83, v83
    v_mfma_f32_16x16x32_bf16 v[92:95], v[120:123], v[44:47], v[68:71]
    s_waitcnt vmcnt(8)
    ds_read_b64_tr_b16 v[144:145], v3 offset:17088
    v_cvt_pk_bf16_f32 v116, v80, v81
    v_mfma_f32_16x16x32_bf16 v[92:95], v[124:127], v[48:51], v[92:95]
    s_getreg_b32 s25, hwreg(HW_REG_IB_STS, 0, 4)
    ds_read_b64_tr_b16 v[146:147], v3 offset:17600
    v_cvt_pk_bf16_f32 v117, v82, v83
    v_mfma_f32_16x16x32_bf16 v[92:95], v[128:131], v[52:55], v[92:95]
    s_cmp_ge_u32 s25, s56
    ds_read_b64_tr_b16 v[148:149], v3 offset:17120
    v_mfma_f32_16x16x32_bf16 v[92:95], v[132:135], v[56:59], v[92:95]
    ds_read_b64_tr_b16 v[150:151], v3 offset:17632
    s_cbranch_scc1 L_df_25
L_df_25i:
    v_mfma_f32_16x16x32_bf16 a[200:203], a[204:207], v[104:107], a[200:203]
    s_barrier
    ds_read_b128 v[120:123], v2 offset:33792
    v_mfma_f32_16x16x32_bf16 a[196:199], a[204:207], v[100:103], a[196:199]
    s_waitcnt lgkmcnt(5)
    ds_read_b128 v[124:127], v2 offset:33856
    v_mfma_f32_16x16x32_bf16 a[192:195], a[204:207], v[96:99], a[192:195]
    ds_read_b128 v[128:131], v2 offset:33920
    v_mfma_f32_16x16x32_bf16 v[208:211], v[136:139], v[96:99], v[208:211]
    s_add_u32 s57, s57, 8192
    ds_read_b128 v[132:135], v2 offset:33984
    v_exp_f32 v84, v84
    v_mfma_f32_16x16x32_bf16 v[212:215], v[136:139], v[100:103], v[212:215]
    s_add_u32 m0, s58, s3
    v_exp_f32 v85, v85
    v_mfma_f32_16x16x32_bf16 v[216:219], v[136:139], v[104:107], v[216:219]
    buffer_load_dwordx4 v1, s[44:47], s64 offen nt lds
    v_mfma_f32_16x16x32_bf16 v[228:231], v[140:143], v[104:107], v[228:231]
    s_waitcnt lgkmcnt(4)
    v_exp_f32 v86, v86
    v_mfma_f32_16x16x32_bf16 v[224:227], v[140:143], v[100:103], v[224:227]
    s_add_u32 m0, m0, 32
    v_exp_f32 v87, v87
    v_mfma_f32_16x16x32_bf16 v[220:223], v[140:143], v[96:99], v[220:223]
    buffer_load_dwordx4 v1, s[44:47], s64 offen offset:1024 nt lds
    v_mfma_f32_16x16x32_bf16 v[232:235], v[144:147], v[96:99], v[232:235]
    s_mov_b32 s64, s65
    v_exp_f32 v88, v88
    v_mfma_f32_16x16x32_bf16 v[236:239], v[144:147], v[100:103], v[236:239]
    s_add_u32 m0, s59, s61
    v_exp_f32 v89, v89
    v_mfma_f32_16x16x32_bf16 v[240:243], v[144:147], v[104:107], v[240:243]
    s_mov_b32 s58, s59
    buffer_load_dwordx4 v1, s[40:43], s65 offen nt lds
    v_mfma_f32_16x16x32_bf16 v[252:255], v[148:151], v[104:107], v[252:255]
    s_waitcnt lgkmcnt(0)
    v_exp_f32 v90, v90
    v_mfma_f32_16x16x32_bf16 v[248:251], v[148:151], v[100:103], v[248:251]
    s_add_u32 m0, m0, 32
    v_exp_f32 v91, v91
    v_mfma_f32_16x16x32_bf16 v[244:247], v[148:151], v[96:99], v[244:247]
    buffer_load_dwordx4 v1, s[40:43], s65 offen offset:1024 nt lds
L_dfb_26:
    v_mfma_f32_16x16x32_bf16 v[72:75], v[120:123], v[12:15], v[60:63]
    ds_read_b64_tr_b16 v[136:137], v3 offset:25344
    v_cvt_pk_bf16_f32 v110, v84, v85
    v_mfma_f32_16x16x32_bf16 v[72:75], v[124:127], v[16:19], v[72:75]
    s_xor_b32 s65, s57, s22
    ds_read_b64_tr_b16 v[138:139], v3 offset:25856
    v_cvt_pk_bf16_f32 v111, v86, v87
    v_mfma_f32_16x16x32_bf16 v[72:75], v[128:131], v[20:23], v[72:75]
    s_bfe_u32 s59, s57, 0x3000d
    v_exp_f32 v92, v92
    v_mfma_f32_16x16x32_bf16 v[72:75], v[132:135], v[24:27], v[72:75]
    s_mul_i32 s59, s59, 8448
    v_exp_f32 v93, v93
    v_mfma_f32_16x16x32_bf16 v[76:79], v[132:135], v[40:43], v[64:67]
    ds_read_b64_tr_b16 v[140:141], v3 offset:25376
    v_cvt_pk_bf16_f32 v114, v88, v89
    v_mfma_f32_16x16x32_bf16 v[76:79], v[128:131], v[36:39], v[76:79]
    ds_read_b64_tr_b16 v[142:143], v3 offset:25888
    v_cvt_pk_bf16_f32 v115, v90, v91
    v_mfma_f32_16x16x32_bf16 v[76:79], v[124:127], v[32:35], v[76:79]
    v_exp_f32 v94, v94
    v_mfma_f32_16x16x32_bf16 v[76:79], v[120:123], v[28:31], v[76:79]
    v_exp_f32 v95, v95
    v_mfma_f32_16x16x32_bf16 v[80:83], v[120:123], v[44:47], v[68:71]
    ds_read_b64_tr_b16 v[144:145], v3 offset:25408
    v_cvt_pk_bf16_f32 v118, v92, v93
    v_mfma_f32_16x16x32_bf16 v[80:83], v[124:127], v[48:51], v[80:83]
    ds_read_b64_tr_b16 v[146:147], v3 offset:25920
    v_cvt_pk_bf16_f32 v119, v94, v95
    v_mfma_f32_16x16x32_bf16 v[80:83], v[128:131], v[52:55], v[80:83]
    ds_read_b64_tr_b16 v[148:149], v3 offset:25440
    v_mfma_f32_16x16x32_bf16 v[80:83], v[132:135], v[56:59], v[80:83]
    s_waitcnt lgkmcnt(5)
    ds_read_b64_tr_b16 v[150:151], v3 offset:25952
    v_mfma_f32_16x16x32_bf16 v[160:163], v[136:139], v[108:111], v[160:163]
    ds_read_b128 v[120:123], v2 offset:34304
    v_mfma_f32_16x16x32_bf16 v[164:167], v[136:139], v[112:115], v[164:167]
    ds_read_b128 v[124:127], v2 offset:34368
    v_mfma_f32_16x16x32_bf16 v[168:171], v[136:139], v[116:119], v[168:171]
    s_waitcnt lgkmcnt(6)
    ds_read_b128 v[128:131], v2 offset:34432
    v_mfma_f32_16x16x32_bf16 v[180:183], v[140:143], v[116:119], v[180:183]
    ds_read_b128 v[132:135], v2 offset:34496
    v_mfma_f32_16x16x32_bf16 v[176:179], v[140:143], v[112:115], v[176:179]
    v_exp_f32 v72, v72
    v_mfma_f32_16x16x32_bf16 v[172:175], v[140:143], v[108:111], v[172:175]
    s_waitcnt lgkmcnt(6)
    v_exp_f32 v73, v73
    v_mfma_f32_16x16x32_bf16 v[184:187], v[144:147], v[108:111], v[184:187]
    v_exp_f32 v74, v74
    v_mfma_f32_16x16x32_bf16 v[188:191], v[144:147], v[112:115], v[188:191]
    v_exp_f32 v75, v75
    v_mfma_f32_16x16x32_bf16 v[192:195], v[144:147], v[116:119], v[192:195]
    s_waitcnt lgkmcnt(4)
    v_exp_f32 v76, v76
    v_mfma_f32_16x16x32_bf16 v[204:207], v[148:151], v[116:119], v[204:207]
    v_exp_f32 v77, v77
    v_mfma_f32_16x16x32_bf16 v[200:203], v[148:151], v[112:115], v[200:203]
    s_waitcnt lgkmcnt(0)
    v_exp_f32 v78, v78
    v_mfma_f32_16x16x32_bf16 v[196:199], v[148:151], v[108:111], v[196:199]
    v_exp_f32 v79, v79
    v_mfma_f32_16x16x32_bf16 v[84:87], v[120:123], v[12:15], v[60:63]
    ds_read_b64_tr_b16 v[136:137], v3 offset:25472
    v_cvt_pk_bf16_f32 v96, v72, v73
    v_mfma_f32_16x16x32_bf16 v[84:87], v[124:127], v[16:19], v[84:87]
    ds_read_b64_tr_b16 v[138:139], v3 offset:25984
    v_cvt_pk_bf16_f32 v97, v74, v75
    v_mfma_f32_16x16x32_bf16 v[84:87], v[128:131], v[20:23], v[84:87]
    s_mov_b32 s56, s62
    v_exp_f32 v80, v80
    v_mfma_f32_16x16x32_bf16 v[84:87], v[132:135], v[24:27], v[84:87]
    v_exp_f32 v81, v81
    v_mfma_f32_16x16x32_bf16 v[88:91], v[132:135], v[40:43], v[64:67]
    ds_read_b64_tr_b16 v[140:141], v3 offset:25504
    v_cvt_pk_bf16_f32 v100, v76, v77
    v_mfma_f32_16x16x32_bf16 v[88:91], v[128:131], v[36:39], v[88:91]
    ds_read_b64_tr_b16 v[142:143], v3 offset:26016
    v_cvt_pk_bf16_f32 v101, v78, v79
    v_mfma_f32_16x16x32_bf16 v[88:91], v[124:127], v[32:35], v[88:91]
    v_exp_f32 v82, v82
    v_mfma_f32_16x16x32_bf16 v[88:91], v[120:123], v[28:31], v[88:91]
    v_exp_f32 v83, v83
    v_mfma_f32_16x16x32_bf16 v[92:95], v[120:123], v[44:47], v[68:71]
    s_waitcnt vmcnt(8)
    ds_read_b64_tr_b16 v[144:145], v3 offset:25536
    v_cvt_pk_bf16_f32 v104, v80, v81
    v_mfma_f32_16x16x32_bf16 v[92:95], v[124:127], v[48:51], v[92:95]
    s_getreg_b32 s25, hwreg(HW_REG_IB_STS, 0, 4)
    ds_read_b64_tr_b16 v[146:147], v3 offset:26048
    v_cvt_pk_bf16_f32 v105, v82, v83
    v_mfma_f32_16x16x32_bf16 v[92:95], v[128:131], v[52:55], v[92:95]
    s_cmp_ge_u32 s25, s56
    ds_read_b64_tr_b16 v[148:149], v3 offset:25568
    v_mfma_f32_16x16x32_bf16 v[92:95], v[132:135], v[56:59], v[92:95]
    ds_read_b64_tr_b16 v[150:151], v3 offset:26080
    s_cbranch_scc1 L_df_27
L_df_27i:
    v_mfma_f32_16x16x32_bf16 a[200:203], a[204:207], v[116:119], a[200:203]
    s_barrier
    ds_read_b128 v[120:123], v2 offset:42240
    v_mfma_f32_16x16x32_bf16 a[196:199], a[204:207], v[112:115], a[196:199]
    s_waitcnt lgkmcnt(5)
    ds_read_b128 v[124:127], v2 offset:42304
    v_mfma_f32_16x16x32_bf16 a[192:195], a[204:207], v[108:111], a[192:195]
    ds_read_b128 v[128:131], v2 offset:42368
    v_mfma_f32_16x16x32_bf16 v[208:211], v[136:139], v[108:111], v[208:211]
    s_add_u32 s57, s57, 8192
    ds_read_b128 v[132:135], v2 offset:42432
    v_exp_f32 v84, v84
    v_mfma_f32_16x16x32_bf16 v[212:215], v[136:139], v[112:115], v[212:215]
    s_add_u32 m0, s58, s3
    v_exp_f32 v85, v85
    v_mfma_f32_16x16x32_bf16 v[216:219], v[136:139], v[116:119], v[216:219]
    buffer_load_dwordx4 v1, s[44:47], s64 offen nt lds
    v_mfma_f32_16x16x32_bf16 v[228:231], v[140:143], v[116:119], v[228:231]
    s_waitcnt lgkmcnt(4)
    v_exp_f32 v86, v86
    v_mfma_f32_16x16x32_bf16 v[224:227], v[140:143], v[112:115], v[224:227]
    s_add_u32 m0, m0, 32
    v_exp_f32 v87, v87
    v_mfma_f32_16x16x32_bf16 v[220:223], v[140:143], v[108:111], v[220:223]
    buffer_load_dwordx4 v1, s[44:47], s64 offen offset:1024 nt lds
    v_mfma_f32_16x16x32_bf16 v[232:235], v[144:147], v[108:111], v[232:235]
    s_mov_b32 s64, s65
    v_exp_f32 v88, v88
    v_mfma_f32_16x16x32_bf16 v[236:239], v[144:147], v[112:115], v[236:239]
    s_add_u32 m0, s59, s61
    v_exp_f32 v89, v89
    v_mfma_f32_16x16x32_bf16 v[240:243], v[144:147], v[116:119], v[240:243]
    s_mov_b32 s58, s59
    buffer_load_dwordx4 v1, s[40:43], s65 offen nt lds
    v_mfma_f32_16x16x32_bf16 v[252:255], v[148:151], v[116:119], v[252:255]
    s_waitcnt lgkmcnt(0)
    v_exp_f32 v90, v90
    v_mfma_f32_16x16x32_bf16 v[248:251], v[148:151], v[112:115], v[248:251]
    s_add_u32 m0, m0, 32
    v_exp_f32 v91, v91
    v_mfma_f32_16x16x32_bf16 v[244:247], v[148:151], v[108:111], v[244:247]
    buffer_load_dwordx4 v1, s[40:43], s65 offen offset:1024 nt lds
L_dfb_28:
    v_mfma_f32_16x16x32_bf16 v[72:75], v[120:123], v[12:15], v[60:63]
    ds_read_b64_tr_b16 v[136:137], v3 offset:33792
    v_cvt_pk_bf16_f32 v98, v84, v85
    v_mfma_f32_16x16x32_bf16 v[72:75], v[124:127], v[16:19], v[72:75]
    s_xor_b32 s65, s57, s22
    ds_read_b64_tr_b16 v[138:139], v3 offset:34304
    v_cvt_pk_bf16_f32 v99, v86, v87
    v_mfma_f32_16x16x32_bf16 v[72:75], v[128:131], v[20:23], v[72:75]
    s_bfe_u32 s59, s57, 0x3000d
    v_exp_f32 v92, v92
    v_mfma_f32_16x16x32_bf16 v[72:75], v[132:135], v[24:27], v[72:75]
    s_mul_i32 s59, s59, 8448
    v_exp_f32 v93, v93
    v_mfma_f32_16x16x32_bf16 v[76:79], v[132:135], v[40:43], v[64:67]
    ds_read_b64_tr_b16 v[140:141], v3 offset:33824
    v_cvt_pk_bf16_f32 v102, v88, v89
    v_mfma_f32_16x16x32_bf16 v[76:79], v[128:131], v[36:39], v[76:79]
    ds_read_b64_tr_b16 v[142:143], v3 offset:34336
    v_cvt_pk_bf16_f32 v103, v90, v91
    v_mfma_f32_16x16x32_bf16 v[76:79], v[124:127], v[32:35], v[76:79]
    v_exp_f32 v94, v94
    v_mfma_f32_16x16x32_bf16 v[76:79], v[120:123], v[28:31], v[76:79]
    v_exp_f32 v95, v95
    v_mfma_f32_16x16x32_bf16 v[80:83], v[120:123], v[44:47], v[68:71]
    ds_read_b64_tr_b16 v[144:145], v3 offset:33856
    v_cvt_pk_bf16_f32 v106, v92, v93
    v_mfma_f32_16x16x32_bf16 v[80:83], v[124:127], v[48:51], v[80:83]
    ds_read_b64_tr_b16 v[146:147], v3 offset:34368
    v_cvt_pk_bf16_f32 v107, v94, v95
    v_mfma_f32_16x16x32_bf16 v[80:83], v[128:131], v[52:55], v[80:83]
    ds_read_b64_tr_b16 v[148:149], v3 offset:33888
    v_mfma_f32_16x16x32_bf16 v[80:83], v[132:135], v[56:59], v[80:83]
    s_waitcnt lgkmcnt(5)
    ds_read_b64_tr_b16 v[150:151], v3 offset:34400
    v_mfma_f32_16x16x32_bf16 v[160:163], v[136:139], v[96:99], v[160:163]
    s_getreg_b32 s25, hwreg(HW_REG_IB_STS, 0, 4)
    ds_read_b128 v[120:123], v2 offset:42752
    v_mfma_f32_16x16x32_bf16 v[164:167], v[136:139], v[100:103], v[164:167]
    s_add_u32 s25, s25, 3
    ds_read_b128 v[124:127], v2 offset:42816
    v_mfma_f32_16x16x32_bf16 v[168:171], v[136:139], v[104:107], v[168:171]
    s_waitcnt lgkmcnt(6)
    ds_read_b128 v[128:131], v2 offset:42880
    v_mfma_f32_16x16x32_bf16 v[180:183], v[140:143], v[104:107], v[180:183]
    s_cmp_le_u32 s25, s56
    ds_read_b128 v[132:135], v2 offset:42944
    v_mfma_f32_16x16x32_bf16 v[176:179], v[140:143], v[100:103], v[176:179]
    s_cselect_b32 s25, s76, 0
    v_exp_f32 v72, v72
    v_mfma_f32_16x16x32_bf16 v[172:175], v[140:143], v[96:99], v[172:175]
    s_waitcnt lgkmcnt(6)
    v_exp_f32 v73, v73
    v_mfma_f32_16x16x32_bf16 v[184:187], v[144:147], v[96:99], v[184:187]
    s_cmp_gt_u32 s25, 0
    v_exp_f32 v74, v74
    v_mfma_f32_16x16x32_bf16 v[188:191], v[144:147], v[100:103], v[188:191]
    s_cbranch_scc1 L_cu_29
L_cub_30:
    v_exp_f32 v75, v75
    v_mfma_f32_16x16x32_bf16 v[192:195], v[144:147], v[104:107], v[192:195]
    s_waitcnt lgkmcnt(4)
    v_exp_f32 v76, v76
    v_mfma_f32_16x16x32_bf16 v[204:207], v[148:151], v[104:107], v[204:207]
    v_exp_f32 v77, v77
    v_mfma_f32_16x16x32_bf16 v[200:203], v[148:151], v[100:103], v[200:203]
    s_waitcnt lgkmcnt(0)
    v_exp_f32 v78, v78
    v_mfma_f32_16x16x32_bf16 v[196:199], v[148:151], v[96:99], v[196:199]
    v_exp_f32 v79, v79
    v_mfma_f32_16x16x32_bf16 v[84:87], v[120:123], v[12:15], v[60:63]
    ds_read_b64_tr_b16 v[136:137], v3 offset:33920
    v_cvt_pk_bf16_f32 v108, v72, v73
    v_mfma_f32_16x16x32_bf16 v[84:87], v[124:127], v[16:19], v[84:87]
    ds_read_b64_tr_b16 v[138:139], v3 offset:34432
    v_cvt_pk_bf16_f32 v109, v74, v75
    v_mfma_f32_16x16x32_bf16 v[84:87], v[128:131], v[20:23], v[84:87]
    v_exp_f32 v80, v80
    v_mfma_f32_16x16x32_bf16 v[84:87], v[132:135], v[24:27], v[84:87]
    v_exp_f32 v81, v81
    v_mfma_f32_16x16x32_bf16 v[88:91], v[132:135], v[40:43], v[64:67]
    ds_read_b64_tr_b16 v[140:141], v3 offset:33952
    v_cvt_pk_bf16_f32 v112, v76, v77
    v_mfma_f32_16x16x32_bf16 v[88:91], v[128:131], v[36:39], v[88:91]
    ds_read_b64_tr_b16 v[142:143], v3 offset:34464
    v_cvt_pk_bf16_f32 v113, v78, v79
    v_mfma_f32_16x16x32_bf16 v[88:91], v[124:127], v[32:35], v[88:91]
    v_exp_f32 v82, v82
    v_mfma_f32_16x16x32_bf16 v[88:91], v[120:123], v[28:31], v[88:91]
    v_exp_f32 v83, v83
    v_mfma_f32_16x16x32_bf16 v[92:95], v[120:123], v[44:47], v[68:71]
    s_waitcnt vmcnt(8)
    ds_read_b64_tr_b16 v[144:145], v3 offset:33984
    v_cvt_pk_bf16_f32 v116, v80, v81
    v_mfma_f32_16x16x32_bf16 v[92:95], v[124:127], v[48:51], v[92:95]
    s_getreg_b32 s25, hwreg(HW_REG_IB_STS, 0, 4)
    ds_read_b64_tr_b16 v[146:147], v3 offset:34496
    v_cvt_pk_bf16_f32 v117, v82, v83
    v_mfma_f32_16x16x32_bf16 v[92:95], v[128:131], v[52:55], v[92:95]
    s_cmp_ge_u32 s25, s56
    ds_read_b64_tr_b16 v[148:149], v3 offset:34016
    v_mfma_f32_16x16x32_bf16 v[92:95], v[132:135], v[56:59], v[92:95]
    ds_read_b64_tr_b16 v[150:151], v3 offset:34528
    s_cbranch_scc1 L_df_31
L_df_31i:
    v_mfma_f32_16x16x32_bf16 a[200:203], a[204:207], v[104:107], a[200:203]
    s_barrier
    ds_read_b128 v[120:123], v2 offset:50688
    v_mfma_f32_16x16x32_bf16 a[196:199], a[204:207], v[100:103], a[196:199]
    s_waitcnt lgkmcnt(5)
    ds_read_b128 v[124:127], v2 offset:50752
    v_mfma_f32_16x16x32_bf16 a[192:195], a[204:207], v[96:99], a[192:195]
    ds_read_b128 v[128:131], v2 offset:50816
    v_mfma_f32_16x16x32_bf16 v[208:211], v[136:139], v[96:99], v[208:211]
    s_add_u32 s57, s57, 8192
    ds_read_b128 v[132:135], v2 offset:50880
    v_exp_f32 v84, v84
    v_mfma_f32_16x16x32_bf16 v[212:215], v[136:139], v[100:103], v[212:215]
    s_add_u32 m0, s58, s3
    v_exp_f32 v85, v85
    v_mfma_f32_16x16x32_bf16 v[216:219], v[136:139], v[104:107], v[216:219]
    buffer_load_dwordx4 v1, s[44:47], s64 offen nt lds
    v_mfma_f32_16x16x32_bf16 v[228:231], v[140:143], v[104:107], v[228:231]
    s_waitcnt lgkmcnt(4)
    v_exp_f32 v86, v86
    v_mfma_f32_16x16x32_bf16 v[224:227], v[140:143], v[100:103], v[224:227]
    s_add_u32 m0, m0, 32
    v_exp_f32 v87, v87
    v_mfma_f32_16x16x32_bf16 v[220:223], v[140:143], v[96:99], v[220:223]
    buffer_load_dwordx4 v1, s[44:47], s64 offen offset:1024 nt lds
    v_mfma_f32_16x16x32_bf16 v[232:235], v[144:147], v[96:99], v[232:235]
    s_mov_b32 s64, s65
    v_exp_f32 v88, v88
    v_mfma_f32_16x16x32_bf16 v[236:239], v[144:147], v[100:103], v[236:239]
    s_add_u32 m0, s59, s61
    v_exp_f32 v89, v89
    v_mfma_f32_16x16x32_bf16 v[240:243], v[144:147], v[104:107], v[240:243]
    s_mov_b32 s58, s59
    buffer_load_dwordx4 v1, s[40:43], s65 offen nt lds
    v_mfma_f32_16x16x32_bf16 v[252:255], v[148:151], v[104:107], v[252:255]
    s_waitcnt lgkmcnt(0)
    v_exp_f32 v90, v90
    v_mfma_f32_16x16x32_bf16 v[248:251], v[148:151], v[100:103], v[248:251]
    s_add_u32 m0, m0, 32
    v_exp_f32 v91, v91
    v_mfma_f32_16x16x32_bf16 v[244:247], v[148:151], v[96:99], v[244:247]
    buffer_load_dwordx4 v1, s[40:43], s65 offen offset:1024 nt lds
L_dfb_32:
    v_mfma_f32_16x16x32_bf16 v[72:75], v[120:123], v[12:15], v[60:63]
    ds_read_b64_tr_b16 v[136:137], v3 offset:42240
    v_cvt_pk_bf16_f32 v110, v84, v85
    v_mfma_f32_16x16x32_bf16 v[72:75], v[124:127], v[16:19], v[72:75]
    s_xor_b32 s65, s57, s22
    ds_read_b64_tr_b16 v[138:139], v3 offset:42752
    v_cvt_pk_bf16_f32 v111, v86, v87
    v_mfma_f32_16x16x32_bf16 v[72:75], v[128:131], v[20:23], v[72:75]
    s_bfe_u32 s59, s57, 0x3000d
    v_exp_f32 v92, v92
    v_mfma_f32_16x16x32_bf16 v[72:75], v[132:135], v[24:27], v[72:75]
    s_mul_i32 s59, s59, 8448
    v_exp_f32 v93, v93
    v_mfma_f32_16x16x32_bf16 v[76:79], v[132:135], v[40:43], v[64:67]
    ds_read_b64_tr_b16 v[140:141], v3 offset:42272
    v_cvt_pk_bf16_f32 v114, v88, v89
    v_mfma_f32_16x16x32_bf16 v[76:79], v[128:131], v[36:39], v[76:79]
    ds_read_b64_tr_b16 v[142:143], v3 offset:42784
    v_cvt_pk_bf16_f32 v115, v90, v91
    v_mfma_f32_16x16x32_bf16 v[76:79], v[124:127], v[32:35], v[76:79]
    v_exp_f32 v94, v94
    v_mfma_f32_16x16x32_bf16 v[76:79], v[120:123], v[28:31], v[76:79]
    v_exp_f32 v95, v95
    v_mfma_f32_16x16x32_bf16 v[80:83], v[120:123], v[44:47], v[68:71]
    ds_read_b64_tr_b16 v[144:145], v3 offset:42304
    v_cvt_pk_bf16_f32 v118, v92, v93
    v_mfma_f32_16x16x32_bf16 v[80:83], v[124:127], v[48:51], v[80:83]
    ds_read_b64_tr_b16 v[146:147], v3 offset:42816
    v_cvt_pk_bf16_f32 v119, v94, v95
    v_mfma_f32_16x16x32_bf16 v[80:83], v[128:131], v[52:55], v[80:83]
    ds_read_b64_tr_b16 v[148:149], v3 offset:42336
    v_mfma_f32_16x16x32_bf16 v[80:83], v[132:135], v[56:59], v[80:83]
    s_waitcnt lgkmcnt(5)
    ds_read_b64_tr_b16 v[150:151], v3 offset:42848
    v_mfma_f32_16x16x32_bf16 v[160:163], v[136:139], v[108:111], v[160:163]
    ds_read_b128 v[120:123], v2 offset:51200
    v_mfma_f32_16x16x32_bf16 v[164:167], v[136:139], v[112:115], v[164:167]
    ds_read_b128 v[124:127], v2 offset:51264
    v_mfma_f32_16x16x32_bf16 v[168:171], v[136:139], v[116:119], v[168:171]
    s_waitcnt lgkmcnt(6)
    ds_read_b128 v[128:131], v2 offset:51328
    v_mfma_f32_16x16x32_bf16 v[180:183], v[140:143], v[116:119], v[180:183]
    ds_read_b128 v[132:135], v2 offset:51392
    v_mfma_f32_16x16x32_bf16 v[176:179], v[140:143], v[112:115], v[176:179]
    v_exp_f32 v72, v72
    v_mfma_f32_16x16x32_bf16 v[172:175], v[140:143], v[108:111], v[172:175]
    s_waitcnt lgkmcnt(6)
    v_exp_f32 v73, v73
    v_mfma_f32_16x16x32_bf16 v[184:187], v[144:147], v[108:111], v[184:187]
    v_exp_f32 v74, v74
    v_mfma_f32_16x16x32_bf16 v[188:191], v[144:147], v[112:115], v[188:191]
    v_exp_f32 v75, v75
    v_mfma_f32_16x16x32_bf16 v[192:195], v[144:147], v[116:119], v[192:195]
    s_waitcnt lgkmcnt(4)
    v_exp_f32 v76, v76
    v_mfma_f32_16x16x32_bf16 v[204:207], v[148:151], v[116:119], v[204:207]
    v_exp_f32 v77, v77
    v_mfma_f32_16x16x32_bf16 v[200:203], v[148:151], v[112:115], v[200:203]
    s_waitcnt lgkmcnt(0)
    v_exp_f32 v78, v78
    v_mfma_f32_16x16x32_bf16 v[196:199], v[148:151], v[108:111], v[196:199]
    v_exp_f32 v79, v79
    v_mfma_f32_16x16x32_bf16 v[84:87], v[120:123], v[12:15], v[60:63]
    ds_read_b64_tr_b16 v[136:137], v3 offset:42368
    v_cvt_pk_bf16_f32 v96, v72, v73
    v_mfma_f32_16x16x32_bf16 v[84:87], v[124:127], v[16:19], v[84:87]
    ds_read_b64_tr_b16 v[138:139], v3 offset:42880
    v_cvt_pk_bf16_f32 v97, v74, v75
    v_mfma_f32_16x16x32_bf16 v[84:87], v[128:131], v[20:23], v[84:87]
    v_exp_f32 v80, v80
    v_mfma_f32_16x16x32_bf16 v[84:87], v[132:135], v[24:27], v[84:87]
    v_exp_f32 v81, v81
    v_mfma_f32_16x16x32_bf16 v[88:91], v[132:135], v[40:43], v[64:67]
    ds_read_b64_tr_b16 v[140:141], v3 offset:42400
    v_cvt_pk_bf16_f32 v100, v76, v77
    v_mfma_f32_16x16x32_bf16 v[88:91], v[128:131], v[36:39], v[88:91]
    ds_read_b64_tr_b16 v[142:143], v3 offset:42912
    v_cvt_pk_bf16_f32 v101, v78, v79
    v_mfma_f32_16x16x32_bf16 v[88:91], v[124:127], v[32:35], v[88:91]
    v_exp_f32 v82, v82
    v_mfma_f32_16x16x32_bf16 v[88:91], v[120:123], v[28:31], v[88:91]
    v_exp_f32 v83, v83
    v_mfma_f32_16x16x32_bf16 v[92:95], v[120:123], v[44:47], v[68:71]
    s_waitcnt vmcnt(8)
    ds_read_b64_tr_b16 v[144:145], v3 offset:42432
    v_cvt_pk_bf16_f32 v104, v80, v81
    v_mfma_f32_16x16x32_bf16 v[92:95], v[124:127], v[48:51], v[92:95]
    s_getreg_b32 s25, hwreg(HW_REG_IB_STS, 0, 4)
    ds_read_b64_tr_b16 v[146:147], v3 offset:42944
    v_cvt_pk_bf16_f32 v105, v82, v83
    v_mfma_f32_16x16x32_bf16 v[92:95], v[128:131], v[52:55], v[92:95]
    s_cmp_ge_u32 s25, s56
    ds_read_b64_tr_b16 v[148:149], v3 offset:42464
    v_mfma_f32_16x16x32_bf16 v[92:95], v[132:135], v[56:59], v[92:95]
    ds_read_b64_tr_b16 v[150:151], v3 offset:42976
    s_cbranch_scc1 L_df_33
L_df_33i:
    v_mfma_f32_16x16x32_bf16 a[200:203], a[204:207], v[116:119], a[200:203]
    s_barrier
    ds_read_b128 v[120:123], v2 offset:59136
    v_mfma_f32_16x16x32_bf16 a[196:199], a[204:207], v[112:115], a[196:199]
    s_waitcnt lgkmcnt(5)
    ds_read_b128 v[124:127], v2 offset:59200
    v_mfma_f32_16x16x32_bf16 a[192:195], a[204:207], v[108:111], a[192:195]
    ds_read_b128 v[128:131], v2 offset:59264
    v_mfma_f32_16x16x32_bf16 v[208:211], v[136:139], v[108:111], v[208:211]
    s_add_u32 s57, s57, 8192
    ds_read_b128 v[132:135], v2 offset:59328
    v_exp_f32 v84, v84
    v_mfma_f32_16x16x32_bf16 v[212:215], v[136:139], v[112:115], v[212:215]
    s_add_u32 m0, s58, s3
    v_exp_f32 v85, v85
    v_mfma_f32_16x16x32_bf16 v[216:219], v[136:139], v[116:119], v[216:219]
    buffer_load_dwordx4 v1, s[44:47], s64 offen nt lds
    v_mfma_f32_16x16x32_bf16 v[228:231], v[140:143], v[116:119], v[228:231]
    s_waitcnt lgkmcnt(4)
    v_exp_f32 v86, v86
    v_mfma_f32_16x16x32_bf16 v[224:227], v[140:143], v[112:115], v[224:227]
    s_add_u32 m0, m0, 32
    v_exp_f32 v87, v87
    v_mfma_f32_16x16x32_bf16 v[220:223], v[140:143], v[108:111], v[220:223]
    buffer_load_dwordx4 v1, s[44:47], s64 offen offset:1024 nt lds
    v_mfma_f32_16x16x32_bf16 v[232:235], v[144:147], v[108:111], v[232:235]
    s_mov_b32 s64, s65
    v_exp_f32 v88, v88
    v_mfma_f32_16x16x32_bf16 v[236:239], v[144:147], v[112:115], v[236:239]
    s_add_u32 m0, s59, s61
    v_exp_f32 v89, v89
    v_mfma_f32_16x16x32_bf16 v[240:243], v[144:147], v[116:119], v[240:243]
    s_mov_b32 s58, s59
    buffer_load_dwordx4 v1, s[40:43], s65 offen nt lds
    v_mfma_f32_16x16x32_bf16 v[252:255], v[148:151], v[116:119], v[252:255]
    s_waitcnt lgkmcnt(0)
    v_exp_f32 v90, v90
    v_mfma_f32_16x16x32_bf16 v[248:251], v[148:151], v[112:115], v[248:251]
    s_add_u32 m0, m0, 32
    v_exp_f32 v91, v91
    v_mfma_f32_16x16x32_bf16 v[244:247], v[148:151], v[108:111], v[244:247]
    buffer_load_dwordx4 v1, s[40:43], s65 offen offset:1024 nt lds
L_dfb_34:
    v_mfma_f32_16x16x32_bf16 v[72:75], v[120:123], v[12:15], v[60:63]
    ds_read_b64_tr_b16 v[136:137], v3 offset:50688
    v_cvt_pk_bf16_f32 v98, v84, v85
    v_mfma_f32_16x16x32_bf16 v[72:75], v[124:127], v[16:19], v[72:75]
    s_xor_b32 s65, s57, s22
    ds_read_b64_tr_b16 v[138:139], v3 offset:51200
    v_cvt_pk_bf16_f32 v99, v86, v87
    v_mfma_f32_16x16x32_bf16 v[72:75], v[128:131], v[20:23], v[72:75]
    s_bfe_u32 s59, s57, 0x3000d
    v_exp_f32 v92, v92
    v_mfma_f32_16x16x32_bf16 v[72:75], v[132:135], v[24:27], v[72:75]
    s_mul_i32 s59, s59, 8448
    v_exp_f32 v93, v93
    v_mfma_f32_16x16x32_bf16 v[76:79], v[132:135], v[40:43], v[64:67]
    ds_read_b64_tr_b16 v[140:141], v3 offset:50720
    v_cvt_pk_bf16_f32 v102, v88, v89
    v_mfma_f32_16x16x32_bf16 v[76:79], v[128:131], v[36:39], v[76:79]
    ds_read_b64_tr_b16 v[142:143], v3 offset:51232
    v_cvt_pk_bf16_f32 v103, v90, v91
    v_mfma_f32_16x16x32_bf16 v[76:79], v[124:127], v[32:35], v[76:79]
    v_exp_f32 v94, v94
    v_mfma_f32_16x16x32_bf16 v[76:79], v[120:123], v[28:31], v[76:79]
    v_exp_f32 v95, v95
    v_mfma_f32_16x16x32_bf16 v[80:83], v[120:123], v[44:47], v[68:71]
    ds_read_b64_tr_b16 v[144:145], v3 offset:50752
    v_cvt_pk_bf16_f32 v106, v92, v93
    v_mfma_f32_16x16x32_bf16 v[80:83], v[124:127], v[48:51], v[80:83]
    ds_read_b64_tr_b16 v[146:147], v3 offset:51264
    v_cvt_pk_bf16_f32 v107, v94, v95
    v_mfma_f32_16x16x32_bf16 v[80:83], v[128:131], v[52:55], v[80:83]
    ds_read_b64_tr_b16 v[148:149], v3 offset:50784
    v_mfma_f32_16x16x32_bf16 v[80:83], v[132:135], v[56:59], v[80:83]
    s_waitcnt lgkmcnt(5)
    ds_read_b64_tr_b16 v[150:151], v3 offset:51296
    v_mfma_f32_16x16x32_bf16 v[160:163], v[136:139], v[96:99], v[160:163]
    s_getreg_b32 s25, hwreg(HW_REG_IB_STS, 0, 4)
    ds_read_b128 v[120:123], v2 offset:59648
    v_mfma_f32_16x16x32_bf16 v[164:167], v[136:139], v[100:103], v[164:167]
    s_add_u32 s25, s25, 3
    ds_read_b128 v[124:127], v2 offset:59712
    v_mfma_f32_16x16x32_bf16 v[168:171], v[136:139], v[104:107], v[168:171]
    s_waitcnt lgkmcnt(6)
    ds_read_b128 v[128:131], v2 offset:59776
    v_mfma_f32_16x16x32_bf16 v[180:183], v[140:143], v[104:107], v[180:183]
    s_cmp_le_u32 s25, s56
    ds_read_b128 v[132:135], v2 offset:59840
    v_mfma_f32_16x16x32_bf16 v[176:179], v[140:143], v[100:103], v[176:179]
    s_cselect_b32 s25, s76, 0
    v_exp_f32 v72, v72
    v_mfma_f32_16x16x32_bf16 v[172:175], v[140:143], v[96:99], v[172:175]
    s_waitcnt lgkmcnt(6)
    v_exp_f32 v73, v73
    v_mfma_f32_16x16x32_bf16 v[184:187], v[144:147], v[96:99], v[184:187]
    s_cmp_gt_u32 s25, 0
    v_exp_f32 v74, v74
    v_mfma_f32_16x16x32_bf16 v[188:191], v[144:147], v[100:103], v[188:191]
    s_cbranch_scc1 L_cu_35
L_cub_36:
    v_exp_f32 v75, v75
    v_mfma_f32_16x16x32_bf16 v[192:195], v[144:147], v[104:107], v[192:195]
    s_waitcnt lgkmcnt(4)
    v_exp_f32 v76, v76
    v_mfma_f32_16x16x32_bf16 v[204:207], v[148:151], v[104:107], v[204:207]
    v_exp_f32 v77, v77
    v_mfma_f32_16x16x32_bf16 v[200:203], v[148:151], v[100:103], v[200:203]
    s_waitcnt lgkmcnt(0)
    v_exp_f32 v78, v78
    v_mfma_f32_16x16x32_bf16 v[196:199], v[148:151], v[96:99], v[196:199]
    v_exp_f32 v79, v79
    v_mfma_f32_16x16x32_bf16 v[84:87], v[120:123], v[12:15], v[60:63]
    ds_read_b64_tr_b16 v[136:137], v3 offset:50816
    v_cvt_pk_bf16_f32 v108, v72, v73
    v_mfma_f32_16x16x32_bf16 v[84:87], v[124:127], v[16:19], v[84:87]
    ds_read_b64_tr_b16 v[138:139], v3 offset:51328
    v_cvt_pk_bf16_f32 v109, v74, v75
    v_mfma_f32_16x16x32_bf16 v[84:87], v[128:131], v[20:23], v[84:87]
    v_exp_f32 v80, v80
    v_mfma_f32_16x16x32_bf16 v[84:87], v[132:135], v[24:27], v[84:87]
    v_exp_f32 v81, v81
    v_mfma_f32_16x16x32_bf16 v[88:91], v[132:135], v[40:43], v[64:67]
    ds_read_b64_tr_b16 v[140:141], v3 offset:50848
    v_cvt_pk_bf16_f32 v112, v76, v77
    v_mfma_f32_16x16x32_bf16 v[88:91], v[128:131], v[36:39], v[88:91]
    ds_read_b64_tr_b16 v[142:143], v3 offset:51360
    v_cvt_pk_bf16_f32 v113, v78, v79
    v_mfma_f32_16x16x32_bf16 v[88:91], v[124:127], v[32:35], v[88:91]
    v_exp_f32 v82, v82
    v_mfma_f32_16x16x32_bf16 v[88:91], v[120:123], v[28:31], v[88:91]
    v_exp_f32 v83, v83
    v_mfma_f32_16x16x32_bf16 v[92:95], v[120:123], v[44:47], v[68:71]
    s_waitcnt vmcnt(8)
    ds_read_b64_tr_b16 v[144:145], v3 offset:50880
    v_cvt_pk_bf16_f32 v116, v80, v81
    v_mfma_f32_16x16x32_bf16 v[92:95], v[124:127], v[48:51], v[92:95]
    s_getreg_b32 s25, hwreg(HW_REG_IB_STS, 0, 4)
    ds_read_b64_tr_b16 v[146:147], v3 offset:51392
    v_cvt_pk_bf16_f32 v117, v82, v83
    v_mfma_f32_16x16x32_bf16 v[92:95], v[128:131], v[52:55], v[92:95]
    s_cmp_ge_u32 s25, s56
    ds_read_b64_tr_b16 v[148:149], v3 offset:50912
    v_mfma_f32_16x16x32_bf16 v[92:95], v[132:135], v[56:59], v[92:95]
    ds_read_b64_tr_b16 v[150:151], v3 offset:51424
    s_cbranch_scc1 L_df_37
L_df_37i:
    v_mfma_f32_16x16x32_bf16 a[200:203], a[204:207], v[104:107], a[200:203]
    s_barrier
    ds_read_b128 v[120:123], v2 offset:0
    v_mfma_f32_16x16x32_bf16 a[196:199], a[204:207], v[100:103], a[196:199]
    s_waitcnt lgkmcnt(5)
    ds_read_b128 v[124:127], v2 offset:64
    v_mfma_f32_16x16x32_bf16 a[192:195], a[204:207], v[96:99], a[192:195]
    ds_read_b128 v[128:131], v2 offset:128
    v_mfma_f32_16x16x32_bf16 v[208:211], v[136:139], v[96:99], v[208:211]
    s_add_u32 s57, s57, 8192
    ds_read_b128 v[132:135], v2 offset:192
    v_exp_f32 v84, v84
    v_mfma_f32_16x16x32_bf16 v[212:215], v[136:139], v[100:103], v[212:215]
    s_add_u32 m0, s58, s3
    v_exp_f32 v85, v85
    v_mfma_f32_16x16x32_bf16 v[216:219], v[136:139], v[104:107], v[216:219]
    buffer_load_dwordx4 v1, s[44:47], s64 offen nt lds
    v_mfma_f32_16x16x32_bf16 v[228:231], v[140:143], v[104:107], v[228:231]
    s_waitcnt lgkmcnt(4)
    v_exp_f32 v86, v86
    v_mfma_f32_16x16x32_bf16 v[224:227], v[140:143], v[100:103], v[224:227]
    s_add_u32 m0, m0, 32
    v_exp_f32 v87, v87
    v_mfma_f32_16x16x32_bf16 v[220:223], v[140:143], v[96:99], v[220:223]
    buffer_load_dwordx4 v1, s[44:47], s64 offen offset:1024 nt lds
    v_mfma_f32_16x16x32_bf16 v[232:235], v[144:147], v[96:99], v[232:235]
    s_mov_b32 s64, s65
    v_exp_f32 v88, v88
    v_mfma_f32_16x16x32_bf16 v[236:239], v[144:147], v[100:103], v[236:239]
    s_add_u32 m0, s59, s61
    v_exp_f32 v89, v89
    v_mfma_f32_16x16x32_bf16 v[240:243], v[144:147], v[104:107], v[240:243]
    s_mov_b32 s58, s59
    buffer_load_dwordx4 v1, s[40:43], s65 offen nt lds
    v_mfma_f32_16x16x32_bf16 v[252:255], v[148:151], v[104:107], v[252:255]
    s_waitcnt lgkmcnt(0)
    v_exp_f32 v90, v90
    v_mfma_f32_16x16x32_bf16 v[248:251], v[148:151], v[100:103], v[248:251]
    s_add_u32 m0, m0, 32
    v_exp_f32 v91, v91
    v_mfma_f32_16x16x32_bf16 v[244:247], v[148:151], v[96:99], v[244:247]
    buffer_load_dwordx4 v1, s[40:43], s65 offen offset:1024 nt lds
L_dfb_38:
    v_mfma_f32_16x16x32_bf16 v[72:75], v[120:123], v[12:15], v[60:63]
    ds_read_b64_tr_b16 v[136:137], v3 offset:59136
    v_cvt_pk_bf16_f32 v110, v84, v85
    v_mfma_f32_16x16x32_bf16 v[72:75], v[124:127], v[16:19], v[72:75]
    s_xor_b32 s65, s57, s22
    ds_read_b64_tr_b16 v[138:139], v3 offset:59648
    v_cvt_pk_bf16_f32 v111, v86, v87
    v_mfma_f32_16x16x32_bf16 v[72:75], v[128:131], v[20:23], v[72:75]
    s_bfe_u32 s59, s57, 0x3000d
    v_exp_f32 v92, v92
    v_mfma_f32_16x16x32_bf16 v[72:75], v[132:135], v[24:27], v[72:75]
    s_mul_i32 s59, s59, 8448
    v_exp_f32 v93, v93
    v_mfma_f32_16x16x32_bf16 v[76:79], v[132:135], v[40:43], v[64:67]
    ds_read_b64_tr_b16 v[140:141], v3 offset:59168
    v_cvt_pk_bf16_f32 v114, v88, v89
    v_mfma_f32_16x16x32_bf16 v[76:79], v[128:131], v[36:39], v[76:79]
    ds_read_b64_tr_b16 v[142:143], v3 offset:59680
    v_cvt_pk_bf16_f32 v115, v90, v91
    v_mfma_f32_16x16x32_bf16 v[76:79], v[124:127], v[32:35], v[76:79]
    v_exp_f32 v94, v94
    v_mfma_f32_16x16x32_bf16 v[76:79], v[120:123], v[28:31], v[76:79]
    v_exp_f32 v95, v95
    v_mfma_f32_16x16x32_bf16 v[80:83], v[120:123], v[44:47], v[68:71]
    ds_read_b64_tr_b16 v[144:145], v3 offset:59200
    v_cvt_pk_bf16_f32 v118, v92, v93
    v_mfma_f32_16x16x32_bf16 v[80:83], v[124:127], v[48:51], v[80:83]
    ds_read_b64_tr_b16 v[146:147], v3 offset:59712
    v_cvt_pk_bf16_f32 v119, v94, v95
    v_mfma_f32_16x16x32_bf16 v[80:83], v[128:131], v[52:55], v[80:83]
    ds_read_b64_tr_b16 v[148:149], v3 offset:59232
    v_mfma_f32_16x16x32_bf16 v[80:83], v[132:135], v[56:59], v[80:83]
    s_waitcnt lgkmcnt(5)
    ds_read_b64_tr_b16 v[150:151], v3 offset:59744
    v_mfma_f32_16x16x32_bf16 v[160:163], v[136:139], v[108:111], v[160:163]
    ds_read_b128 v[120:123], v2 offset:512
    v_mfma_f32_16x16x32_bf16 v[164:167], v[136:139], v[112:115], v[164:167]
    ds_read_b128 v[124:127], v2 offset:576
    v_mfma_f32_16x16x32_bf16 v[168:171], v[136:139], v[116:119], v[168:171]
    s_waitcnt lgkmcnt(6)
    ds_read_b128 v[128:131], v2 offset:640
    v_mfma_f32_16x16x32_bf16 v[180:183], v[140:143], v[116:119], v[180:183]
    ds_read_b128 v[132:135], v2 offset:704
    v_mfma_f32_16x16x32_bf16 v[176:179], v[140:143], v[112:115], v[176:179]
    v_exp_f32 v72, v72
    v_mfma_f32_16x16x32_bf16 v[172:175], v[140:143], v[108:111], v[172:175]
    s_waitcnt lgkmcnt(6)
    v_exp_f32 v73, v73
    v_mfma_f32_16x16x32_bf16 v[184:187], v[144:147], v[108:111], v[184:187]
    v_exp_f32 v74, v74
    v_mfma_f32_16x16x32_bf16 v[188:191], v[144:147], v[112:115], v[188:191]
    v_exp_f32 v75, v75
    v_mfma_f32_16x16x32_bf16 v[192:195], v[144:147], v[116:119], v[192:195]
    s_waitcnt lgkmcnt(4)
    v_exp_f32 v76, v76
    v_mfma_f32_16x16x32_bf16 v[204:207], v[148:151], v[116:119], v[204:207]
    v_exp_f32 v77, v77
    v_mfma_f32_16x16x32_bf16 v[200:203], v[148:151], v[112:115], v[200:203]
    s_waitcnt lgkmcnt(0)
    v_exp_f32 v78, v78
    v_mfma_f32_16x16x32_bf16 v[196:199], v[148:151], v[108:111], v[196:199]
    v_exp_f32 v79, v79
    v_mfma_f32_16x16x32_bf16 v[84:87], v[120:123], v[12:15], v[60:63]
    ds_read_b64_tr_b16 v[136:137], v3 offset:59264
    v_cvt_pk_bf16_f32 v96, v72, v73
    v_mfma_f32_16x16x32_bf16 v[84:87], v[124:127], v[16:19], v[84:87]
    ds_read_b64_tr_b16 v[138:139], v3 offset:59776
    v_cvt_pk_bf16_f32 v97, v74, v75
    v_mfma_f32_16x16x32_bf16 v[84:87], v[128:131], v[20:23], v[84:87]
    v_exp_f32 v80, v80
    v_mfma_f32_16x16x32_bf16 v[84:87], v[132:135], v[24:27], v[84:87]
    v_exp_f32 v81, v81
    v_mfma_f32_16x16x32_bf16 v[88:91], v[132:135], v[40:43], v[64:67]
    ds_read_b64_tr_b16 v[140:141], v3 offset:59296
    v_cvt_pk_bf16_f32 v100, v76, v77
    v_mfma_f32_16x16x32_bf16 v[88:91], v[128:131], v[36:39], v[88:91]
    ds_read_b64_tr_b16 v[142:143], v3 offset:59808
    v_cvt_pk_bf16_f32 v101, v78, v79
    v_mfma_f32_16x16x32_bf16 v[88:91], v[124:127], v[32:35], v[88:91]
    v_exp_f32 v82, v82
    v_mfma_f32_16x16x32_bf16 v[88:91], v[120:123], v[28:31], v[88:91]
    v_exp_f32 v83, v83
    v_mfma_f32_16x16x32_bf16 v[92:95], v[120:123], v[44:47], v[68:71]
    s_waitcnt vmcnt(8)
    ds_read_b64_tr_b16 v[144:145], v3 offset:59328
    v_cvt_pk_bf16_f32 v104, v80, v81
    v_mfma_f32_16x16x32_bf16 v[92:95], v[124:127], v[48:51], v[92:95]
    s_getreg_b32 s25, hwreg(HW_REG_IB_STS, 0, 4)
    ds_read_b64_tr_b16 v[146:147], v3 offset:59840
    v_cvt_pk_bf16_f32 v105, v82, v83
    v_mfma_f32_16x16x32_bf16 v[92:95], v[128:131], v[52:55], v[92:95]
    s_cmp_ge_u32 s25, s56
    ds_read_b64_tr_b16 v[148:149], v3 offset:59360
    v_mfma_f32_16x16x32_bf16 v[92:95], v[132:135], v[56:59], v[92:95]
    ds_read_b64_tr_b16 v[150:151], v3 offset:59872
    s_cbranch_scc1 L_df_39
L_df_39i:
    v_mfma_f32_16x16x32_bf16 a[200:203], a[204:207], v[116:119], a[200:203]
    s_barrier
    ds_read_b128 v[120:123], v2 offset:8448
    v_mfma_f32_16x16x32_bf16 a[196:199], a[204:207], v[112:115], a[196:199]
    s_waitcnt lgkmcnt(5)
    ds_read_b128 v[124:127], v2 offset:8512
    v_mfma_f32_16x16x32_bf16 a[192:195], a[204:207], v[108:111], a[192:195]
    ds_read_b128 v[128:131], v2 offset:8576
    v_mfma_f32_16x16x32_bf16 v[208:211], v[136:139], v[108:111], v[208:211]
    s_add_u32 s57, s57, 8192
    ds_read_b128 v[132:135], v2 offset:8640
    v_exp_f32 v84, v84
    v_mfma_f32_16x16x32_bf16 v[212:215], v[136:139], v[112:115], v[212:215]
    s_add_u32 m0, s58, s3
    v_exp_f32 v85, v85
    v_mfma_f32_16x16x32_bf16 v[216:219], v[136:139], v[116:119], v[216:219]
    buffer_load_dwordx4 v1, s[44:47], s64 offen nt lds
    v_mfma_f32_16x16x32_bf16 v[228:231], v[140:143], v[116:119], v[228:231]
    s_waitcnt lgkmcnt(4)
    v_exp_f32 v86, v86
    v_mfma_f32_16x16x32_bf16 v[224:227], v[140:143], v[112:115], v[224:227]
    s_add_u32 m0, m0, 32
    v_exp_f32 v87, v87
    v_mfma_f32_16x16x32_bf16 v[220:223], v[140:143], v[108:111], v[220:223]
    buffer_load_dwordx4 v1, s[44:47], s64 offen offset:1024 nt lds
    v_mfma_f32_16x16x32_bf16 v[232:235], v[144:147], v[108:111], v[232:235]
    s_mov_b32 s64, s65
    v_exp_f32 v88, v88
    v_mfma_f32_16x16x32_bf16 v[236:239], v[144:147], v[112:115], v[236:239]
    s_add_u32 m0, s59, s61
    v_exp_f32 v89, v89
    v_mfma_f32_16x16x32_bf16 v[240:243], v[144:147], v[116:119], v[240:243]
    s_mov_b32 s58, s59
    buffer_load_dwordx4 v1, s[40:43], s65 offen nt lds
    v_mfma_f32_16x16x32_bf16 v[252:255], v[148:151], v[116:119], v[252:255]
    s_waitcnt lgkmcnt(0)
    v_exp_f32 v90, v90
    v_mfma_f32_16x16x32_bf16 v[248:251], v[148:151], v[112:115], v[248:251]
    s_add_u32 m0, m0, 32
    v_exp_f32 v91, v91
    v_mfma_f32_16x16x32_bf16 v[244:247], v[148:151], v[108:111], v[244:247]
    buffer_load_dwordx4 v1, s[40:43], s65 offen offset:1024 nt lds
L_dfb_40:
    v_mfma_f32_16x16x32_bf16 v[72:75], v[120:123], v[12:15], v[60:63]
    ds_read_b64_tr_b16 v[136:137], v3 offset:0
    v_cvt_pk_bf16_f32 v98, v84, v85
    v_mfma_f32_16x16x32_bf16 v[72:75], v[124:127], v[16:19], v[72:75]
    s_xor_b32 s65, s57, s22
    ds_read_b64_tr_b16 v[138:139], v3 offset:512
    v_cvt_pk_bf16_f32 v99, v86, v87
    v_mfma_f32_16x16x32_bf16 v[72:75], v[128:131], v[20:23], v[72:75]
    s_bfe_u32 s59, s57, 0x3000d
    v_exp_f32 v92, v92
    v_mfma_f32_16x16x32_bf16 v[72:75], v[132:135], v[24:27], v[72:75]
    s_mul_i32 s59, s59, 8448
    v_exp_f32 v93, v93
    v_mfma_f32_16x16x32_bf16 v[76:79], v[132:135], v[40:43], v[64:67]
    ds_read_b64_tr_b16 v[140:141], v3 offset:32
    v_cvt_pk_bf16_f32 v102, v88, v89
    v_mfma_f32_16x16x32_bf16 v[76:79], v[128:131], v[36:39], v[76:79]
    ds_read_b64_tr_b16 v[142:143], v3 offset:544
    v_cvt_pk_bf16_f32 v103, v90, v91
    v_mfma_f32_16x16x32_bf16 v[76:79], v[124:127], v[32:35], v[76:79]
    v_exp_f32 v94, v94
    v_mfma_f32_16x16x32_bf16 v[76:79], v[120:123], v[28:31], v[76:79]
    v_exp_f32 v95, v95
    v_mfma_f32_16x16x32_bf16 v[80:83], v[120:123], v[44:47], v[68:71]
    ds_read_b64_tr_b16 v[144:145], v3 offset:64
    v_cvt_pk_bf16_f32 v106, v92, v93
    v_mfma_f32_16x16x32_bf16 v[80:83], v[124:127], v[48:51], v[80:83]
    ds_read_b64_tr_b16 v[146:147], v3 offset:576
    v_cvt_pk_bf16_f32 v107, v94, v95
    v_mfma_f32_16x16x32_bf16 v[80:83], v[128:131], v[52:55], v[80:83]
    ds_read_b64_tr_b16 v[148:149], v3 offset:96
    v_mfma_f32_16x16x32_bf16 v[80:83], v[132:135], v[56:59], v[80:83]
    s_waitcnt lgkmcnt(5)
    ds_read_b64_tr_b16 v[150:151], v3 offset:608
    v_mfma_f32_16x16x32_bf16 v[160:163], v[136:139], v[96:99], v[160:163]
    s_getreg_b32 s25, hwreg(HW_REG_IB_STS, 0, 4)
    ds_read_b128 v[120:123], v2 offset:8960
    v_mfma_f32_16x16x32_bf16 v[164:167], v[136:139], v[100:103], v[164:167]
    s_add_u32 s25, s25, 3
    ds_read_b128 v[124:127], v2 offset:9024
    v_mfma_f32_16x16x32_bf16 v[168:171], v[136:139], v[104:107], v[168:171]
    s_waitcnt lgkmcnt(6)
    ds_read_b128 v[128:131], v2 offset:9088
    v_mfma_f32_16x16x32_bf16 v[180:183], v[140:143], v[104:107], v[180:183]
    s_cmp_le_u32 s25, s56
    ds_read_b128 v[132:135], v2 offset:9152
    v_mfma_f32_16x16x32_bf16 v[176:179], v[140:143], v[100:103], v[176:179]
    s_cselect_b32 s25, s76, 0
    v_exp_f32 v72, v72
    v_mfma_f32_16x16x32_bf16 v[172:175], v[140:143], v[96:99], v[172:175]
    s_waitcnt lgkmcnt(6)
    v_exp_f32 v73, v73
    v_mfma_f32_16x16x32_bf16 v[184:187], v[144:147], v[96:99], v[184:187]
    s_cmp_gt_u32 s25, 0
    v_exp_f32 v74, v74
    v_mfma_f32_16x16x32_bf16 v[188:191], v[144:147], v[100:103], v[188:191]
    s_cbranch_scc1 L_cu_41
L_cub_42:
    v_exp_f32 v75, v75
    v_mfma_f32_16x16x32_bf16 v[192:195], v[144:147], v[104:107], v[192:195]
    s_waitcnt lgkmcnt(4)
    v_exp_f32 v76, v76
    v_mfma_f32_16x16x32_bf16 v[204:207], v[148:151], v[104:107], v[204:207]
    v_exp_f32 v77, v77
    v_mfma_f32_16x16x32_bf16 v[200:203], v[148:151], v[100:103], v[200:203]
    s_waitcnt lgkmcnt(0)
    v_exp_f32 v78, v78
    v_mfma_f32_16x16x32_bf16 v[196:199], v[148:151], v[96:99], v[196:199]
    v_exp_f32 v79, v79
    v_mfma_f32_16x16x32_bf16 v[84:87], v[120:123], v[12:15], v[60:63]
    ds_read_b64_tr_b16 v[136:137], v3 offset:128
    v_cvt_pk_bf16_f32 v108, v72, v73
    v_mfma_f32_16x16x32_bf16 v[84:87], v[124:127], v[16:19], v[84:87]
    ds_read_b64_tr_b16 v[138:139], v3 offset:640
    v_cvt_pk_bf16_f32 v109, v74, v75
    v_mfma_f32_16x16x32_bf16 v[84:87], v[128:131], v[20:23], v[84:87]
    v_exp_f32 v80, v80
    v_mfma_f32_16x16x32_bf16 v[84:87], v[132:135], v[24:27], v[84:87]
    v_exp_f32 v81, v81
    v_mfma_f32_16x16x32_bf16 v[88:91], v[132:135], v[40:43], v[64:67]
    ds_read_b64_tr_b16 v[140:141], v3 offset:160
    v_cvt_pk_bf16_f32 v112, v76, v77
    v_mfma_f32_16x16x32_bf16 v[88:91], v[128:131], v[36:39], v[88:91]
    ds_read_b64_tr_b16 v[142:143], v3 offset:672
    v_cvt_pk_bf16_f32 v113, v78, v79
    v_mfma_f32_16x16x32_bf16 v[88:91], v[124:127], v[32:35], v[88:91]
    v_exp_f32 v82, v82
    v_mfma_f32_16x16x32_bf16 v[88:91], v[120:123], v[28:31], v[88:91]
    v_exp_f32 v83, v83
    v_mfma_f32_16x16x32_bf16 v[92:95], v[120:123], v[44:47], v[68:71]
    s_waitcnt vmcnt(8)
    ds_read_b64_tr_b16 v[144:145], v3 offset:192
    v_cvt_pk_bf16_f32 v116, v80, v81
    v_mfma_f32_16x16x32_bf16 v[92:95], v[124:127], v[48:51], v[92:95]
    s_getreg_b32 s25, hwreg(HW_REG_IB_STS, 0, 4)
    ds_read_b64_tr_b16 v[146:147], v3 offset:704
    v_cvt_pk_bf16_f32 v117, v82, v83
    v_mfma_f32_16x16x32_bf16 v[92:95], v[128:131], v[52:55], v[92:95]
    s_cmp_ge_u32 s25, s56
    ds_read_b64_tr_b16 v[148:149], v3 offset:224
    v_mfma_f32_16x16x32_bf16 v[92:95], v[132:135], v[56:59], v[92:95]
    ds_read_b64_tr_b16 v[150:151], v3 offset:736
    s_cbranch_scc1 L_df_43
L_df_43i:
    v_mfma_f32_16x16x32_bf16 a[200:203], a[204:207], v[104:107], a[200:203]
    s_barrier
    ds_read_b128 v[120:123], v2 offset:16896
    v_mfma_f32_16x16x32_bf16 a[196:199], a[204:207], v[100:103], a[196:199]
    s_waitcnt lgkmcnt(5)
    ds_read_b128 v[124:127], v2 offset:16960
    v_mfma_f32_16x16x32_bf16 a[192:195], a[204:207], v[96:99], a[192:195]
    ds_read_b128 v[128:131], v2 offset:17024
    v_mfma_f32_16x16x32_bf16 v[208:211], v[136:139], v[96:99], v[208:211]
    s_add_u32 s57, s57, 8192
    ds_read_b128 v[132:135], v2 offset:17088
    v_exp_f32 v84, v84
    v_mfma_f32_16x16x32_bf16 v[212:215], v[136:139], v[100:103], v[212:215]
    s_add_u32 m0, s58, s3
    v_exp_f32 v85, v85
    v_mfma_f32_16x16x32_bf16 v[216:219], v[136:139], v[104:107], v[216:219]
    buffer_load_dwordx4 v1, s[44:47], s64 offen nt lds
    v_mfma_f32_16x16x32_bf16 v[228:231], v[140:143], v[104:107], v[228:231]
    s_waitcnt lgkmcnt(4)
    v_exp_f32 v86, v86
    v_mfma_f32_16x16x32_bf16 v[224:227], v[140:143], v[100:103], v[224:227]
    s_add_u32 m0, m0, 32
    v_exp_f32 v87, v87
    v_mfma_f32_16x16x32_bf16 v[220:223], v[140:143], v[96:99], v[220:223]
    buffer_load_dwordx4 v1, s[44:47], s64 offen offset:1024 nt lds
    v_mfma_f32_16x16x32_bf16 v[232:235], v[144:147], v[96:99], v[232:235]
    s_mov_b32 s64, s65
    v_exp_f32 v88, v88
    v_mfma_f32_16x16x32_bf16 v[236:239], v[144:147], v[100:103], v[236:239]
    s_add_u32 m0, s59, s61
    v_exp_f32 v89, v89
    v_mfma_f32_16x16x32_bf16 v[240:243], v[144:147], v[104:107], v[240:243]
    s_mov_b32 s58, s59
    buffer_load_dwordx4 v1, s[40:43], s65 offen nt lds
    v_mfma_f32_16x16x32_bf16 v[252:255], v[148:151], v[104:107], v[252:255]
    s_waitcnt lgkmcnt(0)
    v_exp_f32 v90, v90
    v_mfma_f32_16x16x32_bf16 v[248:251], v[148:151], v[100:103], v[248:251]
    s_add_u32 m0, m0, 32
    v_exp_f32 v91, v91
    v_mfma_f32_16x16x32_bf16 v[244:247], v[148:151], v[96:99], v[244:247]
    buffer_load_dwordx4 v1, s[40:43], s65 offen offset:1024 nt lds
L_dfb_44:
    v_mfma_f32_16x16x32_bf16 v[72:75], v[120:123], v[12:15], v[60:63]
    ds_read_b64_tr_b16 v[136:137], v3 offset:8448
    v_cvt_pk_bf16_f32 v110, v84, v85
    v_mfma_f32_16x16x32_bf16 v[72:75], v[124:127], v[16:19], v[72:75]
    s_xor_b32 s65, s57, s22
    ds_read_b64_tr_b16 v[138:139], v3 offset:8960
    v_cvt_pk_bf16_f32 v111, v86, v87
    v_mfma_f32_16x16x32_bf16 v[72:75], v[128:131], v[20:23], v[72:75]
    s_bfe_u32 s59, s57, 0x3000d
    v_exp_f32 v92, v92
    v_mfma_f32_16x16x32_bf16 v[72:75], v[132:135], v[24:27], v[72:75]
    s_mul_i32 s59, s59, 8448
    v_exp_f32 v93, v93
    v_mfma_f32_16x16x32_bf16 v[76:79], v[132:135], v[40:43], v[64:67]
    ds_read_b64_tr_b16 v[140:141], v3 offset:8480
    v_cvt_pk_bf16_f32 v114, v88, v89
    v_mfma_f32_16x16x32_bf16 v[76:79], v[128:131], v[36:39], v[76:79]
    ds_read_b64_tr_b16 v[142:143], v3 offset:8992
    v_cvt_pk_bf16_f32 v115, v90, v91
    v_mfma_f32_16x16x32_bf16 v[76:79], v[124:127], v[32:35], v[76:79]
    v_exp_f32 v94, v94
    v_mfma_f32_16x16x32_bf16 v[76:79], v[120:123], v[28:31], v[76:79]
    v_exp_f32 v95, v95
    v_mfma_f32_16x16x32_bf16 v[80:83], v[120:123], v[44:47], v[68:71]
    ds_read_b64_tr_b16 v[144:145], v3 offset:8512
    v_cvt_pk_bf16_f32 v118, v92, v93
    v_mfma_f32_16x16x32_bf16 v[80:83], v[124:127], v[48:51], v[80:83]
    ds_read_b64_tr_b16 v[146:147], v3 offset:9024
    v_cvt_pk_bf16_f32 v119, v94, v95
    v_mfma_f32_16x16x32_bf16 v[80:83], v[128:131], v[52:55], v[80:83]
    ds_read_b64_tr_b16 v[148:149], v3 offset:8544
    v_mfma_f32_16x16x32_bf16 v[80:83], v[132:135], v[56:59], v[80:83]
    s_waitcnt lgkmcnt(5)
    ds_read_b64_tr_b16 v[150:151], v3 offset:9056
    v_mfma_f32_16x16x32_bf16 v[160:163], v[136:139], v[108:111], v[160:163]
    ds_read_b128 v[120:123], v2 offset:17408
    v_mfma_f32_16x16x32_bf16 v[164:167], v[136:139], v[112:115], v[164:167]
    ds_read_b128 v[124:127], v2 offset:17472
    v_mfma_f32_16x16x32_bf16 v[168:171], v[136:139], v[116:119], v[168:171]
    s_waitcnt lgkmcnt(6)
    ds_read_b128 v[128:131], v2 offset:17536
    v_mfma_f32_16x16x32_bf16 v[180:183], v[140:143], v[116:119], v[180:183]
    ds_read_b128 v[132:135], v2 offset:17600
    v_mfma_f32_16x16x32_bf16 v[176:179], v[140:143], v[112:115], v[176:179]
    v_exp_f32 v72, v72
    v_mfma_f32_16x16x32_bf16 v[172:175], v[140:143], v[108:111], v[172:175]
    s_waitcnt lgkmcnt(6)
    v_exp_f32 v73, v73
    v_mfma_f32_16x16x32_bf16 v[184:187], v[144:147], v[108:111], v[184:187]
    v_exp_f32 v74, v74
    v_mfma_f32_16x16x32_bf16 v[188:191], v[144:147], v[112:115], v[188:191]
    v_exp_f32 v75, v75
    v_mfma_f32_16x16x32_bf16 v[192:195], v[144:147], v[116:119], v[192:195]
    s_waitcnt lgkmcnt(4)
    v_exp_f32 v76, v76
    v_mfma_f32_16x16x32_bf16 v[204:207], v[148:151], v[116:119], v[204:207]
    v_exp_f32 v77, v77
    v_mfma_f32_16x16x32_bf16 v[200:203], v[148:151], v[112:115], v[200:203]
    s_waitcnt lgkmcnt(0)
    v_exp_f32 v78, v78
    v_mfma_f32_16x16x32_bf16 v[196:199], v[148:151], v[108:111], v[196:199]
    v_exp_f32 v79, v79
    v_mfma_f32_16x16x32_bf16 v[84:87], v[120:123], v[12:15], v[60:63]
    ds_read_b64_tr_b16 v[136:137], v3 offset:8576
    v_cvt_pk_bf16_f32 v96, v72, v73
    v_mfma_f32_16x16x32_bf16 v[84:87], v[124:127], v[16:19], v[84:87]
    ds_read_b64_tr_b16 v[138:139], v3 offset:9088
    v_cvt_pk_bf16_f32 v97, v74, v75
    v_mfma_f32_16x16x32_bf16 v[84:87], v[128:131], v[20:23], v[84:87]
    s_cmp_eq_u32 s67, s30
    v_exp_f32 v80, v80
    v_mfma_f32_16x16x32_bf16 v[84:87], v[132:135], v[24:27], v[84:87]
    s_cselect_b32 s56, 0, s56
    v_exp_f32 v81, v81
    v_mfma_f32_16x16x32_bf16 v[88:91], v[132:135], v[40:43], v[64:67]
    ds_read_b64_tr_b16 v[140:141], v3 offset:8608
    v_cvt_pk_bf16_f32 v100, v76, v77
    v_mfma_f32_16x16x32_bf16 v[88:91], v[128:131], v[36:39], v[88:91]
    ds_read_b64_tr_b16 v[142:143], v3 offset:9120
    v_cvt_pk_bf16_f32 v101, v78, v79
    v_mfma_f32_16x16x32_bf16 v[88:91], v[124:127], v[32:35], v[88:91]
    v_exp_f32 v82, v82
    v_mfma_f32_16x16x32_bf16 v[88:91], v[120:123], v[28:31], v[88:91]
    v_exp_f32 v83, v83
    v_mfma_f32_16x16x32_bf16 v[92:95], v[120:123], v[44:47], v[68:71]
    s_waitcnt vmcnt(8)
    ds_read_b64_tr_b16 v[144:145], v3 offset:8640
    v_cvt_pk_bf16_f32 v104, v80, v81
    v_mfma_f32_16x16x32_bf16 v[92:95], v[124:127], v[48:51], v[92:95]
    s_getreg_b32 s25, hwreg(HW_REG_IB_STS, 0, 4)
    ds_read_b64_tr_b16 v[146:147], v3 offset:9152
    v_cvt_pk_bf16_f32 v105, v82, v83
    v_mfma_f32_16x16x32_bf16 v[92:95], v[128:131], v[52:55], v[92:95]
    s_cmp_ge_u32 s25, s56
    ds_read_b64_tr_b16 v[148:149], v3 offset:8672
    v_mfma_f32_16x16x32_bf16 v[92:95], v[132:135], v[56:59], v[92:95]
    ds_read_b64_tr_b16 v[150:151], v3 offset:9184
    s_cbranch_scc1 L_df_45
L_df_45i:
    v_mfma_f32_16x16x32_bf16 a[200:203], a[204:207], v[116:119], a[200:203]
    s_barrier
    ds_read_b128 v[120:123], v2 offset:25344
    v_mfma_f32_16x16x32_bf16 a[196:199], a[204:207], v[112:115], a[196:199]
    s_waitcnt lgkmcnt(5)
    ds_read_b128 v[124:127], v2 offset:25408
    v_mfma_f32_16x16x32_bf16 a[192:195], a[204:207], v[108:111], a[192:195]
    ds_read_b128 v[128:131], v2 offset:25472
    v_mfma_f32_16x16x32_bf16 v[208:211], v[136:139], v[108:111], v[208:211]
    s_add_u32 s57, s57, 8192
    ds_read_b128 v[132:135], v2 offset:25536
    v_exp_f32 v84, v84
    v_mfma_f32_16x16x32_bf16 v[212:215], v[136:139], v[112:115], v[212:215]
    s_add_u32 m0, s58, s3
    v_exp_f32 v85, v85
    v_mfma_f32_16x16x32_bf16 v[216:219], v[136:139], v[116:119], v[216:219]
    buffer_load_dwordx4 v1, s[44:47], s64 offen nt lds
    v_mfma_f32_16x16x32_bf16 v[228:231], v[140:143], v[116:119], v[228:231]
    s_waitcnt lgkmcnt(4)
    v_exp_f32 v86, v86
    v_mfma_f32_16x16x32_bf16 v[224:227], v[140:143], v[112:115], v[224:227]
    s_add_u32 m0, m0, 32
    v_exp_f32 v87, v87
    v_mfma_f32_16x16x32_bf16 v[220:223], v[140:143], v[108:111], v[220:223]
    buffer_load_dwordx4 v1, s[44:47], s64 offen offset:1024 nt lds
    v_mfma_f32_16x16x32_bf16 v[232:235], v[144:147], v[108:111], v[232:235]
    s_mov_b32 s64, s65
    v_exp_f32 v88, v88
    v_mfma_f32_16x16x32_bf16 v[236:239], v[144:147], v[112:115], v[236:239]
    s_add_u32 m0, s59, s61
    v_exp_f32 v89, v89
    v_mfma_f32_16x16x32_bf16 v[240:243], v[144:147], v[116:119], v[240:243]
    s_mov_b32 s58, s59
    buffer_load_dwordx4 v1, s[40:43], s65 offen nt lds
    v_mfma_f32_16x16x32_bf16 v[252:255], v[148:151], v[116:119], v[252:255]
    s_waitcnt lgkmcnt(0)
    v_exp_f32 v90, v90
    v_mfma_f32_16x16x32_bf16 v[248:251], v[148:151], v[112:115], v[248:251]
    s_add_u32 m0, m0, 32
    v_exp_f32 v91, v91
    v_mfma_f32_16x16x32_bf16 v[244:247], v[148:151], v[108:111], v[244:247]
    buffer_load_dwordx4 v1, s[40:43], s65 offen offset:1024 nt lds
L_dfb_46:
    v_mfma_f32_16x16x32_bf16 v[72:75], v[120:123], v[12:15], v[60:63]
    ds_read_b64_tr_b16 v[136:137], v3 offset:16896
    v_cvt_pk_bf16_f32 v98, v84, v85
    v_mfma_f32_16x16x32_bf16 v[72:75], v[124:127], v[16:19], v[72:75]
    s_xor_b32 s65, s57, s22
    ds_read_b64_tr_b16 v[138:139], v3 offset:17408
    v_cvt_pk_bf16_f32 v99, v86, v87
    v_mfma_f32_16x16x32_bf16 v[72:75], v[128:131], v[20:23], v[72:75]
    s_bfe_u32 s59, s57, 0x3000d
    v_exp_f32 v92, v92
    v_mfma_f32_16x16x32_bf16 v[72:75], v[132:135], v[24:27], v[72:75]
    s_mul_i32 s59, s59, 8448
    v_exp_f32 v93, v93
    v_mfma_f32_16x16x32_bf16 v[76:79], v[132:135], v[40:43], v[64:67]
    ds_read_b64_tr_b16 v[140:141], v3 offset:16928
    v_cvt_pk_bf16_f32 v102, v88, v89
    v_mfma_f32_16x16x32_bf16 v[76:79], v[128:131], v[36:39], v[76:79]
    ds_read_b64_tr_b16 v[142:143], v3 offset:17440
    v_cvt_pk_bf16_f32 v103, v90, v91
    v_mfma_f32_16x16x32_bf16 v[76:79], v[124:127], v[32:35], v[76:79]
    v_exp_f32 v94, v94
    v_mfma_f32_16x16x32_bf16 v[76:79], v[120:123], v[28:31], v[76:79]
    v_exp_f32 v95, v95
    v_mfma_f32_16x16x32_bf16 v[80:83], v[120:123], v[44:47], v[68:71]
    ds_read_b64_tr_b16 v[144:145], v3 offset:16960
    v_cvt_pk_bf16_f32 v106, v92, v93
    v_mfma_f32_16x16x32_bf16 v[80:83], v[124:127], v[48:51], v[80:83]
    ds_read_b64_tr_b16 v[146:147], v3 offset:17472
    v_cvt_pk_bf16_f32 v107, v94, v95
    v_mfma_f32_16x16x32_bf16 v[80:83], v[128:131], v[52:55], v[80:83]
    ds_read_b64_tr_b16 v[148:149], v3 offset:16992
    v_mfma_f32_16x16x32_bf16 v[80:83], v[132:135], v[56:59], v[80:83]
    s_waitcnt lgkmcnt(5)
    ds_read_b64_tr_b16 v[150:151], v3 offset:17504
    v_mfma_f32_16x16x32_bf16 v[160:163], v[136:139], v[96:99], v[160:163]
    s_getreg_b32 s25, hwreg(HW_REG_IB_STS, 0, 4)
    ds_read_b128 v[120:123], v2 offset:25856
    v_mfma_f32_16x16x32_bf16 v[164:167], v[136:139], v[100:103], v[164:167]
    s_add_u32 s25, s25, 3
    ds_read_b128 v[124:127], v2 offset:25920
    v_mfma_f32_16x16x32_bf16 v[168:171], v[136:139], v[104:107], v[168:171]
    s_waitcnt lgkmcnt(6)
    ds_read_b128 v[128:131], v2 offset:25984
    v_mfma_f32_16x16x32_bf16 v[180:183], v[140:143], v[104:107], v[180:183]
    s_cmp_le_u32 s25, s56
    ds_read_b128 v[132:135], v2 offset:26048
    v_mfma_f32_16x16x32_bf16 v[176:179], v[140:143], v[100:103], v[176:179]
    s_cselect_b32 s25, s76, 0
    v_exp_f32 v72, v72
    v_mfma_f32_16x16x32_bf16 v[172:175], v[140:143], v[96:99], v[172:175]
    s_waitcnt lgkmcnt(6)
    v_exp_f32 v73, v73
    v_mfma_f32_16x16x32_bf16 v[184:187], v[144:147], v[96:99], v[184:187]
    s_cmp_gt_u32 s25, 0
    v_exp_f32 v74, v74
    v_mfma_f32_16x16x32_bf16 v[188:191], v[144:147], v[100:103], v[188:191]
    s_cbranch_scc1 L_cu_47
L_cub_48:
    v_exp_f32 v75, v75
    v_mfma_f32_16x16x32_bf16 v[192:195], v[144:147], v[104:107], v[192:195]
    s_waitcnt lgkmcnt(4)
    v_exp_f32 v76, v76
    v_mfma_f32_16x16x32_bf16 v[204:207], v[148:151], v[104:107], v[204:207]
    v_exp_f32 v77, v77
    v_mfma_f32_16x16x32_bf16 v[200:203], v[148:151], v[100:103], v[200:203]
    s_waitcnt lgkmcnt(0)
    v_exp_f32 v78, v78
    v_mfma_f32_16x16x32_bf16 v[196:199], v[148:151], v[96:99], v[196:199]
    v_exp_f32 v79, v79
    v_mfma_f32_16x16x32_bf16 v[84:87], v[120:123], v[12:15], v[60:63]
    ds_read_b64_tr_b16 v[136:137], v3 offset:17024
    v_cvt_pk_bf16_f32 v108, v72, v73
    v_mfma_f32_16x16x32_bf16 v[84:87], v[124:127], v[16:19], v[84:87]
    ds_read_b64_tr_b16 v[138:139], v3 offset:17536
    v_cvt_pk_bf16_f32 v109, v74, v75
    v_mfma_f32_16x16x32_bf16 v[84:87], v[128:131], v[20:23], v[84:87]
    v_exp_f32 v80, v80
    v_mfma_f32_16x16x32_bf16 v[84:87], v[132:135], v[24:27], v[84:87]
    v_exp_f32 v81, v81
    v_mfma_f32_16x16x32_bf16 v[88:91], v[132:135], v[40:43], v[64:67]
    ds_read_b64_tr_b16 v[140:141], v3 offset:17056
    v_cvt_pk_bf16_f32 v112, v76, v77
    v_mfma_f32_16x16x32_bf16 v[88:91], v[128:131], v[36:39], v[88:91]
    ds_read_b64_tr_b16 v[142:143], v3 offset:17568
    v_cvt_pk_bf16_f32 v113, v78, v79
    v_mfma_f32_16x16x32_bf16 v[88:91], v[124:127], v[32:35], v[88:91]
    v_exp_f32 v82, v82
    v_mfma_f32_16x16x32_bf16 v[88:91], v[120:123], v[28:31], v[88:91]
    v_exp_f32 v83, v83
    v_mfma_f32_16x16x32_bf16 v[92:95], v[120:123], v[44:47], v[68:71]
    s_waitcnt vmcnt(8)
    ds_read_b64_tr_b16 v[144:145], v3 offset:17088
    v_cvt_pk_bf16_f32 v116, v80, v81
    v_mfma_f32_16x16x32_bf16 v[92:95], v[124:127], v[48:51], v[92:95]
    s_getreg_b32 s25, hwreg(HW_REG_IB_STS, 0, 4)
    ds_read_b64_tr_b16 v[146:147], v3 offset:17600
    v_cvt_pk_bf16_f32 v117, v82, v83
    v_mfma_f32_16x16x32_bf16 v[92:95], v[128:131], v[52:55], v[92:95]
    s_cmp_ge_u32 s25, s56
    ds_read_b64_tr_b16 v[148:149], v3 offset:17120
    v_mfma_f32_16x16x32_bf16 v[92:95], v[132:135], v[56:59], v[92:95]
    ds_read_b64_tr_b16 v[150:151], v3 offset:17632
    s_cbranch_scc1 L_df_49
L_df_49i:
    v_mfma_f32_16x16x32_bf16 a[200:203], a[204:207], v[104:107], a[200:203]
    s_barrier
    ds_read_b128 v[120:123], v2 offset:33792
    v_mfma_f32_16x16x32_bf16 a[196:199], a[204:207], v[100:103], a[196:199]
    s_waitcnt lgkmcnt(5)
    ds_read_b128 v[124:127], v2 offset:33856
    v_mfma_f32_16x16x32_bf16 a[192:195], a[204:207], v[96:99], a[192:195]
    ds_read_b128 v[128:131], v2 offset:33920
    v_mfma_f32_16x16x32_bf16 v[208:211], v[136:139], v[96:99], v[208:211]
    s_add_u32 s57, s57, 8192
    ds_read_b128 v[132:135], v2 offset:33984
    v_exp_f32 v84, v84
    v_mfma_f32_16x16x32_bf16 v[212:215], v[136:139], v[100:103], v[212:215]
    s_add_u32 m0, s58, s3
    v_exp_f32 v85, v85
    v_mfma_f32_16x16x32_bf16 v[216:219], v[136:139], v[104:107], v[216:219]
    buffer_load_dwordx4 v1, s[44:47], s64 offen nt lds
    v_mfma_f32_16x16x32_bf16 v[228:231], v[140:143], v[104:107], v[228:231]
    s_waitcnt lgkmcnt(4)
    v_exp_f32 v86, v86
    v_mfma_f32_16x16x32_bf16 v[224:227], v[140:143], v[100:103], v[224:227]
    s_add_u32 m0, m0, 32
    v_exp_f32 v87, v87
    v_mfma_f32_16x16x32_bf16 v[220:223], v[140:143], v[96:99], v[220:223]
    buffer_load_dwordx4 v1, s[44:47], s64 offen offset:1024 nt lds
    v_mfma_f32_16x16x32_bf16 v[232:235], v[144:147], v[96:99], v[232:235]
    s_mov_b32 s64, s65
    v_exp_f32 v88, v88
    v_mfma_f32_16x16x32_bf16 v[236:239], v[144:147], v[100:103], v[236:239]
    s_add_u32 m0, s59, s61
    v_exp_f32 v89, v89
    v_mfma_f32_16x16x32_bf16 v[240:243], v[144:147], v[104:107], v[240:243]
    s_mov_b32 s58, s59
    buffer_load_dwordx4 v1, s[40:43], s65 offen nt lds
    v_mfma_f32_16x16x32_bf16 v[252:255], v[148:151], v[104:107], v[252:255]
    s_waitcnt lgkmcnt(0)
    v_exp_f32 v90, v90
    v_mfma_f32_16x16x32_bf16 v[248:251], v[148:151], v[100:103], v[248:251]
    s_add_u32 m0, m0, 32
    v_exp_f32 v91, v91
    v_mfma_f32_16x16x32_bf16 v[244:247], v[148:151], v[96:99], v[244:247]
    buffer_load_dwordx4 v1, s[40:43], s65 offen offset:1024 nt lds
L_dfb_50:
    v_mfma_f32_16x16x32_bf16 v[72:75], v[120:123], v[12:15], v[60:63]
    ds_read_b64_tr_b16 v[136:137], v3 offset:25344
    v_cvt_pk_bf16_f32 v110, v84, v85
    v_mfma_f32_16x16x32_bf16 v[72:75], v[124:127], v[16:19], v[72:75]
    s_xor_b32 s65, s57, s22
    ds_read_b64_tr_b16 v[138:139], v3 offset:25856
    v_cvt_pk_bf16_f32 v111, v86, v87
    v_mfma_f32_16x16x32_bf16 v[72:75], v[128:131], v[20:23], v[72:75]
    s_bfe_u32 s59, s57, 0x3000d
    v_exp_f32 v92, v92
    v_mfma_f32_16x16x32_bf16 v[72:75], v[132:135], v[24:27], v[72:75]
    s_mul_i32 s59, s59, 8448
    v_exp_f32 v93, v93
    v_mfma_f32_16x16x32_bf16 v[76:79], v[132:135], v[40:43], v[64:67]
    ds_read_b64_tr_b16 v[140:141], v3 offset:25376
    v_cvt_pk_bf16_f32 v114, v88, v89
    v_mfma_f32_16x16x32_bf16 v[76:79], v[128:131], v[36:39], v[76:79]
    ds_read_b64_tr_b16 v[142:143], v3 offset:25888
    v_cvt_pk_bf16_f32 v115, v90, v91
    v_mfma_f32_16x16x32_bf16 v[76:79], v[124:127], v[32:35], v[76:79]
    v_exp_f32 v94, v94
    v_mfma_f32_16x16x32_bf16 v[76:79], v[120:123], v[28:31], v[76:79]
    v_exp_f32 v95, v95
    v_mfma_f32_16x16x32_bf16 v[80:83], v[120:123], v[44:47], v[68:71]
    ds_read_b64_tr_b16 v[144:145], v3 offset:25408
    v_cvt_pk_bf16_f32 v118, v92, v93
    v_mfma_f32_16x16x32_bf16 v[80:83], v[124:127], v[48:51], v[80:83]
    ds_read_b64_tr_b16 v[146:147], v3 offset:25920
    v_cvt_pk_bf16_f32 v119, v94, v95
    v_mfma_f32_16x16x32_bf16 v[80:83], v[128:131], v[52:55], v[80:83]
    ds_read_b64_tr_b16 v[148:149], v3 offset:25440
    v_mfma_f32_16x16x32_bf16 v[80:83], v[132:135], v[56:59], v[80:83]
    s_waitcnt lgkmcnt(5)
    ds_read_b64_tr_b16 v[150:151], v3 offset:25952
    v_mfma_f32_16x16x32_bf16 v[160:163], v[136:139], v[108:111], v[160:163]
    ds_read_b128 v[120:123], v2 offset:34304
    v_mfma_f32_16x16x32_bf16 v[164:167], v[136:139], v[112:115], v[164:167]
    ds_read_b128 v[124:127], v2 offset:34368
    v_mfma_f32_16x16x32_bf16 v[168:171], v[136:139], v[116:119], v[168:171]
    s_waitcnt lgkmcnt(6)
    ds_read_b128 v[128:131], v2 offset:34432
    v_mfma_f32_16x16x32_bf16 v[180:183], v[140:143], v[116:119], v[180:183]
    ds_read_b128 v[132:135], v2 offset:34496
    v_mfma_f32_16x16x32_bf16 v[176:179], v[140:143], v[112:115], v[176:179]
    v_exp_f32 v72, v72
    v_mfma_f32_16x16x32_bf16 v[172:175], v[140:143], v[108:111], v[172:175]
    s_waitcnt lgkmcnt(6)
    v_exp_f32 v73, v73
    v_mfma_f32_16x16x32_bf16 v[184:187], v[144:147], v[108:111], v[184:187]
    v_exp_f32 v74, v74
    v_mfma_f32_16x16x32_bf16 v[188:191], v[144:147], v[112:115], v[188:191]
    v_exp_f32 v75, v75
    v_mfma_f32_16x16x32_bf16 v[192:195], v[144:147], v[116:119], v[192:195]
    s_waitcnt lgkmcnt(4)
    v_exp_f32 v76, v76
    v_mfma_f32_16x16x32_bf16 v[204:207], v[148:151], v[116:119], v[204:207]
    v_exp_f32 v77, v77
    v_mfma_f32_16x16x32_bf16 v[200:203], v[148:151], v[112:115], v[200:203]
    s_waitcnt lgkmcnt(0)
    v_exp_f32 v78, v78
    v_mfma_f32_16x16x32_bf16 v[196:199], v[148:151], v[108:111], v[196:199]
    v_exp_f32 v79, v79
    v_mfma_f32_16x16x32_bf16 v[84:87], v[120:123], v[12:15], v[60:63]
    ds_read_b64_tr_b16 v[136:137], v3 offset:25472
    v_cvt_pk_bf16_f32 v96, v72, v73
    v_mfma_f32_16x16x32_bf16 v[84:87], v[124:127], v[16:19], v[84:87]
    ds_read_b64_tr_b16 v[138:139], v3 offset:25984
    v_cvt_pk_bf16_f32 v97, v74, v75
    v_mfma_f32_16x16x32_bf16 v[84:87], v[128:131], v[20:23], v[84:87]
    v_exp_f32 v80, v80
    v_mfma_f32_16x16x32_bf16 v[84:87], v[132:135], v[24:27], v[84:87]
    v_exp_f32 v81, v81
    v_mfma_f32_16x16x32_bf16 v[88:91], v[132:135], v[40:43], v[64:67]
    ds_read_b64_tr_b16 v[140:141], v3 offset:25504
    v_cvt_pk_bf16_f32 v100, v76, v77
    v_mfma_f32_16x16x32_bf16 v[88:91], v[128:131], v[36:39], v[88:91]
    ds_read_b64_tr_b16 v[142:143], v3 offset:26016
    v_cvt_pk_bf16_f32 v101, v78, v79
    v_mfma_f32_16x16x32_bf16 v[88:91], v[124:127], v[32:35], v[88:91]
    v_exp_f32 v82, v82
    v_mfma_f32_16x16x32_bf16 v[88:91], v[120:123], v[28:31], v[88:91]
    v_exp_f32 v83, v83
    v_mfma_f32_16x16x32_bf16 v[92:95], v[120:123], v[44:47], v[68:71]
    s_waitcnt vmcnt(8)
    ds_read_b64_tr_b16 v[144:145], v3 offset:25536
    v_cvt_pk_bf16_f32 v104, v80, v81
    v_mfma_f32_16x16x32_bf16 v[92:95], v[124:127], v[48:51], v[92:95]
    s_getreg_b32 s25, hwreg(HW_REG_IB_STS, 0, 4)
    ds_read_b64_tr_b16 v[146:147], v3 offset:26048
    v_cvt_pk_bf16_f32 v105, v82, v83
    v_mfma_f32_16x16x32_bf16 v[92:95], v[128:131], v[52:55], v[92:95]
    s_cmp_ge_u32 s25, s56
    ds_read_b64_tr_b16 v[148:149], v3 offset:25568
    v_mfma_f32_16x16x32_bf16 v[92:95], v[132:135], v[56:59], v[92:95]
    ds_read_b64_tr_b16 v[150:151], v3 offset:26080
    s_cbranch_scc1 L_df_51
L_df_51i:
    v_mfma_f32_16x16x32_bf16 a[200:203], a[204:207], v[116:119], a[200:203]
    s_barrier
    ds_read_b128 v[120:123], v2 offset:42240
    v_mfma_f32_16x16x32_bf16 a[196:199], a[204:207], v[112:115], a[196:199]
    s_waitcnt lgkmcnt(5)
    ds_read_b128 v[124:127], v2 offset:42304
    v_mfma_f32_16x16x32_bf16 a[192:195], a[204:207], v[108:111], a[192:195]
    ds_read_b128 v[128:131], v2 offset:42368
    v_mfma_f32_16x16x32_bf16 v[208:211], v[136:139], v[108:111], v[208:211]
    s_add_u32 s57, s57, 8192
    ds_read_b128 v[132:135], v2 offset:42432
    v_exp_f32 v84, v84
    v_mfma_f32_16x16x32_bf16 v[212:215], v[136:139], v[112:115], v[212:215]
    s_add_u32 m0, s58, s3
    v_exp_f32 v85, v85
    v_mfma_f32_16x16x32_bf16 v[216:219], v[136:139], v[116:119], v[216:219]
    buffer_load_dwordx4 v1, s[44:47], s64 offen nt lds
    v_mfma_f32_16x16x32_bf16 v[228:231], v[140:143], v[116:119], v[228:231]
    s_waitcnt lgkmcnt(4)
    v_exp_f32 v86, v86
    v_mfma_f32_16x16x32_bf16 v[224:227], v[140:143], v[112:115], v[224:227]
    s_add_u32 m0, m0, 32
    v_exp_f32 v87, v87
    v_mfma_f32_16x16x32_bf16 v[220:223], v[140:143], v[108:111], v[220:223]
    buffer_load_dwordx4 v1, s[44:47], s64 offen offset:1024 nt lds
    v_mfma_f32_16x16x32_bf16 v[232:235], v[144:147], v[108:111], v[232:235]
    s_mov_b32 s64, s65
    v_exp_f32 v88, v88
    v_mfma_f32_16x16x32_bf16 v[236:239], v[144:147], v[112:115], v[236:239]
    s_add_u32 m0, s59, s61
    v_exp_f32 v89, v89
    v_mfma_f32_16x16x32_bf16 v[240:243], v[144:147], v[116:119], v[240:243]
    s_mov_b32 s58, s59
    buffer_load_dwordx4 v1, s[40:43], s65 offen nt lds
    v_mfma_f32_16x16x32_bf16 v[252:255], v[148:151], v[116:119], v[252:255]
    s_waitcnt lgkmcnt(0)
    v_exp_f32 v90, v90
    v_mfma_f32_16x16x32_bf16 v[248:251], v[148:151], v[112:115], v[248:251]
    s_add_u32 m0, m0, 32
    v_exp_f32 v91, v91
    v_mfma_f32_16x16x32_bf16 v[244:247], v[148:151], v[108:111], v[244:247]
    buffer_load_dwordx4 v1, s[40:43], s65 offen offset:1024 nt lds
L_dfb_52:
    s_cmp_eq_u32 s67, 3
    s_cbranch_scc1 L_altwo
    s_cmp_eq_u32 s67, s30
    s_cbranch_scc1 L_altwq
    v_mfma_f32_16x16x32_bf16 v[72:75], v[120:123], v[12:15], v[60:63]
    ds_read_b64_tr_b16 v[136:137], v3 offset:33792
    v_cvt_pk_bf16_f32 v98, v84, v85
    v_mfma_f32_16x16x32_bf16 v[72:75], v[124:127], v[16:19], v[72:75]
    s_xor_b32 s65, s57, s22
    ds_read_b64_tr_b16 v[138:139], v3 offset:34304
    v_cvt_pk_bf16_f32 v99, v86, v87
    v_mfma_f32_16x16x32_bf16 v[72:75], v[128:131], v[20:23], v[72:75]
    s_bfe_u32 s59, s57, 0x3000d
    v_exp_f32 v92, v92
    v_mfma_f32_16x16x32_bf16 v[72:75], v[132:135], v[24:27], v[72:75]
    s_mul_i32 s59, s59, 8448
    v_exp_f32 v93, v93
    v_mfma_f32_16x16x32_bf16 v[76:79], v[132:135], v[40:43], v[64:67]
    ds_read_b64_tr_b16 v[140:141], v3 offset:33824
    v_cvt_pk_bf16_f32 v102, v88, v89
    v_mfma_f32_16x16x32_bf16 v[76:79], v[128:131], v[36:39], v[76:79]
    ds_read_b64_tr_b16 v[142:143], v3 offset:34336
    v_cvt_pk_bf16_f32 v103, v90, v91
    v_mfma_f32_16x16x32_bf16 v[76:79], v[124:127], v[32:35], v[76:79]
    v_exp_f32 v94, v94
    v_mfma_f32_16x16x32_bf16 v[76:79], v[120:123], v[28:31], v[76:79]
    v_exp_f32 v95, v95
    v_mfma_f32_16x16x32_bf16 v[80:83], v[120:123], v[44:47], v[68:71]
    ds_read_b64_tr_b16 v[144:145], v3 offset:33856
    v_cvt_pk_bf16_f32 v106, v92, v93
    v_mfma_f32_16x16x32_bf16 v[80:83], v[124:127], v[48:51], v[80:83]
    ds_read_b64_tr_b16 v[146:147], v3 offset:34368
    v_cvt_pk_bf16_f32 v107, v94, v95
    v_mfma_f32_16x16x32_bf16 v[80:83], v[128:131], v[52:55], v[80:83]
    ds_read_b64_tr_b16 v[148:149], v3 offset:33888
    v_mfma_f32_16x16x32_bf16 v[80:83], v[132:135], v[56:59], v[80:83]
    s_waitcnt lgkmcnt(5)
    ds_read_b64_tr_b16 v[150:151], v3 offset:34400
    v_mfma_f32_16x16x32_bf16 v[160:163], v[136:139], v[96:99], v[160:163]
    s_getreg_b32 s25, hwreg(HW_REG_IB_STS, 0, 4)
    ds_read_b128 v[120:123], v2 offset:42752
    v_mfma_f32_16x16x32_bf16 v[164:167], v[136:139], v[100:103], v[164:167]
    s_add_u32 s25, s25, 3
    ds_read_b128 v[124:127], v2 offset:42816
    v_mfma_f32_16x16x32_bf16 v[168:171], v[136:139], v[104:107], v[168:171]
    s_waitcnt lgkmcnt(6)
    ds_read_b128 v[128:131], v2 offset:42880
    v_mfma_f32_16x16x32_bf16 v[180:183], v[140:143], v[104:107], v[180:183]
    s_cmp_le_u32 s25, s56
    ds_read_b128 v[132:135], v2 offset:42944
    v_mfma_f32_16x16x32_bf16 v[176:179], v[140:143], v[100:103], v[176:179]
    s_cselect_b32 s25, s76, 0
    v_exp_f32 v72, v72
    v_mfma_f32_16x16x32_bf16 v[172:175], v[140:143], v[96:99], v[172:175]
    s_waitcnt lgkmcnt(6)
    v_exp_f32 v73, v73
    v_mfma_f32_16x16x32_bf16 v[184:187], v[144:147], v[96:99], v[184:187]
    s_cmp_gt_u32 s25, 0
    v_exp_f32 v74, v74
    v_mfma_f32_16x16x32_bf16 v[188:191], v[144:147], v[100:103], v[188:191]
    s_cbranch_scc1 L_cu_53
L_cub_54:
    v_exp_f32 v75, v75
    v_mfma_f32_16x16x32_bf16 v[192:195], v[144:147], v[104:107], v[192:195]
    s_waitcnt lgkmcnt(4)
    v_exp_f32 v76, v76
    v_mfma_f32_16x16x32_bf16 v[204:207], v[148:151], v[104:107], v[204:207]
    v_exp_f32 v77, v77
    v_mfma_f32_16x16x32_bf16 v[200:203], v[148:151], v[100:103], v[200:203]
    s_waitcnt lgkmcnt(0)
    v_exp_f32 v78, v78
    v_mfma_f32_16x16x32_bf16 v[196:199], v[148:151], v[96:99], v[196:199]
    v_exp_f32 v79, v79
    v_mfma_f32_16x16x32_bf16 v[84:87], v[120:123], v[12:15], v[60:63]
    ds_read_b64_tr_b16 v[136:137], v3 offset:33920
    v_cvt_pk_bf16_f32 v108, v72, v73
    v_mfma_f32_16x16x32_bf16 v[84:87], v[124:127], v[16:19], v[84:87]
    ds_read_b64_tr_b16 v[138:139], v3 offset:34432
    v_cvt_pk_bf16_f32 v109, v74, v75
    v_mfma_f32_16x16x32_bf16 v[84:87], v[128:131], v[20:23], v[84:87]
    v_exp_f32 v80, v80
    v_mfma_f32_16x16x32_bf16 v[84:87], v[132:135], v[24:27], v[84:87]
    v_exp_f32 v81, v81
    v_mfma_f32_16x16x32_bf16 v[88:91], v[132:135], v[40:43], v[64:67]
    ds_read_b64_tr_b16 v[140:141], v3 offset:33952
    v_cvt_pk_bf16_f32 v112, v76, v77
    v_mfma_f32_16x16x32_bf16 v[88:91], v[128:131], v[36:39], v[88:91]
    ds_read_b64_tr_b16 v[142:143], v3 offset:34464
    v_cvt_pk_bf16_f32 v113, v78, v79
    v_mfma_f32_16x16x32_bf16 v[88:91], v[124:127], v[32:35], v[88:91]
    v_exp_f32 v82, v82
    v_mfma_f32_16x16x32_bf16 v[88:91], v[120:123], v[28:31], v[88:91]
    v_exp_f32 v83, v83
    v_mfma_f32_16x16x32_bf16 v[92:95], v[120:123], v[44:47], v[68:71]
    s_waitcnt vmcnt(8)
    ds_read_b64_tr_b16 v[144:145], v3 offset:33984
    v_cvt_pk_bf16_f32 v116, v80, v81
    v_mfma_f32_16x16x32_bf16 v[92:95], v[124:127], v[48:51], v[92:95]
    s_getreg_b32 s25, hwreg(HW_REG_IB_STS, 0, 4)
    ds_read_b64_tr_b16 v[146:147], v3 offset:34496
    v_cvt_pk_bf16_f32 v117, v82, v83
    v_mfma_f32_16x16x32_bf16 v[92:95], v[128:131], v[52:55], v[92:95]
    s_cmp_ge_u32 s25, s56
    ds_read_b64_tr_b16 v[148:149], v3 offset:34016
    v_mfma_f32_16x16x32_bf16 v[92:95], v[132:135], v[56:59], v[92:95]
    ds_read_b64_tr_b16 v[150:151], v3 offset:34528
    s_cbranch_scc1 L_df_55
L_df_55i:
    v_mfma_f32_16x16x32_bf16 a[200:203], a[204:207], v[104:107], a[200:203]
    s_barrier
    ds_read_b128 v[120:123], v2 offset:50688
    v_mfma_f32_16x16x32_bf16 a[196:199], a[204:207], v[100:103], a[196:199]
    s_waitcnt lgkmcnt(5)
    ds_read_b128 v[124:127], v2 offset:50752
    v_mfma_f32_16x16x32_bf16 a[192:195], a[204:207], v[96:99], a[192:195]
    ds_read_b128 v[128:131], v2 offset:50816
    v_mfma_f32_16x16x32_bf16 v[208:211], v[136:139], v[96:99], v[208:211]
    s_add_u32 s57, s57, 8192
    ds_read_b128 v[132:135], v2 offset:50880
    v_exp_f32 v84, v84
    v_mfma_f32_16x16x32_bf16 v[212:215], v[136:139], v[100:103], v[212:215]
    s_add_u32 m0, s58, s3
    v_exp_f32 v85, v85
    v_mfma_f32_16x16x32_bf16 v[216:219], v[136:139], v[104:107], v[216:219]
    buffer_load_dwordx4 v1, s[44:47], s64 offen nt lds
    v_mfma_f32_16x16x32_bf16 v[228:231], v[140:143], v[104:107], v[228:231]
    s_waitcnt lgkmcnt(4)
    v_exp_f32 v86, v86
    v_mfma_f32_16x16x32_bf16 v[224:227], v[140:143], v[100:103], v[224:227]
    s_add_u32 m0, m0, 32
    v_exp_f32 v87, v87
    v_mfma_f32_16x16x32_bf16 v[220:223], v[140:143], v[96:99], v[220:223]
    buffer_load_dwordx4 v1, s[44:47], s64 offen offset:1024 nt lds
    v_mfma_f32_16x16x32_bf16 v[232:235], v[144:147], v[96:99], v[232:235]
    s_mov_b32 s64, s65
    v_exp_f32 v88, v88
    v_mfma_f32_16x16x32_bf16 v[236:239], v[144:147], v[100:103], v[236:239]
    s_add_u32 m0, s59, s61
    v_exp_f32 v89, v89
    v_mfma_f32_16x16x32_bf16 v[240:243], v[144:147], v[104:107], v[240:243]
    s_mov_b32 s58, s59
    buffer_load_dwordx4 v1, s[40:43], s65 offen nt lds
    v_mfma_f32_16x16x32_bf16 v[252:255], v[148:151], v[104:107], v[252:255]
    s_waitcnt lgkmcnt(0)
    v_exp_f32 v90, v90
    v_mfma_f32_16x16x32_bf16 v[248:251], v[148:151], v[100:103], v[248:251]
    s_add_u32 m0, m0, 32
    v_exp_f32 v91, v91
    v_mfma_f32_16x16x32_bf16 v[244:247], v[148:151], v[96:99], v[244:247]
    buffer_load_dwordx4 v1, s[40:43], s65 offen offset:1024 nt lds
L_dfb_56:
    v_mfma_f32_16x16x32_bf16 v[72:75], v[120:123], v[12:15], v[60:63]
    ds_read_b64_tr_b16 v[136:137], v3 offset:42240
    v_cvt_pk_bf16_f32 v110, v84, v85
    v_mfma_f32_16x16x32_bf16 v[72:75], v[124:127], v[16:19], v[72:75]
    s_xor_b32 s65, s57, s22
    ds_read_b64_tr_b16 v[138:139], v3 offset:42752
    v_cvt_pk_bf16_f32 v111, v86, v87
    v_mfma_f32_16x16x32_bf16 v[72:75], v[128:131], v[20:23], v[72:75]
    s_bfe_u32 s59, s57, 0x3000d
    v_exp_f32 v92, v92
    v_mfma_f32_16x16x32_bf16 v[72:75], v[132:135], v[24:27], v[72:75]
    s_mul_i32 s59, s59, 8448
    v_exp_f32 v93, v93
    v_mfma_f32_16x16x32_bf16 v[76:79], v[132:135], v[40:43], v[64:67]
    ds_read_b64_tr_b16 v[140:141], v3 offset:42272
    v_cvt_pk_bf16_f32 v114, v88, v89
    v_mfma_f32_16x16x32_bf16 v[76:79], v[128:131], v[36:39], v[76:79]
    ds_read_b64_tr_b16 v[142:143], v3 offset:42784
    v_cvt_pk_bf16_f32 v115, v90, v91
    v_mfma_f32_16x16x32_bf16 v[76:79], v[124:127], v[32:35], v[76:79]
    v_exp_f32 v94, v94
    v_mfma_f32_16x16x32_bf16 v[76:79], v[120:123], v[28:31], v[76:79]
    v_exp_f32 v95, v95
    v_mfma_f32_16x16x32_bf16 v[80:83], v[120:123], v[44:47], v[68:71]
    ds_read_b64_tr_b16 v[144:145], v3 offset:42304
    v_cvt_pk_bf16_f32 v118, v92, v93
    v_mfma_f32_16x16x32_bf16 v[80:83], v[124:127], v[48:51], v[80:83]
    ds_read_b64_tr_b16 v[146:147], v3 offset:42816
    v_cvt_pk_bf16_f32 v119, v94, v95
    v_mfma_f32_16x16x32_bf16 v[80:83], v[128:131], v[52:55], v[80:83]
    ds_read_b64_tr_b16 v[148:149], v3 offset:42336
    v_mfma_f32_16x16x32_bf16 v[80:83], v[132:135], v[56:59], v[80:83]
    s_waitcnt lgkmcnt(5)
    ds_read_b64_tr_b16 v[150:151], v3 offset:42848
    v_mfma_f32_16x16x32_bf16 v[160:163], v[136:139], v[108:111], v[160:163]
    ds_read_b128 v[120:123], v2 offset:51200
    v_mfma_f32_16x16x32_bf16 v[164:167], v[136:139], v[112:115], v[164:167]
    ds_read_b128 v[124:127], v2 offset:51264
    v_mfma_f32_16x16x32_bf16 v[168:171], v[136:139], v[116:119], v[168:171]
    s_waitcnt lgkmcnt(6)
    ds_read_b128 v[128:131], v2 offset:51328
    v_mfma_f32_16x16x32_bf16 v[180:183], v[140:143], v[116:119], v[180:183]
    ds_read_b128 v[132:135], v2 offset:51392
    v_mfma_f32_16x16x32_bf16 v[176:179], v[140:143], v[112:115], v[176:179]
    v_exp_f32 v72, v72
    v_mfma_f32_16x16x32_bf16 v[172:175], v[140:143], v[108:111], v[172:175]
    s_waitcnt lgkmcnt(6)
    v_exp_f32 v73, v73
    v_mfma_f32_16x16x32_bf16 v[184:187], v[144:147], v[108:111], v[184:187]
    v_exp_f32 v74, v74
    v_mfma_f32_16x16x32_bf16 v[188:191], v[144:147], v[112:115], v[188:191]
    v_exp_f32 v75, v75
    v_mfma_f32_16x16x32_bf16 v[192:195], v[144:147], v[116:119], v[192:195]
    s_waitcnt lgkmcnt(4)
    v_exp_f32 v76, v76
    v_mfma_f32_16x16x32_bf16 v[204:207], v[148:151], v[116:119], v[204:207]
    v_exp_f32 v77, v77
    v_mfma_f32_16x16x32_bf16 v[200:203], v[148:151], v[112:115], v[200:203]
    s_waitcnt lgkmcnt(0)
    v_exp_f32 v78, v78
    v_mfma_f32_16x16x32_bf16 v[196:199], v[148:151], v[108:111], v[196:199]
    v_exp_f32 v79, v79
    v_mfma_f32_16x16x32_bf16 v[84:87], v[120:123], v[12:15], v[60:63]
    ds_read_b64_tr_b16 v[136:137], v3 offset:42368
    v_cvt_pk_bf16_f32 v96, v72, v73
    v_mfma_f32_16x16x32_bf16 v[84:87], v[124:127], v[16:19], v[84:87]
    ds_read_b64_tr_b16 v[138:139], v3 offset:42880
    v_cvt_pk_bf16_f32 v97, v74, v75
    v_mfma_f32_16x16x32_bf16 v[84:87], v[128:131], v[20:23], v[84:87]
    v_exp_f32 v80, v80
    v_mfma_f32_16x16x32_bf16 v[84:87], v[132:135], v[24:27], v[84:87]
    v_exp_f32 v81, v81
    v_mfma_f32_16x16x32_bf16 v[88:91], v[132:135], v[40:43], v[64:67]
    ds_read_b64_tr_b16 v[140:141], v3 offset:42400
    v_cvt_pk_bf16_f32 v100, v76, v77
    v_mfma_f32_16x16x32_bf16 v[88:91], v[128:131], v[36:39], v[88:91]
    ds_read_b64_tr_b16 v[142:143], v3 offset:42912
    v_cvt_pk_bf16_f32 v101, v78, v79
    v_mfma_f32_16x16x32_bf16 v[88:91], v[124:127], v[32:35], v[88:91]
    v_exp_f32 v82, v82
    v_mfma_f32_16x16x32_bf16 v[88:91], v[120:123], v[28:31], v[88:91]
    v_exp_f32 v83, v83
    v_mfma_f32_16x16x32_bf16 v[92:95], v[120:123], v[44:47], v[68:71]
    s_waitcnt vmcnt(8)
    ds_read_b64_tr_b16 v[144:145], v3 offset:42432
    v_cvt_pk_bf16_f32 v104, v80, v81
    v_mfma_f32_16x16x32_bf16 v[92:95], v[124:127], v[48:51], v[92:95]
    s_getreg_b32 s25, hwreg(HW_REG_IB_STS, 0, 4)
    ds_read_b64_tr_b16 v[146:147], v3 offset:42944
    v_cvt_pk_bf16_f32 v105, v82, v83
    v_mfma_f32_16x16x32_bf16 v[92:95], v[128:131], v[52:55], v[92:95]
    s_cmp_ge_u32 s25, s56
    ds_read_b64_tr_b16 v[148:149], v3 offset:42464
    v_mfma_f32_16x16x32_bf16 v[92:95], v[132:135], v[56:59], v[92:95]
    ds_read_b64_tr_b16 v[150:151], v3 offset:42976
    s_cbranch_scc1 L_df_57
L_df_57i:
    v_mfma_f32_16x16x32_bf16 a[200:203], a[204:207], v[116:119], a[200:203]
    s_barrier
    ds_read_b128 v[120:123], v2 offset:59136
    v_mfma_f32_16x16x32_bf16 a[196:199], a[204:207], v[112:115], a[196:199]
    s_waitcnt lgkmcnt(5)
    ds_read_b128 v[124:127], v2 offset:59200
    v_mfma_f32_16x16x32_bf16 a[192:195], a[204:207], v[108:111], a[192:195]
    ds_read_b128 v[128:131], v2 offset:59264
    v_mfma_f32_16x16x32_bf16 v[208:211], v[136:139], v[108:111], v[208:211]
    s_add_u32 s57, s57, 8192
    ds_read_b128 v[132:135], v2 offset:59328
    v_exp_f32 v84, v84
    v_mfma_f32_16x16x32_bf16 v[212:215], v[136:139], v[112:115], v[212:215]
    s_add_u32 m0, s58, s3
    v_exp_f32 v85, v85
    v_mfma_f32_16x16x32_bf16 v[216:219], v[136:139], v[116:119], v[216:219]
    buffer_load_dwordx4 v1, s[44:47], s64 offen nt lds
    v_mfma_f32_16x16x32_bf16 v[228:231], v[140:143], v[116:119], v[228:231]
    s_waitcnt lgkmcnt(4)
    v_exp_f32 v86, v86
    v_mfma_f32_16x16x32_bf16 v[224:227], v[140:143], v[112:115], v[224:227]
    s_add_u32 m0, m0, 32
    v_exp_f32 v87, v87
    v_mfma_f32_16x16x32_bf16 v[220:223], v[140:143], v[108:111], v[220:223]
    buffer_load_dwordx4 v1, s[44:47], s64 offen offset:1024 nt lds
    v_mfma_f32_16x16x32_bf16 v[232:235], v[144:147], v[108:111], v[232:235]
    s_mov_b32 s64, s65
    v_exp_f32 v88, v88
    v_mfma_f32_16x16x32_bf16 v[236:239], v[144:147], v[112:115], v[236:239]
    s_add_u32 m0, s59, s61
    v_exp_f32 v89, v89
    v_mfma_f32_16x16x32_bf16 v[240:243], v[144:147], v[116:119], v[240:243]
    s_mov_b32 s58, s59
    buffer_load_dwordx4 v1, s[40:43], s65 offen nt lds
    v_mfma_f32_16x16x32_bf16 v[252:255], v[148:151], v[116:119], v[252:255]
    s_waitcnt lgkmcnt(0)
    v_exp_f32 v90, v90
    v_mfma_f32_16x16x32_bf16 v[248:251], v[148:151], v[112:115], v[248:251]
    s_add_u32 m0, m0, 32
    v_exp_f32 v91, v91
    v_mfma_f32_16x16x32_bf16 v[244:247], v[148:151], v[108:111], v[244:247]
    buffer_load_dwordx4 v1, s[40:43], s65 offen offset:1024 nt lds
L_dfb_58:
    v_mfma_f32_16x16x32_bf16 v[72:75], v[120:123], v[12:15], v[60:63]
    ds_read_b64_tr_b16 v[136:137], v3 offset:50688
    v_cvt_pk_bf16_f32 v98, v84, v85
    v_mfma_f32_16x16x32_bf16 v[72:75], v[124:127], v[16:19], v[72:75]
    s_xor_b32 s65, s57, s22
    ds_read_b64_tr_b16 v[138:139], v3 offset:51200
    v_cvt_pk_bf16_f32 v99, v86, v87
    v_mfma_f32_16x16x32_bf16 v[72:75], v[128:131], v[20:23], v[72:75]
    s_bfe_u32 s59, s57, 0x3000d
    v_exp_f32 v92, v92
    v_mfma_f32_16x16x32_bf16 v[72:75], v[132:135], v[24:27], v[72:75]
    s_mul_i32 s59, s59, 8448
    v_exp_f32 v93, v93
    v_mfma_f32_16x16x32_bf16 v[76:79], v[132:135], v[40:43], v[64:67]
    ds_read_b64_tr_b16 v[140:141], v3 offset:50720
    v_cvt_pk_bf16_f32 v102, v88, v89
    v_mfma_f32_16x16x32_bf16 v[76:79], v[128:131], v[36:39], v[76:79]
    ds_read_b64_tr_b16 v[142:143], v3 offset:51232
    v_cvt_pk_bf16_f32 v103, v90, v91
    v_mfma_f32_16x16x32_bf16 v[76:79], v[124:127], v[32:35], v[76:79]
    v_exp_f32 v94, v94
    v_mfma_f32_16x16x32_bf16 v[76:79], v[120:123], v[28:31], v[76:79]
    v_exp_f32 v95, v95
    v_mfma_f32_16x16x32_bf16 v[80:83], v[120:123], v[44:47], v[68:71]
    ds_read_b64_tr_b16 v[144:145], v3 offset:50752
    v_cvt_pk_bf16_f32 v106, v92, v93
    v_mfma_f32_16x16x32_bf16 v[80:83], v[124:127], v[48:51], v[80:83]
    ds_read_b64_tr_b16 v[146:147], v3 offset:51264
    v_cvt_pk_bf16_f32 v107, v94, v95
    v_mfma_f32_16x16x32_bf16 v[80:83], v[128:131], v[52:55], v[80:83]
    ds_read_b64_tr_b16 v[148:149], v3 offset:50784
    v_mfma_f32_16x16x32_bf16 v[80:83], v[132:135], v[56:59], v[80:83]
    s_waitcnt lgkmcnt(5)
    ds_read_b64_tr_b16 v[150:151], v3 offset:51296
    v_mfma_f32_16x16x32_bf16 v[160:163], v[136:139], v[96:99], v[160:163]
    s_getreg_b32 s25, hwreg(HW_REG_IB_STS, 0, 4)
    ds_read_b128 v[120:123], v2 offset:59648
    v_mfma_f32_16x16x32_bf16 v[164:167], v[136:139], v[100:103], v[164:167]
    s_add_u32 s25, s25, 3
    ds_read_b128 v[124:127], v2 offset:59712
    v_mfma_f32_16x16x32_bf16 v[168:171], v[136:139], v[104:107], v[168:171]
    s_waitcnt lgkmcnt(6)
    ds_read_b128 v[128:131], v2 offset:59776
    v_mfma_f32_16x16x32_bf16 v[180:183], v[140:143], v[104:107], v[180:183]
    s_cmp_le_u32 s25, s56
    ds_read_b128 v[132:135], v2 offset:59840
    v_mfma_f32_16x16x32_bf16 v[176:179], v[140:143], v[100:103], v[176:179]
    s_cselect_b32 s25, s76, 0
    v_exp_f32 v72, v72
    v_mfma_f32_16x16x32_bf16 v[172:175], v[140:143], v[96:99], v[172:175]
    s_waitcnt lgkmcnt(6)
    v_exp_f32 v73, v73
    v_mfma_f32_16x16x32_bf16 v[184:187], v[144:147], v[96:99], v[184:187]
    s_cmp_gt_u32 s25, 0
    v_exp_f32 v74, v74
    v_mfma_f32_16x16x32_bf16 v[188:191], v[144:147], v[100:103], v[188:191]
    s_cbranch_scc1 L_cu_59
L_cub_60:
    v_exp_f32 v75, v75
    v_mfma_f32_16x16x32_bf16 v[192:195], v[144:147], v[104:107], v[192:195]
    s_waitcnt lgkmcnt(4)
    v_exp_f32 v76, v76
    v_mfma_f32_16x16x32_bf16 v[204:207], v[148:151], v[104:107], v[204:207]
    v_exp_f32 v77, v77
    v_mfma_f32_16x16x32_bf16 v[200:203], v[148:151], v[100:103], v[200:203]
    s_waitcnt lgkmcnt(0)
    v_exp_f32 v78, v78
    v_mfma_f32_16x16x32_bf16 v[196:199], v[148:151], v[96:99], v[196:199]
    v_exp_f32 v79, v79
    v_mfma_f32_16x16x32_bf16 v[84:87], v[120:123], v[12:15], v[60:63]
    ds_read_b64_tr_b16 v[136:137], v3 offset:50816
    v_cvt_pk_bf16_f32 v108, v72, v73
    v_mfma_f32_16x16x32_bf16 v[84:87], v[124:127], v[16:19], v[84:87]
    ds_read_b64_tr_b16 v[138:139], v3 offset:51328
    v_cvt_pk_bf16_f32 v109, v74, v75
    v_mfma_f32_16x16x32_bf16 v[84:87], v[128:131], v[20:23], v[84:87]
    v_exp_f32 v80, v80
    v_mfma_f32_16x16x32_bf16 v[84:87], v[132:135], v[24:27], v[84:87]
    v_exp_f32 v81, v81
    v_mfma_f32_16x16x32_bf16 v[88:91], v[132:135], v[40:43], v[64:67]
    ds_read_b64_tr_b16 v[140:141], v3 offset:50848
    v_cvt_pk_bf16_f32 v112, v76, v77
    v_mfma_f32_16x16x32_bf16 v[88:91], v[128:131], v[36:39], v[88:91]
    ds_read_b64_tr_b16 v[142:143], v3 offset:51360
    v_cvt_pk_bf16_f32 v113, v78, v79
    v_mfma_f32_16x16x32_bf16 v[88:91], v[124:127], v[32:35], v[88:91]
    v_exp_f32 v82, v82
    v_mfma_f32_16x16x32_bf16 v[88:91], v[120:123], v[28:31], v[88:91]
    v_exp_f32 v83, v83
    v_mfma_f32_16x16x32_bf16 v[92:95], v[120:123], v[44:47], v[68:71]
    s_waitcnt vmcnt(8)
    ds_read_b64_tr_b16 v[144:145], v3 offset:50880
    v_cvt_pk_bf16_f32 v116, v80, v81
    v_mfma_f32_16x16x32_bf16 v[92:95], v[124:127], v[48:51], v[92:95]
    s_getreg_b32 s25, hwreg(HW_REG_IB_STS, 0, 4)
    ds_read_b64_tr_b16 v[146:147], v3 offset:51392
    v_cvt_pk_bf16_f32 v117, v82, v83
    v_mfma_f32_16x16x32_bf16 v[92:95], v[128:131], v[52:55], v[92:95]
    s_cmp_ge_u32 s25, s56
    ds_read_b64_tr_b16 v[148:149], v3 offset:50912
    v_mfma_f32_16x16x32_bf16 v[92:95], v[132:135], v[56:59], v[92:95]
    ds_read_b64_tr_b16 v[150:151], v3 offset:51424
    s_cbranch_scc1 L_df_61
L_df_61i:
    v_mfma_f32_16x16x32_bf16 a[200:203], a[204:207], v[104:107], a[200:203]
    s_barrier
    ds_read_b64_tr_b16 v[120:121], v3 offset:59136
    v_mfma_f32_16x16x32_bf16 a[196:199], a[204:207], v[100:103], a[196:199]
    s_waitcnt lgkmcnt(5)
    ds_read_b64_tr_b16 v[122:123], v3 offset:59648
    v_mfma_f32_16x16x32_bf16 a[192:195], a[204:207], v[96:99], a[192:195]
    ds_read_b64_tr_b16 v[124:125], v3 offset:59168
    v_mfma_f32_16x16x32_bf16 v[208:211], v[136:139], v[96:99], v[208:211]
    s_add_u32 s57, s57, 8192
    ds_read_b64_tr_b16 v[126:127], v3 offset:59680
    v_exp_f32 v84, v84
    v_mfma_f32_16x16x32_bf16 v[212:215], v[136:139], v[100:103], v[212:215]
    s_add_u32 m0, s58, s3
    ds_read_b64_tr_b16 v[128:129], v3 offset:59200
    v_exp_f32 v85, v85
    v_mfma_f32_16x16x32_bf16 v[216:219], v[136:139], v[104:107], v[216:219]
    buffer_load_dwordx4 v1, s[44:47], s64 offen nt lds
    v_mfma_f32_16x16x32_bf16 v[228:231], v[140:143], v[104:107], v[228:231]
    s_waitcnt lgkmcnt(5)
    ds_read_b64_tr_b16 v[130:131], v3 offset:59712
    v_exp_f32 v86, v86
    v_mfma_f32_16x16x32_bf16 v[224:227], v[140:143], v[100:103], v[224:227]
    s_add_u32 m0, m0, 32
    ds_read_b64_tr_b16 v[132:133], v3 offset:59232
    v_exp_f32 v87, v87
    v_mfma_f32_16x16x32_bf16 v[220:223], v[140:143], v[96:99], v[220:223]
    buffer_load_dwordx4 v1, s[44:47], s64 offen offset:1024 nt lds
    v_mfma_f32_16x16x32_bf16 v[232:235], v[144:147], v[96:99], v[232:235]
    s_mov_b32 s64, s65
    ds_read_b64_tr_b16 v[134:135], v3 offset:59744
    v_exp_f32 v88, v88
    v_mfma_f32_16x16x32_bf16 v[236:239], v[144:147], v[100:103], v[236:239]
    s_add_u32 m0, s59, s61
    v_cvt_pk_bf16_f32 v110, v84, v85
    v_exp_f32 v89, v89
    v_mfma_f32_16x16x32_bf16 v[240:243], v[144:147], v[104:107], v[240:243]
    s_mov_b32 s58, s59
    buffer_load_dwordx4 v1, s[40:43], s65 offen nt lds
    v_mfma_f32_16x16x32_bf16 v[252:255], v[148:151], v[104:107], v[252:255]
    v_cvt_pk_bf16_f32 v111, v86, v87
    v_exp_f32 v90, v90
    v_mfma_f32_16x16x32_bf16 v[248:251], v[148:151], v[100:103], v[248:251]
    s_add_u32 m0, m0, 32
    v_exp_f32 v91, v91
    v_mfma_f32_16x16x32_bf16 v[244:247], v[148:151], v[96:99], v[244:247]
    s_waitcnt lgkmcnt(0)
    buffer_load_dwordx4 v1, s[40:43], s65 offen offset:1024 nt lds
L_dfb_62:
    v_mfma_f32_16x16x32_bf16 a[192:195], a[204:207], v[108:111], a[192:195]
    ds_read_b64_tr_b16 v[136:137], v3 offset:59264
    v_cvt_pk_bf16_f32 v114, v88, v89
    v_mfma_f32_16x16x32_bf16 v[160:163], v[120:123], v[108:111], v[160:163]
    s_xor_b32 s65, s57, s22
    ds_read_b64_tr_b16 v[138:139], v3 offset:59776
    v_cvt_pk_bf16_f32 v115, v90, v91
    v_mfma_f32_16x16x32_bf16 v[172:175], v[124:127], v[108:111], v[172:175]
    s_bfe_u32 s59, s57, 0x3000d
    v_exp_f32 v92, v92
    v_mfma_f32_16x16x32_bf16 v[184:187], v[128:131], v[108:111], v[184:187]
    s_mul_i32 s59, s59, 8448
    v_exp_f32 v93, v93
    v_mfma_f32_16x16x32_bf16 v[196:199], v[132:135], v[108:111], v[196:199]
    v_exp_f32 v94, v94
    v_mfma_f32_16x16x32_bf16 a[196:199], a[204:207], v[112:115], a[196:199]
    v_exp_f32 v95, v95
    v_mfma_f32_16x16x32_bf16 v[164:167], v[120:123], v[112:115], v[164:167]
    ds_read_b64_tr_b16 v[140:141], v3 offset:59296
    v_cvt_pk_bf16_f32 v118, v92, v93
    v_mfma_f32_16x16x32_bf16 v[176:179], v[124:127], v[112:115], v[176:179]
    ds_read_b64_tr_b16 v[142:143], v3 offset:59808
    v_cvt_pk_bf16_f32 v119, v94, v95
    v_mfma_f32_16x16x32_bf16 v[188:191], v[128:131], v[112:115], v[188:191]
    ds_read_b64_tr_b16 v[144:145], v3 offset:59328
    v_accvgpr_read_b32 v7, a192
    v_mfma_f32_16x16x32_bf16 v[200:203], v[132:135], v[112:115], v[200:203]
    ds_read_b64_tr_b16 v[146:147], v3 offset:59840
    v_accvgpr_read_b32 v8, a196
    v_mfma_f32_16x16x32_bf16 a[200:203], a[204:207], v[116:119], a[200:203]
    ds_read_b64_tr_b16 v[148:149], v3 offset:59360
    v_add_f32 v10, v7, v8
    v_mfma_f32_16x16x32_bf16 v[168:171], v[120:123], v[116:119], v[168:171]
    ds_read_b64_tr_b16 v[150:151], v3 offset:59872
    v_mov_b32 v11, 0x5d800000
    v_mfma_f32_16x16x32_bf16 v[180:183], v[124:127], v[116:119], v[180:183]
    v_rcp_f32 v7, v7
    v_mfma_f32_16x16x32_bf16 v[192:195], v[128:131], v[116:119], v[192:195]
    v_rcp_f32 v8, v8
    v_mfma_f32_16x16x32_bf16 v[204:207], v[132:135], v[116:119], v[204:207]
    s_waitcnt lgkmcnt(6)
    v_accvgpr_read_b32 v9, a200
    v_add_f32 v10, v10, v9
    v_mfma_f32_16x16x32_bf16 v[208:211], v[136:139], v[108:111], v[208:211]
    v_cmp_nle_f32 vcc, v10, v11
    v_mfma_f32_16x16x32_bf16 v[212:215], v[136:139], v[112:115], v[212:215]
    v_rcp_f32 v9, v9
    v_mfma_f32_16x16x32_bf16 v[216:219], v[136:139], v[116:119], v[216:219]
    s_waitcnt lgkmcnt(4)
    v_mul_f32 v160, v160, v7
    v_mul_f32 v161, v161, v7
    v_mfma_f32_16x16x32_bf16 v[228:231], v[140:143], v[116:119], v[228:231]
    v_mul_f32 v162, v162, v7
    v_mul_f32 v163, v163, v7
    v_mfma_f32_16x16x32_bf16 v[224:227], v[140:143], v[112:115], v[224:227]
    v_mul_f32 v164, v164, v8
    v_mul_f32 v165, v165, v8
    v_mfma_f32_16x16x32_bf16 v[220:223], v[140:143], v[108:111], v[220:223]
    s_waitcnt lgkmcnt(2)
    v_mul_f32 v166, v166, v8
    v_mul_f32 v167, v167, v8
    v_mfma_f32_16x16x32_bf16 v[232:235], v[144:147], v[108:111], v[232:235]
    v_mul_f32 v168, v168, v9
    v_mul_f32 v169, v169, v9
    v_mfma_f32_16x16x32_bf16 v[236:239], v[144:147], v[112:115], v[236:239]
    v_mul_f32 v170, v170, v9
    v_mul_f32 v171, v171, v9
    v_mfma_f32_16x16x32_bf16 v[240:243], v[144:147], v[116:119], v[240:243]
    s_waitcnt lgkmcnt(0)
    v_mul_f32 v172, v172, v7
    v_mul_f32 v173, v173, v7
    v_mfma_f32_16x16x32_bf16 v[252:255], v[148:151], v[116:119], v[252:255]
    v_mul_f32 v174, v174, v7
    v_mul_f32 v175, v175, v7
    v_mfma_f32_16x16x32_bf16 v[248:251], v[148:151], v[112:115], v[248:251]
    v_mul_f32 v176, v176, v8
    v_mul_f32 v177, v177, v8
    v_mfma_f32_16x16x32_bf16 v[244:247], v[148:151], v[108:111], v[244:247]
    v_mul_f32 v178, v178, v8
    v_mul_f32 v179, v179, v8
    s_cbranch_vccnz L_slow
L_epi:
    ds_read_b128 v[120:123], v2 offset:0
    ds_read_b128 v[124:127], v2 offset:64
    ds_read_b128 v[128:131], v2 offset:128
    ds_read_b128 v[132:135], v2 offset:192
    ds_read_b128 v[136:139], v2 offset:512
    ds_read_b128 v[140:143], v2 offset:576
    ds_read_b128 v[144:147], v2 offset:640
    ds_read_b128 v[148:151], v2 offset:704
    v_pk_mul_f32 v[180:181], v[180:181], v[8:9] op_sel:[0,1] op_sel_hi:[1,1]
    v_pk_mul_f32 v[182:183], v[182:183], v[8:9] op_sel:[0,1] op_sel_hi:[1,1]
    v_cvt_pk_bf16_f32 v160, v160, v161
    v_cvt_pk_bf16_f32 v161, v162, v163
    v_cvt_pk_bf16_f32 v162, v172, v173
    v_cvt_pk_bf16_f32 v163, v174, v175
    v_cvt_pk_bf16_f32 v164, v164, v165
    v_cvt_pk_bf16_f32 v165, v166, v167
    v_cvt_pk_bf16_f32 v166, v176, v177
    v_cvt_pk_bf16_f32 v167, v178, v179
    v_cvt_pk_bf16_f32 v168, v168, v169
    v_cvt_pk_bf16_f32 v169, v170, v171
    v_cvt_pk_bf16_f32 v170, v180, v181
    v_cvt_pk_bf16_f32 v171, v182, v183
    v_pk_mul_f32 v[184:185], v[184:185], v[6:7] op_sel:[0,1] op_sel_hi:[1,1]
    v_pk_mul_f32 v[186:187], v[186:187], v[6:7] op_sel:[0,1] op_sel_hi:[1,1]
    v_pk_mul_f32 v[196:197], v[196:197], v[6:7] op_sel:[0,1] op_sel_hi:[1,1]
    v_pk_mul_f32 v[198:199], v[198:199], v[6:7] op_sel:[0,1] op_sel_hi:[1,1]
    v_cvt_pk_bf16_f32 v184, v184, v185
    v_cvt_pk_bf16_f32 v185, v186, v187
    v_cvt_pk_bf16_f32 v186, v196, v197
    v_cvt_pk_bf16_f32 v187, v198, v199
    v_pk_mul_f32 v[188:189], v[188:189], v[8:9] op_sel:[0,0] op_sel_hi:[1,0]
    v_pk_mul_f32 v[190:191], v[190:191], v[8:9] op_sel:[0,0] op_sel_hi:[1,0]
    v_pk_mul_f32 v[200:201], v[200:201], v[8:9] op_sel:[0,0] op_sel_hi:[1,0]
    v_pk_mul_f32 v[202:203], v[202:203], v[8:9] op_sel:[0,0] op_sel_hi:[1,0]
    v_cvt_pk_bf16_f32 v188, v188, v189
    v_cvt_pk_bf16_f32 v189, v190, v191
    v_cvt_pk_bf16_f32 v190, v200, v201
    v_cvt_pk_bf16_f32 v191, v202, v203
    v_pk_mul_f32 v[192:193], v[192:193], v[8:9] op_sel:[0,1] op_sel_hi:[1,1]
    v_pk_mul_f32 v[194:195], v[194:195], v[8:9] op_sel:[0,1] op_sel_hi:[1,1]
    v_pk_mul_f32 v[204:205], v[204:205], v[8:9] op_sel:[0,1] op_sel_hi:[1,1]
    v_pk_mul_f32 v[206:207], v[206:207], v[8:9] op_sel:[0,1] op_sel_hi:[1,1]
    v_cvt_pk_bf16_f32 v192, v192, v193
    v_cvt_pk_bf16_f32 v193, v194, v195
    v_cvt_pk_bf16_f32 v194, v204, v205
    v_cvt_pk_bf16_f32 v195, v206, v207
    v_pk_mul_f32 v[208:209], v[208:209], v[6:7] op_sel:[0,1] op_sel_hi:[1,1]
    v_pk_mul_f32 v[210:211], v[210:211], v[6:7] op_sel:[0,1] op_sel_hi:[1,1]
    v_pk_mul_f32 v[220:221], v[220:221], v[6:7] op_sel:[0,1] op_sel_hi:[1,1]
    v_pk_mul_f32 v[222:223], v[222:223], v[6:7] op_sel:[0,1] op_sel_hi:[1,1]
    v_cvt_pk_bf16_f32 v208, v208, v209
    v_cvt_pk_bf16_f32 v209, v210, v211
    v_cvt_pk_bf16_f32 v210, v220, v221
    v_cvt_pk_bf16_f32 v211, v222, v223
    v_pk_mul_f32 v[212:213], v[212:213], v[8:9] op_sel:[0,0] op_sel_hi:[1,0]
    v_pk_mul_f32 v[214:215], v[214:215], v[8:9] op_sel:[0,0] op_sel_hi:[1,0]
    v_pk_mul_f32 v[224:225], v[224:225], v[8:9] op_sel:[0,0] op_sel_hi:[1,0]
    v_pk_mul_f32 v[226:227], v[226:227], v[8:9] op_sel:[0,0] op_sel_hi:[1,0]
    v_cvt_pk_bf16_f32 v212, v212, v213
    v_cvt_pk_bf16_f32 v213, v214, v215
    v_cvt_pk_bf16_f32 v214, v224, v225
    v_cvt_pk_bf16_f32 v215, v226, v227
    v_pk_mul_f32 v[216:217], v[216:217], v[8:9] op_sel:[0,1] op_sel_hi:[1,1]
    v_pk_mul_f32 v[218:219], v[218:219], v[8:9] op_sel:[0,1] op_sel_hi:[1,1]
    v_pk_mul_f32 v[228:229], v[228:229], v[8:9] op_sel:[0,1] op_sel_hi:[1,1]
    v_pk_mul_f32 v[230:231], v[230:231], v[8:9] op_sel:[0,1] op_sel_hi:[1,1]
    v_cvt_pk_bf16_f32 v216, v216, v217
    v_cvt_pk_bf16_f32 v217, v218, v219
    v_cvt_pk_bf16_f32 v218, v228, v229
    v_cvt_pk_bf16_f32 v219, v230, v231
    v_pk_mul_f32 v[232:233], v[232:233], v[6:7] op_sel:[0,1] op_sel_hi:[1,1]
    v_pk_mul_f32 v[234:235], v[234:235], v[6:7] op_sel:[0,1] op_sel_hi:[1,1]
    v_pk_mul_f32 v[244:245], v[244:245], v[6:7] op_sel:[0,1] op_sel_hi:[1,1]
    v_pk_mul_f32 v[246:247], v[246:247], v[6:7] op_sel:[0,1] op_sel_hi:[1,1]
    v_cvt_pk_bf16_f32 v232, v232, v233
    v_cvt_pk_bf16_f32 v233, v234, v235
    v_cvt_pk_bf16_f32 v234, v244, v245
    v_cvt_pk_bf16_f32 v235, v246, v247
    v_pk_mul_f32 v[236:237], v[236:237], v[8:9] op_sel:[0,0] op_sel_hi:[1,0]
    v_pk_mul_f32 v[238:239], v[238:239], v[8:9] op_sel:[0,0] op_sel_hi:[1,0]
    v_pk_mul_f32 v[248:249], v[248:249], v[8:9] op_sel:[0,0] op_sel_hi:[1,0]
    v_pk_mul_f32 v[250:251], v[250:251], v[8:9] op_sel:[0,0] op_sel_hi:[1,0]
    v_cvt_pk_bf16_f32 v236, v236, v237
    v_cvt_pk_bf16_f32 v237, v238, v239
    v_cvt_pk_bf16_f32 v238, v248, v249
    v_cvt_pk_bf16_f32 v239, v250, v251
    v_pk_mul_f32 v[240:241], v[240:241], v[8:9] op_sel:[0,1] op_sel_hi:[1,1]
    v_pk_mul_f32 v[242:243], v[242:243], v[8:9] op_sel:[0,1] op_sel_hi:[1,1]
    v_pk_mul_f32 v[252:253], v[252:253], v[8:9] op_sel:[0,1] op_sel_hi:[1,1]
    v_pk_mul_f32 v[254:255], v[254:255], v[8:9] op_sel:[0,1] op_sel_hi:[1,1]
    v_cvt_pk_bf16_f32 v240, v240, v241
    v_cvt_pk_bf16_f32 v241, v242, v243
    v_cvt_pk_bf16_f32 v242, v252, v253
    v_cvt_pk_bf16_f32 v243, v254, v255
    s_add_u32 s68, s68, 131072
    s_add_u32 s67, s67, 1
    s_cmp_eq_u32 s67, 3
    s_cbranch_scc1 L_sw2
    s_cmp_eq_u32 s67, 2
    s_cbranch_scc1 L_sw1
L_sw0:
    s_getpc_b64 s[14:15]
L_pc_63:
    s_add_u32 s14, s14, L_rare-L_pc_63
    s_addc_u32 s15, s15, 0
    s_lshr_b32 s69, s2, 3
    s_lshl_b32 s69, s69, 2
    s_add_u32 s69, s69, s60
    s_lshl_b32 s69, s69, 7
    v_and_b32 v10, 3, v0
    v_lshlrev_b32 v10, 14, v10
    v_add_u32 v10, s69, v10
    v_min_u32 v10, L_altwo-L_rare-4, v10
    global_load_dword v11, v10, s[14:15]
    v_accvgpr_read_b32 v12, a96
    v_accvgpr_read_b32 v13, a97
    v_accvgpr_read_b32 v14, a98
    v_accvgpr_read_b32 v15, a99
    v_accvgpr_read_b32 v16, a108
    v_accvgpr_read_b32 v17, a109
    v_accvgpr_read_b32 v18, a110
    v_accvgpr_read_b32 v19, a111
    v_accvgpr_read_b32 v20, a120
    v_accvgpr_read_b32 v21, a121
    v_accvgpr_read_b32 v22, a122
    v_accvgpr_read_b32 v23, a123
    v_accvgpr_read_b32 v24, a132
    v_accvgpr_read_b32 v25, a133
    v_accvgpr_read_b32 v26, a134
    v_accvgpr_read_b32 v27, a135
    v_accvgpr_read_b32 v28, a100
    v_accvgpr_read_b32 v29, a101
    v_accvgpr_read_b32 v30, a102
    v_accvgpr_read_b32 v31, a103
    v_accvgpr_read_b32 v32, a112
    v_accvgpr_read_b32 v33, a113
    v_accvgpr_read_b32 v34, a114
    v_accvgpr_read_b32 v35, a115
    v_accvgpr_read_b32 v36, a124
    v_accvgpr_read_b32 v37, a125
    v_accvgpr_read_b32 v38, a126
    v_accvgpr_read_b32 v39, a127
    v_accvgpr_read_b32 v40, a136
    v_accvgpr_read_b32 v41, a137
    v_accvgpr_read_b32 v42, a138
    v_accvgpr_read_b32 v43, a139
    v_accvgpr_read_b32 v44, a104
    v_accvgpr_read_b32 v45, a105
    v_accvgpr_read_b32 v46, a106
    v_accvgpr_read_b32 v47, a107
    v_accvgpr_read_b32 v48, a116
    v_accvgpr_read_b32 v49, a117
    v_accvgpr_read_b32 v50, a118
    v_accvgpr_read_b32 v51, a119
    v_accvgpr_read_b32 v52, a128
    v_accvgpr_read_b32 v53, a129
    v_accvgpr_read_b32 v54, a130
    v_accvgpr_read_b32 v55, a131
    v_accvgpr_read_b32 v56, a140
    v_accvgpr_read_b32 v57, a141
    v_accvgpr_read_b32 v58, a142
    v_accvgpr_read_b32 v59, a143
    s_waitcnt lgkmcnt(0)
    v_mfma_f32_16x16x32_bf16 v[72:75], v[120:123], v[12:15], 0
    v_accvgpr_write_b32 a144, v160
    v_accvgpr_write_b32 a145, v161
    v_mfma_f32_16x16x32_bf16 v[72:75], v[124:127], v[16:19], v[72:75]
    v_accvgpr_write_b32 a146, v162
    v_accvgpr_write_b32 a147, v163
    v_mfma_f32_16x16x32_bf16 v[72:75], v[128:131], v[20:23], v[72:75]
    s_waitcnt vmcnt(8)
    v_accvgpr_write_b32 a148, v164
    v_accvgpr_write_b32 a149, v165
    v_mfma_f32_16x16x32_bf16 v[72:75], v[132:135], v[24:27], v[72:75]
    s_getreg_b32 s25, hwreg(HW_REG_IB_STS, 0, 4)
    v_accvgpr_write_b32 a150, v166
    v_accvgpr_write_b32 a151, v167
    v_mfma_f32_16x16x32_bf16 v[76:79], v[120:123], v[28:31], 0
    s_cmp_ge_u32 s25, s56
    v_accvgpr_write_b32 a152, v168
    v_accvgpr_write_b32 a153, v169
    v_mfma_f32_16x16x32_bf16 v[76:79], v[124:127], v[32:35], v[76:79]
    v_accvgpr_write_b32 a154, v170
    v_accvgpr_write_b32 a155, v171
    v_mfma_f32_16x16x32_bf16 v[76:79], v[128:131], v[36:39], v[76:79]
    v_accvgpr_write_b32 a156, v184
    v_accvgpr_write_b32 a157, v185
    v_mfma_f32_16x16x32_bf16 v[76:79], v[132:135], v[40:43], v[76:79]
    v_accvgpr_write_b32 a158, v186
    v_accvgpr_write_b32 a159, v187
    v_mfma_f32_16x16x32_bf16 v[80:83], v[120:123], v[44:47], 0
    v_accvgpr_write_b32 a160, v188
    v_accvgpr_write_b32 a161, v189
    v_mfma_f32_16x16x32_bf16 v[80:83], v[124:127], v[48:51], v[80:83]
    v_accvgpr_write_b32 a162, v190
    v_accvgpr_write_b32 a163, v191
    v_mfma_f32_16x16x32_bf16 v[80:83], v[128:131], v[52:55], v[80:83]
    v_accvgpr_write_b32 a164, v192
    v_accvgpr_write_b32 a165, v193
    v_mfma_f32_16x16x32_bf16 v[80:83], v[132:135], v[56:59], v[80:83]
    v_accvgpr_write_b32 a166, v194
    v_accvgpr_write_b32 a167, v195
    v_accvgpr_write_b32 a168, v208
    v_accvgpr_write_b32 a169, v209
    v_accvgpr_write_b32 a170, v210
    v_accvgpr_write_b32 a171, v211
    v_accvgpr_write_b32 a172, v212
    v_accvgpr_write_b32 a173, v213
    v_accvgpr_write_b32 a174, v214
    v_accvgpr_write_b32 a175, v215
    v_accvgpr_write_b32 a176, v216
    v_accvgpr_write_b32 a177, v217
    v_accvgpr_write_b32 a178, v218
    v_accvgpr_write_b32 a179, v219
    v_accvgpr_write_b32 a180, v232
    v_accvgpr_write_b32 a181, v233
    v_accvgpr_write_b32 a182, v234
    v_accvgpr_write_b32 a183, v235
    v_accvgpr_write_b32 a184, v236
    v_accvgpr_write_b32 a185, v237
    v_accvgpr_write_b32 a186, v238
    v_accvgpr_write_b32 a187, v239
    v_accvgpr_write_b32 a188, v240
    v_accvgpr_write_b32 a189, v241
    v_accvgpr_write_b32 a190, v242
    v_accvgpr_write_b32 a191, v243
    s_branch L_head2
L_sw1:
    s_cmp_eq_u32 s30, 1
    s_cbranch_scc1 L_q2b
    s_getpc_b64 s[14:15]
L_pc_64:
    s_add_u32 s14, s14, L_rare-L_pc_64
    s_addc_u32 s15, s15, 0
    s_lshr_b32 s69, s2, 3
    s_lshl_b32 s69, s69, 2
    s_add_u32 s69, s69, s60
    s_lshl_b32 s69, s69, 7
    v_and_b32 v10, 3, v0
    v_lshlrev_b32 v10, 14, v10
    v_add_u32 v10, s69, v10
    v_min_u32 v10, L_q2b-L_rare-4, v10
    global_load_dword v11, v10, s[14:15]
    v_accvgpr_read_b32 v12, a48
    v_accvgpr_read_b32 v13, a49
    v_accvgpr_read_b32 v14, a50
    v_accvgpr_read_b32 v15, a51
    v_accvgpr_read_b32 v16, a60
    v_accvgpr_read_b32 v17, a61
    v_accvgpr_read_b32 v18, a62
    v_accvgpr_read_b32 v19, a63
    v_accvgpr_read_b32 v20, a72
    v_accvgpr_read_b32 v21, a73
    v_accvgpr_read_b32 v22, a74
    v_accvgpr_read_b32 v23, a75
    v_accvgpr_read_b32 v24, a84
    v_accvgpr_read_b32 v25, a85
    v_accvgpr_read_b32 v26, a86
    v_accvgpr_read_b32 v27, a87
    v_accvgpr_read_b32 v28, a52
    v_accvgpr_read_b32 v29, a53
    v_accvgpr_read_b32 v30, a54
    v_accvgpr_read_b32 v31, a55
    v_accvgpr_read_b32 v32, a64
    v_accvgpr_read_b32 v33, a65
    v_accvgpr_read_b32 v34, a66
    v_accvgpr_read_b32 v35, a67
    v_accvgpr_read_b32 v36, a76
    v_accvgpr_read_b32 v37, a77
    v_accvgpr_read_b32 v38, a78
    v_accvgpr_read_b32 v39, a79
    v_accvgpr_read_b32 v40, a88
    v_accvgpr_read_b32 v41, a89
    v_accvgpr_read_b32 v42, a90
    v_accvgpr_read_b32 v43, a91
    v_accvgpr_read_b32 v44, a56
    v_accvgpr_read_b32 v45, a57
    v_accvgpr_read_b32 v46, a58
    v_accvgpr_read_b32 v47, a59
    v_accvgpr_read_b32 v48, a68
    v_accvgpr_read_b32 v49, a69
    v_accvgpr_read_b32 v50, a70
    v_accvgpr_read_b32 v51, a71
    v_accvgpr_read_b32 v52, a80
    v_accvgpr_read_b32 v53, a81
    v_accvgpr_read_b32 v54, a82
    v_accvgpr_read_b32 v55, a83
    v_accvgpr_read_b32 v56, a92
    v_accvgpr_read_b32 v57, a93
    v_accvgpr_read_b32 v58, a94
    v_accvgpr_read_b32 v59, a95
    s_waitcnt lgkmcnt(0)
    v_mfma_f32_16x16x32_bf16 v[72:75], v[120:123], v[12:15], 0
    v_accvgpr_write_b32 a96, v160
    v_accvgpr_write_b32 a97, v161
    v_mfma_f32_16x16x32_bf16 v[72:75], v[124:127], v[16:19], v[72:75]
    v_accvgpr_write_b32 a98, v162
    v_accvgpr_write_b32 a99, v163
    v_mfma_f32_16x16x32_bf16 v[72:75], v[128:131], v[20:23], v[72:75]
    s_waitcnt vmcnt(8)
    v_accvgpr_write_b32 a100, v164
    v_accvgpr_write_b32 a101, v165
    v_mfma_f32_16x16x32_bf16 v[72:75], v[132:135], v[24:27], v[72:75]
    s_getreg_b32 s25, hwreg(HW_REG_IB_STS, 0, 4)
    v_accvgpr_write_b32 a102, v166
    v_accvgpr_write_b32 a103, v167
    v_mfma_f32_16x16x32_bf16 v[76:79], v[120:123], v[28:31], 0
    s_cmp_ge_u32 s25, s56
    v_accvgpr_write_b32 a104, v168
    v_accvgpr_write_b32 a105, v169
    v_mfma_f32_16x16x32_bf16 v[76:79], v[124:127], v[32:35], v[76:79]
    v_accvgpr_write_b32 a106, v170
    v_accvgpr_write_b32 a107, v171
    v_mfma_f32_16x16x32_bf16 v[76:79], v[128:131], v[36:39], v[76:79]
    v_accvgpr_write_b32 a108, v184
    v_accvgpr_write_b32 a109, v185
    v_mfma_f32_16x16x32_bf16 v[76:79], v[132:135], v[40:43], v[76:79]
    v_accvgpr_write_b32 a110, v186
    v_accvgpr_write_b32 a111, v187
    v_mfma_f32_16x16x32_bf16 v[80:83], v[120:123], v[44:47], 0
    v_accvgpr_write_b32 a112, v188
    v_accvgpr_write_b32 a113, v189
    v_mfma_f32_16x16x32_bf16 v[80:83], v[124:127], v[48:51], v[80:83]
    v_accvgpr_write_b32 a114, v190
    v_accvgpr_write_b32 a115, v191
    v_mfma_f32_16x16x32_bf16 v[80:83], v[128:131], v[52:55], v[80:83]
    v_accvgpr_write_b32 a116, v192
    v_accvgpr_write_b32 a117, v193
    v_mfma_f32_16x16x32_bf16 v[80:83], v[132:135], v[56:59], v[80:83]
    v_accvgpr_write_b32 a118, v194
    v_accvgpr_write_b32 a119, v195
    v_accvgpr_write_b32 a120, v208
    v_accvgpr_write_b32 a121, v209
    v_accvgpr_write_b32 a122, v210
    v_accvgpr_write_b32 a123, v211
    v_accvgpr_write_b32 a124, v212
    v_accvgpr_write_b32 a125, v213
    v_accvgpr_write_b32 a126, v214
    v_accvgpr_write_b32 a127, v215
    v_accvgpr_write_b32 a128, v216
    v_accvgpr_write_b32 a129, v217
    v_accvgpr_write_b32 a130, v218
    v_accvgpr_write_b32 a131, v219
    v_accvgpr_write_b32 a132, v232
    v_accvgpr_write_b32 a133, v233
    v_accvgpr_write_b32 a134, v234
    v_accvgpr_write_b32 a135, v235
    v_accvgpr_write_b32 a136, v236
    v_accvgpr_write_b32 a137, v237
    v_accvgpr_write_b32 a138, v238
    v_accvgpr_write_b32 a139, v239
    v_accvgpr_write_b32 a140, v240
    v_accvgpr_write_b32 a141, v241
    v_accvgpr_write_b32 a142, v242
    v_accvgpr_write_b32 a143, v243
    s_branch L_head2
L_sw2:
    s_getpc_b64 s[14:15]
L_pc_65:
    s_add_u32 s14, s14, L_rare-L_pc_65
    s_addc_u32 s15, s15, 0
    s_lshr_b32 s69, s2, 3
    s_lshl_b32 s69, s69, 2
    s_add_u32 s69, s69, s60
    s_lshl_b32 s69, s69, 7
    v_and_b32 v158, 3, v0
    v_lshlrev_b32 v158, 14, v158
    v_add_u32 v158, s69, v158
    v_min_u32 v158, L_hot_end-L_rare-4, v158
    global_load_dword v159, v158, s[14:15]
    s_cmp_lg_u32 s60, 0
    s_cbranch_scc1 L_bp_66
    global_load_dword v156, v157, s[18:19] sc1
L_bp_66:
    v_accvgpr_read_b32 v12, a0
    v_accvgpr_read_b32 v13, a1
    v_accvgpr_read_b32 v14, a2
    v_accvgpr_read_b32 v15, a3
    v_accvgpr_read_b32 v16, a12
    v_accvgpr_read_b32 v17, a13
    v_accvgpr_read_b32 v18, a14
    v_accvgpr_read_b32 v19, a15
    v_accvgpr_read_b32 v20, a24
    v_accvgpr_read_b32 v21, a25
    v_accvgpr_read_b32 v22, a26
    v_accvgpr_read_b32 v23, a27
    v_accvgpr_read_b32 v24, a36
    v_accvgpr_read_b32 v25, a37
    v_accvgpr_read_b32 v26, a38
    v_accvgpr_read_b32 v27, a39
    v_accvgpr_read_b32 v28, a4
    v_accvgpr_read_b32 v29, a5
    v_accvgpr_read_b32 v30, a6
    v_accvgpr_read_b32 v31, a7
    v_accvgpr_read_b32 v32, a16
    v_accvgpr_read_b32 v33, a17
    v_accvgpr_read_b32 v34, a18
    v_accvgpr_read_b32 v35, a19
    v_accvgpr_read_b32 v36, a28
    v_accvgpr_read_b32 v37, a29
    v_accvgpr_read_b32 v38, a30
    v_accvgpr_read_b32 v39, a31
    v_accvgpr_read_b32 v40, a40
    v_accvgpr_read_b32 v41, a41
    v_accvgpr_read_b32 v42, a42
    v_accvgpr_read_b32 v43, a43
    v_accvgpr_read_b32 v44, a8
    v_accvgpr_read_b32 v45, a9
    v_accvgpr_read_b32 v46, a10
    v_accvgpr_read_b32 v47, a11
    v_accvgpr_read_b32 v48, a20
    v_accvgpr_read_b32 v49, a21
    v_accvgpr_read_b32 v50, a22
    v_accvgpr_read_b32 v51, a23
    v_accvgpr_read_b32 v52, a32
    v_accvgpr_read_b32 v53, a33
    v_accvgpr_read_b32 v54, a34
    v_accvgpr_read_b32 v55, a35
    v_accvgpr_read_b32 v56, a44
    v_accvgpr_read_b32 v57, a45
    v_accvgpr_read_b32 v58, a46
    v_accvgpr_read_b32 v59, a47
    s_waitcnt lgkmcnt(0)
    v_mfma_f32_16x16x32_bf16 v[72:75], v[120:123], v[12:15], 0
    v_accvgpr_write_b32 a48, v160
    v_accvgpr_write_b32 a49, v161
    v_mfma_f32_16x16x32_bf16 v[72:75], v[124:127], v[16:19], v[72:75]
    v_accvgpr_write_b32 a50, v162
    v_accvgpr_write_b32 a51, v163
    v_mfma_f32_16x16x32_bf16 v[72:75], v[128:131], v[20:23], v[72:75]
    s_waitcnt vmcnt(8)
    v_accvgpr_write_b32 a52, v164
    v_accvgpr_write_b32 a53, v165
    v_mfma_f32_16x16x32_bf16 v[72:75], v[132:135], v[24:27], v[72:75]
    s_getreg_b32 s25, hwreg(HW_REG_IB_STS, 0, 4)
    v_accvgpr_write_b32 a54, v166
    v_accvgpr_write_b32 a55, v167
    v_mfma_f32_16x16x32_bf16 v[76:79], v[120:123], v[28:31], 0
    s_cmp_ge_u32 s25, s56
    v_accvgpr_write_b32 a56, v168
    v_accvgpr_write_b32 a57, v169
    v_mfma_f32_16x16x32_bf16 v[76:79], v[124:127], v[32:35], v[76:79]
    v_accvgpr_write_b32 a58, v170
    v_accvgpr_write_b32 a59, v171
    v_mfma_f32_16x16x32_bf16 v[76:79], v[128:131], v[36:39], v[76:79]
    v_accvgpr_write_b32 a60, v184
    v_accvgpr_write_b32 a61, v185
    v_mfma_f32_16x16x32_bf16 v[76:79], v[132:135], v[40:43], v[76:79]
    v_accvgpr_write_b32 a62, v186
    v_accvgpr_write_b32 a63, v187
    v_mfma_f32_16x16x32_bf16 v[80:83], v[120:123], v[44:47], 0
    v_accvgpr_write_b32 a64, v188
    v_accvgpr_write_b32 a65, v189
    v_mfma_f32_16x16x32_bf16 v[80:83], v[124:127], v[48:51], v[80:83]
    v_accvgpr_write_b32 a66, v190
    v_accvgpr_write_b32 a67, v191
    v_mfma_f32_16x16x32_bf16 v[80:83], v[128:131], v[52:55], v[80:83]
    v_accvgpr_write_b32 a68, v192
    v_accvgpr_write_b32 a69, v193
    v_mfma_f32_16x16x32_bf16 v[80:83], v[132:135], v[56:59], v[80:83]
    v_accvgpr_write_b32 a70, v194
    v_accvgpr_write_b32 a71, v195
    v_accvgpr_write_b32 a72, v208
    v_accvgpr_write_b32 a73, v209
    v_accvgpr_write_b32 a74, v210
    v_accvgpr_write_b32 a75, v211
    v_accvgpr_write_b32 a76, v212
    v_accvgpr_write_b32 a77, v213
    v_accvgpr_write_b32 a78, v214
    v_accvgpr_write_b32 a79, v215
    v_accvgpr_write_b32 a80, v216
    v_accvgpr_write_b32 a81, v217
    v_accvgpr_write_b32 a82, v218
    v_accvgpr_write_b32 a83, v219
    v_accvgpr_write_b32 a84, v232
    v_accvgpr_write_b32 a85, v233
    v_accvgpr_write_b32 a86, v234
    v_accvgpr_write_b32 a87, v235
    v_accvgpr_write_b32 a88, v236
    v_accvgpr_write_b32 a89, v237
    v_accvgpr_write_b32 a90, v238
    v_accvgpr_write_b32 a91, v239
    v_accvgpr_write_b32 a92, v240
    v_accvgpr_write_b32 a93, v241
    v_accvgpr_write_b32 a94, v242
    v_accvgpr_write_b32 a95, v243
    s_branch L_head2
L_rare:
L_cu_29:
    s_add_u32 m0, s58, s3
    s_nop 0
    buffer_load_dwordx4 v1, s[44:47], s64 offen nt lds
    s_add_u32 m0, m0, 32
    s_nop 0
    buffer_load_dwordx4 v1, s[44:47], s64 offen offset:1024 nt lds
    s_add_u32 m0, s59, s61
    s_nop 0
    buffer_load_dwordx4 v1, s[40:43], s65 offen nt lds
    s_add_u32 m0, m0, 32
    s_nop 0
    buffer_load_dwordx4 v1, s[40:43], s65 offen offset:1024 nt lds
    s_mov_b32 s64, s65
    s_mov_b32 s58, s59
    s_add_u32 s57, s57, 8192
    s_xor_b32 s65, s57, s22
    s_bfe_u32 s59, s57, 0x3000d
    s_mul_i32 s59, s59, 8448
    s_sub_u32 s76, s76, 1
    s_branch L_cub_30
L_cu_35:
    s_add_u32 m0, s58, s3
    s_nop 0
    buffer_load_dwordx4 v1, s[44:47], s64 offen nt lds
    s_add_u32 m0, m0, 32
    s_nop 0
    buffer_load_dwordx4 v1, s[44:47], s64 offen offset:1024 nt lds
    s_add_u32 m0, s59, s61
    s_nop 0
    buffer_load_dwordx4 v1, s[40:43], s65 offen nt lds
    s_add_u32 m0, m0, 32
    s_nop 0
    buffer_load_dwordx4 v1, s[40:43], s65 offen offset:1024 nt lds
    s_mov_b32 s64, s65
    s_mov_b32 s58, s59
    s_add_u32 s57, s57, 8192
    s_xor_b32 s65, s57, s22
    s_bfe_u32 s59, s57, 0x3000d
    s_mul_i32 s59, s59, 8448
    s_sub_u32 s76, s76, 1
    s_branch L_cub_36
L_cu_41:
    s_add_u32 m0, s58, s3
    s_nop 0
    buffer_load_dwordx4 v1, s[44:47], s64 offen nt lds
    s_add_u32 m0, m0, 32
    s_nop 0
    buffer_load_dwordx4 v1, s[44:47], s64 offen offset:1024 nt lds
    s_add_u32 m0, s59, s61
    s_nop 0
    buffer_load_dwordx4 v1, s[40:43], s65 offen nt lds
    s_add_u32 m0, m0, 32
    s_nop 0
    buffer_load_dwordx4 v1, s[40:43], s65 offen offset:1024 nt lds
    s_mov_b32 s64, s65
    s_mov_b32 s58, s59
    s_add_u32 s57, s57, 8192
    s_xor_b32 s65, s57, s22
    s_bfe_u32 s59, s57, 0x3000d
    s_mul_i32 s59, s59, 8448
    s_sub_u32 s76, s76, 1
    s_branch L_cub_42
L_cu_47:
    s_add_u32 m0, s58, s3
    s_nop 0
    buffer_load_dwordx4 v1, s[44:47], s64 offen nt lds
    s_add_u32 m0, m0, 32
    s_nop 0
    buffer_load_dwordx4 v1, s[44:47], s64 offen offset:1024 nt lds
    s_add_u32 m0, s59, s61
    s_nop 0
    buffer_load_dwordx4 v1, s[40:43], s65 offen nt lds
    s_add_u32 m0, m0, 32
    s_nop 0
    buffer_load_dwordx4 v1, s[40:43], s65 offen offset:1024 nt lds
    s_mov_b32 s64, s65
    s_mov_b32 s58, s59
    s_add_u32 s57, s57, 8192
    s_xor_b32 s65, s57, s22
    s_bfe_u32 s59, s57, 0x3000d
    s_mul_i32 s59, s59, 8448
    s_sub_u32 s76, s76, 1
    s_branch L_cub_48
L_cu_53:
    s_add_u32 m0, s58, s3
    s_nop 0
    buffer_load_dwordx4 v1, s[44:47], s64 offen nt lds
    s_add_u32 m0, m0, 32
    s_nop 0
    buffer_load_dwordx4 v1, s[44:47], s64 offen offset:1024 nt lds
    s_add_u32 m0, s59, s61
    s_nop 0
    buffer_load_dwordx4 v1, s[40:43], s65 offen nt lds
    s_add_u32 m0, m0, 32
    s_nop 0
    buffer_load_dwordx4 v1, s[40:43], s65 offen offset:1024 nt lds
    s_mov_b32 s64, s65
    s_mov_b32 s58, s59
    s_add_u32 s57, s57, 8192
    s_xor_b32 s65, s57, s22
    s_bfe_u32 s59, s57, 0x3000d
    s_mul_i32 s59, s59, 8448
    s_sub_u32 s76, s76, 1
    s_branch L_cub_54
L_cu_59:
    s_add_u32 m0, s58, s3
    s_nop 0
    buffer_load_dwordx4 v1, s[44:47], s64 offen nt lds
    s_add_u32 m0, m0, 32
    s_nop 0
    buffer_load_dwordx4 v1, s[44:47], s64 offen offset:1024 nt lds
    s_add_u32 m0, s59, s61
    s_nop 0
    buffer_load_dwordx4 v1, s[40:43], s65 offen nt lds
    s_add_u32 m0, m0, 32
    s_nop 0
    buffer_load_dwordx4 v1, s[40:43], s65 offen offset:1024 nt lds
    s_mov_b32 s64, s65
    s_mov_b32 s58, s59
    s_add_u32 s57, s57, 8192
    s_xor_b32 s65, s57, s22
    s_bfe_u32 s59, s57, 0x3000d
    s_mul_i32 s59, s59, 8448
    s_sub_u32 s76, s76, 1
    s_branch L_cub_60
L_df_19w:
    s_waitcnt vmcnt(4)
    s_branch L_df_19i
L_df_19:
    s_cmp_ge_u32 s76, 4
    s_cbranch_scc1 L_df_19w
    v_mfma_f32_16x16x32_bf16 v[84:87], v[136:139], v[12:15], v[60:63]
    s_barrier
    ds_read_b128 v[120:123], v2 offset:8448
    v_add_f32 v72, v72, v60
    v_mfma_f32_16x16x32_bf16 v[84:87], v[140:143], v[16:19], v[84:87]
    s_add_u32 s76, s76, 1
    v_add_f32 v73, v73, v60
    v_add_f32 v74, v74, v60
    v_mfma_f32_16x16x32_bf16 v[84:87], v[144:147], v[20:23], v[84:87]
    v_mfma_f32_16x16x32_bf16 v[84:87], v[148:151], v[24:27], v[84:87]
    ds_read_b128 v[124:127], v2 offset:8512
    v_add_f32 v75, v75, v60
    v_mfma_f32_16x16x32_bf16 v[88:91], v[136:139], v[28:31], v[64:67]
    v_add_f32 v76, v76, v64
    v_add_f32 v77, v77, v64
    v_mfma_f32_16x16x32_bf16 v[88:91], v[140:143], v[32:35], v[88:91]
    v_mfma_f32_16x16x32_bf16 v[88:91], v[144:147], v[36:39], v[88:91]
    ds_read_b128 v[128:131], v2 offset:8576
    v_add_f32 v78, v78, v64
    v_mfma_f32_16x16x32_bf16 v[88:91], v[148:151], v[40:43], v[88:91]
    v_add_f32 v79, v79, v64
    v_add_f32 v80, v80, v68
    v_mfma_f32_16x16x32_bf16 v[92:95], v[136:139], v[44:47], v[68:71]
    v_mfma_f32_16x16x32_bf16 v[92:95], v[140:143], v[48:51], v[92:95]
    ds_read_b128 v[132:135], v2 offset:8640
    v_add_f32 v81, v81, v68
    v_mfma_f32_16x16x32_bf16 v[92:95], v[144:147], v[52:55], v[92:95]
    v_add_f32 v82, v82, v68
    v_add_f32 v83, v83, v68
    v_mfma_f32_16x16x32_bf16 v[92:95], v[148:151], v[56:59], v[92:95]
    s_branch L_dfb_20
L_df_21w:
    s_waitcnt vmcnt(4)
    s_branch L_df_21i
L_df_21:
    s_cmp_ge_u32 s76, 4
    s_cbranch_scc1 L_df_21w
    v_mfma_f32_16x16x32_bf16 a[200:203], a[204:207], v[104:107], 0
    s_barrier
    ds_read_b128 v[120:123], v2 offset:16896
    v_mfma_f32_16x16x32_bf16 a[196:199], a[204:207], v[100:103], 0
    s_waitcnt lgkmcnt(5)
    ds_read_b128 v[124:127], v2 offset:16960
    v_mfma_f32_16x16x32_bf16 a[192:195], a[204:207], v[96:99], 0
    ds_read_b128 v[128:131], v2 offset:17024
    v_mfma_f32_16x16x32_bf16 v[208:211], v[136:139], v[96:99], 0
    s_add_u32 s76, s76, 1
    ds_read_b128 v[132:135], v2 offset:17088
    v_exp_f32 v84, v84
    v_mfma_f32_16x16x32_bf16 v[212:215], v[136:139], v[100:103], 0
    v_exp_f32 v85, v85
    v_mfma_f32_16x16x32_bf16 v[216:219], v[136:139], v[104:107], 0
    v_mfma_f32_16x16x32_bf16 v[228:231], v[140:143], v[104:107], 0
    s_waitcnt lgkmcnt(4)
    v_exp_f32 v86, v86
    v_mfma_f32_16x16x32_bf16 v[224:227], v[140:143], v[100:103], 0
    v_exp_f32 v87, v87
    v_mfma_f32_16x16x32_bf16 v[220:223], v[140:143], v[96:99], 0
    v_mfma_f32_16x16x32_bf16 v[232:235], v[144:147], v[96:99], 0
    v_exp_f32 v88, v88
    v_mfma_f32_16x16x32_bf16 v[236:239], v[144:147], v[100:103], 0
    v_exp_f32 v89, v89
    v_mfma_f32_16x16x32_bf16 v[240:243], v[144:147], v[104:107], 0
    v_mfma_f32_16x16x32_bf16 v[252:255], v[148:151], v[104:107], 0
    s_waitcnt lgkmcnt(0)
    v_exp_f32 v90, v90
    v_mfma_f32_16x16x32_bf16 v[248:251], v[148:151], v[100:103], 0
    v_exp_f32 v91, v91
    v_mfma_f32_16x16x32_bf16 v[244:247], v[148:151], v[96:99], 0
    s_branch L_dfb_22
L_df_23w:
    s_waitcnt vmcnt(4)
    s_branch L_df_23i
L_df_23:
    s_cmp_ge_u32 s76, 4
    s_cbranch_scc1 L_df_23w
    v_mfma_f32_16x16x32_bf16 a[200:203], a[204:207], v[116:119], a[200:203]
    s_barrier
    ds_read_b128 v[120:123], v2 offset:25344
    v_mfma_f32_16x16x32_bf16 a[196:199], a[204:207], v[112:115], a[196:199]
    s_waitcnt lgkmcnt(5)
    ds_read_b128 v[124:127], v2 offset:25408
    v_mfma_f32_16x16x32_bf16 a[192:195], a[204:207], v[108:111], a[192:195]
    ds_read_b128 v[128:131], v2 offset:25472
    v_mfma_f32_16x16x32_bf16 v[208:211], v[136:139], v[108:111], v[208:211]
    s_add_u32 s76, s76, 1
    ds_read_b128 v[132:135], v2 offset:25536
    v_exp_f32 v84, v84
    v_mfma_f32_16x16x32_bf16 v[212:215], v[136:139], v[112:115], v[212:215]
    v_exp_f32 v85, v85
    v_mfma_f32_16x16x32_bf16 v[216:219], v[136:139], v[116:119], v[216:219]
    v_mfma_f32_16x16x32_bf16 v[228:231], v[140:143], v[116:119], v[228:231]
    s_waitcnt lgkmcnt(4)
    v_exp_f32 v86, v86
    v_mfma_f32_16x16x32_bf16 v[224:227], v[140:143], v[112:115], v[224:227]
    v_exp_f32 v87, v87
    v_mfma_f32_16x16x32_bf16 v[220:223], v[140:143], v[108:111], v[220:223]
    v_mfma_f32_16x16x32_bf16 v[232:235], v[144:147], v[108:111], v[232:235]
    v_exp_f32 v88, v88
    v_mfma_f32_16x16x32_bf16 v[236:239], v[144:147], v[112:115], v[236:239]
    v_exp_f32 v89, v89
    v_mfma_f32_16x16x32_bf16 v[240:243], v[144:147], v[116:119], v[240:243]
    v_mfma_f32_16x16x32_bf16 v[252:255], v[148:151], v[116:119], v[252:255]
    s_waitcnt lgkmcnt(0)
    v_exp_f32 v90, v90
    v_mfma_f32_16x16x32_bf16 v[248:251], v[148:151], v[112:115], v[248:251]
    v_exp_f32 v91, v91
    v_mfma_f32_16x16x32_bf16 v[244:247], v[148:151], v[108:111], v[244:247]
    s_branch L_dfb_24
L_df_25w:
    s_waitcnt vmcnt(4)
    s_branch L_df_25i
L_df_25:
    s_cmp_ge_u32 s76, 4
    s_cbranch_scc1 L_df_25w
    v_mfma_f32_16x16x32_bf16 a[200:203], a[204:207], v[104:107], a[200:203]
    s_barrier
    ds_read_b128 v[120:123], v2 offset:33792
    v_mfma_f32_16x16x32_bf16 a[196:199], a[204:207], v[100:103], a[196:199]
    s_waitcnt lgkmcnt(5)
    ds_read_b128 v[124:127], v2 offset:33856
    v_mfma_f32_16x16x32_bf16 a[192:195], a[204:207], v[96:99], a[192:195]
    ds_read_b128 v[128:131], v2 offset:33920
    v_mfma_f32_16x16x32_bf16 v[208:211], v[136:139], v[96:99], v[208:211]
    s_add_u32 s76, s76, 1
    ds_read_b128 v[132:135], v2 offset:33984
    v_exp_f32 v84, v84
    v_mfma_f32_16x16x32_bf16 v[212:215], v[136:139], v[100:103], v[212:215]
    v_exp_f32 v85, v85
    v_mfma_f32_16x16x32_bf16 v[216:219], v[136:139], v[104:107], v[216:219]
    v_mfma_f32_16x16x32_bf16 v[228:231], v[140:143], v[104:107], v[228:231]
    s_waitcnt lgkmcnt(4)
    v_exp_f32 v86, v86
    v_mfma_f32_16x16x32_bf16 v[224:227], v[140:143], v[100:103], v[224:227]
    v_exp_f32 v87, v87
    v_mfma_f32_16x16x32_bf16 v[220:223], v[140:143], v[96:99], v[220:223]
    v_mfma_f32_16x16x32_bf16 v[232:235], v[144:147], v[96:99], v[232:235]
    v_exp_f32 v88, v88
    v_mfma_f32_16x16x32_bf16 v[236:239], v[144:147], v[100:103], v[236:239]
    v_exp_f32 v89, v89
    v_mfma_f32_16x16x32_bf16 v[240:243], v[144:147], v[104:107], v[240:243]
    v_mfma_f32_16x16x32_bf16 v[252:255], v[148:151], v[104:107], v[252:255]
    s_waitcnt lgkmcnt(0)
    v_exp_f32 v90, v90
    v_mfma_f32_16x16x32_bf16 v[248:251], v[148:151], v[100:103], v[248:251]
    v_exp_f32 v91, v91
    v_mfma_f32_16x16x32_bf16 v[244:247], v[148:151], v[96:99], v[244:247]
    s_branch L_dfb_26
L_df_27w:
    s_waitcnt vmcnt(4)
    s_branch L_df_27i
L_df_27:
    s_cmp_ge_u32 s76, 4
    s_cbranch_scc1 L_df_27w
    v_mfma_f32_16x16x32_bf16 a[200:203], a[204:207], v[116:119], a[200:203]
    s_barrier
    ds_read_b128 v[120:123], v2 offset:42240
    v_mfma_f32_16x16x32_bf16 a[196:199], a[204:207], v[112:115], a[196:199]
    s_waitcnt lgkmcnt(5)
    ds_read_b128 v[124:127], v2 offset:42304
    v_mfma_f32_16x16x32_bf16 a[192:195], a[204:207], v[108:111], a[192:195]
    ds_read_b128 v[128:131], v2 offset:42368
    v_mfma_f32_16x16x32_bf16 v[208:211], v[136:139], v[108:111], v[208:211]
    s_add_u32 s76, s76, 1
    ds_read_b128 v[132:135], v2 offset:42432
    v_exp_f32 v84, v84
    v_mfma_f32_16x16x32_bf16 v[212:215], v[136:139], v[112:115], v[212:215]
    v_exp_f32 v85, v85
    v_mfma_f32_16x16x32_bf16 v[216:219], v[136:139], v[116:119], v[216:219]
    v_mfma_f32_16x16x32_bf16 v[228:231], v[140:143], v[116:119], v[228:231]
    s_waitcnt lgkmcnt(4)
    v_exp_f32 v86, v86
    v_mfma_f32_16x16x32_bf16 v[224:227], v[140:143], v[112:115], v[224:227]
    v_exp_f32 v87, v87
    v_mfma_f32_16x16x32_bf16 v[220:223], v[140:143], v[108:111], v[220:223]
    v_mfma_f32_16x16x32_bf16 v[232:235], v[144:147], v[108:111], v[232:235]
    v_exp_f32 v88, v88
    v_mfma_f32_16x16x32_bf16 v[236:239], v[144:147], v[112:115], v[236:239]
    v_exp_f32 v89, v89
    v_mfma_f32_16x16x32_bf16 v[240:243], v[144:147], v[116:119], v[240:243]
    v_mfma_f32_16x16x32_bf16 v[252:255], v[148:151], v[116:119], v[252:255]
    s_waitcnt lgkmcnt(0)
    v_exp_f32 v90, v90
    v_mfma_f32_16x16x32_bf16 v[248:251], v[148:151], v[112:115], v[248:251]
    v_exp_f32 v91, v91
    v_mfma_f32_16x16x32_bf16 v[244:247], v[148:151], v[108:111], v[244:247]
    s_branch L_dfb_28
L_df_31w:
    s_waitcnt vmcnt(4)
    s_branch L_df_31i
L_df_31:
    s_cmp_ge_u32 s76, 4
    s_cbranch_scc1 L_df_31w
    v_mfma_f32_16x16x32_bf16 a[200:203], a[204:207], v[104:107], a[200:203]
    s_barrier
    ds_read_b128 v[120:123], v2 offset:50688
    v_mfma_f32_16x16x32_bf16 a[196:199], a[204:207], v[100:103], a[196:199]
    s_waitcnt lgkmcnt(5)
    ds_read_b128 v[124:127], v2 offset:50752
    v_mfma_f32_16x16x32_bf16 a[192:195], a[204:207], v[96:99], a[192:195]
    ds_read_b128 v[128:131], v2 offset:50816
    v_mfma_f32_16x16x32_bf16 v[208:211], v[136:139], v[96:99], v[208:211]
    s_add_u32 s76, s76, 1
    ds_read_b128 v[132:135], v2 offset:50880
    v_exp_f32 v84, v84
    v_mfma_f32_16x16x32_bf16 v[212:215], v[136:139], v[100:103], v[212:215]
    v_exp_f32 v85, v85
    v_mfma_f32_16x16x32_bf16 v[216:219], v[136:139], v[104:107], v[216:219]
    v_mfma_f32_16x16x32_bf16 v[228:231], v[140:143], v[104:107], v[228:231]
    s_waitcnt lgkmcnt(4)
    v_exp_f32 v86, v86
    v_mfma_f32_16x16x32_bf16 v[224:227], v[140:143], v[100:103], v[224:227]
    v_exp_f32 v87, v87
    v_mfma_f32_16x16x32_bf16 v[220:223], v[140:143], v[96:99], v[220:223]
    v_mfma_f32_16x16x32_bf16 v[232:235], v[144:147], v[96:99], v[232:235]
    v_exp_f32 v88, v88
    v_mfma_f32_16x16x32_bf16 v[236:239], v[144:147], v[100:103], v[236:239]
    v_exp_f32 v89, v89
    v_mfma_f32_16x16x32_bf16 v[240:243], v[144:147], v[104:107], v[240:243]
    v_mfma_f32_16x16x32_bf16 v[252:255], v[148:151], v[104:107], v[252:255]
    s_waitcnt lgkmcnt(0)
    v_exp_f32 v90, v90
    v_mfma_f32_16x16x32_bf16 v[248:251], v[148:151], v[100:103], v[248:251]
    v_exp_f32 v91, v91
    v_mfma_f32_16x16x32_bf16 v[244:247], v[148:151], v[96:99], v[244:247]
    s_branch L_dfb_32
L_df_33w:
    s_waitcnt vmcnt(4)
    s_branch L_df_33i
L_df_33:
    s_cmp_ge_u32 s76, 4
    s_cbranch_scc1 L_df_33w
    v_mfma_f32_16x16x32_bf16 a[200:203], a[204:207], v[116:119], a[200:203]
    s_barrier
    ds_read_b128 v[120:123], v2 offset:59136
    v_mfma_f32_16x16x32_bf16 a[196:199], a[204:207], v[112:115], a[196:199]
    s_waitcnt lgkmcnt(5)
    ds_read_b128 v[124:127], v2 offset:59200
    v_mfma_f32_16x16x32_bf16 a[192:195], a[204:207], v[108:111], a[192:195]
    ds_read_b128 v[128:131], v2 offset:59264
    v_mfma_f32_16x16x32_bf16 v[208:211], v[136:139], v[108:111], v[208:211]
    s_add_u32 s76, s76, 1
    ds_read_b128 v[132:135], v2 offset:59328
    v_exp_f32 v84, v84
    v_mfma_f32_16x16x32_bf16 v[212:215], v[136:139], v[112:115], v[212:215]
    v_exp_f32 v85, v85
    v_mfma_f32_16x16x32_bf16 v[216:219], v[136:139], v[116:119], v[216:219]
    v_mfma_f32_16x16x32_bf16 v[228:231], v[140:143], v[116:119], v[228:231]
    s_waitcnt lgkmcnt(4)
    v_exp_f32 v86, v86
    v_mfma_f32_16x16x32_bf16 v[224:227], v[140:143], v[112:115], v[224:227]
    v_exp_f32 v87, v87
    v_mfma_f32_16x16x32_bf16 v[220:223], v[140:143], v[108:111], v[220:223]
    v_mfma_f32_16x16x32_bf16 v[232:235], v[144:147], v[108:111], v[232:235]
    v_exp_f32 v88, v88
    v_mfma_f32_16x16x32_bf16 v[236:239], v[144:147], v[112:115], v[236:239]
    v_exp_f32 v89, v89
    v_mfma_f32_16x16x32_bf16 v[240:243], v[144:147], v[116:119], v[240:243]
    v_mfma_f32_16x16x32_bf16 v[252:255], v[148:151], v[116:119], v[252:255]
    s_waitcnt lgkmcnt(0)
    v_exp_f32 v90, v90
    v_mfma_f32_16x16x32_bf16 v[248:251], v[148:151], v[112:115], v[248:251]
    v_exp_f32 v91, v91
    v_mfma_f32_16x16x32_bf16 v[244:247], v[148:151], v[108:111], v[244:247]
    s_branch L_dfb_34
L_df_37w:
    s_waitcnt vmcnt(4)
    s_branch L_df_37i
L_df_37:
    s_cmp_ge_u32 s76, 4
    s_cbranch_scc1 L_df_37w
    v_mfma_f32_16x16x32_bf16 a[200:203], a[204:207], v[104:107], a[200:203]
    s_barrier
    ds_read_b128 v[120:123], v2 offset:0
    v_mfma_f32_16x16x32_bf16 a[196:199], a[204:207], v[100:103], a[196:199]
    s_waitcnt lgkmcnt(5)
    ds_read_b128 v[124:127], v2 offset:64
    v_mfma_f32_16x16x32_bf16 a[192:195], a[204:207], v[96:99], a[192:195]
    ds_read_b128 v[128:131], v2 offset:128
    v_mfma_f32_16x16x32_bf16 v[208:211], v[136:139], v[96:99], v[208:211]
    s_add_u32 s76, s76, 1
    ds_read_b128 v[132:135], v2 offset:192
    v_exp_f32 v84, v84
    v_mfma_f32_16x16x32_bf16 v[212:215], v[136:139], v[100:103], v[212:215]
    v_exp_f32 v85, v85
    v_mfma_f32_16x16x32_bf16 v[216:219], v[136:139], v[104:107], v[216:219]
    v_mfma_f32_16x16x32_bf16 v[228:231], v[140:143], v[104:107], v[228:231]
    s_waitcnt lgkmcnt(4)
    v_exp_f32 v86, v86
    v_mfma_f32_16x16x32_bf16 v[224:227], v[140:143], v[100:103], v[224:227]
    v_exp_f32 v87, v87
    v_mfma_f32_16x16x32_bf16 v[220:223], v[140:143], v[96:99], v[220:223]
    v_mfma_f32_16x16x32_bf16 v[232:235], v[144:147], v[96:99], v[232:235]
    v_exp_f32 v88, v88
    v_mfma_f32_16x16x32_bf16 v[236:239], v[144:147], v[100:103], v[236:239]
    v_exp_f32 v89, v89
    v_mfma_f32_16x16x32_bf16 v[240:243], v[144:147], v[104:107], v[240:243]
    v_mfma_f32_16x16x32_bf16 v[252:255], v[148:151], v[104:107], v[252:255]
    s_waitcnt lgkmcnt(0)
    v_exp_f32 v90, v90
    v_mfma_f32_16x16x32_bf16 v[248:251], v[148:151], v[100:103], v[248:251]
    v_exp_f32 v91, v91
    v_mfma_f32_16x16x32_bf16 v[244:247], v[148:151], v[96:99], v[244:247]
    s_branch L_dfb_38
L_df_39w:
    s_waitcnt vmcnt(4)
    s_branch L_df_39i
L_df_39:
    s_cmp_ge_u32 s76, 4
    s_cbranch_scc1 L_df_39w
    v_mfma_f32_16x16x32_bf16 a[200:203], a[204:207], v[116:119], a[200:203]
    s_barrier
    ds_read_b128 v[120:123], v2 offset:8448
    v_mfma_f32_16x16x32_bf16 a[196:199], a[204:207], v[112:115], a[196:199]
    s_waitcnt lgkmcnt(5)
    ds_read_b128 v[124:127], v2 offset:8512
    v_mfma_f32_16x16x32_bf16 a[192:195], a[204:207], v[108:111], a[192:195]
    ds_read_b128 v[128:131], v2 offset:8576
    v_mfma_f32_16x16x32_bf16 v[208:211], v[136:139], v[108:111], v[208:211]
    s_add_u32 s76, s76, 1
    ds_read_b128 v[132:135], v2 offset:8640
    v_exp_f32 v84, v84
    v_mfma_f32_16x16x32_bf16 v[212:215], v[136:139], v[112:115], v[212:215]
    v_exp_f32 v85, v85
    v_mfma_f32_16x16x32_bf16 v[216:219], v[136:139], v[116:119], v[216:219]
    v_mfma_f32_16x16x32_bf16 v[228:231], v[140:143], v[116:119], v[228:231]
    s_waitcnt lgkmcnt(4)
    v_exp_f32 v86, v86
    v_mfma_f32_16x16x32_bf16 v[224:227], v[140:143], v[112:115], v[224:227]
    v_exp_f32 v87, v87
    v_mfma_f32_16x16x32_bf16 v[220:223], v[140:143], v[108:111], v[220:223]
    v_mfma_f32_16x16x32_bf16 v[232:235], v[144:147], v[108:111], v[232:235]
    v_exp_f32 v88, v88
    v_mfma_f32_16x16x32_bf16 v[236:239], v[144:147], v[112:115], v[236:239]
    v_exp_f32 v89, v89
    v_mfma_f32_16x16x32_bf16 v[240:243], v[144:147], v[116:119], v[240:243]
    v_mfma_f32_16x16x32_bf16 v[252:255], v[148:151], v[116:119], v[252:255]
    s_waitcnt lgkmcnt(0)
    v_exp_f32 v90, v90
    v_mfma_f32_16x16x32_bf16 v[248:251], v[148:151], v[112:115], v[248:251]
    v_exp_f32 v91, v91
    v_mfma_f32_16x16x32_bf16 v[244:247], v[148:151], v[108:111], v[244:247]
    s_branch L_dfb_40
L_df_43w:
    s_waitcnt vmcnt(4)
    s_branch L_df_43i
L_df_43:
    s_cmp_ge_u32 s76, 4
    s_cbranch_scc1 L_df_43w
    v_mfma_f32_16x16x32_bf16 a[200:203], a[204:207], v[104:107], a[200:203]
    s_barrier
    ds_read_b128 v[120:123], v2 offset:16896
    v_mfma_f32_16x16x32_bf16 a[196:199], a[204:207], v[100:103], a[196:199]
    s_waitcnt lgkmcnt(5)
    ds_read_b128 v[124:127], v2 offset:16960
    v_mfma_f32_16x16x32_bf16 a[192:195], a[204:207], v[96:99], a[192:195]
    ds_read_b128 v[128:131], v2 offset:17024
    v_mfma_f32_16x16x32_bf16 v[208:211], v[136:139], v[96:99], v[208:211]
    s_add_u32 s76, s76, 1
    ds_read_b128 v[132:135], v2 offset:17088
    v_exp_f32 v84, v84
    v_mfma_f32_16x16x32_bf16 v[212:215], v[136:139], v[100:103], v[212:215]
    v_exp_f32 v85, v85
    v_mfma_f32_16x16x32_bf16 v[216:219], v[136:139], v[104:107], v[216:219]
    v_mfma_f32_16x16x32_bf16 v[228:231], v[140:143], v[104:107], v[228:231]
    s_waitcnt lgkmcnt(4)
    v_exp_f32 v86, v86
    v_mfma_f32_16x16x32_bf16 v[224:227], v[140:143], v[100:103], v[224:227]
    v_exp_f32 v87, v87
    v_mfma_f32_16x16x32_bf16 v[220:223], v[140:143], v[96:99], v[220:223]
    v_mfma_f32_16x16x32_bf16 v[232:235], v[144:147], v[96:99], v[232:235]
    v_exp_f32 v88, v88
    v_mfma_f32_16x16x32_bf16 v[236:239], v[144:147], v[100:103], v[236:239]
    v_exp_f32 v89, v89
    v_mfma_f32_16x16x32_bf16 v[240:243], v[144:147], v[104:107], v[240:243]
    v_mfma_f32_16x16x32_bf16 v[252:255], v[148:151], v[104:107], v[252:255]
    s_waitcnt lgkmcnt(0)
    v_exp_f32 v90, v90
    v_mfma_f32_16x16x32_bf16 v[248:251], v[148:151], v[100:103], v[248:251]
    v_exp_f32 v91, v91
    v_mfma_f32_16x16x32_bf16 v[244:247], v[148:151], v[96:99], v[244:247]
    s_branch L_dfb_44
L_df_45w:
    s_waitcnt vmcnt(4)
    s_branch L_df_45i
L_df_45:
    s_cmp_ge_u32 s76, 4
    s_cbranch_scc1 L_df_45w
    v_mfma_f32_16x16x32_bf16 a[200:203], a[204:207], v[116:119], a[200:203]
    s_barrier
    ds_read_b128 v[120:123], v2 offset:25344
    v_mfma_f32_16x16x32_bf16 a[196:199], a[204:207], v[112:115], a[196:199]
    s_waitcnt lgkmcnt(5)
    ds_read_b128 v[124:127], v2 offset:25408
    v_mfma_f32_16x16x32_bf16 a[192:195], a[204:207], v[108:111], a[192:195]
    ds_read_b128 v[128:131], v2 offset:25472
    v_mfma_f32_16x16x32_bf16 v[208:211], v[136:139], v[108:111], v[208:211]
    s_add_u32 s76, s76, 1
    ds_read_b128 v[132:135], v2 offset:25536
    v_exp_f32 v84, v84
    v_mfma_f32_16x16x32_bf16 v[212:215], v[136:139], v[112:115], v[212:215]
    v_exp_f32 v85, v85
    v_mfma_f32_16x16x32_bf16 v[216:219], v[136:139], v[116:119], v[216:219]
    v_mfma_f32_16x16x32_bf16 v[228:231], v[140:143], v[116:119], v[228:231]
    s_waitcnt lgkmcnt(4)
    v_exp_f32 v86, v86
    v_mfma_f32_16x16x32_bf16 v[224:227], v[140:143], v[112:115], v[224:227]
    v_exp_f32 v87, v87
    v_mfma_f32_16x16x32_bf16 v[220:223], v[140:143], v[108:111], v[220:223]
    v_mfma_f32_16x16x32_bf16 v[232:235], v[144:147], v[108:111], v[232:235]
    v_exp_f32 v88, v88
    v_mfma_f32_16x16x32_bf16 v[236:239], v[144:147], v[112:115], v[236:239]
    v_exp_f32 v89, v89
    v_mfma_f32_16x16x32_bf16 v[240:243], v[144:147], v[116:119], v[240:243]
    v_mfma_f32_16x16x32_bf16 v[252:255], v[148:151], v[116:119], v[252:255]
    s_waitcnt lgkmcnt(0)
    v_exp_f32 v90, v90
    v_mfma_f32_16x16x32_bf16 v[248:251], v[148:151], v[112:115], v[248:251]
    v_exp_f32 v91, v91
    v_mfma_f32_16x16x32_bf16 v[244:247], v[148:151], v[108:111], v[244:247]
    s_branch L_dfb_46
L_df_49w:
    s_waitcnt vmcnt(4)
    s_branch L_df_49i
L_df_49:
    s_cmp_ge_u32 s76, 4
    s_cbranch_scc1 L_df_49w
    v_mfma_f32_16x16x32_bf16 a[200:203], a[204:207], v[104:107], a[200:203]
    s_barrier
    ds_read_b128 v[120:123], v2 offset:33792
    v_mfma_f32_16x16x32_bf16 a[196:199], a[204:207], v[100:103], a[196:199]
    s_waitcnt lgkmcnt(5)
    ds_read_b128 v[124:127], v2 offset:33856
    v_mfma_f32_16x16x32_bf16 a[192:195], a[204:207], v[96:99], a[192:195]
    ds_read_b128 v[128:131], v2 offset:33920
    v_mfma_f32_16x16x32_bf16 v[208:211], v[136:139], v[96:99], v[208:211]
    s_add_u32 s76, s76, 1
    ds_read_b128 v[132:135], v2 offset:33984
    v_exp_f32 v84, v84
    v_mfma_f32_16x16x32_bf16 v[212:215], v[136:139], v[100:103], v[212:215]
    v_exp_f32 v85, v85
    v_mfma_f32_16x16x32_bf16 v[216:219], v[136:139], v[104:107], v[216:219]
    v_mfma_f32_16x16x32_bf16 v[228:231], v[140:143], v[104:107], v[228:231]
    s_waitcnt lgkmcnt(4)
    v_exp_f32 v86, v86
    v_mfma_f32_16x16x32_bf16 v[224:227], v[140:143], v[100:103], v[224:227]
    v_exp_f32 v87, v87
    v_mfma_f32_16x16x32_bf16 v[220:223], v[140:143], v[96:99], v[220:223]
    v_mfma_f32_16x16x32_bf16 v[232:235], v[144:147], v[96:99], v[232:235]
    v_exp_f32 v88, v88
    v_mfma_f32_16x16x32_bf16 v[236:239], v[144:147], v[100:103], v[236:239]
    v_exp_f32 v89, v89
    v_mfma_f32_16x16x32_bf16 v[240:243], v[144:147], v[104:107], v[240:243]
    v_mfma_f32_16x16x32_bf16 v[252:255], v[148:151], v[104:107], v[252:255]
    s_waitcnt lgkmcnt(0)
    v_exp_f32 v90, v90
    v_mfma_f32_16x16x32_bf16 v[248:251], v[148:151], v[100:103], v[248:251]
    v_exp_f32 v91, v91
    v_mfma_f32_16x16x32_bf16 v[244:247], v[148:151], v[96:99], v[244:247]
    s_branch L_dfb_50
L_df_51w:
    s_waitcnt vmcnt(4)
    s_branch L_df_51i
L_df_51:
    s_cmp_ge_u32 s76, 4
    s_cbranch_scc1 L_df_51w
    v_mfma_f32_16x16x32_bf16 a[200:203], a[204:207], v[116:119], a[200:203]
    s_barrier
    ds_read_b128 v[120:123], v2 offset:42240
    v_mfma_f32_16x16x32_bf16 a[196:199], a[204:207], v[112:115], a[196:199]
    s_waitcnt lgkmcnt(5)
    ds_read_b128 v[124:127], v2 offset:42304
    v_mfma_f32_16x16x32_bf16 a[192:195], a[204:207], v[108:111], a[192:195]
    ds_read_b128 v[128:131], v2 offset:42368
    v_mfma_f32_16x16x32_bf16 v[208:211], v[136:139], v[108:111], v[208:211]
    s_add_u32 s76, s76, 1
    ds_read_b128 v[132:135], v2 offset:42432
    v_exp_f32 v84, v84
    v_mfma_f32_16x16x32_bf16 v[212:215], v[136:139], v[112:115], v[212:215]
    v_exp_f32 v85, v85
    v_mfma_f32_16x16x32_bf16 v[216:219], v[136:139], v[116:119], v[216:219]
    v_mfma_f32_16x16x32_bf16 v[228:231], v[140:143], v[116:119], v[228:231]
    s_waitcnt lgkmcnt(4)
    v_exp_f32 v86, v86
    v_mfma_f32_16x16x32_bf16 v[224:227], v[140:143], v[112:115], v[224:227]
    v_exp_f32 v87, v87
    v_mfma_f32_16x16x32_bf16 v[220:223], v[140:143], v[108:111], v[220:223]
    v_mfma_f32_16x16x32_bf16 v[232:235], v[144:147], v[108:111], v[232:235]
    v_exp_f32 v88, v88
    v_mfma_f32_16x16x32_bf16 v[236:239], v[144:147], v[112:115], v[236:239]
    v_exp_f32 v89, v89
    v_mfma_f32_16x16x32_bf16 v[240:243], v[144:147], v[116:119], v[240:243]
    v_mfma_f32_16x16x32_bf16 v[252:255], v[148:151], v[116:119], v[252:255]
    s_waitcnt lgkmcnt(0)
    v_exp_f32 v90, v90
    v_mfma_f32_16x16x32_bf16 v[248:251], v[148:151], v[112:115], v[248:251]
    v_exp_f32 v91, v91
    v_mfma_f32_16x16x32_bf16 v[244:247], v[148:151], v[108:111], v[244:247]
    s_branch L_dfb_52
L_df_55w:
    s_waitcnt vmcnt(4)
    s_branch L_df_55i
L_df_55:
    s_cmp_ge_u32 s76, 4
    s_cbranch_scc1 L_df_55w
    v_mfma_f32_16x16x32_bf16 a[200:203], a[204:207], v[104:107], a[200:203]
    s_barrier
    ds_read_b128 v[120:123], v2 offset:50688
    v_mfma_f32_16x16x32_bf16 a[196:199], a[204:207], v[100:103], a[196:199]
    s_waitcnt lgkmcnt(5)
    ds_read_b128 v[124:127], v2 offset:50752
    v_mfma_f32_16x16x32_bf16 a[192:195], a[204:207], v[96:99], a[192:195]
    ds_read_b128 v[128:131], v2 offset:50816
    v_mfma_f32_16x16x32_bf16 v[208:211], v[136:139], v[96:99], v[208:211]
    s_add_u32 s76, s76, 1
    ds_read_b128 v[132:135], v2 offset:50880
    v_exp_f32 v84, v84
    v_mfma_f32_16x16x32_bf16 v[212:215], v[136:139], v[100:103], v[212:215]
    v_exp_f32 v85, v85
    v_mfma_f32_16x16x32_bf16 v[216:219], v[136:139], v[104:107], v[216:219]
    v_mfma_f32_16x16x32_bf16 v[228:231], v[140:143], v[104:107], v[228:231]
    s_waitcnt lgkmcnt(4)
    v_exp_f32 v86, v86
    v_mfma_f32_16x16x32_bf16 v[224:227], v[140:143], v[100:103], v[224:227]
    v_exp_f32 v87, v87
    v_mfma_f32_16x16x32_bf16 v[220:223], v[140:143], v[96:99], v[220:223]
    v_mfma_f32_16x16x32_bf16 v[232:235], v[144:147], v[96:99], v[232:235]
    v_exp_f32 v88, v88
    v_mfma_f32_16x16x32_bf16 v[236:239], v[144:147], v[100:103], v[236:239]
    v_exp_f32 v89, v89
    v_mfma_f32_16x16x32_bf16 v[240:243], v[144:147], v[104:107], v[240:243]
    v_mfma_f32_16x16x32_bf16 v[252:255], v[148:151], v[104:107], v[252:255]
    s_waitcnt lgkmcnt(0)
    v_exp_f32 v90, v90
    v_mfma_f32_16x16x32_bf16 v[248:251], v[148:151], v[100:103], v[248:251]
    v_exp_f32 v91, v91
    v_mfma_f32_16x16x32_bf16 v[244:247], v[148:151], v[96:99], v[244:247]
    s_branch L_dfb_56
L_df_57w:
    s_waitcnt vmcnt(4)
    s_branch L_df_57i
L_df_57:
    s_cmp_ge_u32 s76, 4
    s_cbranch_scc1 L_df_57w
    v_mfma_f32_16x16x32_bf16 a[200:203], a[204:207], v[116:119], a[200:203]
    s_barrier
    ds_read_b128 v[120:123], v2 offset:59136
    v_mfma_f32_16x16x32_bf16 a[196:199], a[204:207], v[112:115], a[196:199]
    s_waitcnt lgkmcnt(5)
    ds_read_b128 v[124:127], v2 offset:59200
    v_mfma_f32_16x16x32_bf16 a[192:195], a[204:207], v[108:111], a[192:195]
    ds_read_b128 v[128:131], v2 offset:59264
    v_mfma_f32_16x16x32_bf16 v[208:211], v[136:139], v[108:111], v[208:211]
    s_add_u32 s76, s76, 1
    ds_read_b128 v[132:135], v2 offset:59328
    v_exp_f32 v84, v84
    v_mfma_f32_16x16x32_bf16 v[212:215], v[136:139], v[112:115], v[212:215]
    v_exp_f32 v85, v85
    v_mfma_f32_16x16x32_bf16 v[216:219], v[136:139], v[116:119], v[216:219]
    v_mfma_f32_16x16x32_bf16 v[228:231], v[140:143], v[116:119], v[228:231]
    s_waitcnt lgkmcnt(4)
    v_exp_f32 v86, v86
    v_mfma_f32_16x16x32_bf16 v[224:227], v[140:143], v[112:115], v[224:227]
    v_exp_f32 v87, v87
    v_mfma_f32_16x16x32_bf16 v[220:223], v[140:143], v[108:111], v[220:223]
    v_mfma_f32_16x16x32_bf16 v[232:235], v[144:147], v[108:111], v[232:235]
    v_exp_f32 v88, v88
    v_mfma_f32_16x16x32_bf16 v[236:239], v[144:147], v[112:115], v[236:239]
    v_exp_f32 v89, v89
    v_mfma_f32_16x16x32_bf16 v[240:243], v[144:147], v[116:119], v[240:243]
    v_mfma_f32_16x16x32_bf16 v[252:255], v[148:151], v[116:119], v[252:255]
    s_waitcnt lgkmcnt(0)
    v_exp_f32 v90, v90
    v_mfma_f32_16x16x32_bf16 v[248:251], v[148:151], v[112:115], v[248:251]
    v_exp_f32 v91, v91
    v_mfma_f32_16x16x32_bf16 v[244:247], v[148:151], v[108:111], v[244:247]
    s_branch L_dfb_58
L_df_61w:
    s_waitcnt vmcnt(4)
    s_branch L_df_61i
L_df_61:
    s_cmp_ge_u32 s76, 4
    s_cbranch_scc1 L_df_61w
    v_mfma_f32_16x16x32_bf16 a[200:203], a[204:207], v[104:107], a[200:203]
    s_barrier
    ds_read_b64_tr_b16 v[120:121], v3 offset:59136
    v_mfma_f32_16x16x32_bf16 a[196:199], a[204:207], v[100:103], a[196:199]
    s_waitcnt lgkmcnt(5)
    ds_read_b64_tr_b16 v[122:123], v3 offset:59648
    v_mfma_f32_16x16x32_bf16 a[192:195], a[204:207], v[96:99], a[192:195]
    ds_read_b64_tr_b16 v[124:125], v3 offset:59168
    v_mfma_f32_16x16x32_bf16 v[208:211], v[136:139], v[96:99], v[208:211]
    s_add_u32 s76, s76, 1
    ds_read_b64_tr_b16 v[126:127], v3 offset:59680
    v_exp_f32 v84, v84
    v_mfma_f32_16x16x32_bf16 v[212:215], v[136:139], v[100:103], v[212:215]
    ds_read_b64_tr_b16 v[128:129], v3 offset:59200
    v_exp_f32 v85, v85
    v_mfma_f32_16x16x32_bf16 v[216:219], v[136:139], v[104:107], v[216:219]
    v_mfma_f32_16x16x32_bf16 v[228:231], v[140:143], v[104:107], v[228:231]
    s_waitcnt lgkmcnt(5)
    ds_read_b64_tr_b16 v[130:131], v3 offset:59712
    v_exp_f32 v86, v86
    v_mfma_f32_16x16x32_bf16 v[224:227], v[140:143], v[100:103], v[224:227]
    ds_read_b64_tr_b16 v[132:133], v3 offset:59232
    v_exp_f32 v87, v87
    v_mfma_f32_16x16x32_bf16 v[220:223], v[140:143], v[96:99], v[220:223]
    v_mfma_f32_16x16x32_bf16 v[232:235], v[144:147], v[96:99], v[232:235]
    ds_read_b64_tr_b16 v[134:135], v3 offset:59744
    v_exp_f32 v88, v88
    v_mfma_f32_16x16x32_bf16 v[236:239], v[144:147], v[100:103], v[236:239]
    v_cvt_pk_bf16_f32 v110, v84, v85
    v_exp_f32 v89, v89
    v_mfma_f32_16x16x32_bf16 v[240:243], v[144:147], v[104:107], v[240:243]
    v_mfma_f32_16x16x32_bf16 v[252:255], v[148:151], v[104:107], v[252:255]
    v_cvt_pk_bf16_f32 v111, v86, v87
    v_exp_f32 v90, v90
    v_mfma_f32_16x16x32_bf16 v[248:251], v[148:151], v[100:103], v[248:251]
    v_exp_f32 v91, v91
    v_mfma_f32_16x16x32_bf16 v[244:247], v[148:151], v[96:99], v[244:247]
    s_waitcnt lgkmcnt(0)
    s_branch L_dfb_62
L_q2b:
    v_accvgpr_write_b32 a96, v160
    v_accvgpr_write_b32 a97, v161
    v_accvgpr_write_b32 a98, v162
    v_accvgpr_write_b32 a99, v163
    v_accvgpr_write_b32 a100, v164
    v_accvgpr_write_b32 a101, v165
    v_accvgpr_write_b32 a102, v166
    v_accvgpr_write_b32 a103, v167
    v_accvgpr_write_b32 a104, v168
    v_accvgpr_write_b32 a105, v169
    v_accvgpr_write_b32 a106, v170
    v_accvgpr_write_b32 a107, v171
    v_accvgpr_write_b32 a108, v184
    v_accvgpr_write_b32 a109, v185
    v_accvgpr_write_b32 a110, v186
    v_accvgpr_write_b32 a111, v187
    v_accvgpr_write_b32 a112, v188
    v_accvgpr_write_b32 a113, v189
    v_accvgpr_write_b32 a114, v190
    v_accvgpr_write_b32 a115, v191
    v_accvgpr_write_b32 a116, v192
    v_accvgpr_write_b32 a117, v193
    v_accvgpr_write_b32 a118, v194
    v_accvgpr_write_b32 a119, v195
    v_accvgpr_write_b32 a120, v208
    v_accvgpr_write_b32 a121, v209
    v_accvgpr_write_b32 a122, v210
    v_accvgpr_write_b32 a123, v211
    v_accvgpr_write_b32 a124, v212
    v_accvgpr_write_b32 a125, v213
    v_accvgpr_write_b32 a126, v214
    v_accvgpr_write_b32 a127, v215
    v_accvgpr_write_b32 a128, v216
    v_accvgpr_write_b32 a129, v217
    v_accvgpr_write_b32 a130, v218
    v_accvgpr_write_b32 a131, v219
    v_accvgpr_write_b32 a132, v232
    v_accvgpr_write_b32 a133, v233
    v_accvgpr_write_b32 a134, v234
    v_accvgpr_write_b32 a135, v235
    v_accvgpr_write_b32 a136, v236
    v_accvgpr_write_b32 a137, v237
    v_accvgpr_write_b32 a138, v238
    v_accvgpr_write_b32 a139, v239
    v_accvgpr_write_b32 a140, v240
    v_accvgpr_write_b32 a141, v241
    v_accvgpr_write_b32 a142, v242
    v_accvgpr_write_b32 a143, v243
    s_sub_u32 s23, s57, 8192
    s_add_u32 s76, s68, 24576
    s_waitcnt vmcnt(0) lgkmcnt(0)
    s_branch L_q2go
.p2align 6
L_altwq:
    s_cmp_lt_u32 s76, 4
    s_cbranch_scc1 L_st_67
    s_xor_b32 s65, s57, s22
    s_bfe_u32 s59, s57, 0x3000d
    s_mul_i32 s59, s59, 8448
    s_add_u32 m0, s58, s3
    s_nop 0
    buffer_load_dwordx4 v1, s[44:47], s64 offen nt lds
    s_add_u32 m0, m0, 32
    s_nop 0
    buffer_load_dwordx4 v1, s[44:47], s64 offen offset:1024 nt lds
    s_add_u32 m0, s59, s61
    s_nop 0
    buffer_load_dwordx4 v1, s[40:43], s65 offen nt lds
    s_add_u32 m0, m0, 32
    s_nop 0
    buffer_load_dwordx4 v1, s[40:43], s65 offen offset:1024 nt lds
    s_add_u32 s57, s57, 8192
L_st_67:
    v_mfma_f32_16x16x32_bf16 v[72:75], v[120:123], v[12:15], v[60:63]
    ds_read_b64_tr_b16 v[136:137], v3 offset:33792
    v_cvt_pk_bf16_f32 v98, v84, v85
    v_mfma_f32_16x16x32_bf16 v[72:75], v[124:127], v[16:19], v[72:75]
    ds_read_b64_tr_b16 v[138:139], v3 offset:34304
    v_cvt_pk_bf16_f32 v99, v86, v87
    v_mfma_f32_16x16x32_bf16 v[72:75], v[128:131], v[20:23], v[72:75]
    v_exp_f32 v92, v92
    v_mfma_f32_16x16x32_bf16 v[72:75], v[132:135], v[24:27], v[72:75]
    v_exp_f32 v93, v93
    v_mfma_f32_16x16x32_bf16 v[76:79], v[132:135], v[40:43], v[64:67]
    ds_read_b64_tr_b16 v[140:141], v3 offset:33824
    v_cvt_pk_bf16_f32 v102, v88, v89
    v_mfma_f32_16x16x32_bf16 v[76:79], v[128:131], v[36:39], v[76:79]
    ds_read_b64_tr_b16 v[142:143], v3 offset:34336
    v_cvt_pk_bf16_f32 v103, v90, v91
    v_mfma_f32_16x16x32_bf16 v[76:79], v[124:127], v[32:35], v[76:79]
    v_exp_f32 v94, v94
    v_mfma_f32_16x16x32_bf16 v[76:79], v[120:123], v[28:31], v[76:79]
    v_exp_f32 v95, v95
    v_mfma_f32_16x16x32_bf16 v[80:83], v[120:123], v[44:47], v[68:71]
    ds_read_b64_tr_b16 v[144:145], v3 offset:33856
    v_cvt_pk_bf16_f32 v106, v92, v93
    v_mfma_f32_16x16x32_bf16 v[80:83], v[124:127], v[48:51], v[80:83]
    ds_read_b64_tr_b16 v[146:147], v3 offset:34368
    v_cvt_pk_bf16_f32 v107, v94, v95
    v_mfma_f32_16x16x32_bf16 v[80:83], v[128:131], v[52:55], v[80:83]
    ds_read_b64_tr_b16 v[148:149], v3 offset:33888
    v_mfma_f32_16x16x32_bf16 v[80:83], v[132:135], v[56:59], v[80:83]
    s_waitcnt lgkmcnt(5)
    ds_read_b64_tr_b16 v[150:151], v3 offset:34400
    v_mfma_f32_16x16x32_bf16 v[160:163], v[136:139], v[96:99], v[160:163]
    ds_read_b128 v[120:123], v2 offset:42752
    v_mfma_f32_16x16x32_bf16 v[164:167], v[136:139], v[100:103], v[164:167]
    ds_read_b128 v[124:127], v2 offset:42816
    v_mfma_f32_16x16x32_bf16 v[168:171], v[136:139], v[104:107], v[168:171]
    s_waitcnt lgkmcnt(6)
    ds_read_b128 v[128:131], v2 offset:42880
    v_mfma_f32_16x16x32_bf16 v[180:183], v[140:143], v[104:107], v[180:183]
    ds_read_b128 v[132:135], v2 offset:42944
    v_mfma_f32_16x16x32_bf16 v[176:179], v[140:143], v[100:103], v[176:179]
    v_exp_f32 v72, v72
    v_mfma_f32_16x16x32_bf16 v[172:175], v[140:143], v[96:99], v[172:175]
    s_waitcnt lgkmcnt(6)
    v_exp_f32 v73, v73
    v_mfma_f32_16x16x32_bf16 v[184:187], v[144:147], v[96:99], v[184:187]
    v_exp_f32 v74, v74
    v_mfma_f32_16x16x32_bf16 v[188:191], v[144:147], v[100:103], v[188:191]
    v_exp_f32 v75, v75
    v_mfma_f32_16x16x32_bf16 v[192:195], v[144:147], v[104:107], v[192:195]
    s_waitcnt lgkmcnt(4)
    v_exp_f32 v76, v76
    v_mfma_f32_16x16x32_bf16 v[204:207], v[148:151], v[104:107], v[204:207]
    v_exp_f32 v77, v77
    v_mfma_f32_16x16x32_bf16 v[200:203], v[148:151], v[100:103], v[200:203]
    s_waitcnt lgkmcnt(0)
    v_exp_f32 v78, v78
    v_mfma_f32_16x16x32_bf16 v[196:199], v[148:151], v[96:99], v[196:199]
    v_exp_f32 v79, v79
    v_mfma_f32_16x16x32_bf16 v[84:87], v[120:123], v[12:15], v[60:63]
    ds_read_b64_tr_b16 v[136:137], v3 offset:33920
    v_cvt_pk_bf16_f32 v108, v72, v73
    v_mfma_f32_16x16x32_bf16 v[84:87], v[124:127], v[16:19], v[84:87]
    ds_read_b64_tr_b16 v[138:139], v3 offset:34432
    v_cvt_pk_bf16_f32 v109, v74, v75
    v_mfma_f32_16x16x32_bf16 v[84:87], v[128:131], v[20:23], v[84:87]
    v_exp_f32 v80, v80
    v_mfma_f32_16x16x32_bf16 v[84:87], v[132:135], v[24:27], v[84:87]
    v_exp_f32 v81, v81
    v_mfma_f32_16x16x32_bf16 v[88:91], v[132:135], v[40:43], v[64:67]
    ds_read_b64_tr_b16 v[140:141], v3 offset:33952
    v_cvt_pk_bf16_f32 v112, v76, v77
    v_mfma_f32_16x16x32_bf16 v[88:91], v[128:131], v[36:39], v[88:91]
    ds_read_b64_tr_b16 v[142:143], v3 offset:34464
    v_cvt_pk_bf16_f32 v113, v78, v79
    v_mfma_f32_16x16x32_bf16 v[88:91], v[124:127], v[32:35], v[88:91]
    v_exp_f32 v82, v82
    v_mfma_f32_16x16x32_bf16 v[88:91], v[120:123], v[28:31], v[88:91]
    v_exp_f32 v83, v83
    v_mfma_f32_16x16x32_bf16 v[92:95], v[120:123], v[44:47], v[68:71]
    ds_read_b64_tr_b16 v[144:145], v3 offset:33984
    v_cvt_pk_bf16_f32 v116, v80, v81
    v_mfma_f32_16x16x32_bf16 v[92:95], v[124:127], v[48:51], v[92:95]
    ds_read_b64_tr_b16 v[146:147], v3 offset:34496
    v_cvt_pk_bf16_f32 v117, v82, v83
    v_mfma_f32_16x16x32_bf16 v[92:95], v[128:131], v[52:55], v[92:95]
    ds_read_b64_tr_b16 v[148:149], v3 offset:34016
    v_mfma_f32_16x16x32_bf16 v[92:95], v[132:135], v[56:59], v[92:95]
    s_waitcnt vmcnt(8)
    ds_read_b64_tr_b16 v[150:151], v3 offset:34528
    v_mfma_f32_16x16x32_bf16 a[200:203], a[204:207], v[104:107], a[200:203]
    s_barrier
    ds_read_b128 v[120:123], v2 offset:50688
    v_mfma_f32_16x16x32_bf16 a[196:199], a[204:207], v[100:103], a[196:199]
    s_waitcnt lgkmcnt(5)
    ds_read_b128 v[124:127], v2 offset:50752
    v_mfma_f32_16x16x32_bf16 a[192:195], a[204:207], v[96:99], a[192:195]
    ds_read_b128 v[128:131], v2 offset:50816
    v_mfma_f32_16x16x32_bf16 v[208:211], v[136:139], v[96:99], v[208:211]
    s_add_u32 s65, s75, 0
    ds_read_b128 v[132:135], v2 offset:50880
    v_exp_f32 v84, v84
    v_mfma_f32_16x16x32_bf16 v[212:215], v[136:139], v[100:103], v[212:215]
    s_add_u32 m0, s63, 0
    v_exp_f32 v85, v85
    v_mfma_f32_16x16x32_bf16 v[216:219], v[136:139], v[104:107], v[216:219]
    buffer_load_dwordx4 v156, s[32:35], s65 offen lds
    v_mfma_f32_16x16x32_bf16 v[228:231], v[140:143], v[104:107], v[228:231]
    s_waitcnt lgkmcnt(4)
    v_exp_f32 v86, v86
    v_mfma_f32_16x16x32_bf16 v[224:227], v[140:143], v[100:103], v[224:227]
    s_add_u32 m0, s63, 1024
    v_exp_f32 v87, v87
    v_mfma_f32_16x16x32_bf16 v[220:223], v[140:143], v[96:99], v[220:223]
    buffer_load_dwordx4 v157, s[32:35], s65 offen lds
    v_mfma_f32_16x16x32_bf16 v[232:235], v[144:147], v[96:99], v[232:235]
    s_xor_b32 s64, s26, 256
    v_exp_f32 v88, v88
    v_mfma_f32_16x16x32_bf16 v[236:239], v[144:147], v[100:103], v[236:239]
    s_add_u32 m0, s61, 33792
    v_exp_f32 v89, v89
    v_mfma_f32_16x16x32_bf16 v[240:243], v[144:147], v[104:107], v[240:243]
    buffer_load_dwordx4 v6, s[36:39], s64 offen lds
    v_mfma_f32_16x16x32_bf16 v[252:255], v[148:151], v[104:107], v[252:255]
    s_xor_b32 s64, s26, 8448
    s_waitcnt lgkmcnt(0)
    v_exp_f32 v90, v90
    v_mfma_f32_16x16x32_bf16 v[248:251], v[148:151], v[100:103], v[248:251]
    s_add_u32 m0, s61, 34824
    v_exp_f32 v91, v91
    v_mfma_f32_16x16x32_bf16 v[244:247], v[148:151], v[96:99], v[244:247]
    buffer_load_dwordx4 v6, s[36:39], s64 offen lds
    v_mfma_f32_16x16x32_bf16 v[72:75], v[120:123], v[12:15], v[60:63]
    ds_read_b64_tr_b16 v[136:137], v3 offset:42240
    v_cvt_pk_bf16_f32 v110, v84, v85
    v_mfma_f32_16x16x32_bf16 v[72:75], v[124:127], v[16:19], v[72:75]
    ds_read_b64_tr_b16 v[138:139], v3 offset:42752
    v_cvt_pk_bf16_f32 v111, v86, v87
    v_mfma_f32_16x16x32_bf16 v[72:75], v[128:131], v[20:23], v[72:75]
    v_exp_f32 v92, v92
    v_mfma_f32_16x16x32_bf16 v[72:75], v[132:135], v[24:27], v[72:75]
    v_exp_f32 v93, v93
    v_mfma_f32_16x16x32_bf16 v[76:79], v[132:135], v[40:43], v[64:67]
    ds_read_b64_tr_b16 v[140:141], v3 offset:42272
    v_cvt_pk_bf16_f32 v114, v88, v89
    v_mfma_f32_16x16x32_bf16 v[76:79], v[128:131], v[36:39], v[76:79]
    ds_read_b64_tr_b16 v[142:143], v3 offset:42784
    v_cvt_pk_bf16_f32 v115, v90, v91
    v_mfma_f32_16x16x32_bf16 v[76:79], v[124:127], v[32:35], v[76:79]
    v_exp_f32 v94, v94
    v_mfma_f32_16x16x32_bf16 v[76:79], v[120:123], v[28:31], v[76:79]
    v_exp_f32 v95, v95
    v_mfma_f32_16x16x32_bf16 v[80:83], v[120:123], v[44:47], v[68:71]
    ds_read_b64_tr_b16 v[144:145], v3 offset:42304
    v_cvt_pk_bf16_f32 v118, v92, v93
    v_mfma_f32_16x16x32_bf16 v[80:83], v[124:127], v[48:51], v[80:83]
    ds_read_b64_tr_b16 v[146:147], v3 offset:42816
    v_cvt_pk_bf16_f32 v119, v94, v95
    v_mfma_f32_16x16x32_bf16 v[80:83], v[128:131], v[52:55], v[80:83]
    ds_read_b64_tr_b16 v[148:149], v3 offset:42336
    v_mfma_f32_16x16x32_bf16 v[80:83], v[132:135], v[56:59], v[80:83]
    s_waitcnt lgkmcnt(5)
    ds_read_b64_tr_b16 v[150:151], v3 offset:42848
    v_mfma_f32_16x16x32_bf16 v[160:163], v[136:139], v[108:111], v[160:163]
    s_add_u32 s65, s75, 20480
    ds_read_b128 v[120:123], v2 offset:51200
    v_mfma_f32_16x16x32_bf16 v[164:167], v[136:139], v[112:115], v[164:167]
    s_add_u32 m0, s63, 2048
    ds_read_b128 v[124:127], v2 offset:51264
    v_mfma_f32_16x16x32_bf16 v[168:171], v[136:139], v[116:119], v[168:171]
    s_waitcnt lgkmcnt(6)
    ds_read_b128 v[128:131], v2 offset:51328
    buffer_load_dwordx4 v156, s[32:35], s65 offen lds
    v_mfma_f32_16x16x32_bf16 v[180:183], v[140:143], v[116:119], v[180:183]
    s_add_u32 m0, s63, 3072
    ds_read_b128 v[132:135], v2 offset:51392
    v_mfma_f32_16x16x32_bf16 v[176:179], v[140:143], v[112:115], v[176:179]
    v_exp_f32 v72, v72
    buffer_load_dwordx4 v157, s[32:35], s65 offen lds
    v_mfma_f32_16x16x32_bf16 v[172:175], v[140:143], v[108:111], v[172:175]
    s_waitcnt lgkmcnt(6)
    s_add_u32 s65, s75, 40960
    v_exp_f32 v73, v73
    v_mfma_f32_16x16x32_bf16 v[184:187], v[144:147], v[108:111], v[184:187]
    s_add_u32 m0, s63, 4096
    v_exp_f32 v74, v74
    v_mfma_f32_16x16x32_bf16 v[188:191], v[144:147], v[112:115], v[188:191]
    v_exp_f32 v75, v75
    buffer_load_dwordx4 v156, s[32:35], s65 offen lds
    v_mfma_f32_16x16x32_bf16 v[192:195], v[144:147], v[116:119], v[192:195]
    s_waitcnt lgkmcnt(4)
    s_add_u32 m0, s63, 5120
    v_exp_f32 v76, v76
    v_mfma_f32_16x16x32_bf16 v[204:207], v[148:151], v[116:119], v[204:207]
    v_exp_f32 v77, v77
    buffer_load_dwordx4 v157, s[32:35], s65 offen lds
    v_mfma_f32_16x16x32_bf16 v[200:203], v[148:151], v[112:115], v[200:203]
    s_waitcnt lgkmcnt(0)
    v_exp_f32 v78, v78
    v_mfma_f32_16x16x32_bf16 v[196:199], v[148:151], v[108:111], v[196:199]
    v_exp_f32 v79, v79
    v_mfma_f32_16x16x32_bf16 v[84:87], v[120:123], v[12:15], v[60:63]
    ds_read_b64_tr_b16 v[136:137], v3 offset:42368
    v_cvt_pk_bf16_f32 v96, v72, v73
    v_mfma_f32_16x16x32_bf16 v[84:87], v[124:127], v[16:19], v[84:87]
    ds_read_b64_tr_b16 v[138:139], v3 offset:42880
    v_cvt_pk_bf16_f32 v97, v74, v75
    v_mfma_f32_16x16x32_bf16 v[84:87], v[128:131], v[20:23], v[84:87]
    v_exp_f32 v80, v80
    v_mfma_f32_16x16x32_bf16 v[84:87], v[132:135], v[24:27], v[84:87]
    v_exp_f32 v81, v81
    v_mfma_f32_16x16x32_bf16 v[88:91], v[132:135], v[40:43], v[64:67]
    ds_read_b64_tr_b16 v[140:141], v3 offset:42400
    v_cvt_pk_bf16_f32 v100, v76, v77
    v_mfma_f32_16x16x32_bf16 v[88:91], v[128:131], v[36:39], v[88:91]
    ds_read_b64_tr_b16 v[142:143], v3 offset:42912
    v_cvt_pk_bf16_f32 v101, v78, v79
    v_mfma_f32_16x16x32_bf16 v[88:91], v[124:127], v[32:35], v[88:91]
    v_exp_f32 v82, v82
    v_mfma_f32_16x16x32_bf16 v[88:91], v[120:123], v[28:31], v[88:91]
    v_exp_f32 v83, v83
    v_mfma_f32_16x16x32_bf16 v[92:95], v[120:123], v[44:47], v[68:71]
    ds_read_b64_tr_b16 v[144:145], v3 offset:42432
    v_cvt_pk_bf16_f32 v104, v80, v81
    v_mfma_f32_16x16x32_bf16 v[92:95], v[124:127], v[48:51], v[92:95]
    ds_read_b64_tr_b16 v[146:147], v3 offset:42944
    v_cvt_pk_bf16_f32 v105, v82, v83
    v_mfma_f32_16x16x32_bf16 v[92:95], v[128:131], v[52:55], v[92:95]
    ds_read_b64_tr_b16 v[148:149], v3 offset:42464
    v_mfma_f32_16x16x32_bf16 v[92:95], v[132:135], v[56:59], v[92:95]
    s_waitcnt vmcnt(8)
    ds_read_b64_tr_b16 v[150:151], v3 offset:42976
    v_mfma_f32_16x16x32_bf16 a[200:203], a[204:207], v[116:119], a[200:203]
    s_barrier
    ds_read_b128 v[120:123], v2 offset:59136
    v_mfma_f32_16x16x32_bf16 a[196:199], a[204:207], v[112:115], a[196:199]
    s_waitcnt lgkmcnt(5)
    ds_read_b128 v[124:127], v2 offset:59200
    v_mfma_f32_16x16x32_bf16 a[192:195], a[204:207], v[108:111], a[192:195]
    ds_read_b128 v[128:131], v2 offset:59264
    v_mfma_f32_16x16x32_bf16 v[208:211], v[136:139], v[108:111], v[208:211]
    s_xor_b32 s64, s26, 262400
    ds_read_b128 v[132:135], v2 offset:59328
    v_exp_f32 v84, v84
    v_mfma_f32_16x16x32_bf16 v[212:215], v[136:139], v[112:115], v[212:215]
    s_add_u32 m0, s61, 101376
    v_exp_f32 v85, v85
    v_mfma_f32_16x16x32_bf16 v[216:219], v[136:139], v[116:119], v[216:219]
    buffer_load_dwordx4 v6, s[36:39], s64 offen lds
    v_mfma_f32_16x16x32_bf16 v[228:231], v[140:143], v[116:119], v[228:231]
    s_waitcnt lgkmcnt(4)
    s_xor_b32 s64, s26, 270592
    v_exp_f32 v86, v86
    v_mfma_f32_16x16x32_bf16 v[224:227], v[140:143], v[112:115], v[224:227]
    s_add_u32 m0, s61, 102408
    v_exp_f32 v87, v87
    v_mfma_f32_16x16x32_bf16 v[220:223], v[140:143], v[108:111], v[220:223]
    buffer_load_dwordx4 v6, s[36:39], s64 offen lds
    v_mfma_f32_16x16x32_bf16 v[232:235], v[144:147], v[108:111], v[232:235]
    s_xor_b32 s64, s26, 0
    v_exp_f32 v88, v88
    v_mfma_f32_16x16x32_bf16 v[236:239], v[144:147], v[112:115], v[236:239]
    s_add_u32 m0, s61, 42240
    v_exp_f32 v89, v89
    v_mfma_f32_16x16x32_bf16 v[240:243], v[144:147], v[116:119], v[240:243]
    buffer_load_dwordx4 v6, s[36:39], s64 offen lds
    v_mfma_f32_16x16x32_bf16 v[252:255], v[148:151], v[116:119], v[252:255]
    s_xor_b32 s64, s26, 8192
    s_waitcnt lgkmcnt(0)
    v_exp_f32 v90, v90
    v_mfma_f32_16x16x32_bf16 v[248:251], v[148:151], v[112:115], v[248:251]
    s_add_u32 m0, s61, 43272
    v_exp_f32 v91, v91
    v_mfma_f32_16x16x32_bf16 v[244:247], v[148:151], v[108:111], v[244:247]
    buffer_load_dwordx4 v6, s[36:39], s64 offen lds
    v_mfma_f32_16x16x32_bf16 v[72:75], v[120:123], v[12:15], v[60:63]
    ds_read_b64_tr_b16 v[136:137], v3 offset:50688
    v_cvt_pk_bf16_f32 v98, v84, v85
    v_mfma_f32_16x16x32_bf16 v[72:75], v[124:127], v[16:19], v[72:75]
    ds_read_b64_tr_b16 v[138:139], v3 offset:51200
    v_cvt_pk_bf16_f32 v99, v86, v87
    v_mfma_f32_16x16x32_bf16 v[72:75], v[128:131], v[20:23], v[72:75]
    v_exp_f32 v92, v92
    v_mfma_f32_16x16x32_bf16 v[72:75], v[132:135], v[24:27], v[72:75]
    v_exp_f32 v93, v93
    v_mfma_f32_16x16x32_bf16 v[76:79], v[132:135], v[40:43], v[64:67]
    ds_read_b64_tr_b16 v[140:141], v3 offset:50720
    v_cvt_pk_bf16_f32 v102, v88, v89
    v_mfma_f32_16x16x32_bf16 v[76:79], v[128:131], v[36:39], v[76:79]
    ds_read_b64_tr_b16 v[142:143], v3 offset:51232
    v_cvt_pk_bf16_f32 v103, v90, v91
    v_mfma_f32_16x16x32_bf16 v[76:79], v[124:127], v[32:35], v[76:79]
    v_exp_f32 v94, v94
    v_mfma_f32_16x16x32_bf16 v[76:79], v[120:123], v[28:31], v[76:79]
    v_exp_f32 v95, v95
    v_mfma_f32_16x16x32_bf16 v[80:83], v[120:123], v[44:47], v[68:71]
    ds_read_b64_tr_b16 v[144:145], v3 offset:50752
    v_cvt_pk_bf16_f32 v106, v92, v93
    v_mfma_f32_16x16x32_bf16 v[80:83], v[124:127], v[48:51], v[80:83]
    ds_read_b64_tr_b16 v[146:147], v3 offset:51264
    v_cvt_pk_bf16_f32 v107, v94, v95
    v_mfma_f32_16x16x32_bf16 v[80:83], v[128:131], v[52:55], v[80:83]
    ds_read_b64_tr_b16 v[148:149], v3 offset:50784
    v_mfma_f32_16x16x32_bf16 v[80:83], v[132:135], v[56:59], v[80:83]
    s_waitcnt lgkmcnt(5)
    ds_read_b64_tr_b16 v[150:151], v3 offset:51296
    v_mfma_f32_16x16x32_bf16 v[160:163], v[136:139], v[96:99], v[160:163]
    ds_read_b128 v[120:123], v2 offset:59648
    v_mfma_f32_16x16x32_bf16 v[164:167], v[136:139], v[100:103], v[164:167]
    ds_read_b128 v[124:127], v2 offset:59712
    v_mfma_f32_16x16x32_bf16 v[168:171], v[136:139], v[104:107], v[168:171]
    s_waitcnt lgkmcnt(6)
    ds_read_b128 v[128:131], v2 offset:59776
    v_mfma_f32_16x16x32_bf16 v[180:183], v[140:143], v[104:107], v[180:183]
    ds_read_b128 v[132:135], v2 offset:59840
    v_mfma_f32_16x16x32_bf16 v[176:179], v[140:143], v[100:103], v[176:179]
    v_exp_f32 v72, v72
    v_mfma_f32_16x16x32_bf16 v[172:175], v[140:143], v[96:99], v[172:175]
    s_waitcnt lgkmcnt(6)
    v_exp_f32 v73, v73
    v_mfma_f32_16x16x32_bf16 v[184:187], v[144:147], v[96:99], v[184:187]
    v_exp_f32 v74, v74
    v_mfma_f32_16x16x32_bf16 v[188:191], v[144:147], v[100:103], v[188:191]
    v_exp_f32 v75, v75
    v_mfma_f32_16x16x32_bf16 v[192:195], v[144:147], v[104:107], v[192:195]
    s_waitcnt lgkmcnt(4)
    v_exp_f32 v76, v76
    v_mfma_f32_16x16x32_bf16 v[204:207], v[148:151], v[104:107], v[204:207]
    v_exp_f32 v77, v77
    v_mfma_f32_16x16x32_bf16 v[200:203], v[148:151], v[100:103], v[200:203]
    s_waitcnt lgkmcnt(0)
    v_exp_f32 v78, v78
    v_mfma_f32_16x16x32_bf16 v[196:199], v[148:151], v[96:99], v[196:199]
    v_exp_f32 v79, v79
    v_mfma_f32_16x16x32_bf16 v[84:87], v[120:123], v[12:15], v[60:63]
    ds_read_b64_tr_b16 v[136:137], v3 offset:50816
    v_cvt_pk_bf16_f32 v108, v72, v73
    v_mfma_f32_16x16x32_bf16 v[84:87], v[124:127], v[16:19], v[84:87]
    ds_read_b64_tr_b16 v[138:139], v3 offset:51328
    v_cvt_pk_bf16_f32 v109, v74, v75
    v_mfma_f32_16x16x32_bf16 v[84:87], v[128:131], v[20:23], v[84:87]
    v_exp_f32 v80, v80
    v_mfma_f32_16x16x32_bf16 v[84:87], v[132:135], v[24:27], v[84:87]
    v_exp_f32 v81, v81
    v_mfma_f32_16x16x32_bf16 v[88:91], v[132:135], v[40:43], v[64:67]
    ds_read_b64_tr_b16 v[140:141], v3 offset:50848
    v_cvt_pk_bf16_f32 v112, v76, v77
    v_mfma_f32_16x16x32_bf16 v[88:91], v[128:131], v[36:39], v[88:91]
    ds_read_b64_tr_b16 v[142:143], v3 offset:51360
    v_cvt_pk_bf16_f32 v113, v78, v79
    v_mfma_f32_16x16x32_bf16 v[88:91], v[124:127], v[32:35], v[88:91]
    v_exp_f32 v82, v82
    v_mfma_f32_16x16x32_bf16 v[88:91], v[120:123], v[28:31], v[88:91]
    v_exp_f32 v83, v83
    v_mfma_f32_16x16x32_bf16 v[92:95], v[120:123], v[44:47], v[68:71]
    ds_read_b64_tr_b16 v[144:145], v3 offset:50880
    v_cvt_pk_bf16_f32 v116, v80, v81
    v_mfma_f32_16x16x32_bf16 v[92:95], v[124:127], v[48:51], v[92:95]
    ds_read_b64_tr_b16 v[146:147], v3 offset:51392
    v_cvt_pk_bf16_f32 v117, v82, v83
    v_mfma_f32_16x16x32_bf16 v[92:95], v[128:131], v[52:55], v[92:95]
    ds_read_b64_tr_b16 v[148:149], v3 offset:50912
    v_mfma_f32_16x16x32_bf16 v[92:95], v[132:135], v[56:59], v[92:95]
    s_waitcnt vmcnt(4)
    ds_read_b64_tr_b16 v[150:151], v3 offset:51424
    v_mfma_f32_16x16x32_bf16 a[200:203], a[204:207], v[104:107], a[200:203]
    s_barrier
    ds_read_b64_tr_b16 v[120:121], v3 offset:59136
    ds_read_b128 a[0:3], v158 offset:0
    v_mfma_f32_16x16x32_bf16 a[196:199], a[204:207], v[100:103], a[196:199]
    s_waitcnt lgkmcnt(6)
    ds_read_b64_tr_b16 v[122:123], v3 offset:59648
    ds_read_b128 a[4:7], v159 offset:0
    v_mfma_f32_16x16x32_bf16 a[192:195], a[204:207], v[96:99], a[192:195]
    ds_read_b64_tr_b16 v[124:125], v3 offset:59168
    ds_read_b128 a[8:11], v158 offset:2048
    v_mfma_f32_16x16x32_bf16 v[208:211], v[136:139], v[96:99], v[208:211]
    s_xor_b32 s64, s26, 262144
    ds_read_b64_tr_b16 v[126:127], v3 offset:59680
    v_exp_f32 v84, v84
    v_mfma_f32_16x16x32_bf16 v[212:215], v[136:139], v[100:103], v[212:215]
    s_add_u32 m0, s61, 109824
    ds_read_b64_tr_b16 v[128:129], v3 offset:59200
    v_exp_f32 v85, v85
    v_mfma_f32_16x16x32_bf16 v[216:219], v[136:139], v[104:107], v[216:219]
    ds_read_b128 a[12:15], v159 offset:2048
    buffer_load_dwordx4 v6, s[36:39], s64 offen lds
    v_mfma_f32_16x16x32_bf16 v[228:231], v[140:143], v[104:107], v[228:231]
    s_waitcnt lgkmcnt(9)
    s_xor_b32 s64, s26, 270336
    ds_read_b64_tr_b16 v[130:131], v3 offset:59712
    v_exp_f32 v86, v86
    v_mfma_f32_16x16x32_bf16 v[224:227], v[140:143], v[100:103], v[224:227]
    s_add_u32 m0, s61, 110856
    ds_read_b64_tr_b16 v[132:133], v3 offset:59232
    v_exp_f32 v87, v87
    v_mfma_f32_16x16x32_bf16 v[220:223], v[140:143], v[96:99], v[220:223]
    ds_read_b128 a[16:19], v158 offset:4096
    buffer_load_dwordx4 v6, s[36:39], s64 offen lds
    v_mfma_f32_16x16x32_bf16 v[232:235], v[144:147], v[96:99], v[232:235]
    s_xor_b32 s64, s26, 524544
    ds_read_b64_tr_b16 v[134:135], v3 offset:59744
    v_exp_f32 v88, v88
    v_mfma_f32_16x16x32_bf16 v[236:239], v[144:147], v[100:103], v[236:239]
    s_add_u32 m0, s61, 50688
    ds_read_b128 a[20:23], v159 offset:4096
    v_cvt_pk_bf16_f32 v110, v84, v85
    v_exp_f32 v89, v89
    v_mfma_f32_16x16x32_bf16 v[240:243], v[144:147], v[104:107], v[240:243]
    buffer_load_dwordx4 v6, s[36:39], s64 offen lds
    v_mfma_f32_16x16x32_bf16 v[252:255], v[148:151], v[104:107], v[252:255]
    s_xor_b32 s64, s26, 532736
    v_cvt_pk_bf16_f32 v111, v86, v87
    v_exp_f32 v90, v90
    v_mfma_f32_16x16x32_bf16 v[248:251], v[148:151], v[100:103], v[248:251]
    s_add_u32 m0, s61, 51720
    v_exp_f32 v91, v91
    v_mfma_f32_16x16x32_bf16 v[244:247], v[148:151], v[96:99], v[244:247]
    s_waitcnt lgkmcnt(0)
    buffer_load_dwordx4 v6, s[36:39], s64 offen lds
    v_mfma_f32_16x16x32_bf16 a[192:195], a[204:207], v[108:111], a[192:195]
    ds_read_b64_tr_b16 v[136:137], v3 offset:59264
    v_cvt_pk_bf16_f32 v114, v88, v89
    v_mfma_f32_16x16x32_bf16 v[160:163], v[120:123], v[108:111], v[160:163]
    ds_read_b64_tr_b16 v[138:139], v3 offset:59776
    v_cvt_pk_bf16_f32 v115, v90, v91
    v_mfma_f32_16x16x32_bf16 v[172:175], v[124:127], v[108:111], v[172:175]
    v_exp_f32 v92, v92
    v_mfma_f32_16x16x32_bf16 v[184:187], v[128:131], v[108:111], v[184:187]
    v_exp_f32 v93, v93
    v_mfma_f32_16x16x32_bf16 v[196:199], v[132:135], v[108:111], v[196:199]
    v_exp_f32 v94, v94
    v_mfma_f32_16x16x32_bf16 a[196:199], a[204:207], v[112:115], a[196:199]
    v_exp_f32 v95, v95
    v_mfma_f32_16x16x32_bf16 v[164:167], v[120:123], v[112:115], v[164:167]
    ds_read_b64_tr_b16 v[140:141], v3 offset:59296
    v_cvt_pk_bf16_f32 v118, v92, v93
    v_mfma_f32_16x16x32_bf16 v[176:179], v[124:127], v[112:115], v[176:179]
    ds_read_b64_tr_b16 v[142:143], v3 offset:59808
    v_cvt_pk_bf16_f32 v119, v94, v95
    v_mfma_f32_16x16x32_bf16 v[188:191], v[128:131], v[112:115], v[188:191]
    ds_read_b64_tr_b16 v[144:145], v3 offset:59328
    v_accvgpr_read_b32 v7, a192
    v_mfma_f32_16x16x32_bf16 v[200:203], v[132:135], v[112:115], v[200:203]
    ds_read_b64_tr_b16 v[146:147], v3 offset:59840
    v_accvgpr_read_b32 v8, a196
    v_mfma_f32_16x16x32_bf16 a[200:203], a[204:207], v[116:119], a[200:203]
    s_add_u32 s65, s77, 0
    ds_read_b64_tr_b16 v[148:149], v3 offset:59360
    v_add_f32 v10, v7, v8
    v_mfma_f32_16x16x32_bf16 v[168:171], v[120:123], v[116:119], v[168:171]
    s_add_u32 m0, s63, 0
    ds_read_b64_tr_b16 v[150:151], v3 offset:59872
    v_mov_b32 v11, 0x5d800000
    v_mfma_f32_16x16x32_bf16 v[180:183], v[124:127], v[116:119], v[180:183]
    v_rcp_f32 v7, v7
    buffer_load_dwordx4 v156, s[32:35], s65 offen lds
    v_mfma_f32_16x16x32_bf16 v[192:195], v[128:131], v[116:119], v[192:195]
    s_add_u32 m0, s63, 1024
    v_rcp_f32 v8, v8
    v_mfma_f32_16x16x32_bf16 v[204:207], v[132:135], v[116:119], v[204:207]
    s_waitcnt lgkmcnt(6)
    v_accvgpr_read_b32 v9, a200
    v_add_f32 v10, v10, v9
    buffer_load_dwordx4 v157, s[32:35], s65 offen lds
    v_mfma_f32_16x16x32_bf16 v[208:211], v[136:139], v[108:111], v[208:211]
    s_add_u32 s65, s77, 20480
    v_cmp_nle_f32 vcc, v10, v11
    v_mfma_f32_16x16x32_bf16 v[212:215], v[136:139], v[112:115], v[212:215]
    s_add_u32 m0, s63, 2048
    v_rcp_f32 v9, v9
    v_mfma_f32_16x16x32_bf16 v[216:219], v[136:139], v[116:119], v[216:219]
    s_waitcnt lgkmcnt(4)
    v_mul_f32 v160, v160, v7
    v_mul_f32 v161, v161, v7
    buffer_load_dwordx4 v156, s[32:35], s65 offen lds
    v_mfma_f32_16x16x32_bf16 v[228:231], v[140:143], v[116:119], v[228:231]
    s_add_u32 m0, s63, 3072
    v_mul_f32 v162, v162, v7
    v_mul_f32 v163, v163, v7
    v_mfma_f32_16x16x32_bf16 v[224:227], v[140:143], v[112:115], v[224:227]
    v_mul_f32 v164, v164, v8
    v_mul_f32 v165, v165, v8
    buffer_load_dwordx4 v157, s[32:35], s65 offen lds
    v_mfma_f32_16x16x32_bf16 v[220:223], v[140:143], v[108:111], v[220:223]
    s_waitcnt lgkmcnt(2)
    s_add_u32 s65, s77, 40960
    v_mul_f32 v166, v166, v8
    v_mul_f32 v167, v167, v8
    v_mfma_f32_16x16x32_bf16 v[232:235], v[144:147], v[108:111], v[232:235]
    s_add_u32 m0, s63, 4096
    v_mul_f32 v168, v168, v9
    v_mul_f32 v169, v169, v9
    v_mfma_f32_16x16x32_bf16 v[236:239], v[144:147], v[112:115], v[236:239]
    v_mul_f32 v170, v170, v9
    v_mul_f32 v171, v171, v9
    buffer_load_dwordx4 v156, s[32:35], s65 offen lds
    v_mfma_f32_16x16x32_bf16 v[240:243], v[144:147], v[116:119], v[240:243]
    s_waitcnt lgkmcnt(0)
    s_add_u32 m0, s63, 5120
    v_mul_f32 v172, v172, v7
    v_mul_f32 v173, v173, v7
    v_mfma_f32_16x16x32_bf16 v[252:255], v[148:151], v[116:119], v[252:255]
    v_mul_f32 v174, v174, v7
    v_mul_f32 v175, v175, v7
    buffer_load_dwordx4 v157, s[32:35], s65 offen lds
    v_mfma_f32_16x16x32_bf16 v[248:251], v[148:151], v[112:115], v[248:251]
    v_mul_f32 v176, v176, v8
    v_mul_f32 v177, v177, v8
    v_mfma_f32_16x16x32_bf16 v[244:247], v[148:151], v[108:111], v[244:247]
    v_mul_f32 v178, v178, v8
    v_mul_f32 v179, v179, v8
    s_cbranch_vccnz L_slow
    s_branch L_epi
.p2align 6
L_altwo:
    s_cmp_lt_u32 s76, 4
    s_cbranch_scc1 L_st_68
    s_xor_b32 s65, s57, s22
    s_bfe_u32 s59, s57, 0x3000d
    s_mul_i32 s59, s59, 8448
    s_add_u32 m0, s58, s3
    s_nop 0
    buffer_load_dwordx4 v1, s[44:47], s64 offen nt lds
    s_add_u32 m0, m0, 32
    s_nop 0
    buffer_load_dwordx4 v1, s[44:47], s64 offen offset:1024 nt lds
    s_add_u32 m0, s59, s61
    s_nop 0
    buffer_load_dwordx4 v1, s[40:43], s65 offen nt lds
    s_add_u32 m0, m0, 32
    s_nop 0
    buffer_load_dwordx4 v1, s[40:43], s65 offen offset:1024 nt lds
    s_add_u32 s57, s57, 8192
L_st_68:
    v_mfma_f32_16x16x32_bf16 v[72:75], v[120:123], v[12:15], v[60:63]
    ds_read_b64_tr_b16 v[136:137], v3 offset:33792
    v_cvt_pk_bf16_f32 v98, v84, v85
    v_mfma_f32_16x16x32_bf16 v[72:75], v[124:127], v[16:19], v[72:75]
    ds_read_b64_tr_b16 v[138:139], v3 offset:34304
    v_cvt_pk_bf16_f32 v99, v86, v87
    v_mfma_f32_16x16x32_bf16 v[72:75], v[128:131], v[20:23], v[72:75]
    v_exp_f32 v92, v92
    v_mfma_f32_16x16x32_bf16 v[72:75], v[132:135], v[24:27], v[72:75]
    v_exp_f32 v93, v93
    v_mfma_f32_16x16x32_bf16 v[76:79], v[132:135], v[40:43], v[64:67]
    ds_read_b64_tr_b16 v[140:141], v3 offset:33824
    v_cvt_pk_bf16_f32 v102, v88, v89
    v_mfma_f32_16x16x32_bf16 v[76:79], v[128:131], v[36:39], v[76:79]
    ds_read_b64_tr_b16 v[142:143], v3 offset:34336
    v_cvt_pk_bf16_f32 v103, v90, v91
    v_mfma_f32_16x16x32_bf16 v[76:79], v[124:127], v[32:35], v[76:79]
    v_exp_f32 v94, v94
    v_mfma_f32_16x16x32_bf16 v[76:79], v[120:123], v[28:31], v[76:79]
    v_exp_f32 v95, v95
    v_mfma_f32_16x16x32_bf16 v[80:83], v[120:123], v[44:47], v[68:71]
    ds_read_b64_tr_b16 v[144:145], v3 offset:33856
    v_cvt_pk_bf16_f32 v106, v92, v93
    v_mfma_f32_16x16x32_bf16 v[80:83], v[124:127], v[48:51], v[80:83]
    ds_read_b64_tr_b16 v[146:147], v3 offset:34368
    v_cvt_pk_bf16_f32 v107, v94, v95
    v_mfma_f32_16x16x32_bf16 v[80:83], v[128:131], v[52:55], v[80:83]
    ds_read_b64_tr_b16 v[148:149], v3 offset:33888
    v_mfma_f32_16x16x32_bf16 v[80:83], v[132:135], v[56:59], v[80:83]
    s_waitcnt lgkmcnt(5)
    ds_read_b64_tr_b16 v[150:151], v3 offset:34400
    v_mfma_f32_16x16x32_bf16 v[160:163], v[136:139], v[96:99], v[160:163]
    ds_read_b128 v[120:123], v2 offset:42752
    v_mfma_f32_16x16x32_bf16 v[164:167], v[136:139], v[100:103], v[164:167]
    ds_read_b128 v[124:127], v2 offset:42816
    v_mfma_f32_16x16x32_bf16 v[168:171], v[136:139], v[104:107], v[168:171]
    s_waitcnt lgkmcnt(6)
    ds_read_b128 v[128:131], v2 offset:42880
    v_mfma_f32_16x16x32_bf16 v[180:183], v[140:143], v[104:107], v[180:183]
    ds_read_b128 v[132:135], v2 offset:42944
    v_mfma_f32_16x16x32_bf16 v[176:179], v[140:143], v[100:103], v[176:179]
    v_exp_f32 v72, v72
    v_mfma_f32_16x16x32_bf16 v[172:175], v[140:143], v[96:99], v[172:175]
    s_waitcnt lgkmcnt(6)
    v_exp_f32 v73, v73
    v_mfma_f32_16x16x32_bf16 v[184:187], v[144:147], v[96:99], v[184:187]
    v_exp_f32 v74, v74
    v_mfma_f32_16x16x32_bf16 v[188:191], v[144:147], v[100:103], v[188:191]
    v_exp_f32 v75, v75
    v_mfma_f32_16x16x32_bf16 v[192:195], v[144:147], v[104:107], v[192:195]
    s_waitcnt lgkmcnt(4)
    v_exp_f32 v76, v76
    v_mfma_f32_16x16x32_bf16 v[204:207], v[148:151], v[104:107], v[204:207]
    v_exp_f32 v77, v77
    v_mfma_f32_16x16x32_bf16 v[200:203], v[148:151], v[100:103], v[200:203]
    s_waitcnt lgkmcnt(0)
    v_exp_f32 v78, v78
    v_mfma_f32_16x16x32_bf16 v[196:199], v[148:151], v[96:99], v[196:199]
    v_exp_f32 v79, v79
    v_mfma_f32_16x16x32_bf16 v[84:87], v[120:123], v[12:15], v[60:63]
    ds_read_b64_tr_b16 v[136:137], v3 offset:33920
    v_cvt_pk_bf16_f32 v108, v72, v73
    v_mfma_f32_16x16x32_bf16 v[84:87], v[124:127], v[16:19], v[84:87]
    ds_read_b64_tr_b16 v[138:139], v3 offset:34432
    v_cvt_pk_bf16_f32 v109, v74, v75
    v_mfma_f32_16x16x32_bf16 v[84:87], v[128:131], v[20:23], v[84:87]
    v_exp_f32 v80, v80
    v_mfma_f32_16x16x32_bf16 v[84:87], v[132:135], v[24:27], v[84:87]
    v_exp_f32 v81, v81
    v_mfma_f32_16x16x32_bf16 v[88:91], v[132:135], v[40:43], v[64:67]
    ds_read_b64_tr_b16 v[140:141], v3 offset:33952
    v_cvt_pk_bf16_f32 v112, v76, v77
    v_mfma_f32_16x16x32_bf16 v[88:91], v[128:131], v[36:39], v[88:91]
    ds_read_b64_tr_b16 v[142:143], v3 offset:34464
    v_cvt_pk_bf16_f32 v113, v78, v79
    v_mfma_f32_16x16x32_bf16 v[88:91], v[124:127], v[32:35], v[88:91]
    v_exp_f32 v82, v82
    v_mfma_f32_16x16x32_bf16 v[88:91], v[120:123], v[28:31], v[88:91]
    v_exp_f32 v83, v83
    v_mfma_f32_16x16x32_bf16 v[92:95], v[120:123], v[44:47], v[68:71]
    ds_read_b64_tr_b16 v[144:145], v3 offset:33984
    v_cvt_pk_bf16_f32 v116, v80, v81
    v_mfma_f32_16x16x32_bf16 v[92:95], v[124:127], v[48:51], v[92:95]
    ds_read_b64_tr_b16 v[146:147], v3 offset:34496
    v_cvt_pk_bf16_f32 v117, v82, v83
    v_mfma_f32_16x16x32_bf16 v[92:95], v[128:131], v[52:55], v[92:95]
    ds_read_b64_tr_b16 v[148:149], v3 offset:34016
    v_mfma_f32_16x16x32_bf16 v[92:95], v[132:135], v[56:59], v[92:95]
    s_waitcnt vmcnt(8)
    ds_read_b64_tr_b16 v[150:151], v3 offset:34528
    v_mfma_f32_16x16x32_bf16 a[200:203], a[204:207], v[104:107], a[200:203]
    s_barrier
    ds_read_b128 v[120:123], v2 offset:50688
    v_mfma_f32_16x16x32_bf16 a[196:199], a[204:207], v[100:103], a[196:199]
    s_waitcnt lgkmcnt(5)
    ds_read_b128 v[124:127], v2 offset:50752
    v_mfma_f32_16x16x32_bf16 a[192:195], a[204:207], v[96:99], a[192:195]
    ds_read_b128 v[128:131], v2 offset:50816
    v_mfma_f32_16x16x32_bf16 v[208:211], v[136:139], v[96:99], v[208:211]
    s_add_u32 s64, s4, 0
    ds_read_b128 v[132:135], v2 offset:50880
    v_exp_f32 v84, v84
    v_mfma_f32_16x16x32_bf16 v[212:215], v[136:139], v[100:103], v[212:215]
    s_add_u32 m0, s61, 0
    v_exp_f32 v85, v85
    v_mfma_f32_16x16x32_bf16 v[216:219], v[136:139], v[104:107], v[216:219]
    buffer_load_dwordx4 v155, s[48:51], s64 offen lds
    v_mfma_f32_16x16x32_bf16 v[228:231], v[140:143], v[104:107], v[228:231]
    s_waitcnt lgkmcnt(4)
    s_add_u32 s64, s4, 1280
    v_exp_f32 v86, v86
    v_mfma_f32_16x16x32_bf16 v[224:227], v[140:143], v[100:103], v[224:227]
    s_add_u32 m0, s61, 1056
    v_exp_f32 v87, v87
    v_mfma_f32_16x16x32_bf16 v[220:223], v[140:143], v[96:99], v[220:223]
    buffer_load_dwordx4 v155, s[48:51], s64 offen lds
    v_mfma_f32_16x16x32_bf16 v[232:235], v[144:147], v[96:99], v[232:235]
    s_add_u32 s64, s4, 81920
    v_exp_f32 v88, v88
    v_mfma_f32_16x16x32_bf16 v[236:239], v[144:147], v[100:103], v[236:239]
    s_add_u32 m0, s61, 67584
    v_exp_f32 v89, v89
    v_mfma_f32_16x16x32_bf16 v[240:243], v[144:147], v[104:107], v[240:243]
    buffer_load_dwordx4 v155, s[48:51], s64 offen lds
    v_mfma_f32_16x16x32_bf16 v[252:255], v[148:151], v[104:107], v[252:255]
    s_add_u32 s64, s4, 83200
    s_waitcnt lgkmcnt(0)
    v_exp_f32 v90, v90
    v_mfma_f32_16x16x32_bf16 v[248:251], v[148:151], v[100:103], v[248:251]
    s_add_u32 m0, s61, 68640
    v_exp_f32 v91, v91
    v_mfma_f32_16x16x32_bf16 v[244:247], v[148:151], v[96:99], v[244:247]
    s_add_u32 s4, s4, s12
    buffer_load_dwordx4 v155, s[48:51], s64 offen lds
    v_mfma_f32_16x16x32_bf16 v[72:75], v[120:123], v[12:15], v[60:63]
    ds_read_b64_tr_b16 v[136:137], v3 offset:42240
    v_cvt_pk_bf16_f32 v110, v84, v85
    v_mfma_f32_16x16x32_bf16 v[72:75], v[124:127], v[16:19], v[72:75]
    ds_read_b64_tr_b16 v[138:139], v3 offset:42752
    v_cvt_pk_bf16_f32 v111, v86, v87
    v_mfma_f32_16x16x32_bf16 v[72:75], v[128:131], v[20:23], v[72:75]
    v_exp_f32 v92, v92
    v_mfma_f32_16x16x32_bf16 v[72:75], v[132:135], v[24:27], v[72:75]
    v_exp_f32 v93, v93
    v_mfma_f32_16x16x32_bf16 v[76:79], v[132:135], v[40:43], v[64:67]
    ds_read_b64_tr_b16 v[140:141], v3 offset:42272
    v_cvt_pk_bf16_f32 v114, v88, v89
    v_mfma_f32_16x16x32_bf16 v[76:79], v[128:131], v[36:39], v[76:79]
    ds_read_b64_tr_b16 v[142:143], v3 offset:42784
    v_cvt_pk_bf16_f32 v115, v90, v91
    v_mfma_f32_16x16x32_bf16 v[76:79], v[124:127], v[32:35], v[76:79]
    v_exp_f32 v94, v94
    v_mfma_f32_16x16x32_bf16 v[76:79], v[120:123], v[28:31], v[76:79]
    v_exp_f32 v95, v95
    v_mfma_f32_16x16x32_bf16 v[80:83], v[120:123], v[44:47], v[68:71]
    ds_read_b64_tr_b16 v[144:145], v3 offset:42304
    v_cvt_pk_bf16_f32 v118, v92, v93
    v_mfma_f32_16x16x32_bf16 v[80:83], v[124:127], v[48:51], v[80:83]
    ds_read_b64_tr_b16 v[146:147], v3 offset:42816
    v_cvt_pk_bf16_f32 v119, v94, v95
    v_mfma_f32_16x16x32_bf16 v[80:83], v[128:131], v[52:55], v[80:83]
    ds_read_b64_tr_b16 v[148:149], v3 offset:42336
    v_mfma_f32_16x16x32_bf16 v[80:83], v[132:135], v[56:59], v[80:83]
    s_waitcnt lgkmcnt(5)
    ds_read_b64_tr_b16 v[150:151], v3 offset:42848
    v_mfma_f32_16x16x32_bf16 v[160:163], v[136:139], v[108:111], v[160:163]
    ds_read_b128 v[120:123], v2 offset:51200
    v_mfma_f32_16x16x32_bf16 v[164:167], v[136:139], v[112:115], v[164:167]
    ds_read_b128 v[124:127], v2 offset:51264
    v_mfma_f32_16x16x32_bf16 v[168:171], v[136:139], v[116:119], v[168:171]
    s_waitcnt lgkmcnt(6)
    ds_read_b128 v[128:131], v2 offset:51328
    v_mfma_f32_16x16x32_bf16 v[180:183], v[140:143], v[116:119], v[180:183]
    ds_read_b128 v[132:135], v2 offset:51392
    v_mfma_f32_16x16x32_bf16 v[176:179], v[140:143], v[112:115], v[176:179]
    v_exp_f32 v72, v72
    v_mfma_f32_16x16x32_bf16 v[172:175], v[140:143], v[108:111], v[172:175]
    s_waitcnt lgkmcnt(6)
    v_exp_f32 v73, v73
    v_mfma_f32_16x16x32_bf16 v[184:187], v[144:147], v[108:111], v[184:187]
    v_exp_f32 v74, v74
    v_mfma_f32_16x16x32_bf16 v[188:191], v[144:147], v[112:115], v[188:191]
    v_exp_f32 v75, v75
    v_mfma_f32_16x16x32_bf16 v[192:195], v[144:147], v[116:119], v[192:195]
    s_waitcnt lgkmcnt(4)
    v_exp_f32 v76, v76
    v_mfma_f32_16x16x32_bf16 v[204:207], v[148:151], v[116:119], v[204:207]
    v_exp_f32 v77, v77
    v_mfma_f32_16x16x32_bf16 v[200:203], v[148:151], v[112:115], v[200:203]
    s_waitcnt lgkmcnt(0)
    v_exp_f32 v78, v78
    v_mfma_f32_16x16x32_bf16 v[196:199], v[148:151], v[108:111], v[196:199]
    v_exp_f32 v79, v79
    v_mfma_f32_16x16x32_bf16 v[84:87], v[120:123], v[12:15], v[60:63]
    ds_read_b64_tr_b16 v[136:137], v3 offset:42368
    v_cvt_pk_bf16_f32 v96, v72, v73
    v_mfma_f32_16x16x32_bf16 v[84:87], v[124:127], v[16:19], v[84:87]
    ds_read_b64_tr_b16 v[138:139], v3 offset:42880
    v_cvt_pk_bf16_f32 v97, v74, v75
    v_mfma_f32_16x16x32_bf16 v[84:87], v[128:131], v[20:23], v[84:87]
    v_exp_f32 v80, v80
    v_mfma_f32_16x16x32_bf16 v[84:87], v[132:135], v[24:27], v[84:87]
    v_exp_f32 v81, v81
    v_mfma_f32_16x16x32_bf16 v[88:91], v[132:135], v[40:43], v[64:67]
    ds_read_b64_tr_b16 v[140:141], v3 offset:42400
    v_cvt_pk_bf16_f32 v100, v76, v77
    v_mfma_f32_16x16x32_bf16 v[88:91], v[128:131], v[36:39], v[88:91]
    ds_read_b64_tr_b16 v[142:143], v3 offset:42912
    v_cvt_pk_bf16_f32 v101, v78, v79
    v_mfma_f32_16x16x32_bf16 v[88:91], v[124:127], v[32:35], v[88:91]
    v_exp_f32 v82, v82
    v_mfma_f32_16x16x32_bf16 v[88:91], v[120:123], v[28:31], v[88:91]
    v_exp_f32 v83, v83
    v_mfma_f32_16x16x32_bf16 v[92:95], v[120:123], v[44:47], v[68:71]
    ds_read_b64_tr_b16 v[144:145], v3 offset:42432
    v_cvt_pk_bf16_f32 v104, v80, v81
    v_mfma_f32_16x16x32_bf16 v[92:95], v[124:127], v[48:51], v[92:95]
    ds_read_b64_tr_b16 v[146:147], v3 offset:42944
    v_cvt_pk_bf16_f32 v105, v82, v83
    v_mfma_f32_16x16x32_bf16 v[92:95], v[128:131], v[52:55], v[92:95]
    ds_read_b64_tr_b16 v[148:149], v3 offset:42464
    v_mfma_f32_16x16x32_bf16 v[92:95], v[132:135], v[56:59], v[92:95]
    s_waitcnt vmcnt(8)
    ds_read_b64_tr_b16 v[150:151], v3 offset:42976
    v_mfma_f32_16x16x32_bf16 a[200:203], a[204:207], v[116:119], a[200:203]
    s_barrier
    ds_read_b128 v[120:123], v2 offset:59136
    v_mfma_f32_16x16x32_bf16 a[196:199], a[204:207], v[112:115], a[196:199]
    s_waitcnt lgkmcnt(5)
    ds_read_b128 v[124:127], v2 offset:59200
    v_mfma_f32_16x16x32_bf16 a[192:195], a[204:207], v[108:111], a[192:195]
    ds_read_b128 v[128:131], v2 offset:59264
    v_mfma_f32_16x16x32_bf16 v[208:211], v[136:139], v[108:111], v[208:211]
    s_add_u32 s64, s5, 0
    ds_read_b128 v[132:135], v2 offset:59328
    v_exp_f32 v84, v84
    v_mfma_f32_16x16x32_bf16 v[212:215], v[136:139], v[112:115], v[212:215]
    s_add_u32 m0, s61, 8448
    v_exp_f32 v85, v85
    v_mfma_f32_16x16x32_bf16 v[216:219], v[136:139], v[116:119], v[216:219]
    buffer_load_dwordx4 v155, s[48:51], s64 offen lds
    v_mfma_f32_16x16x32_bf16 v[228:231], v[140:143], v[116:119], v[228:231]
    s_waitcnt lgkmcnt(4)
    s_add_u32 s64, s5, 1280
    v_exp_f32 v86, v86
    v_mfma_f32_16x16x32_bf16 v[224:227], v[140:143], v[112:115], v[224:227]
    s_add_u32 m0, s61, 9504
    v_exp_f32 v87, v87
    v_mfma_f32_16x16x32_bf16 v[220:223], v[140:143], v[108:111], v[220:223]
    buffer_load_dwordx4 v155, s[48:51], s64 offen lds
    v_mfma_f32_16x16x32_bf16 v[232:235], v[144:147], v[108:111], v[232:235]
    s_add_u32 s64, s5, 81920
    v_exp_f32 v88, v88
    v_mfma_f32_16x16x32_bf16 v[236:239], v[144:147], v[112:115], v[236:239]
    s_add_u32 m0, s61, 76032
    v_exp_f32 v89, v89
    v_mfma_f32_16x16x32_bf16 v[240:243], v[144:147], v[116:119], v[240:243]
    buffer_load_dwordx4 v155, s[48:51], s64 offen lds
    v_mfma_f32_16x16x32_bf16 v[252:255], v[148:151], v[116:119], v[252:255]
    s_add_u32 s64, s5, 83200
    s_waitcnt lgkmcnt(0)
    v_exp_f32 v90, v90
    v_mfma_f32_16x16x32_bf16 v[248:251], v[148:151], v[112:115], v[248:251]
    s_add_u32 m0, s61, 77088
    v_exp_f32 v91, v91
    v_mfma_f32_16x16x32_bf16 v[244:247], v[148:151], v[108:111], v[244:247]
    s_add_u32 s5, s5, s12
    buffer_load_dwordx4 v155, s[48:51], s64 offen lds
    v_mfma_f32_16x16x32_bf16 v[72:75], v[120:123], v[12:15], v[60:63]
    ds_read_b64_tr_b16 v[136:137], v3 offset:50688
    v_cvt_pk_bf16_f32 v98, v84, v85
    v_mfma_f32_16x16x32_bf16 v[72:75], v[124:127], v[16:19], v[72:75]
    ds_read_b64_tr_b16 v[138:139], v3 offset:51200
    v_cvt_pk_bf16_f32 v99, v86, v87
    v_mfma_f32_16x16x32_bf16 v[72:75], v[128:131], v[20:23], v[72:75]
    v_exp_f32 v92, v92
    v_mfma_f32_16x16x32_bf16 v[72:75], v[132:135], v[24:27], v[72:75]
    v_exp_f32 v93, v93
    v_mfma_f32_16x16x32_bf16 v[76:79], v[132:135], v[40:43], v[64:67]
    ds_read_b64_tr_b16 v[140:141], v3 offset:50720
    v_cvt_pk_bf16_f32 v102, v88, v89
    v_mfma_f32_16x16x32_bf16 v[76:79], v[128:131], v[36:39], v[76:79]
    ds_read_b64_tr_b16 v[142:143], v3 offset:51232
    v_cvt_pk_bf16_f32 v103, v90, v91
    v_mfma_f32_16x16x32_bf16 v[76:79], v[124:127], v[32:35], v[76:79]
    v_exp_f32 v94, v94
    v_mfma_f32_16x16x32_bf16 v[76:79], v[120:123], v[28:31], v[76:79]
    v_exp_f32 v95, v95
    v_mfma_f32_16x16x32_bf16 v[80:83], v[120:123], v[44:47], v[68:71]
    ds_read_b64_tr_b16 v[144:145], v3 offset:50752
    v_cvt_pk_bf16_f32 v106, v92, v93
    v_mfma_f32_16x16x32_bf16 v[80:83], v[124:127], v[48:51], v[80:83]
    ds_read_b64_tr_b16 v[146:147], v3 offset:51264
    v_cvt_pk_bf16_f32 v107, v94, v95
    v_mfma_f32_16x16x32_bf16 v[80:83], v[128:131], v[52:55], v[80:83]
    ds_read_b64_tr_b16 v[148:149], v3 offset:50784
    v_mfma_f32_16x16x32_bf16 v[80:83], v[132:135], v[56:59], v[80:83]
    s_waitcnt lgkmcnt(5)
    ds_read_b64_tr_b16 v[150:151], v3 offset:51296
    v_mfma_f32_16x16x32_bf16 v[160:163], v[136:139], v[96:99], v[160:163]
    ds_read_b128 v[120:123], v2 offset:59648
    v_mfma_f32_16x16x32_bf16 v[164:167], v[136:139], v[100:103], v[164:167]
    ds_read_b128 v[124:127], v2 offset:59712
    v_mfma_f32_16x16x32_bf16 v[168:171], v[136:139], v[104:107], v[168:171]
    s_waitcnt lgkmcnt(6)
    ds_read_b128 v[128:131], v2 offset:59776
    v_mfma_f32_16x16x32_bf16 v[180:183], v[140:143], v[104:107], v[180:183]
    ds_read_b128 v[132:135], v2 offset:59840
    v_mfma_f32_16x16x32_bf16 v[176:179], v[140:143], v[100:103], v[176:179]
    v_exp_f32 v72, v72
    v_mfma_f32_16x16x32_bf16 v[172:175], v[140:143], v[96:99], v[172:175]
    s_waitcnt lgkmcnt(6)
    v_exp_f32 v73, v73
    v_mfma_f32_16x16x32_bf16 v[184:187], v[144:147], v[96:99], v[184:187]
    v_exp_f32 v74, v74
    v_mfma_f32_16x16x32_bf16 v[188:191], v[144:147], v[100:103], v[188:191]
    v_exp_f32 v75, v75
    v_mfma_f32_16x16x32_bf16 v[192:195], v[144:147], v[104:107], v[192:195]
    s_waitcnt lgkmcnt(4)
    v_exp_f32 v76, v76
    v_mfma_f32_16x16x32_bf16 v[204:207], v[148:151], v[104:107], v[204:207]
    v_exp_f32 v77, v77
    v_mfma_f32_16x16x32_bf16 v[200:203], v[148:151], v[100:103], v[200:203]
    s_waitcnt lgkmcnt(0)
    v_exp_f32 v78, v78
    v_mfma_f32_16x16x32_bf16 v[196:199], v[148:151], v[96:99], v[196:199]
    v_exp_f32 v79, v79
    v_mfma_f32_16x16x32_bf16 v[84:87], v[120:123], v[12:15], v[60:63]
    ds_read_b64_tr_b16 v[136:137], v3 offset:50816
    v_cvt_pk_bf16_f32 v108, v72, v73
    v_mfma_f32_16x16x32_bf16 v[84:87], v[124:127], v[16:19], v[84:87]
    ds_read_b64_tr_b16 v[138:139], v3 offset:51328
    v_cvt_pk_bf16_f32 v109, v74, v75
    v_mfma_f32_16x16x32_bf16 v[84:87], v[128:131], v[20:23], v[84:87]
    v_exp_f32 v80, v80
    v_mfma_f32_16x16x32_bf16 v[84:87], v[132:135], v[24:27], v[84:87]
    v_exp_f32 v81, v81
    v_mfma_f32_16x16x32_bf16 v[88:91], v[132:135], v[40:43], v[64:67]
    ds_read_b64_tr_b16 v[140:141], v3 offset:50848
    v_cvt_pk_bf16_f32 v112, v76, v77
    v_mfma_f32_16x16x32_bf16 v[88:91], v[128:131], v[36:39], v[88:91]
    ds_read_b64_tr_b16 v[142:143], v3 offset:51360
    v_cvt_pk_bf16_f32 v113, v78, v79
    v_mfma_f32_16x16x32_bf16 v[88:91], v[124:127], v[32:35], v[88:91]
    v_exp_f32 v82, v82
    v_mfma_f32_16x16x32_bf16 v[88:91], v[120:123], v[28:31], v[88:91]
    v_exp_f32 v83, v83
    v_mfma_f32_16x16x32_bf16 v[92:95], v[120:123], v[44:47], v[68:71]
    ds_read_b64_tr_b16 v[144:145], v3 offset:50880
    v_cvt_pk_bf16_f32 v116, v80, v81
    v_mfma_f32_16x16x32_bf16 v[92:95], v[124:127], v[48:51], v[92:95]
    ds_read_b64_tr_b16 v[146:147], v3 offset:51392
    v_cvt_pk_bf16_f32 v117, v82, v83
    v_mfma_f32_16x16x32_bf16 v[92:95], v[128:131], v[52:55], v[92:95]
    ds_read_b64_tr_b16 v[148:149], v3 offset:50912
    v_mfma_f32_16x16x32_bf16 v[92:95], v[132:135], v[56:59], v[92:95]
    s_waitcnt vmcnt(8)
    ds_read_b64_tr_b16 v[150:151], v3 offset:51424
    v_mfma_f32_16x16x32_bf16 a[200:203], a[204:207], v[104:107], a[200:203]
    s_barrier
    ds_read_b64_tr_b16 v[120:121], v3 offset:59136
    v_mfma_f32_16x16x32_bf16 a[196:199], a[204:207], v[100:103], a[196:199]
    s_waitcnt lgkmcnt(5)
    ds_read_b64_tr_b16 v[122:123], v3 offset:59648
    v_mfma_f32_16x16x32_bf16 a[192:195], a[204:207], v[96:99], a[192:195]
    ds_read_b64_tr_b16 v[124:125], v3 offset:59168
    v_mfma_f32_16x16x32_bf16 v[208:211], v[136:139], v[96:99], v[208:211]
    s_add_u32 s64, s6, 0
    ds_read_b64_tr_b16 v[126:127], v3 offset:59680
    v_exp_f32 v84, v84
    v_mfma_f32_16x16x32_bf16 v[212:215], v[136:139], v[100:103], v[212:215]
    s_add_u32 m0, s61, 16896
    ds_read_b64_tr_b16 v[128:129], v3 offset:59200
    v_exp_f32 v85, v85
    v_mfma_f32_16x16x32_bf16 v[216:219], v[136:139], v[104:107], v[216:219]
    buffer_load_dwordx4 v155, s[48:51], s64 offen lds
    v_mfma_f32_16x16x32_bf16 v[228:231], v[140:143], v[104:107], v[228:231]
    s_waitcnt lgkmcnt(5)
    s_add_u32 s64, s6, 1280
    ds_read_b64_tr_b16 v[130:131], v3 offset:59712
    v_exp_f32 v86, v86
    v_mfma_f32_16x16x32_bf16 v[224:227], v[140:143], v[100:103], v[224:227]
    s_add_u32 m0, s61, 17952
    ds_read_b64_tr_b16 v[132:133], v3 offset:59232
    v_exp_f32 v87, v87
    v_mfma_f32_16x16x32_bf16 v[220:223], v[140:143], v[96:99], v[220:223]
    buffer_load_dwordx4 v155, s[48:51], s64 offen lds
    v_mfma_f32_16x16x32_bf16 v[232:235], v[144:147], v[96:99], v[232:235]
    s_add_u32 s64, s6, 81920
    ds_read_b64_tr_b16 v[134:135], v3 offset:59744
    v_exp_f32 v88, v88
    v_mfma_f32_16x16x32_bf16 v[236:239], v[144:147], v[100:103], v[236:239]
    s_add_u32 m0, s61, 84480
    v_cvt_pk_bf16_f32 v110, v84, v85
    v_exp_f32 v89, v89
    v_mfma_f32_16x16x32_bf16 v[240:243], v[144:147], v[104:107], v[240:243]
    buffer_load_dwordx4 v155, s[48:51], s64 offen lds
    v_mfma_f32_16x16x32_bf16 v[252:255], v[148:151], v[104:107], v[252:255]
    s_add_u32 s64, s6, 83200
    v_cvt_pk_bf16_f32 v111, v86, v87
    v_exp_f32 v90, v90
    v_mfma_f32_16x16x32_bf16 v[248:251], v[148:151], v[100:103], v[248:251]
    s_add_u32 m0, s61, 85536
    v_exp_f32 v91, v91
    v_mfma_f32_16x16x32_bf16 v[244:247], v[148:151], v[96:99], v[244:247]
    s_add_u32 s6, s6, s12
    s_waitcnt lgkmcnt(0)
    buffer_load_dwordx4 v155, s[48:51], s64 offen lds
    v_mfma_f32_16x16x32_bf16 a[192:195], a[204:207], v[108:111], a[192:195]
    ds_read_b64_tr_b16 v[136:137], v3 offset:59264
    v_cvt_pk_bf16_f32 v114, v88, v89
    v_mfma_f32_16x16x32_bf16 v[160:163], v[120:123], v[108:111], v[160:163]
    ds_read_b64_tr_b16 v[138:139], v3 offset:59776
    v_cvt_pk_bf16_f32 v115, v90, v91
    v_mfma_f32_16x16x32_bf16 v[172:175], v[124:127], v[108:111], v[172:175]
    v_exp_f32 v92, v92
    v_mfma_f32_16x16x32_bf16 v[184:187], v[128:131], v[108:111], v[184:187]
    v_exp_f32 v93, v93
    v_mfma_f32_16x16x32_bf16 v[196:199], v[132:135], v[108:111], v[196:199]
    v_exp_f32 v94, v94
    v_mfma_f32_16x16x32_bf16 a[196:199], a[204:207], v[112:115], a[196:199]
    v_exp_f32 v95, v95
    v_mfma_f32_16x16x32_bf16 v[164:167], v[120:123], v[112:115], v[164:167]
    ds_read_b64_tr_b16 v[140:141], v3 offset:59296
    v_cvt_pk_bf16_f32 v118, v92, v93
    v_mfma_f32_16x16x32_bf16 v[176:179], v[124:127], v[112:115], v[176:179]
    ds_read_b64_tr_b16 v[142:143], v3 offset:59808
    v_cvt_pk_bf16_f32 v119, v94, v95
    v_mfma_f32_16x16x32_bf16 v[188:191], v[128:131], v[112:115], v[188:191]
    ds_read_b64_tr_b16 v[144:145], v3 offset:59328
    v_accvgpr_read_b32 v7, a192
    v_mfma_f32_16x16x32_bf16 v[200:203], v[132:135], v[112:115], v[200:203]
    s_add_u32 s64, s7, 0
    ds_read_b64_tr_b16 v[146:147], v3 offset:59840
    v_accvgpr_read_b32 v8, a196
    v_mfma_f32_16x16x32_bf16 a[200:203], a[204:207], v[116:119], a[200:203]
    s_add_u32 m0, s61, 25344
    ds_read_b64_tr_b16 v[148:149], v3 offset:59360
    v_add_f32 v10, v7, v8
    v_mfma_f32_16x16x32_bf16 v[168:171], v[120:123], v[116:119], v[168:171]
    ds_read_b64_tr_b16 v[150:151], v3 offset:59872
    v_mov_b32 v11, 0x5d800000
    buffer_load_dwordx4 v155, s[48:51], s64 offen lds
    v_mfma_f32_16x16x32_bf16 v[180:183], v[124:127], v[116:119], v[180:183]
    s_add_u32 s64, s7, 1280
    v_rcp_f32 v7, v7
    v_mfma_f32_16x16x32_bf16 v[192:195], v[128:131], v[116:119], v[192:195]
    s_add_u32 m0, s61, 26400
    v_rcp_f32 v8, v8
    v_mfma_f32_16x16x32_bf16 v[204:207], v[132:135], v[116:119], v[204:207]
    s_waitcnt lgkmcnt(6)
    v_accvgpr_read_b32 v9, a200
    v_add_f32 v10, v10, v9
    buffer_load_dwordx4 v155, s[48:51], s64 offen lds
    v_mfma_f32_16x16x32_bf16 v[208:211], v[136:139], v[108:111], v[208:211]
    s_add_u32 s64, s7, 81920
    v_cmp_nle_f32 vcc, v10, v11
    v_mfma_f32_16x16x32_bf16 v[212:215], v[136:139], v[112:115], v[212:215]
    s_add_u32 m0, s61, 92928
    v_rcp_f32 v9, v9
    v_mfma_f32_16x16x32_bf16 v[216:219], v[136:139], v[116:119], v[216:219]
    s_waitcnt lgkmcnt(4)
    buffer_load_dwordx4 v155, s[48:51], s64 offen lds
    v_mfma_f32_16x16x32_bf16 v[228:231], v[140:143], v[116:119], v[228:231]
    s_add_u32 s64, s7, 83200
    v_mfma_f32_16x16x32_bf16 v[224:227], v[140:143], v[112:115], v[224:227]
    s_add_u32 m0, s61, 93984
    v_mfma_f32_16x16x32_bf16 v[220:223], v[140:143], v[108:111], v[220:223]
    s_waitcnt lgkmcnt(2)
    s_add_u32 s7, s7, s12
    buffer_load_dwordx4 v155, s[48:51], s64 offen lds
    v_mfma_f32_16x16x32_bf16 v[232:235], v[144:147], v[108:111], v[232:235]
    s_add_u32 s64, s4, 0
    v_mfma_f32_16x16x32_bf16 v[236:239], v[144:147], v[112:115], v[236:239]
    s_add_u32 m0, s61, 33792
    v_mfma_f32_16x16x32_bf16 v[240:243], v[144:147], v[116:119], v[240:243]
    s_waitcnt lgkmcnt(0)
    buffer_load_dwordx4 v155, s[48:51], s64 offen lds
    v_mfma_f32_16x16x32_bf16 v[252:255], v[148:151], v[116:119], v[252:255]
    s_add_u32 s64, s4, 1280
    v_mfma_f32_16x16x32_bf16 v[248:251], v[148:151], v[112:115], v[248:251]
    s_add_u32 m0, s61, 34848
    v_mfma_f32_16x16x32_bf16 v[244:247], v[148:151], v[108:111], v[244:247]
    buffer_load_dwordx4 v155, s[48:51], s64 offen lds
    s_cbranch_vccnz L_slow
L_g:
    v_lshrrev_b32 v120, 5, v0
    v_lshlrev_b32 v120, 7, v120
    v_sub_u32 v5, v3, v120
    v_subrev_u32 v4, 67584, v5
    v_mov_b32 v121, 135168
    s_waitcnt vmcnt(12)
    s_cmp_lg_u32 s60, 0
    s_cbranch_scc1 L_bc_69
    v_and_b32 v120, 0xff, v156
    v_cmp_gt_u32 vcc, 8, v120
    s_lshl_b32 s66, s24, 3
    s_nop 3
    s_cbranch_vccnz L_bs_70
L_bok_71:
    v_xor_b32 v156, s66, v156
    ds_write_b32 v121, v156
L_bc_69:
    s_barrier
    ds_read_b64_tr_b16 a[192:193], v4 offset:0
    ds_read_b64_tr_b16 a[194:195], v4 offset:256
    ds_read_b64_tr_b16 a[196:197], v4 offset:512
    ds_read_b64_tr_b16 a[198:199], v4 offset:768
    ds_read_b64_tr_b16 a[200:201], v4 offset:32
    ds_read_b64_tr_b16 a[202:203], v4 offset:288
    ds_read_b64_tr_b16 a[204:205], v4 offset:544
    ds_read_b64_tr_b16 a[206:207], v4 offset:800
    ds_read_b64_tr_b16 a[208:209], v4 offset:64
    ds_read_b64_tr_b16 a[210:211], v4 offset:320
    ds_read_b64_tr_b16 a[212:213], v4 offset:576
    ds_read_b64_tr_b16 a[214:215], v4 offset:832
    ds_read_b64_tr_b16 a[216:217], v4 offset:96
    ds_read_b64_tr_b16 a[218:219], v4 offset:352
    ds_read_b64_tr_b16 a[220:221], v4 offset:608
    ds_read_b64_tr_b16 a[222:223], v4 offset:864
    v_pk_mul_f32 v[160:161], v[160:161], v[6:7] op_sel:[0,1] op_sel_hi:[1,1]
    v_pk_mul_f32 v[162:163], v[162:163], v[6:7] op_sel:[0,1] op_sel_hi:[1,1]
    v_pk_mul_f32 v[164:165], v[164:165], v[8:9] op_sel:[0,0] op_sel_hi:[1,0]
    v_pk_mul_f32 v[166:167], v[166:167], v[8:9] op_sel:[0,0] op_sel_hi:[1,0]
    v_pk_mul_f32 v[168:169], v[168:169], v[8:9] op_sel:[0,1] op_sel_hi:[1,1]
    v_pk_mul_f32 v[170:171], v[170:171], v[8:9] op_sel:[0,1] op_sel_hi:[1,1]
    v_pk_mul_f32 v[172:173], v[172:173], v[6:7] op_sel:[0,1] op_sel_hi:[1,1]
    v_pk_mul_f32 v[174:175], v[174:175], v[6:7] op_sel:[0,1] op_sel_hi:[1,1]
    v_pk_mul_f32 v[176:177], v[176:177], v[8:9] op_sel:[0,0] op_sel_hi:[1,0]
    v_pk_mul_f32 v[178:179], v[178:179], v[8:9] op_sel:[0,0] op_sel_hi:[1,0]
    v_pk_mul_f32 v[180:181], v[180:181], v[8:9] op_sel:[0,1] op_sel_hi:[1,1]
    v_pk_mul_f32 v[182:183], v[182:183], v[8:9] op_sel:[0,1] op_sel_hi:[1,1]
    s_waitcnt lgkmcnt(14)
    v_mfma_f32_16x16x32_bf16 v[72:75], a[192:195], a[144:147], 0
    s_waitcnt lgkmcnt(12)
    s_mul_i32 s66, s74, 2064384
    ds_read_b64_tr_b16 a[224:225], v5 offset:0
    v_cvt_pk_bf16_f32 v12, v160, v161
    v_mfma_f32_16x16x32_bf16 v[72:75], a[196:199], a[156:159], v[72:75]
    s_add_u32 s52, s28, s66
    s_addc_u32 s53, s29, 0
    ds_read_b64_tr_b16 a[226:227], v5 offset:256
    v_mfma_f32_16x16x32_bf16 v[76:79], a[196:199], a[160:163], 0
    s_and_b32 s53, s53, 0xffff
    ds_read_b64_tr_b16 a[228:229], v5 offset:512
    v_cvt_pk_bf16_f32 v13, v162, v163
    v_mfma_f32_16x16x32_bf16 v[76:79], a[192:195], a[148:151], v[76:79]
    s_mov_b32 s55, 0x20000
    ds_read_b64_tr_b16 a[230:231], v5 offset:768
    v_cvt_pk_bf16_f32 v14, v172, v173
    v_mfma_f32_16x16x32_bf16 v[80:83], a[192:195], a[152:155], 0
    s_add_u32 s64, s4, 81920
    ds_read_b64_tr_b16 a[232:233], v5 offset:32
    v_cvt_pk_bf16_f32 v15, v174, v175
    v_mfma_f32_16x16x32_bf16 v[80:83], a[196:199], a[164:167], v[80:83]
    s_waitcnt lgkmcnt(13)
    s_add_u32 m0, s61, 101376
    ds_read_b64_tr_b16 a[234:235], v5 offset:288
    v_cvt_pk_bf16_f32 v28, v164, v165
    v_mfma_f32_16x16x32_bf16 v[92:95], a[204:207], a[164:167], 0
    s_mov_b32 s54, 2064384
    buffer_load_dwordx4 v155, s[48:51], s64 offen lds
    v_mfma_f32_16x16x32_bf16 v[92:95], a[200:203], a[152:155], v[92:95]
    s_mul_i32 s69, s72, 43008
    ds_read_b64_tr_b16 a[236:237], v5 offset:544
    v_cvt_pk_bf16_f32 v29, v166, v167
    v_mfma_f32_16x16x32_bf16 v[88:91], a[200:203], a[148:151], 0
    s_add_u32 s66, s66, s69
    ds_read_b64_tr_b16 a[238:239], v5 offset:800
    v_cvt_pk_bf16_f32 v30, v176, v177
    v_mfma_f32_16x16x32_bf16 v[88:91], a[204:207], a[160:163], v[88:91]
    s_add_u32 s64, s4, 83200
    ds_read_b64_tr_b16 a[240:241], v5 offset:64
    v_cvt_pk_bf16_f32 v31, v178, v179
    v_mfma_f32_16x16x32_bf16 v[84:87], a[204:207], a[156:159], 0
    s_add_u32 m0, s61, 102432
    ds_read_b64_tr_b16 a[242:243], v5 offset:320
    v_cvt_pk_bf16_f32 v44, v168, v169
    v_mfma_f32_16x16x32_bf16 v[84:87], a[200:203], a[144:147], v[84:87]
    s_waitcnt lgkmcnt(14)
    s_add_u32 s4, s4, s13
    buffer_load_dwordx4 v155, s[48:51], s64 offen lds
    v_mfma_f32_16x16x32_bf16 v[96:99], a[208:211], a[144:147], 0
    s_add_u32 s32, s28, s66
    s_addc_u32 s33, s29, 0
    ds_read_b64_tr_b16 a[244:245], v5 offset:576
    v_mfma_f32_16x16x32_bf16 v[96:99], a[212:215], a[156:159], v[96:99]
    s_and_b32 s33, s33, 0xffff
    ds_read_b64_tr_b16 a[246:247], v5 offset:832
    v_cvt_pk_bf16_f32 v45, v170, v171
    v_mfma_f32_16x16x32_bf16 v[100:103], a[212:215], a[160:163], 0
    s_add_u32 s64, s5, 0
    ds_read_b64_tr_b16 a[248:249], v5 offset:96
    v_cvt_pk_bf16_f32 v46, v180, v181
    v_mfma_f32_16x16x32_bf16 v[100:103], a[208:211], a[148:151], v[100:103]
    s_add_u32 m0, s61, 42240
    ds_read_b64_tr_b16 a[250:251], v5 offset:352
    v_cvt_pk_bf16_f32 v47, v182, v183
    v_mfma_f32_16x16x32_bf16 v[104:107], a[208:211], a[152:155], 0
    s_mov_b32 s35, 0x20000
    buffer_load_dwordx4 v155, s[48:51], s64 offen lds
    v_mfma_f32_16x16x32_bf16 v[104:107], a[212:215], a[164:167], v[104:107]
    s_waitcnt lgkmcnt(14)
    s_add_u32 s64, s5, 1280
    ds_read_b64_tr_b16 a[252:253], v5 offset:608
    v_mul_f32 v184, v184, v7
    v_mfma_f32_16x16x32_bf16 v[116:119], a[220:223], a[164:167], 0
    s_add_u32 m0, s61, 43296
    ds_read_b64_tr_b16 a[254:255], v5 offset:864
    v_mul_f32 v185, v185, v7
    v_mfma_f32_16x16x32_bf16 v[116:119], a[216:219], a[152:155], v[116:119]
    s_mov_b32 s34, 0
    buffer_load_dwordx4 v155, s[48:51], s64 offen lds
    v_mfma_f32_16x16x32_bf16 v[112:115], a[216:219], a[148:151], 0
    s_mul_i32 s69, s60, 1536
    v_mul_f32 v186, v186, v7
    v_mul_f32 v187, v187, v7
    v_mfma_f32_16x16x32_bf16 v[112:115], a[220:223], a[160:163], v[112:115]
    s_add_u32 s69, s69, s66
    v_mul_f32 v196, v196, v7
    v_mfma_f32_16x16x32_bf16 v[108:111], a[220:223], a[156:159], 0
    s_waitcnt lgkmcnt(0)
    v_mul_f32 v197, v197, v7
    v_mul_f32 v198, v198, v7
    v_mfma_f32_16x16x32_bf16 v[108:111], a[216:219], a[144:147], v[108:111]
    s_add_u32 s69, s69, 1720320
    v_mul_f32 v199, v199, v7
    v_mfma_f32_16x16x32_bf16 v[72:75], a[224:227], a[168:171], v[72:75]
    ds_read_b64_tr_b16 a[192:193], v4 offset:8448
    v_min_u32 v3, 47, v0
    v_mfma_f32_16x16x32_bf16 v[72:75], a[228:231], a[180:183], v[72:75]
    ds_read_b64_tr_b16 a[194:195], v4 offset:8704
    v_mul_u32_u24 v132, 43, v3
    v_mfma_f32_16x16x32_bf16 v[76:79], a[228:231], a[184:187], v[76:79]
    ds_read_b64_tr_b16 a[196:197], v4 offset:8960
    v_lshrrev_b32 v132, 9, v132
    v_mfma_f32_16x16x32_bf16 v[76:79], a[224:227], a[172:175], v[76:79]
    ds_read_b64_tr_b16 a[198:199], v4 offset:9216
    v_lshlrev_b32 v3, 7, v3
    v_mfma_f32_16x16x32_bf16 v[80:83], a[224:227], a[176:179], v[80:83]
    s_add_u32 s64, s5, 81920
    ds_read_b64_tr_b16 a[200:201], v4 offset:8480
    v_mul_u32_u24 v132, 4608, v132
    v_mfma_f32_16x16x32_bf16 v[80:83], a[228:231], a[188:191], v[80:83]
    s_add_u32 m0, s61, 109824
    ds_read_b64_tr_b16 a[202:203], v4 offset:8736
    v_add3_u32 v3, v3, v132, s69
    v_mfma_f32_16x16x32_bf16 v[92:95], a[236:239], a[188:191], v[92:95]
    s_add_u32 s69, s69, 38272
    buffer_load_dwordx4 v155, s[48:51], s64 offen lds
    v_mfma_f32_16x16x32_bf16 v[92:95], a[232:235], a[176:179], v[92:95]
    ds_read_b64_tr_b16 a[204:205], v4 offset:8992
    v_add_u32 v157, 24576, v3
    v_mfma_f32_16x16x32_bf16 v[88:91], a[232:235], a[172:175], v[88:91]
    ds_read_b64_tr_b16 a[206:207], v4 offset:9248
    v_min_u32 v157, s69, v157
    v_mfma_f32_16x16x32_bf16 v[88:91], a[236:239], a[184:187], v[88:91]
    s_add_u32 s64, s5, 83200
    ds_read_b64_tr_b16 a[208:209], v4 offset:8512
    v_cvt_pk_bf16_f32 v16, v184, v185
    v_mfma_f32_16x16x32_bf16 v[84:87], a[236:239], a[180:183], v[84:87]
    s_add_u32 m0, s61, 110880
    ds_read_b64_tr_b16 a[210:211], v4 offset:8768
    v_cvt_pk_bf16_f32 v17, v186, v187
    v_mfma_f32_16x16x32_bf16 v[84:87], a[232:235], a[168:171], v[84:87]
    s_add_u32 s5, s5, s13
    buffer_load_dwordx4 v155, s[48:51], s64 offen lds
    v_mfma_f32_16x16x32_bf16 v[96:99], a[240:243], a[168:171], v[96:99]
    s_xor_b32 s40, s72, 7
    ds_read_b64_tr_b16 a[212:213], v4 offset:9024
    v_cvt_pk_bf16_f32 v18, v196, v197
    v_mfma_f32_16x16x32_bf16 v[96:99], a[244:247], a[180:183], v[96:99]
    s_mul_i32 s40, s40, 43008
    ds_read_b64_tr_b16 a[214:215], v4 offset:9280
    v_cvt_pk_bf16_f32 v19, v198, v199
    v_mfma_f32_16x16x32_bf16 v[100:103], a[244:247], a[184:187], v[100:103]
    s_add_u32 s64, s6, 0
    ds_read_b64_tr_b16 a[216:217], v4 offset:8544
    v_mul_f32 v188, v188, v8
    v_mfma_f32_16x16x32_bf16 v[100:103], a[240:243], a[172:175], v[100:103]
    s_add_u32 m0, s61, 50688
    ds_read_b64_tr_b16 a[218:219], v4 offset:8800
    v_mul_f32 v189, v189, v8
    v_mfma_f32_16x16x32_bf16 v[104:107], a[240:243], a[176:179], v[104:107]
    s_add_u32 s40, s40, 0
    buffer_load_dwordx4 v155, s[48:51], s64 offen lds
    v_mfma_f32_16x16x32_bf16 v[104:107], a[244:247], a[188:191], v[104:107]
    s_add_u32 s64, s6, 1280
    ds_read_b64_tr_b16 a[220:221], v4 offset:9056
    v_mul_f32 v190, v190, v8
    v_mfma_f32_16x16x32_bf16 v[116:119], a[252:255], a[188:191], v[116:119]
    s_add_u32 m0, s61, 51744
    ds_read_b64_tr_b16 a[222:223], v4 offset:9312
    v_mul_f32 v191, v191, v8
    v_mfma_f32_16x16x32_bf16 v[116:119], a[248:251], a[176:179], v[116:119]
    s_xor_b32 s41, s72, 6
    buffer_load_dwordx4 v155, s[48:51], s64 offen lds
    v_mfma_f32_16x16x32_bf16 v[112:115], a[248:251], a[172:175], v[112:115]
    s_mul_i32 s41, s41, 43008
    v_mul_f32 v200, v200, v8
    v_mul_f32 v201, v201, v8
    v_mfma_f32_16x16x32_bf16 v[112:115], a[252:255], a[184:187], v[112:115]
    s_add_u32 s41, s41, 6144
    v_mul_f32 v202, v202, v8
    v_mfma_f32_16x16x32_bf16 v[108:111], a[252:255], a[180:183], v[108:111]
    s_waitcnt vmcnt(12) lgkmcnt(0)
    v_mul_f32 v203, v203, v8
    v_cvt_pk_bf16_f32 v32, v188, v189
    v_mfma_f32_16x16x32_bf16 v[108:111], a[248:251], a[168:171], v[108:111]
    s_barrier
    v_mfma_f32_16x16x32_bf16 v[72:75], a[192:195], a[96:99], v[72:75]
    s_xor_b32 s42, s72, 5
    ds_read_b64_tr_b16 a[224:225], v5 offset:8448
    v_cvt_pk_bf16_f32 v33, v190, v191
    v_mfma_f32_16x16x32_bf16 v[72:75], a[196:199], a[108:111], v[72:75]
    s_mul_i32 s42, s42, 43008
    ds_read_b64_tr_b16 a[226:227], v5 offset:8704
    v_cvt_pk_bf16_f32 v34, v200, v201
    v_mfma_f32_16x16x32_bf16 v[76:79], a[196:199], a[112:115], v[76:79]
    s_add_u32 s42, s42, 12288
    ds_read_b64_tr_b16 a[228:229], v5 offset:8960
    v_cvt_pk_bf16_f32 v35, v202, v203
    v_mfma_f32_16x16x32_bf16 v[76:79], a[192:195], a[100:103], v[76:79]
    s_xor_b32 s43, s72, 4
    ds_read_b64_tr_b16 a[230:231], v5 offset:9216
    v_mul_f32 v192, v192, v9
    v_mfma_f32_16x16x32_bf16 v[80:83], a[192:195], a[104:107], v[80:83]
    s_add_u32 s64, s6, 81920
    ds_read_b64_tr_b16 a[232:233], v5 offset:8480
    v_mul_f32 v193, v193, v9
    v_mfma_f32_16x16x32_bf16 v[80:83], a[196:199], a[116:119], v[80:83]
    s_add_u32 m0, s61, 118272
    ds_read_b64_tr_b16 a[234:235], v5 offset:8736
    v_mul_f32 v194, v194, v9
    v_mfma_f32_16x16x32_bf16 v[92:95], a[204:207], a[116:119], v[92:95]
    s_mul_i32 s43, s43, 43008
    buffer_load_dwordx4 v155, s[48:51], s64 offen lds
    v_mfma_f32_16x16x32_bf16 v[92:95], a[200:203], a[104:107], v[92:95]
    s_add_u32 s43, s43, 18432
    ds_read_b64_tr_b16 a[236:237], v5 offset:8992
    v_mul_f32 v195, v195, v9
    v_mfma_f32_16x16x32_bf16 v[88:91], a[200:203], a[100:103], v[88:91]
    s_xor_b32 s44, s72, 3
    ds_read_b64_tr_b16 a[238:239], v5 offset:9248
    v_mul_f32 v204, v204, v9
    v_mfma_f32_16x16x32_bf16 v[88:91], a[204:207], a[112:115], v[88:91]
    s_add_u32 s64, s6, 83200
    ds_read_b64_tr_b16 a[240:241], v5 offset:8512
    v_mul_f32 v205, v205, v9
    v_mfma_f32_16x16x32_bf16 v[84:87], a[204:207], a[108:111], v[84:87]
    s_add_u32 m0, s61, 119328
    ds_read_b64_tr_b16 a[242:243], v5 offset:8768
    v_mul_f32 v206, v206, v9
    v_mfma_f32_16x16x32_bf16 v[84:87], a[200:203], a[96:99], v[84:87]
    s_add_u32 s6, s6, s13
    buffer_load_dwordx4 v155, s[48:51], s64 offen lds
    v_mfma_f32_16x16x32_bf16 v[96:99], a[208:211], a[96:99], v[96:99]
    s_mul_i32 s44, s44, 43008
    ds_read_b64_tr_b16 a[244:245], v5 offset:9024
    v_mul_f32 v207, v207, v9
    v_mfma_f32_16x16x32_bf16 v[96:99], a[212:215], a[108:111], v[96:99]
    s_add_u32 s44, s44, 24576
    ds_read_b64_tr_b16 a[246:247], v5 offset:9280
    v_cvt_pk_bf16_f32 v48, v192, v193
    v_mfma_f32_16x16x32_bf16 v[100:103], a[212:215], a[112:115], v[100:103]
    s_add_u32 s64, s7, 0
    ds_read_b64_tr_b16 a[248:249], v5 offset:8544
    v_cvt_pk_bf16_f32 v49, v194, v195
    v_mfma_f32_16x16x32_bf16 v[100:103], a[208:211], a[100:103], v[100:103]
    s_add_u32 m0, s61, 59136
    ds_read_b64_tr_b16 a[250:251], v5 offset:8800
    v_cvt_pk_bf16_f32 v50, v204, v205
    v_mfma_f32_16x16x32_bf16 v[104:107], a[208:211], a[104:107], v[104:107]
    s_xor_b32 s45, s72, 2
    buffer_load_dwordx4 v155, s[48:51], s64 offen lds
    v_mfma_f32_16x16x32_bf16 v[104:107], a[212:215], a[116:119], v[104:107]
    s_add_u32 s64, s7, 1280
    ds_read_b64_tr_b16 a[252:253], v5 offset:9056
    v_cvt_pk_bf16_f32 v51, v206, v207
    v_mfma_f32_16x16x32_bf16 v[116:119], a[220:223], a[116:119], v[116:119]
    s_add_u32 m0, s61, 60192
    ds_read_b64_tr_b16 a[254:255], v5 offset:9312
    v_mul_f32 v208, v208, v7
    v_mfma_f32_16x16x32_bf16 v[116:119], a[216:219], a[104:107], v[116:119]
    s_mul_i32 s45, s45, 43008
    buffer_load_dwordx4 v155, s[48:51], s64 offen lds
    v_mfma_f32_16x16x32_bf16 v[112:115], a[216:219], a[100:103], v[112:115]
    s_add_u32 s45, s45, 30720
    ds_read_b32 v122, v121
    v_mul_f32 v209, v209, v7
    v_mfma_f32_16x16x32_bf16 v[112:115], a[220:223], a[112:115], v[112:115]
    s_xor_b32 s46, s72, 1
    v_mul_f32 v210, v210, v7
    v_mul_f32 v211, v211, v7
    v_mfma_f32_16x16x32_bf16 v[108:111], a[220:223], a[108:111], v[108:111]
    s_waitcnt lgkmcnt(0)
    v_mul_f32 v220, v220, v7
    v_mfma_f32_16x16x32_bf16 v[108:111], a[216:219], a[96:99], v[108:111]
    s_mul_i32 s46, s46, 43008
    v_mul_f32 v221, v221, v7
    v_mul_f32 v222, v222, v7
    v_mfma_f32_16x16x32_bf16 v[72:75], a[224:227], a[120:123], v[72:75]
    s_add_u32 s46, s46, 36864
    ds_read_b64_tr_b16 a[192:193], v4 offset:16896
    v_mul_f32 v223, v223, v7
    v_mfma_f32_16x16x32_bf16 v[72:75], a[228:231], a[132:135], v[72:75]
    s_mul_i32 s66, s71, 491520
    ds_read_b64_tr_b16 a[194:195], v4 offset:17152
    v_cvt_pk_bf16_f32 v20, v208, v209
    v_mfma_f32_16x16x32_bf16 v[76:79], a[228:231], a[136:139], v[76:79]
    s_mul_i32 s69, s73, 1280
    ds_read_b64_tr_b16 a[196:197], v4 offset:17408
    v_cvt_pk_bf16_f32 v21, v210, v211
    v_mfma_f32_16x16x32_bf16 v[76:79], a[224:227], a[124:127], v[76:79]
    s_add_u32 s66, s66, s69
    ds_read_b64_tr_b16 a[198:199], v4 offset:17664
    v_cvt_pk_bf16_f32 v22, v220, v221
    v_mfma_f32_16x16x32_bf16 v[80:83], a[224:227], a[128:131], v[80:83]
    s_add_u32 s64, s7, 81920
    ds_read_b64_tr_b16 a[200:201], v4 offset:16928
    v_cvt_pk_bf16_f32 v23, v222, v223
    v_mfma_f32_16x16x32_bf16 v[80:83], a[228:231], a[140:143], v[80:83]
    s_add_u32 m0, s61, 126720
    ds_read_b64_tr_b16 a[202:203], v4 offset:17184
    v_mul_f32 v212, v212, v8
    v_mfma_f32_16x16x32_bf16 v[92:95], a[236:239], a[140:143], v[92:95]
    s_lshl_b32 s69, s72, 5
    buffer_load_dwordx4 v155, s[48:51], s64 offen lds
    v_mfma_f32_16x16x32_bf16 v[92:95], a[232:235], a[128:131], v[92:95]
    s_add_u32 s66, s66, s69
    ds_read_b64_tr_b16 a[204:205], v4 offset:17440
    v_mul_f32 v213, v213, v8
    v_mfma_f32_16x16x32_bf16 v[88:91], a[232:235], a[124:127], v[88:91]
    s_add_u32 s36, s16, s66
    s_addc_u32 s37, s17, 0
    ds_read_b64_tr_b16 a[206:207], v4 offset:17696
    v_mfma_f32_16x16x32_bf16 v[88:91], a[236:239], a[136:139], v[88:91]
    s_add_u32 s64, s7, 83200
    ds_read_b64_tr_b16 a[208:209], v4 offset:16960
    v_mul_f32 v214, v214, v8
    v_mfma_f32_16x16x32_bf16 v[84:87], a[236:239], a[132:135], v[84:87]
    s_add_u32 m0, s61, 127776
    ds_read_b64_tr_b16 a[210:211], v4 offset:17216
    v_mul_f32 v215, v215, v8
    v_mfma_f32_16x16x32_bf16 v[84:87], a[232:235], a[120:123], v[84:87]
    s_add_u32 s7, s7, s13
    buffer_load_dwordx4 v155, s[48:51], s64 offen lds
    v_mfma_f32_16x16x32_bf16 v[96:99], a[240:243], a[120:123], v[96:99]
    s_and_b32 s37, s37, 0xffff
    ds_read_b64_tr_b16 a[212:213], v4 offset:17472
    v_mul_f32 v224, v224, v8
    v_mfma_f32_16x16x32_bf16 v[96:99], a[244:247], a[132:135], v[96:99]
    s_mov_b32 s39, 0x20000
    ds_read_b64_tr_b16 a[214:215], v4 offset:17728
    v_mul_f32 v225, v225, v8
    v_mfma_f32_16x16x32_bf16 v[100:103], a[244:247], a[136:139], v[100:103]
    s_add_u32 s64, s4, 0
    ds_read_b64_tr_b16 a[216:217], v4 offset:16992
    v_mul_f32 v226, v226, v8
    v_mfma_f32_16x16x32_bf16 v[100:103], a[240:243], a[124:127], v[100:103]
    s_add_u32 m0, s61, 0
    ds_read_b64_tr_b16 a[218:219], v4 offset:17248
    v_mul_f32 v227, v227, v8
    v_mfma_f32_16x16x32_bf16 v[104:107], a[240:243], a[128:131], v[104:107]
    s_mov_b32 s38, 0
    buffer_load_dwordx4 v155, s[48:51], s64 offen lds
    v_mfma_f32_16x16x32_bf16 v[104:107], a[244:247], a[140:143], v[104:107]
    s_add_u32 s64, s4, 1280
    ds_read_b64_tr_b16 a[220:221], v4 offset:17504
    v_cvt_pk_bf16_f32 v36, v212, v213
    v_mfma_f32_16x16x32_bf16 v[116:119], a[252:255], a[140:143], v[116:119]
    s_add_u32 m0, s61, 1056
    ds_read_b64_tr_b16 a[222:223], v4 offset:17760
    v_cvt_pk_bf16_f32 v37, v214, v215
    v_mfma_f32_16x16x32_bf16 v[116:119], a[248:251], a[128:131], v[116:119]
    s_mul_i32 s66, s60, 1536
    buffer_load_dwordx4 v155, s[48:51], s64 offen lds
    v_mfma_f32_16x16x32_bf16 v[112:115], a[248:251], a[124:127], v[112:115]
    v_lshl_add_u32 v152, v0, 4, s66
    v_cvt_pk_bf16_f32 v38, v224, v225
    v_mfma_f32_16x16x32_bf16 v[112:115], a[252:255], a[136:139], v[112:115]
    s_add_u32 s66, s66, 1024
    v_cvt_pk_bf16_f32 v39, v226, v227
    v_mul_f32 v216, v216, v9
    v_mfma_f32_16x16x32_bf16 v[108:111], a[252:255], a[132:135], v[108:111]
    s_waitcnt lgkmcnt(0)
    v_lshl_add_u32 v153, v0, 3, s66
    v_mul_f32 v217, v217, v9
    v_mfma_f32_16x16x32_bf16 v[108:111], a[248:251], a[120:123], v[108:111]
    v_lshrrev_b32 v120, 2, v0
    v_mul_f32 v218, v218, v9
    v_mfma_f32_16x16x32_bf16 v[72:75], a[192:195], a[48:51], v[72:75]
    ds_read_b64_tr_b16 a[224:225], v5 offset:16896
    v_and_b32 v123, 3, v0
    v_mfma_f32_16x16x32_bf16 v[72:75], a[196:199], a[60:63], v[72:75]
    ds_read_b64_tr_b16 a[226:227], v5 offset:17152
    v_lshl_add_u32 v11, v123, 4, v120
    v_mfma_f32_16x16x32_bf16 v[76:79], a[196:199], a[64:67], v[76:79]
    ds_read_b64_tr_b16 a[228:229], v5 offset:17408
    v_lshlrev_b32 v11, 2, v11
    v_mfma_f32_16x16x32_bf16 v[76:79], a[192:195], a[52:55], v[76:79]
    ds_read_b64_tr_b16 a[230:231], v5 offset:17664
    v_mul_u32_u24 v120, 2560, v120
    v_mfma_f32_16x16x32_bf16 v[80:83], a[192:195], a[56:59], v[80:83]
    s_add_u32 s64, s4, 81920
    ds_read_b64_tr_b16 a[232:233], v5 offset:16928
    v_lshl_add_u32 v120, v123, 3, v120
    v_mfma_f32_16x16x32_bf16 v[80:83], a[196:199], a[68:71], v[80:83]
    s_add_u32 m0, s61, 67584
    ds_read_b64_tr_b16 a[234:235], v5 offset:17184
    v_mul_f32 v219, v219, v9
    v_mfma_f32_16x16x32_bf16 v[92:95], a[204:207], a[68:71], v[92:95]
    s_mul_i32 s66, s60, 122880
    buffer_load_dwordx4 v155, s[48:51], s64 offen lds
    v_mfma_f32_16x16x32_bf16 v[92:95], a[200:203], a[56:59], v[92:95]
    ds_read_b64_tr_b16 a[236:237], v5 offset:17440
    v_add_u32 v159, s66, v120
    v_mfma_f32_16x16x32_bf16 v[88:91], a[200:203], a[52:55], v[88:91]
    s_lshl_b32 s66, s60, 7
    ds_read_b64_tr_b16 a[238:239], v5 offset:17696
    v_mul_f32 v228, v228, v9
    v_mfma_f32_16x16x32_bf16 v[88:91], a[204:207], a[64:67], v[88:91]
    s_add_u32 s64, s4, 83200
    ds_read_b64_tr_b16 a[240:241], v5 offset:16960
    v_mul_f32 v229, v229, v9
    v_mfma_f32_16x16x32_bf16 v[84:87], a[204:207], a[60:63], v[84:87]
    s_add_u32 m0, s61, 68640
    ds_read_b64_tr_b16 a[242:243], v5 offset:17216
    v_mul_f32 v230, v230, v9
    v_mfma_f32_16x16x32_bf16 v[84:87], a[200:203], a[48:51], v[84:87]
    s_add_u32 s4, s4, s12
    buffer_load_dwordx4 v155, s[48:51], s64 offen lds
    v_mfma_f32_16x16x32_bf16 v[96:99], a[208:211], a[48:51], v[96:99]
    s_lshl_b32 s69, s72, 2
    ds_read_b64_tr_b16 a[244:245], v5 offset:17472
    v_mul_f32 v231, v231, v9
    v_mfma_f32_16x16x32_bf16 v[96:99], a[212:215], a[60:63], v[96:99]
    s_add_u32 s69, s69, s66
    ds_read_b64_tr_b16 a[246:247], v5 offset:17728
    v_cvt_pk_bf16_f32 v52, v216, v217
    v_mfma_f32_16x16x32_bf16 v[100:103], a[212:215], a[64:67], v[100:103]
    ds_read_b64_tr_b16 a[248:249], v5 offset:16992
    v_lshl_add_u32 v1, v0, 9, s69
    v_mfma_f32_16x16x32_bf16 v[100:103], a[208:211], a[52:55], v[100:103]
    s_lshl_b32 s69, s72, 9
    ds_read_b64_tr_b16 a[250:251], v5 offset:17248
    v_cvt_pk_bf16_f32 v53, v218, v219
    v_mfma_f32_16x16x32_bf16 v[104:107], a[208:211], a[56:59], v[104:107]
    s_add_u32 s69, s69, s66
    global_load_dword v132, v3, s[28:29]
    v_mfma_f32_16x16x32_bf16 v[104:107], a[212:215], a[68:71], v[104:107]
    ds_read_b64_tr_b16 a[252:253], v5 offset:17504
    v_and_b32 v120, 7, v0
    v_mfma_f32_16x16x32_bf16 v[116:119], a[220:223], a[68:71], v[116:119]
    ds_read_b64_tr_b16 a[254:255], v5 offset:17760
    v_lshl_add_u32 v2, v120, 2, s69
    v_mfma_f32_16x16x32_bf16 v[116:119], a[216:219], a[56:59], v[116:119]
    v_mov_b32 v10, 0
    v_cvt_pk_bf16_f32 v54, v228, v229
    v_mfma_f32_16x16x32_bf16 v[112:115], a[216:219], a[52:55], v[112:115]
    v_mov_b32 v6, 0
    v_cvt_pk_bf16_f32 v55, v230, v231
    v_mfma_f32_16x16x32_bf16 v[112:115], a[220:223], a[64:67], v[112:115]
    s_mov_b32 s27, 0
    v_mul_f32 v232, v232, v7
    v_mul_f32 v233, v233, v7
    v_mfma_f32_16x16x32_bf16 v[108:111], a[220:223], a[60:63], v[108:111]
    s_waitcnt lgkmcnt(0)
    v_mul_f32 v234, v234, v7
    v_mfma_f32_16x16x32_bf16 v[108:111], a[216:219], a[48:51], v[108:111]
    s_mov_b32 s58, -512
    v_mul_f32 v235, v235, v7
    v_mul_f32 v244, v244, v7
    v_mfma_f32_16x16x32_bf16 v[72:75], a[224:227], a[72:75], v[72:75]
    s_mov_b32 s59, 0xffff0000
    ds_read_b64_tr_b16 a[192:193], v4 offset:25344
    v_mul_f32 v245, v245, v7
    v_mfma_f32_16x16x32_bf16 v[72:75], a[228:231], a[84:87], v[72:75]
    ds_read_b64_tr_b16 a[194:195], v4 offset:25600
    v_mul_f32 v246, v246, v7
    v_mfma_f32_16x16x32_bf16 v[76:79], a[228:231], a[88:91], v[76:79]
    ds_read_b64_tr_b16 a[196:197], v4 offset:25856
    v_mul_f32 v247, v247, v7
    v_mfma_f32_16x16x32_bf16 v[76:79], a[224:227], a[76:79], v[76:79]
    ds_read_b64_tr_b16 a[198:199], v4 offset:26112
    v_cvt_pk_bf16_f32 v24, v232, v233
    v_mfma_f32_16x16x32_bf16 v[80:83], a[224:227], a[80:83], v[80:83]
    s_add_u32 s64, s5, 0
    ds_read_b64_tr_b16 a[200:201], v4 offset:25376
    v_cvt_pk_bf16_f32 v25, v234, v235
    v_mfma_f32_16x16x32_bf16 v[80:83], a[228:231], a[92:95], v[80:83]
    s_add_u32 m0, s61, 8448
    ds_read_b64_tr_b16 a[202:203], v4 offset:25632
    v_cvt_pk_bf16_f32 v26, v244, v245
    v_mfma_f32_16x16x32_bf16 v[92:95], a[236:239], a[92:95], v[92:95]
    buffer_load_dwordx4 v155, s[48:51], s64 offen lds
    v_mfma_f32_16x16x32_bf16 v[92:95], a[232:235], a[80:83], v[92:95]
    ds_read_b64_tr_b16 a[204:205], v4 offset:25888
    v_cvt_pk_bf16_f32 v27, v246, v247
    v_mfma_f32_16x16x32_bf16 v[88:91], a[232:235], a[76:79], v[88:91]
    ds_read_b64_tr_b16 a[206:207], v4 offset:26144
    v_mul_f32 v236, v236, v8
    v_mfma_f32_16x16x32_bf16 v[88:91], a[236:239], a[88:91], v[88:91]
    s_add_u32 s64, s5, 1280
    ds_read_b64_tr_b16 a[208:209], v4 offset:25408
    v_mul_f32 v237, v237, v8
    v_mfma_f32_16x16x32_bf16 v[84:87], a[236:239], a[84:87], v[84:87]
    s_add_u32 m0, s61, 9504
    ds_read_b64_tr_b16 a[210:211], v4 offset:25664
    v_mul_f32 v238, v238, v8
    v_mfma_f32_16x16x32_bf16 v[84:87], a[232:235], a[72:75], v[84:87]
    buffer_load_dwordx4 v155, s[48:51], s64 offen lds
    v_mfma_f32_16x16x32_bf16 v[96:99], a[240:243], a[72:75], v[96:99]
    ds_read_b64_tr_b16 a[212:213], v4 offset:25920
    v_mul_f32 v239, v239, v8
    v_mfma_f32_16x16x32_bf16 v[96:99], a[244:247], a[84:87], v[96:99]
    ds_read_b64_tr_b16 a[214:215], v4 offset:26176
    v_mul_f32 v248, v248, v8
    v_mfma_f32_16x16x32_bf16 v[100:103], a[244:247], a[88:91], v[100:103]
    ds_read_b64_tr_b16 a[216:217], v4 offset:25440
    v_mul_f32 v249, v249, v8
    v_mfma_f32_16x16x32_bf16 v[100:103], a[240:243], a[76:79], v[100:103]
    ds_read_b64_tr_b16 a[218:219], v4 offset:25696
    v_mul_f32 v250, v250, v8
    v_mfma_f32_16x16x32_bf16 v[104:107], a[240:243], a[80:83], v[104:107]
    v_mul_f32 v251, v251, v8
    v_cvt_pk_bf16_f32 v40, v236, v237
    v_mfma_f32_16x16x32_bf16 v[104:107], a[244:247], a[92:95], v[104:107]
    ds_read_b64_tr_b16 a[220:221], v4 offset:25952
    v_cvt_pk_bf16_f32 v41, v238, v239
    v_mfma_f32_16x16x32_bf16 v[116:119], a[252:255], a[92:95], v[116:119]
    ds_read_b64_tr_b16 a[222:223], v4 offset:26208
    v_cvt_pk_bf16_f32 v42, v248, v249
    v_mfma_f32_16x16x32_bf16 v[116:119], a[248:251], a[80:83], v[116:119]
    v_cvt_pk_bf16_f32 v43, v250, v251
    v_mul_f32 v240, v240, v9
    v_mfma_f32_16x16x32_bf16 v[112:115], a[248:251], a[76:79], v[112:115]
    v_mul_f32 v241, v241, v9
    v_mfma_f32_16x16x32_bf16 v[112:115], a[252:255], a[88:91], v[112:115]
    v_mul_f32 v242, v242, v9
    v_mul_f32 v243, v243, v9
    v_mfma_f32_16x16x32_bf16 v[108:111], a[252:255], a[84:87], v[108:111]
    s_waitcnt vmcnt(16) lgkmcnt(0)
    v_mul_f32 v252, v252, v9
    v_mfma_f32_16x16x32_bf16 v[108:111], a[248:251], a[72:75], v[108:111]
    s_barrier
    v_mfma_f32_16x16x32_bf16 v[72:75], a[192:195], v[12:15], v[72:75]
    ds_read_b64_tr_b16 a[224:225], v5 offset:25344
    v_mul_f32 v253, v253, v9
    v_mfma_f32_16x16x32_bf16 v[72:75], a[196:199], v[16:19], v[72:75]
    ds_read_b64_tr_b16 a[226:227], v5 offset:25600
    v_mul_f32 v254, v254, v9
    v_mfma_f32_16x16x32_bf16 v[76:79], a[196:199], v[32:35], v[76:79]
    ds_read_b64_tr_b16 a[228:229], v5 offset:25856
    v_mul_f32 v255, v255, v9
    v_mfma_f32_16x16x32_bf16 v[76:79], a[192:195], v[28:31], v[76:79]
    ds_read_b64_tr_b16 a[230:231], v5 offset:26112
    v_cvt_pk_bf16_f32 v56, v240, v241
    v_mfma_f32_16x16x32_bf16 v[80:83], a[192:195], v[44:47], v[80:83]
    s_add_u32 s64, s5, 81920
    ds_read_b64_tr_b16 a[232:233], v5 offset:25376
    v_cvt_pk_bf16_f32 v57, v242, v243
    v_mfma_f32_16x16x32_bf16 v[80:83], a[196:199], v[48:51], v[80:83]
    s_add_u32 m0, s61, 76032
    ds_read_b64_tr_b16 a[234:235], v5 offset:25632
    v_cvt_pk_bf16_f32 v58, v252, v253
    v_mfma_f32_16x16x32_bf16 v[92:95], a[204:207], v[48:51], v[92:95]
    buffer_load_dwordx4 v155, s[48:51], s64 offen lds
    v_mfma_f32_16x16x32_bf16 v[92:95], a[200:203], v[44:47], v[92:95]
    ds_read_b64_tr_b16 a[236:237], v5 offset:25888
    v_cvt_pk_bf16_f32 v59, v254, v255
    v_mfma_f32_16x16x32_bf16 v[88:91], a[200:203], v[28:31], v[88:91]
    ds_read_b64_tr_b16 a[238:239], v5 offset:26144
    v_mfma_f32_16x16x32_bf16 v[88:91], a[204:207], v[32:35], v[88:91]
    s_add_u32 s64, s5, 83200
    ds_read_b64_tr_b16 a[240:241], v5 offset:25408
    v_mfma_f32_16x16x32_bf16 v[84:87], a[204:207], v[16:19], v[84:87]
    s_add_u32 m0, s61, 77088
    ds_read_b64_tr_b16 a[242:243], v5 offset:25664
    v_mfma_f32_16x16x32_bf16 v[84:87], a[200:203], v[12:15], v[84:87]
    s_add_u32 s5, s5, s12
    buffer_load_dwordx4 v155, s[48:51], s64 offen lds
    v_mfma_f32_16x16x32_bf16 v[96:99], a[208:211], v[12:15], v[96:99]
    ds_read_b64_tr_b16 a[244:245], v5 offset:25920
    v_mfma_f32_16x16x32_bf16 v[96:99], a[212:215], v[16:19], v[96:99]
    ds_read_b64_tr_b16 a[246:247], v5 offset:26176
    v_mfma_f32_16x16x32_bf16 v[100:103], a[212:215], v[32:35], v[100:103]
    ds_read_b64_tr_b16 a[248:249], v5 offset:25440
    v_mfma_f32_16x16x32_bf16 v[100:103], a[208:211], v[28:31], v[100:103]
    ds_read_b64_tr_b16 a[250:251], v5 offset:25696
    v_mfma_f32_16x16x32_bf16 v[104:107], a[208:211], v[44:47], v[104:107]
    v_mfma_f32_16x16x32_bf16 v[104:107], a[212:215], v[48:51], v[104:107]
    ds_read_b64_tr_b16 a[252:253], v5 offset:25952
    v_mfma_f32_16x16x32_bf16 v[116:119], a[220:223], v[48:51], v[116:119]
    ds_read_b64_tr_b16 a[254:255], v5 offset:26208
    v_mfma_f32_16x16x32_bf16 v[116:119], a[216:219], v[44:47], v[116:119]
    v_mfma_f32_16x16x32_bf16 v[112:115], a[216:219], v[28:31], v[112:115]
    v_mfma_f32_16x16x32_bf16 v[112:115], a[220:223], v[32:35], v[112:115]
    v_mfma_f32_16x16x32_bf16 v[108:111], a[220:223], v[16:19], v[108:111]
    s_waitcnt lgkmcnt(0)
    v_mfma_f32_16x16x32_bf16 v[108:111], a[216:219], v[12:15], v[108:111]
    v_mfma_f32_16x16x32_bf16 v[72:75], a[224:227], v[20:23], v[72:75]
    ds_read_b64_tr_b16 a[192:193], v4 offset:33792
    v_and_b32 v134, 1, v0
    v_mfma_f32_16x16x32_bf16 v[72:75], a[228:231], v[24:27], v[72:75]
    ds_read_b64_tr_b16 a[194:195], v4 offset:34048
    v_lshlrev_b32 v134, 4, v134
    v_mfma_f32_16x16x32_bf16 v[76:79], a[228:231], v[40:43], v[76:79]
    ds_read_b64_tr_b16 a[196:197], v4 offset:34304
    v_mov_b32 v135, 0x3f80
    v_mfma_f32_16x16x32_bf16 v[76:79], a[224:227], v[36:39], v[76:79]
    ds_read_b64_tr_b16 a[198:199], v4 offset:34560
    v_lshlrev_b32 v134, v134, v135
    v_mfma_f32_16x16x32_bf16 v[80:83], a[224:227], v[52:55], v[80:83]
    s_add_u32 s64, s6, 0
    ds_read_b64_tr_b16 a[200:201], v4 offset:33824
    v_bfe_u32 v135, v0, 1, 3
    v_mfma_f32_16x16x32_bf16 v[80:83], a[228:231], v[56:59], v[80:83]
    s_add_u32 m0, s61, 16896
    ds_read_b64_tr_b16 a[202:203], v4 offset:34080
    v_lshrrev_b32 v136, 4, v0
    v_mfma_f32_16x16x32_bf16 v[92:95], a[236:239], v[56:59], v[92:95]
    buffer_load_dwordx4 v155, s[48:51], s64 offen lds
    v_mfma_f32_16x16x32_bf16 v[92:95], a[232:235], v[52:55], v[92:95]
    ds_read_b64_tr_b16 a[204:205], v4 offset:34336
    v_lshlrev_b32 v136, 1, v136
    v_mfma_f32_16x16x32_bf16 v[88:91], a[232:235], v[36:39], v[88:91]
    ds_read_b64_tr_b16 a[206:207], v4 offset:34592
    v_xor_b32 v135, v135, v136
    v_mfma_f32_16x16x32_bf16 v[88:91], a[236:239], v[40:43], v[88:91]
    s_add_u32 s64, s6, 1280
    ds_read_b64_tr_b16 a[208:209], v4 offset:33856
    v_cmp_eq_u32 vcc, 0, v135
    v_mfma_f32_16x16x32_bf16 v[84:87], a[236:239], v[24:27], v[84:87]
    s_add_u32 m0, s61, 17952
    ds_read_b64_tr_b16 a[210:211], v4 offset:34112
    v_mov_b32 v142, 0
    v_mfma_f32_16x16x32_bf16 v[84:87], a[232:235], v[20:23], v[84:87]
    buffer_load_dwordx4 v155, s[48:51], s64 offen lds
    v_mfma_f32_16x16x32_bf16 v[96:99], a[240:243], v[20:23], v[96:99]
    ds_read_b64_tr_b16 a[212:213], v4 offset:34368
    v_cndmask_b32 v136, 0, v134, vcc
    v_mfma_f32_16x16x32_bf16 v[96:99], a[244:247], v[24:27], v[96:99]
    ds_read_b64_tr_b16 a[214:215], v4 offset:34624
    v_cmp_eq_u32 vcc, 1, v135
    v_mfma_f32_16x16x32_bf16 v[100:103], a[244:247], v[40:43], v[100:103]
    ds_read_b64_tr_b16 a[216:217], v4 offset:33888
    v_mov_b32 v143, 0
    v_mfma_f32_16x16x32_bf16 v[100:103], a[240:243], v[36:39], v[100:103]
    ds_read_b64_tr_b16 a[218:219], v4 offset:34144
    v_cndmask_b32 v137, 0, v134, vcc
    v_mfma_f32_16x16x32_bf16 v[104:107], a[240:243], v[52:55], v[104:107]
    global_load_dword v133, v157, s[28:29]
    v_mfma_f32_16x16x32_bf16 v[104:107], a[244:247], v[56:59], v[104:107]
    ds_read_b64_tr_b16 a[220:221], v4 offset:34400
    v_accvgpr_write_b32 a0, v136
    v_mfma_f32_16x16x32_bf16 v[116:119], a[252:255], v[56:59], v[116:119]
    ds_read_b64_tr_b16 a[222:223], v4 offset:34656
    v_accvgpr_write_b32 a2, v136
    v_mfma_f32_16x16x32_bf16 v[116:119], a[248:251], v[52:55], v[116:119]
    v_readfirstlane_b32 s66, v122
    v_accvgpr_write_b32 a1, v137
    v_mfma_f32_16x16x32_bf16 v[112:115], a[248:251], v[36:39], v[112:115]
    v_accvgpr_write_b32 a3, v137
    v_mov_b32 v148, 0
    v_mfma_f32_16x16x32_bf16 v[112:115], a[252:255], v[40:43], v[112:115]
    s_cmp_lg_u32 s66, 0
    v_mov_b32 v149, 0
    v_mfma_f32_16x16x32_bf16 v[108:111], a[252:255], v[24:27], v[108:111]
    s_waitcnt lgkmcnt(0)
    v_mfma_f32_16x16x32_bf16 v[108:111], a[248:251], v[20:23], v[108:111]
    s_cbranch_scc1 L_gx
    v_add_u32 v152, 1720320, v152
    v_add_u32 v153, 1720320, v153
    s_branch L_gmid1
.p2align 6
L_gl_fast:
    v_mfma_f32_16x16x32_bf16 v[72:75], a[192:195], a[144:147], 0
    ds_read_b64_tr_b16 a[224:225], v5 offset:0
    v_mfma_f32_16x16x32_bf16 v[72:75], a[196:199], a[156:159], v[72:75]
    ds_read_b64_tr_b16 a[226:227], v5 offset:256
    v_cvt_pk_bf16_f32 v160, v208, v209
    v_mfma_f32_16x16x32_bf16 v[76:79], a[196:199], a[160:163], 0
    ds_read_b64_tr_b16 a[228:229], v5 offset:512
    v_cvt_pk_bf16_f32 v161, v210, v211
    v_mfma_f32_16x16x32_bf16 v[76:79], a[192:195], a[148:151], v[76:79]
    ds_read_b64_tr_b16 a[230:231], v5 offset:768
    v_cvt_pk_bf16_f32 v162, v212, v213
    v_mfma_f32_16x16x32_bf16 v[80:83], a[192:195], a[152:155], 0
    s_add_u32 s64, s6, 81920
    ds_read_b64_tr_b16 a[232:233], v5 offset:32
    v_cvt_pk_bf16_f32 v163, v214, v215
    v_mfma_f32_16x16x32_bf16 v[80:83], a[196:199], a[164:167], v[80:83]
    s_add_u32 m0, s61, 118272
    ds_read_b64_tr_b16 a[234:235], v5 offset:288
    v_cvt_pk_bf16_f32 v164, v216, v217
    v_mfma_f32_16x16x32_bf16 v[92:95], a[204:207], a[164:167], 0
    buffer_load_dwordx4 v155, s[48:51], s64 offen lds
    v_mfma_f32_16x16x32_bf16 v[92:95], a[200:203], a[152:155], v[92:95]
    ds_read_b64_tr_b16 a[236:237], v5 offset:544
    v_cvt_pk_bf16_f32 v165, v218, v219
    v_mfma_f32_16x16x32_bf16 v[88:91], a[200:203], a[148:151], 0
    ds_read_b64_tr_b16 a[238:239], v5 offset:800
    v_cvt_pk_bf16_f32 v166, v220, v221
    v_mfma_f32_16x16x32_bf16 v[88:91], a[204:207], a[160:163], v[88:91]
    s_add_u32 s64, s6, 83200
    ds_read_b64_tr_b16 a[240:241], v5 offset:64
    v_cvt_pk_bf16_f32 v167, v222, v223
    v_mfma_f32_16x16x32_bf16 v[84:87], a[204:207], a[156:159], 0
    s_add_u32 m0, s61, 119328
    ds_read_b64_tr_b16 a[242:243], v5 offset:320
    v_cvt_pk_bf16_f32 v168, v224, v225
    v_mfma_f32_16x16x32_bf16 v[84:87], a[200:203], a[144:147], v[84:87]
    s_add_u32 s6, s6, s13
    buffer_load_dwordx4 v155, s[48:51], s64 offen lds
    v_mfma_f32_16x16x32_bf16 v[96:99], a[208:211], a[144:147], 0
    ds_read_b64_tr_b16 a[244:245], v5 offset:576
    v_cvt_pk_bf16_f32 v169, v226, v227
    v_mfma_f32_16x16x32_bf16 v[96:99], a[212:215], a[156:159], v[96:99]
    ds_read_b64_tr_b16 a[246:247], v5 offset:832
    v_cvt_pk_bf16_f32 v170, v228, v229
    v_mfma_f32_16x16x32_bf16 v[100:103], a[212:215], a[160:163], 0
    ds_read_b64_tr_b16 a[248:249], v5 offset:96
    v_cvt_pk_bf16_f32 v171, v230, v231
    v_mfma_f32_16x16x32_bf16 v[100:103], a[208:211], a[148:151], v[100:103]
    ds_read_b64_tr_b16 a[250:251], v5 offset:352
    v_cvt_pk_bf16_f32 v172, v232, v233
    v_mfma_f32_16x16x32_bf16 v[104:107], a[208:211], a[152:155], 0
    v_cvt_pk_bf16_f32 v173, v234, v235
    v_cvt_pk_bf16_f32 v174, v236, v237
    v_mfma_f32_16x16x32_bf16 v[104:107], a[212:215], a[164:167], v[104:107]
    ds_read_b64_tr_b16 a[252:253], v5 offset:608
    v_cvt_pk_bf16_f32 v175, v238, v239
    v_mfma_f32_16x16x32_bf16 v[116:119], a[220:223], a[164:167], 0
    ds_read_b64_tr_b16 a[254:255], v5 offset:864
    v_cvt_pk_bf16_f32 v176, v240, v241
    v_mfma_f32_16x16x32_bf16 v[116:119], a[216:219], a[152:155], v[116:119]
    v_cvt_pk_bf16_f32 v177, v242, v243
    v_mfma_f32_16x16x32_bf16 v[112:115], a[216:219], a[148:151], 0
    v_mfma_f32_16x16x32_bf16 v[112:115], a[220:223], a[160:163], v[112:115]
    v_mfma_f32_16x16x32_bf16 v[108:111], a[220:223], a[156:159], 0
    s_waitcnt lgkmcnt(0)
    v_mfma_f32_16x16x32_bf16 v[108:111], a[216:219], a[144:147], v[108:111]
    v_mfma_f32_16x16x32_bf16 v[72:75], a[224:227], a[168:171], v[72:75]
    ds_read_b64_tr_b16 a[192:193], v4 offset:8448
    v_mfma_f32_16x16x32_bf16 v[72:75], a[228:231], a[180:183], v[72:75]
    ds_read_b64_tr_b16 a[194:195], v4 offset:8704
    v_mfma_f32_16x16x32_bf16 v[76:79], a[228:231], a[184:187], v[76:79]
    ds_read_b64_tr_b16 a[196:197], v4 offset:8960
    v_mfma_f32_16x16x32_bf16 v[76:79], a[224:227], a[172:175], v[76:79]
    ds_read_b64_tr_b16 a[198:199], v4 offset:9216
    v_mfma_f32_16x16x32_bf16 v[80:83], a[224:227], a[176:179], v[80:83]
    s_add_u32 s64, s7, 0
    ds_read_b64_tr_b16 a[200:201], v4 offset:8480
    v_mfma_f32_16x16x32_bf16 v[80:83], a[228:231], a[188:191], v[80:83]
    s_add_u32 m0, s61, 59136
    ds_read_b64_tr_b16 a[202:203], v4 offset:8736
    v_mfma_f32_16x16x32_bf16 v[92:95], a[236:239], a[188:191], v[92:95]
    buffer_load_dwordx4 v155, s[48:51], s64 offen lds
    v_mfma_f32_16x16x32_bf16 v[92:95], a[232:235], a[176:179], v[92:95]
    ds_read_b64_tr_b16 a[204:205], v4 offset:8992
    v_mfma_f32_16x16x32_bf16 v[88:91], a[232:235], a[172:175], v[88:91]
    ds_read_b64_tr_b16 a[206:207], v4 offset:9248
    v_mfma_f32_16x16x32_bf16 v[88:91], a[236:239], a[184:187], v[88:91]
    s_add_u32 s64, s7, 1280
    ds_read_b64_tr_b16 a[208:209], v4 offset:8512
    v_mfma_f32_16x16x32_bf16 v[84:87], a[236:239], a[180:183], v[84:87]
    s_add_u32 m0, s61, 60192
    ds_read_b64_tr_b16 a[210:211], v4 offset:8768
    v_mfma_f32_16x16x32_bf16 v[84:87], a[232:235], a[168:171], v[84:87]
    buffer_load_dwordx4 v155, s[48:51], s64 offen lds
    v_mfma_f32_16x16x32_bf16 v[96:99], a[240:243], a[168:171], v[96:99]
    ds_read_b64_tr_b16 a[212:213], v4 offset:9024
    v_mfma_f32_16x16x32_bf16 v[96:99], a[244:247], a[180:183], v[96:99]
    ds_read_b64_tr_b16 a[214:215], v4 offset:9280
    v_mfma_f32_16x16x32_bf16 v[100:103], a[244:247], a[184:187], v[100:103]
    ds_read_b64_tr_b16 a[216:217], v4 offset:8544
    v_mfma_f32_16x16x32_bf16 v[100:103], a[240:243], a[172:175], v[100:103]
    ds_read_b64_tr_b16 a[218:219], v4 offset:8800
    v_mfma_f32_16x16x32_bf16 v[104:107], a[240:243], a[176:179], v[104:107]
    s_waitcnt vmcnt(6)
    v_cmp_gt_u32 vcc, v10, v6
    v_mfma_f32_16x16x32_bf16 v[104:107], a[244:247], a[188:191], v[104:107]
    ds_read_b64_tr_b16 a[220:221], v4 offset:9056
    v_mfma_f32_16x16x32_bf16 v[116:119], a[252:255], a[188:191], v[116:119]
    ds_read_b64_tr_b16 a[222:223], v4 offset:9312
    v_mfma_f32_16x16x32_bf16 v[116:119], a[248:251], a[176:179], v[116:119]
    v_mfma_f32_16x16x32_bf16 v[112:115], a[248:251], a[172:175], v[112:115]
    s_cbranch_vccnz L_sp_76
L_ok_77:
    v_mfma_f32_16x16x32_bf16 v[112:115], a[252:255], a[184:187], v[112:115]
    v_mfma_f32_16x16x32_bf16 v[108:111], a[252:255], a[180:183], v[108:111]
    s_waitcnt vmcnt(16) lgkmcnt(0)
    v_mfma_f32_16x16x32_bf16 v[108:111], a[248:251], a[168:171], v[108:111]
    s_barrier
    v_mfma_f32_16x16x32_bf16 v[72:75], a[192:195], a[96:99], v[72:75]
    ds_read_b64_tr_b16 a[224:225], v5 offset:8448
    v_mfma_f32_16x16x32_bf16 v[72:75], a[196:199], a[108:111], v[72:75]
    ds_read_b64_tr_b16 a[226:227], v5 offset:8704
    v_mfma_f32_16x16x32_bf16 v[76:79], a[196:199], a[112:115], v[76:79]
    ds_read_b64_tr_b16 a[228:229], v5 offset:8960
    v_mfma_f32_16x16x32_bf16 v[76:79], a[192:195], a[100:103], v[76:79]
    ds_read_b64_tr_b16 a[230:231], v5 offset:9216
    v_mfma_f32_16x16x32_bf16 v[80:83], a[192:195], a[104:107], v[80:83]
    ds_read_b64_tr_b16 a[232:233], v5 offset:8480
    v_mfma_f32_16x16x32_bf16 v[80:83], a[196:199], a[116:119], v[80:83]
    ds_read_b64_tr_b16 a[234:235], v5 offset:8736
    v_mfma_f32_16x16x32_bf16 v[92:95], a[204:207], a[116:119], v[92:95]
    buffer_store_dwordx4 v[160:163], v152, s[52:55], s44 offen
    v_mfma_f32_16x16x32_bf16 v[92:95], a[200:203], a[104:107], v[92:95]
    ds_read_b64_tr_b16 a[236:237], v5 offset:8992
    v_mfma_f32_16x16x32_bf16 v[88:91], a[200:203], a[100:103], v[88:91]
    ds_read_b64_tr_b16 a[238:239], v5 offset:9248
    v_mfma_f32_16x16x32_bf16 v[88:91], a[204:207], a[112:115], v[88:91]
    ds_read_b64_tr_b16 a[240:241], v5 offset:8512
    v_mfma_f32_16x16x32_bf16 v[84:87], a[204:207], a[108:111], v[84:87]
    ds_read_b64_tr_b16 a[242:243], v5 offset:8768
    v_mfma_f32_16x16x32_bf16 v[84:87], a[200:203], a[96:99], v[84:87]
    s_mov_b32 s65, 0
    buffer_load_dwordx4 v[186:189], v152, s[32:35], s65 offen sc1
    v_mfma_f32_16x16x32_bf16 v[96:99], a[208:211], a[96:99], v[96:99]
    ds_read_b64_tr_b16 a[244:245], v5 offset:9024
    v_mfma_f32_16x16x32_bf16 v[96:99], a[212:215], a[108:111], v[96:99]
    ds_read_b64_tr_b16 a[246:247], v5 offset:9280
    v_mfma_f32_16x16x32_bf16 v[100:103], a[212:215], a[112:115], v[100:103]
    ds_read_b64_tr_b16 a[248:249], v5 offset:8544
    v_mfma_f32_16x16x32_bf16 v[100:103], a[208:211], a[100:103], v[100:103]
    ds_read_b64_tr_b16 a[250:251], v5 offset:8800
    v_mfma_f32_16x16x32_bf16 v[104:107], a[208:211], a[104:107], v[104:107]
    buffer_store_dwordx2 v[164:165], v153, s[52:55], s44 offen
    v_mfma_f32_16x16x32_bf16 v[104:107], a[212:215], a[116:119], v[104:107]
    ds_read_b64_tr_b16 a[252:253], v5 offset:9056
    v_mfma_f32_16x16x32_bf16 v[116:119], a[220:223], a[116:119], v[116:119]
    ds_read_b64_tr_b16 a[254:255], v5 offset:9312
    v_mfma_f32_16x16x32_bf16 v[116:119], a[216:219], a[104:107], v[116:119]
    buffer_load_dwordx2 v[194:195], v153, s[32:35], s65 offen sc1
    v_mfma_f32_16x16x32_bf16 v[112:115], a[216:219], a[100:103], v[112:115]
    s_mov_b32 s65, 6144
    buffer_load_dwordx4 v[190:193], v152, s[32:35], s65 offen sc1
    v_mfma_f32_16x16x32_bf16 v[112:115], a[220:223], a[112:115], v[112:115]
    buffer_store_dwordx4 v[168:171], v152, s[52:55], s45 offen
    v_mfma_f32_16x16x32_bf16 v[108:111], a[220:223], a[108:111], v[108:111]
    s_waitcnt lgkmcnt(0)
    buffer_load_dwordx2 v[184:185], v153, s[32:35], s65 offen sc1
    v_mfma_f32_16x16x32_bf16 v[108:111], a[216:219], a[96:99], v[108:111]
    ds_bpermute_b32 v124, v11, v124
    v_mfma_f32_16x16x32_bf16 v[72:75], a[224:227], a[120:123], v[72:75]
    ds_read_b64_tr_b16 a[192:193], v4 offset:16896
    v_mfma_f32_16x16x32_bf16 v[72:75], a[228:231], a[132:135], v[72:75]
    ds_read_b64_tr_b16 a[194:195], v4 offset:17152
    v_mfma_f32_16x16x32_bf16 v[76:79], a[228:231], a[136:139], v[76:79]
    ds_read_b64_tr_b16 a[196:197], v4 offset:17408
    v_mfma_f32_16x16x32_bf16 v[76:79], a[224:227], a[124:127], v[76:79]
    ds_read_b64_tr_b16 a[198:199], v4 offset:17664
    v_mfma_f32_16x16x32_bf16 v[80:83], a[224:227], a[128:131], v[80:83]
    ds_read_b64_tr_b16 a[200:201], v4 offset:16928
    v_mfma_f32_16x16x32_bf16 v[80:83], a[228:231], a[140:143], v[80:83]
    ds_read_b64_tr_b16 a[202:203], v4 offset:17184
    v_mfma_f32_16x16x32_bf16 v[92:95], a[236:239], a[140:143], v[92:95]
    buffer_store_dwordx2 v[166:167], v153, s[52:55], s45 offen
    v_mfma_f32_16x16x32_bf16 v[92:95], a[232:235], a[128:131], v[92:95]
    ds_read_b64_tr_b16 a[204:205], v4 offset:17440
    v_mfma_f32_16x16x32_bf16 v[88:91], a[232:235], a[124:127], v[88:91]
    ds_read_b64_tr_b16 a[206:207], v4 offset:17696
    v_mfma_f32_16x16x32_bf16 v[88:91], a[236:239], a[136:139], v[88:91]
    ds_read_b64_tr_b16 a[208:209], v4 offset:16960
    v_mfma_f32_16x16x32_bf16 v[84:87], a[236:239], a[132:135], v[84:87]
    ds_read_b64_tr_b16 a[210:211], v4 offset:17216
    v_mfma_f32_16x16x32_bf16 v[84:87], a[232:235], a[120:123], v[84:87]
    s_mov_b32 s65, 12288
    buffer_load_dwordx4 v[198:201], v152, s[32:35], s65 offen sc1
    v_mfma_f32_16x16x32_bf16 v[96:99], a[240:243], a[120:123], v[96:99]
    ds_read_b64_tr_b16 a[212:213], v4 offset:17472
    v_mfma_f32_16x16x32_bf16 v[96:99], a[244:247], a[132:135], v[96:99]
    ds_read_b64_tr_b16 a[214:215], v4 offset:17728
    v_mfma_f32_16x16x32_bf16 v[100:103], a[244:247], a[136:139], v[100:103]
    ds_read_b64_tr_b16 a[216:217], v4 offset:16992
    v_mfma_f32_16x16x32_bf16 v[100:103], a[240:243], a[124:127], v[100:103]
    ds_read_b64_tr_b16 a[218:219], v4 offset:17248
    v_mfma_f32_16x16x32_bf16 v[104:107], a[240:243], a[128:131], v[104:107]
    buffer_store_dwordx4 v[172:175], v152, s[52:55], s46 offen
    v_mfma_f32_16x16x32_bf16 v[104:107], a[244:247], a[140:143], v[104:107]
    ds_read_b64_tr_b16 a[220:221], v4 offset:17504
    v_mfma_f32_16x16x32_bf16 v[116:119], a[252:255], a[140:143], v[116:119]
    ds_read_b64_tr_b16 a[222:223], v4 offset:17760
    v_mfma_f32_16x16x32_bf16 v[116:119], a[248:251], a[128:131], v[116:119]
    buffer_load_dwordx2 v[206:207], v153, s[32:35], s65 offen sc1
    v_mfma_f32_16x16x32_bf16 v[112:115], a[248:251], a[124:127], v[112:115]
    s_mov_b32 s65, 18432
    buffer_load_dwordx4 v[202:205], v152, s[32:35], s65 offen sc1
    v_mfma_f32_16x16x32_bf16 v[112:115], a[252:255], a[136:139], v[112:115]
    buffer_store_dwordx2 v[176:177], v153, s[52:55], s46 offen
    v_mfma_f32_16x16x32_bf16 v[108:111], a[252:255], a[132:135], v[108:111]
    s_waitcnt lgkmcnt(0)
    buffer_load_dwordx2 v[196:197], v153, s[32:35], s65 offen sc1
    v_mfma_f32_16x16x32_bf16 v[108:111], a[248:251], a[120:123], v[108:111]
    ds_bpermute_b32 v125, v11, v125
    v_mfma_f32_16x16x32_bf16 v[72:75], a[192:195], a[48:51], v[72:75]
    ds_read_b64_tr_b16 a[224:225], v5 offset:16896
    v_mfma_f32_16x16x32_bf16 v[72:75], a[196:199], a[60:63], v[72:75]
    ds_read_b64_tr_b16 a[226:227], v5 offset:17152
    v_mfma_f32_16x16x32_bf16 v[76:79], a[196:199], a[64:67], v[76:79]
    ds_read_b64_tr_b16 a[228:229], v5 offset:17408
    v_mfma_f32_16x16x32_bf16 v[76:79], a[192:195], a[52:55], v[76:79]
    ds_read_b64_tr_b16 a[230:231], v5 offset:17664
    v_mfma_f32_16x16x32_bf16 v[80:83], a[192:195], a[56:59], v[80:83]
    s_add_u32 s64, s7, 81920
    ds_read_b64_tr_b16 a[232:233], v5 offset:16928
    v_mfma_f32_16x16x32_bf16 v[80:83], a[196:199], a[68:71], v[80:83]
    s_add_u32 m0, s61, 126720
    ds_read_b64_tr_b16 a[234:235], v5 offset:17184
    v_mfma_f32_16x16x32_bf16 v[92:95], a[204:207], a[68:71], v[92:95]
    buffer_load_dwordx4 v155, s[48:51], s64 offen lds
    v_mfma_f32_16x16x32_bf16 v[92:95], a[200:203], a[56:59], v[92:95]
    ds_read_b64_tr_b16 a[236:237], v5 offset:17440
    v_mfma_f32_16x16x32_bf16 v[88:91], a[200:203], a[52:55], v[88:91]
    ds_read_b64_tr_b16 a[238:239], v5 offset:17696
    v_mfma_f32_16x16x32_bf16 v[88:91], a[204:207], a[64:67], v[88:91]
    s_add_u32 s64, s7, 83200
    ds_read_b64_tr_b16 a[240:241], v5 offset:16960
    v_mfma_f32_16x16x32_bf16 v[84:87], a[204:207], a[60:63], v[84:87]
    s_add_u32 m0, s61, 127776
    ds_read_b64_tr_b16 a[242:243], v5 offset:17216
    v_mfma_f32_16x16x32_bf16 v[84:87], a[200:203], a[48:51], v[84:87]
    s_add_u32 s7, s7, s13
    buffer_load_dwordx4 v155, s[48:51], s64 offen lds
    v_mfma_f32_16x16x32_bf16 v[96:99], a[208:211], a[48:51], v[96:99]
    s_cmp_eq_u32 s27, 4
    ds_read_b64_tr_b16 a[244:245], v5 offset:17472
    v_mfma_f32_16x16x32_bf16 v[96:99], a[212:215], a[60:63], v[96:99]
    s_cselect_b32 s50, 0, s50
    ds_read_b64_tr_b16 a[246:247], v5 offset:17728
    v_mfma_f32_16x16x32_bf16 v[100:103], a[212:215], a[64:67], v[100:103]
    s_add_u32 s64, s4, 0
    ds_read_b64_tr_b16 a[248:249], v5 offset:16992
    v_mfma_f32_16x16x32_bf16 v[100:103], a[208:211], a[52:55], v[100:103]
    s_add_u32 m0, s61, 0
    ds_read_b64_tr_b16 a[250:251], v5 offset:17248
    v_mfma_f32_16x16x32_bf16 v[104:107], a[208:211], a[56:59], v[104:107]
    buffer_load_dwordx4 v155, s[48:51], s64 offen lds
    v_mfma_f32_16x16x32_bf16 v[104:107], a[212:215], a[68:71], v[104:107]
    s_add_u32 s64, s4, 1280
    ds_read_b64_tr_b16 a[252:253], v5 offset:17504
    v_mfma_f32_16x16x32_bf16 v[116:119], a[220:223], a[68:71], v[116:119]
    s_add_u32 m0, s61, 1056
    ds_read_b64_tr_b16 a[254:255], v5 offset:17760
    v_mfma_f32_16x16x32_bf16 v[116:119], a[216:219], a[56:59], v[116:119]
    buffer_load_dwordx4 v155, s[48:51], s64 offen lds
    v_mfma_f32_16x16x32_bf16 v[112:115], a[216:219], a[52:55], v[112:115]
    v_mfma_f32_16x16x32_bf16 v[112:115], a[220:223], a[64:67], v[112:115]
    v_mfma_f32_16x16x32_bf16 v[108:111], a[220:223], a[60:63], v[108:111]
    s_waitcnt lgkmcnt(0)
    ds_bpermute_b32 v126, v11, v126
    v_mfma_f32_16x16x32_bf16 v[108:111], a[216:219], a[48:51], v[108:111]
    ds_bpermute_b32 v127, v11, v127
    v_mfma_f32_16x16x32_bf16 v[72:75], a[224:227], a[72:75], v[72:75]
    ds_read_b64_tr_b16 a[192:193], v4 offset:25344
    v_mfma_f32_16x16x32_bf16 v[72:75], a[228:231], a[84:87], v[72:75]
    ds_read_b64_tr_b16 a[194:195], v4 offset:25600
    v_mfma_f32_16x16x32_bf16 v[76:79], a[228:231], a[88:91], v[76:79]
    s_waitcnt vmcnt(4)
    ds_read_b64_tr_b16 a[196:197], v4 offset:25856
    v_mfma_f32_16x16x32_bf16 v[76:79], a[224:227], a[76:79], v[76:79]
    ds_read_b64_tr_b16 a[198:199], v4 offset:26112
    v_mfma_f32_16x16x32_bf16 v[80:83], a[224:227], a[80:83], v[80:83]
    ds_read_b64_tr_b16 a[200:201], v4 offset:25376
    v_add_u32 v10, 1, v10
    v_mfma_f32_16x16x32_bf16 v[80:83], a[228:231], a[92:95], v[80:83]
    ds_read_b64_tr_b16 a[202:203], v4 offset:25632
    v_mfma_f32_16x16x32_bf16 v[92:95], a[236:239], a[92:95], v[92:95]
    buffer_store_dword v10, v1, s[8:11], 0 offen
    v_mfma_f32_16x16x32_bf16 v[92:95], a[232:235], a[80:83], v[92:95]
    ds_read_b64_tr_b16 a[204:205], v4 offset:25888
    v_mfma_f32_16x16x32_bf16 v[88:91], a[232:235], a[76:79], v[88:91]
    ds_read_b64_tr_b16 a[206:207], v4 offset:26144
    v_mfma_f32_16x16x32_bf16 v[88:91], a[236:239], a[88:91], v[88:91]
    s_add_u32 s64, s4, 81920
    ds_read_b64_tr_b16 a[208:209], v4 offset:25408
    v_mfma_f32_16x16x32_bf16 v[84:87], a[236:239], a[84:87], v[84:87]
    s_add_u32 m0, s61, 67584
    ds_read_b64_tr_b16 a[210:211], v4 offset:25664
    v_mfma_f32_16x16x32_bf16 v[84:87], a[232:235], a[72:75], v[84:87]
    buffer_load_dwordx4 v155, s[48:51], s64 offen lds
    v_mfma_f32_16x16x32_bf16 v[96:99], a[240:243], a[72:75], v[96:99]
    ds_read_b64_tr_b16 a[212:213], v4 offset:25920
    v_mfma_f32_16x16x32_bf16 v[96:99], a[244:247], a[84:87], v[96:99]
    ds_read_b64_tr_b16 a[214:215], v4 offset:26176
    v_mfma_f32_16x16x32_bf16 v[100:103], a[244:247], a[88:91], v[100:103]
    s_add_u32 s64, s4, 83200
    ds_read_b64_tr_b16 a[216:217], v4 offset:25440
    v_mfma_f32_16x16x32_bf16 v[100:103], a[240:243], a[76:79], v[100:103]
    s_add_u32 m0, s61, 68640
    ds_read_b64_tr_b16 a[218:219], v4 offset:25696
    v_mfma_f32_16x16x32_bf16 v[104:107], a[240:243], a[80:83], v[104:107]
    s_add_u32 s4, s4, s12
    buffer_load_dwordx4 v155, s[48:51], s64 offen lds
    v_mfma_f32_16x16x32_bf16 v[104:107], a[244:247], a[92:95], v[104:107]
    s_add_u32 s64, s5, 0
    ds_read_b64_tr_b16 a[220:221], v4 offset:25952
    v_mfma_f32_16x16x32_bf16 v[116:119], a[252:255], a[92:95], v[116:119]
    s_add_u32 m0, s61, 8448
    ds_read_b64_tr_b16 a[222:223], v4 offset:26208
    v_mfma_f32_16x16x32_bf16 v[116:119], a[248:251], a[80:83], v[116:119]
    buffer_load_dwordx4 v155, s[48:51], s64 offen lds
    v_mfma_f32_16x16x32_bf16 v[112:115], a[248:251], a[76:79], v[112:115]
    s_add_u32 s64, s5, 1280
    v_mfma_f32_16x16x32_bf16 v[112:115], a[252:255], a[88:91], v[112:115]
    s_add_u32 m0, s61, 9504
    v_mfma_f32_16x16x32_bf16 v[108:111], a[252:255], a[84:87], v[108:111]
    s_waitcnt vmcnt(30) lgkmcnt(0)
    buffer_load_dwordx4 v155, s[48:51], s64 offen lds
    v_mfma_f32_16x16x32_bf16 v[108:111], a[248:251], a[72:75], v[108:111]
    s_barrier
    v_mfma_f32_16x16x32_bf16 v[72:75], a[192:195], v[12:15], v[72:75]
    ds_read_b64_tr_b16 a[224:225], v5 offset:25344
    v_mfma_f32_16x16x32_bf16 v[72:75], a[196:199], v[16:19], v[72:75]
    ds_read_b64_tr_b16 a[226:227], v5 offset:25600
    v_mfma_f32_16x16x32_bf16 v[76:79], a[196:199], v[32:35], v[76:79]
    ds_read_b64_tr_b16 a[228:229], v5 offset:25856
    v_mfma_f32_16x16x32_bf16 v[76:79], a[192:195], v[28:31], v[76:79]
    ds_read_b64_tr_b16 a[230:231], v5 offset:26112
    v_mfma_f32_16x16x32_bf16 v[80:83], a[192:195], v[44:47], v[80:83]
    s_add_u32 s64, s5, 81920
    ds_read_b64_tr_b16 a[232:233], v5 offset:25376
    v_mfma_f32_16x16x32_bf16 v[80:83], a[196:199], v[48:51], v[80:83]
    s_add_u32 m0, s61, 76032
    ds_read_b64_tr_b16 a[234:235], v5 offset:25632
    v_mfma_f32_16x16x32_bf16 v[92:95], a[204:207], v[48:51], v[92:95]
    buffer_load_dwordx4 v155, s[48:51], s64 offen lds
    v_mfma_f32_16x16x32_bf16 v[92:95], a[200:203], v[44:47], v[92:95]
    ds_read_b64_tr_b16 a[236:237], v5 offset:25888
    v_mfma_f32_16x16x32_bf16 v[88:91], a[200:203], v[28:31], v[88:91]
    ds_read_b64_tr_b16 a[238:239], v5 offset:26144
    v_mfma_f32_16x16x32_bf16 v[88:91], a[204:207], v[32:35], v[88:91]
    s_add_u32 s64, s5, 83200
    ds_read_b64_tr_b16 a[240:241], v5 offset:25408
    v_mfma_f32_16x16x32_bf16 v[84:87], a[204:207], v[16:19], v[84:87]
    s_add_u32 m0, s61, 77088
    ds_read_b64_tr_b16 a[242:243], v5 offset:25664
    v_mfma_f32_16x16x32_bf16 v[84:87], a[200:203], v[12:15], v[84:87]
    s_add_u32 s5, s5, s12
    buffer_load_dwordx4 v155, s[48:51], s64 offen lds
    v_mfma_f32_16x16x32_bf16 v[96:99], a[208:211], v[12:15], v[96:99]
    ds_read_b64_tr_b16 a[244:245], v5 offset:25920
    v_mfma_f32_16x16x32_bf16 v[96:99], a[212:215], v[16:19], v[96:99]
    ds_read_b64_tr_b16 a[246:247], v5 offset:26176
    v_mfma_f32_16x16x32_bf16 v[100:103], a[212:215], v[32:35], v[100:103]
    ds_read_b64_tr_b16 a[248:249], v5 offset:25440
    v_mfma_f32_16x16x32_bf16 v[100:103], a[208:211], v[28:31], v[100:103]
    ds_read_b64_tr_b16 a[250:251], v5 offset:25696
    v_mfma_f32_16x16x32_bf16 v[104:107], a[208:211], v[44:47], v[104:107]
    s_add_u32 s65, s58, 0
    buffer_store_dwordx2 v[124:125], v159, s[36:39], s65 offen nt
    v_mfma_f32_16x16x32_bf16 v[104:107], a[212:215], v[48:51], v[104:107]
    ds_read_b64_tr_b16 a[252:253], v5 offset:25952
    v_mfma_f32_16x16x32_bf16 v[116:119], a[220:223], v[48:51], v[116:119]
    ds_read_b64_tr_b16 a[254:255], v5 offset:26208
    v_mfma_f32_16x16x32_bf16 v[116:119], a[216:219], v[44:47], v[116:119]
    v_mfma_f32_16x16x32_bf16 v[112:115], a[216:219], v[28:31], v[112:115]
    v_mfma_f32_16x16x32_bf16 v[112:115], a[220:223], v[32:35], v[112:115]
    v_mfma_f32_16x16x32_bf16 v[108:111], a[220:223], v[16:19], v[108:111]
    s_waitcnt lgkmcnt(0)
    ds_bpermute_b32 v128, v11, v128
    v_mfma_f32_16x16x32_bf16 v[108:111], a[216:219], v[12:15], v[108:111]
    ds_bpermute_b32 v129, v11, v129
    v_mfma_f32_16x16x32_bf16 v[60:63], a[0:3], v[184:187], v[244:247]
    v_mfma_f32_16x16x32_bf16 v[64:67], a[0:3], v[188:191], v[248:251]
    v_mfma_f32_16x16x32_bf16 v[68:71], a[0:3], v[192:195], v[252:255]
    v_mfma_f32_16x16x32_bf16 v[60:63], a[0:3], v[196:199], v[60:63]
    v_mfma_f32_16x16x32_bf16 v[64:67], a[0:3], v[200:203], v[64:67]
    v_mfma_f32_16x16x32_bf16 v[68:71], a[0:3], v[204:207], v[68:71]
    v_mfma_f32_16x16x32_bf16 v[72:75], a[224:227], v[20:23], v[72:75]
    ds_read_b64_tr_b16 a[192:193], v4 offset:33792
    v_mfma_f32_16x16x32_bf16 v[72:75], a[228:231], v[24:27], v[72:75]
    ds_read_b64_tr_b16 a[194:195], v4 offset:34048
    v_mfma_f32_16x16x32_bf16 v[76:79], a[228:231], v[40:43], v[76:79]
    ds_read_b64_tr_b16 a[196:197], v4 offset:34304
    v_mfma_f32_16x16x32_bf16 v[76:79], a[224:227], v[36:39], v[76:79]
    ds_read_b64_tr_b16 a[198:199], v4 offset:34560
    v_mfma_f32_16x16x32_bf16 v[80:83], a[224:227], v[52:55], v[80:83]
    ds_read_b64_tr_b16 a[200:201], v4 offset:33824
    v_mfma_f32_16x16x32_bf16 v[80:83], a[228:231], v[56:59], v[80:83]
    ds_read_b64_tr_b16 a[202:203], v4 offset:34080
    v_mfma_f32_16x16x32_bf16 v[92:95], a[236:239], v[56:59], v[92:95]
    buffer_load_dword v6, v2, s[8:11], 0 offen sc1
    v_mfma_f32_16x16x32_bf16 v[92:95], a[232:235], v[52:55], v[92:95]
    ds_read_b64_tr_b16 a[204:205], v4 offset:34336
    v_mfma_f32_16x16x32_bf16 v[88:91], a[232:235], v[36:39], v[88:91]
    ds_read_b64_tr_b16 a[206:207], v4 offset:34592
    v_mfma_f32_16x16x32_bf16 v[88:91], a[236:239], v[40:43], v[88:91]
    s_add_u32 s64, s6, 0
    ds_read_b64_tr_b16 a[208:209], v4 offset:33856
    v_mfma_f32_16x16x32_bf16 v[84:87], a[236:239], v[24:27], v[84:87]
    s_add_u32 m0, s61, 16896
    ds_read_b64_tr_b16 a[210:211], v4 offset:34112
    v_mfma_f32_16x16x32_bf16 v[84:87], a[232:235], v[20:23], v[84:87]
    buffer_load_dwordx4 v155, s[48:51], s64 offen lds
    v_mfma_f32_16x16x32_bf16 v[96:99], a[240:243], v[20:23], v[96:99]
    ds_read_b64_tr_b16 a[212:213], v4 offset:34368
    v_mfma_f32_16x16x32_bf16 v[96:99], a[244:247], v[24:27], v[96:99]
    ds_read_b64_tr_b16 a[214:215], v4 offset:34624
    v_mfma_f32_16x16x32_bf16 v[100:103], a[244:247], v[40:43], v[100:103]
    s_add_u32 s64, s6, 1280
    ds_read_b64_tr_b16 a[216:217], v4 offset:33888
    v_mfma_f32_16x16x32_bf16 v[100:103], a[240:243], v[36:39], v[100:103]
    s_add_u32 m0, s61, 17952
    ds_read_b64_tr_b16 a[218:219], v4 offset:34144
    v_mfma_f32_16x16x32_bf16 v[104:107], a[240:243], v[52:55], v[104:107]
    buffer_load_dwordx4 v155, s[48:51], s64 offen lds
    v_mfma_f32_16x16x32_bf16 v[104:107], a[244:247], v[56:59], v[104:107]
    ds_read_b64_tr_b16 a[220:221], v4 offset:34400
    v_mfma_f32_16x16x32_bf16 v[116:119], a[252:255], v[56:59], v[116:119]
    ds_read_b64_tr_b16 a[222:223], v4 offset:34656
    v_mfma_f32_16x16x32_bf16 v[116:119], a[248:251], v[52:55], v[116:119]
    v_mfma_f32_16x16x32_bf16 v[112:115], a[248:251], v[36:39], v[112:115]
    v_mfma_f32_16x16x32_bf16 v[112:115], a[252:255], v[40:43], v[112:115]
    v_mfma_f32_16x16x32_bf16 v[108:111], a[252:255], v[24:27], v[108:111]
    s_waitcnt lgkmcnt(0)
    v_mfma_f32_16x16x32_bf16 v[108:111], a[248:251], v[20:23], v[108:111]
L_gmid1:
    v_mfma_f32_16x16x32_bf16 v[208:211], a[192:195], a[144:147], 0
    ds_read_b64_tr_b16 a[224:225], v5 offset:33792
    v_mfma_f32_16x16x32_bf16 v[208:211], a[196:199], a[156:159], v[208:211]
    ds_read_b64_tr_b16 a[226:227], v5 offset:34048
    v_cvt_pk_bf16_f32 v160, v72, v73
    v_mfma_f32_16x16x32_bf16 v[212:215], a[196:199], a[160:163], 0
    ds_read_b64_tr_b16 a[228:229], v5 offset:34304
    v_cvt_pk_bf16_f32 v161, v74, v75
    v_mfma_f32_16x16x32_bf16 v[212:215], a[192:195], a[148:151], v[212:215]
    ds_read_b64_tr_b16 a[230:231], v5 offset:34560
    v_cvt_pk_bf16_f32 v162, v76, v77
    v_mfma_f32_16x16x32_bf16 v[216:219], a[192:195], a[152:155], 0
    s_add_u32 s64, s6, 81920
    ds_read_b64_tr_b16 a[232:233], v5 offset:33824
    v_cvt_pk_bf16_f32 v163, v78, v79
    v_mfma_f32_16x16x32_bf16 v[216:219], a[196:199], a[164:167], v[216:219]
    s_add_u32 m0, s61, 84480
    ds_read_b64_tr_b16 a[234:235], v5 offset:34080
    v_cvt_pk_bf16_f32 v164, v80, v81
    v_mfma_f32_16x16x32_bf16 v[228:231], a[204:207], a[164:167], 0
    buffer_load_dwordx4 v155, s[48:51], s64 offen lds
    v_mfma_f32_16x16x32_bf16 v[228:231], a[200:203], a[152:155], v[228:231]
    ds_read_b64_tr_b16 a[236:237], v5 offset:34336
    v_cvt_pk_bf16_f32 v165, v82, v83
    v_mfma_f32_16x16x32_bf16 v[224:227], a[200:203], a[148:151], 0
    ds_read_b64_tr_b16 a[238:239], v5 offset:34592
    v_cvt_pk_bf16_f32 v166, v84, v85
    v_mfma_f32_16x16x32_bf16 v[224:227], a[204:207], a[160:163], v[224:227]
    s_add_u32 s64, s6, 83200
    ds_read_b64_tr_b16 a[240:241], v5 offset:33856
    v_cvt_pk_bf16_f32 v167, v86, v87
    v_mfma_f32_16x16x32_bf16 v[220:223], a[204:207], a[156:159], 0
    s_add_u32 m0, s61, 85536
    ds_read_b64_tr_b16 a[242:243], v5 offset:34112
    v_cvt_pk_bf16_f32 v168, v88, v89
    v_mfma_f32_16x16x32_bf16 v[220:223], a[200:203], a[144:147], v[220:223]
    s_add_u32 s6, s6, s12
    buffer_load_dwordx4 v155, s[48:51], s64 offen lds
    v_mfma_f32_16x16x32_bf16 v[232:235], a[208:211], a[144:147], 0
    ds_read_b64_tr_b16 a[244:245], v5 offset:34368
    v_cvt_pk_bf16_f32 v169, v90, v91
    v_mfma_f32_16x16x32_bf16 v[232:235], a[212:215], a[156:159], v[232:235]
    ds_read_b64_tr_b16 a[246:247], v5 offset:34624
    v_cvt_pk_bf16_f32 v170, v92, v93
    v_mfma_f32_16x16x32_bf16 v[236:239], a[212:215], a[160:163], 0
    ds_read_b64_tr_b16 a[248:249], v5 offset:33888
    v_cvt_pk_bf16_f32 v171, v94, v95
    v_mfma_f32_16x16x32_bf16 v[236:239], a[208:211], a[148:151], v[236:239]
    ds_read_b64_tr_b16 a[250:251], v5 offset:34144
    v_cvt_pk_bf16_f32 v172, v96, v97
    v_mfma_f32_16x16x32_bf16 v[240:243], a[208:211], a[152:155], 0
    s_add_u32 s65, s58, 40960
    buffer_store_dwordx2 v[126:127], v159, s[36:39], s65 offen nt
    v_mfma_f32_16x16x32_bf16 v[240:243], a[212:215], a[164:167], v[240:243]
    ds_read_b64_tr_b16 a[252:253], v5 offset:34400
    v_cvt_pk_bf16_f32 v173, v98, v99
    v_mfma_f32_16x16x32_bf16 v[252:255], a[220:223], a[164:167], 0
    ds_read_b64_tr_b16 a[254:255], v5 offset:34656
    v_cvt_pk_bf16_f32 v174, v100, v101
    v_mfma_f32_16x16x32_bf16 v[252:255], a[216:219], a[152:155], v[252:255]
    v_cvt_pk_bf16_f32 v175, v102, v103
    v_cvt_pk_bf16_f32 v176, v104, v105
    v_mfma_f32_16x16x32_bf16 v[248:251], a[216:219], a[148:151], 0
    v_cvt_pk_bf16_f32 v177, v106, v107
    v_mfma_f32_16x16x32_bf16 v[248:251], a[220:223], a[160:163], v[248:251]
    v_cvt_pk_bf16_f32 v178, v108, v109
    v_mfma_f32_16x16x32_bf16 v[244:247], a[220:223], a[156:159], 0
    s_waitcnt lgkmcnt(0)
    v_cvt_pk_bf16_f32 v179, v110, v111
    v_cvt_pk_bf16_f32 v180, v112, v113
    v_mfma_f32_16x16x32_bf16 v[244:247], a[216:219], a[144:147], v[244:247]
    v_cvt_pk_bf16_f32 v181, v114, v115
    v_mfma_f32_16x16x32_bf16 v[208:211], a[224:227], a[168:171], v[208:211]
    ds_read_b64_tr_b16 a[192:193], v4 offset:42240
    v_cvt_pk_bf16_f32 v182, v116, v117
    v_mfma_f32_16x16x32_bf16 v[208:211], a[228:231], a[180:183], v[208:211]
    ds_read_b64_tr_b16 a[194:195], v4 offset:42496
    v_cvt_pk_bf16_f32 v183, v118, v119
    v_mfma_f32_16x16x32_bf16 v[212:215], a[228:231], a[184:187], v[212:215]
    ds_read_b64_tr_b16 a[196:197], v4 offset:42752
    v_mfma_f32_16x16x32_bf16 v[212:215], a[224:227], a[172:175], v[212:215]
    ds_read_b64_tr_b16 a[198:199], v4 offset:43008
    v_mfma_f32_16x16x32_bf16 v[216:219], a[224:227], a[176:179], v[216:219]
    s_add_u32 s64, s7, 0
    ds_read_b64_tr_b16 a[200:201], v4 offset:42272
    v_mfma_f32_16x16x32_bf16 v[216:219], a[228:231], a[188:191], v[216:219]
    s_add_u32 m0, s61, 25344
    ds_read_b64_tr_b16 a[202:203], v4 offset:42528
    v_mfma_f32_16x16x32_bf16 v[228:231], a[236:239], a[188:191], v[228:231]
    buffer_load_dwordx4 v155, s[48:51], s64 offen lds
    v_mfma_f32_16x16x32_bf16 v[228:231], a[232:235], a[176:179], v[228:231]
    ds_read_b64_tr_b16 a[204:205], v4 offset:42784
    v_mfma_f32_16x16x32_bf16 v[224:227], a[232:235], a[172:175], v[224:227]
    ds_read_b64_tr_b16 a[206:207], v4 offset:43040
    v_mfma_f32_16x16x32_bf16 v[224:227], a[236:239], a[184:187], v[224:227]
    s_add_u32 s64, s7, 1280
    ds_read_b64_tr_b16 a[208:209], v4 offset:42304
    v_mfma_f32_16x16x32_bf16 v[220:223], a[236:239], a[180:183], v[220:223]
    s_add_u32 m0, s61, 26400
    ds_read_b64_tr_b16 a[210:211], v4 offset:42560
    v_mfma_f32_16x16x32_bf16 v[220:223], a[232:235], a[168:171], v[220:223]
    buffer_load_dwordx4 v155, s[48:51], s64 offen lds
    v_mfma_f32_16x16x32_bf16 v[232:235], a[240:243], a[168:171], v[232:235]
    ds_read_b64_tr_b16 a[212:213], v4 offset:42816
    v_mfma_f32_16x16x32_bf16 v[232:235], a[244:247], a[180:183], v[232:235]
    ds_read_b64_tr_b16 a[214:215], v4 offset:43072
    v_mfma_f32_16x16x32_bf16 v[236:239], a[244:247], a[184:187], v[236:239]
    ds_read_b64_tr_b16 a[216:217], v4 offset:42336
    v_mfma_f32_16x16x32_bf16 v[236:239], a[240:243], a[172:175], v[236:239]
    ds_read_b64_tr_b16 a[218:219], v4 offset:42592
    v_mfma_f32_16x16x32_bf16 v[240:243], a[240:243], a[176:179], v[240:243]
    s_waitcnt vmcnt(7)
    v_cmp_gt_u32 vcc, v10, v6
    v_mfma_f32_16x16x32_bf16 v[240:243], a[244:247], a[188:191], v[240:243]
    ds_read_b64_tr_b16 a[220:221], v4 offset:42848
    v_mfma_f32_16x16x32_bf16 v[252:255], a[252:255], a[188:191], v[252:255]
    ds_read_b64_tr_b16 a[222:223], v4 offset:43104
    v_mfma_f32_16x16x32_bf16 v[252:255], a[248:251], a[176:179], v[252:255]
    v_mfma_f32_16x16x32_bf16 v[248:251], a[248:251], a[172:175], v[248:251]
    s_cbranch_vccnz L_sp_78
L_ok_79:
    v_mfma_f32_16x16x32_bf16 v[248:251], a[252:255], a[184:187], v[248:251]
    v_mfma_f32_16x16x32_bf16 v[244:247], a[252:255], a[180:183], v[244:247]
    s_waitcnt vmcnt(17) lgkmcnt(0)
    v_mfma_f32_16x16x32_bf16 v[244:247], a[248:251], a[168:171], v[244:247]
    s_barrier
    v_mfma_f32_16x16x32_bf16 v[208:211], a[192:195], a[96:99], v[208:211]
    ds_read_b64_tr_b16 a[224:225], v5 offset:42240
    v_mfma_f32_16x16x32_bf16 v[208:211], a[196:199], a[108:111], v[208:211]
    ds_read_b64_tr_b16 a[226:227], v5 offset:42496
    v_mfma_f32_16x16x32_bf16 v[212:215], a[196:199], a[112:115], v[212:215]
    ds_read_b64_tr_b16 a[228:229], v5 offset:42752
    v_mfma_f32_16x16x32_bf16 v[212:215], a[192:195], a[100:103], v[212:215]
    ds_read_b64_tr_b16 a[230:231], v5 offset:43008
    v_mfma_f32_16x16x32_bf16 v[216:219], a[192:195], a[104:107], v[216:219]
    ds_read_b64_tr_b16 a[232:233], v5 offset:42272
    v_mfma_f32_16x16x32_bf16 v[216:219], a[196:199], a[116:119], v[216:219]
    ds_read_b64_tr_b16 a[234:235], v5 offset:42528
    v_mfma_f32_16x16x32_bf16 v[228:231], a[204:207], a[116:119], v[228:231]
    buffer_store_dwordx4 v[160:163], v152, s[52:55], s40 offen
    v_mfma_f32_16x16x32_bf16 v[228:231], a[200:203], a[104:107], v[228:231]
    ds_read_b64_tr_b16 a[236:237], v5 offset:42784
    v_mfma_f32_16x16x32_bf16 v[224:227], a[200:203], a[100:103], v[224:227]
    ds_read_b64_tr_b16 a[238:239], v5 offset:43040
    v_mfma_f32_16x16x32_bf16 v[224:227], a[204:207], a[112:115], v[224:227]
    ds_read_b64_tr_b16 a[240:241], v5 offset:42304
    v_mfma_f32_16x16x32_bf16 v[220:223], a[204:207], a[108:111], v[220:223]
    ds_read_b64_tr_b16 a[242:243], v5 offset:42560
    v_mfma_f32_16x16x32_bf16 v[220:223], a[200:203], a[96:99], v[220:223]
    buffer_store_dwordx2 v[164:165], v153, s[52:55], s40 offen
    v_mfma_f32_16x16x32_bf16 v[232:235], a[208:211], a[96:99], v[232:235]
    ds_read_b64_tr_b16 a[244:245], v5 offset:42816
    v_mfma_f32_16x16x32_bf16 v[232:235], a[212:215], a[108:111], v[232:235]
    ds_read_b64_tr_b16 a[246:247], v5 offset:43072
    v_mfma_f32_16x16x32_bf16 v[236:239], a[212:215], a[112:115], v[236:239]
    ds_read_b64_tr_b16 a[248:249], v5 offset:42336
    v_mfma_f32_16x16x32_bf16 v[236:239], a[208:211], a[100:103], v[236:239]
    ds_read_b64_tr_b16 a[250:251], v5 offset:42592
    v_mfma_f32_16x16x32_bf16 v[240:243], a[208:211], a[104:107], v[240:243]
    s_mov_b32 s65, 24576
    buffer_load_dwordx4 v[132:135], v152, s[32:35], s65 offen sc1
    v_mfma_f32_16x16x32_bf16 v[240:243], a[212:215], a[116:119], v[240:243]
    ds_read_b64_tr_b16 a[252:253], v5 offset:42848
    v_mfma_f32_16x16x32_bf16 v[252:255], a[220:223], a[116:119], v[252:255]
    ds_read_b64_tr_b16 a[254:255], v5 offset:43104
    v_mfma_f32_16x16x32_bf16 v[252:255], a[216:219], a[104:107], v[252:255]
    buffer_store_dwordx4 v[168:171], v152, s[52:55], s41 offen
    v_mfma_f32_16x16x32_bf16 v[248:251], a[216:219], a[100:103], v[248:251]
    buffer_load_dwordx2 v[140:141], v153, s[32:35], s65 offen sc1
    v_mfma_f32_16x16x32_bf16 v[248:251], a[220:223], a[112:115], v[248:251]
    buffer_store_dwordx2 v[166:167], v153, s[52:55], s41 offen
    v_mfma_f32_16x16x32_bf16 v[244:247], a[220:223], a[108:111], v[244:247]
    s_mov_b32 s65, 30720
    s_waitcnt lgkmcnt(0)
    buffer_load_dwordx4 v[136:139], v152, s[32:35], s65 offen sc1
    v_mfma_f32_16x16x32_bf16 v[244:247], a[216:219], a[96:99], v[244:247]
    v_mfma_f32_16x16x32_bf16 v[208:211], a[224:227], a[120:123], v[208:211]
    ds_read_b64_tr_b16 a[192:193], v4 offset:50688
    v_mfma_f32_16x16x32_bf16 v[208:211], a[228:231], a[132:135], v[208:211]
    ds_read_b64_tr_b16 a[194:195], v4 offset:50944
    v_mfma_f32_16x16x32_bf16 v[212:215], a[228:231], a[136:139], v[212:215]
    ds_read_b64_tr_b16 a[196:197], v4 offset:51200
    v_mfma_f32_16x16x32_bf16 v[212:215], a[224:227], a[124:127], v[212:215]
    ds_read_b64_tr_b16 a[198:199], v4 offset:51456
    v_mfma_f32_16x16x32_bf16 v[216:219], a[224:227], a[128:131], v[216:219]
    ds_read_b64_tr_b16 a[200:201], v4 offset:50720
    v_mfma_f32_16x16x32_bf16 v[216:219], a[228:231], a[140:143], v[216:219]
    ds_read_b64_tr_b16 a[202:203], v4 offset:50976
    v_mfma_f32_16x16x32_bf16 v[228:231], a[236:239], a[140:143], v[228:231]
    buffer_store_dwordx4 v[172:175], v152, s[52:55], s42 offen
    v_mfma_f32_16x16x32_bf16 v[228:231], a[232:235], a[128:131], v[228:231]
    ds_read_b64_tr_b16 a[204:205], v4 offset:51232
    v_mfma_f32_16x16x32_bf16 v[224:227], a[232:235], a[124:127], v[224:227]
    ds_read_b64_tr_b16 a[206:207], v4 offset:51488
    v_mfma_f32_16x16x32_bf16 v[224:227], a[236:239], a[136:139], v[224:227]
    ds_read_b64_tr_b16 a[208:209], v4 offset:50752
    v_mfma_f32_16x16x32_bf16 v[220:223], a[236:239], a[132:135], v[220:223]
    ds_read_b64_tr_b16 a[210:211], v4 offset:51008
    v_mfma_f32_16x16x32_bf16 v[220:223], a[232:235], a[120:123], v[220:223]
    buffer_store_dwordx2 v[176:177], v153, s[52:55], s42 offen
    v_mfma_f32_16x16x32_bf16 v[232:235], a[240:243], a[120:123], v[232:235]
    ds_read_b64_tr_b16 a[212:213], v4 offset:51264
    v_mfma_f32_16x16x32_bf16 v[232:235], a[244:247], a[132:135], v[232:235]
    ds_read_b64_tr_b16 a[214:215], v4 offset:51520
    v_mfma_f32_16x16x32_bf16 v[236:239], a[244:247], a[136:139], v[236:239]
    ds_read_b64_tr_b16 a[216:217], v4 offset:50784
    v_mfma_f32_16x16x32_bf16 v[236:239], a[240:243], a[124:127], v[236:239]
    ds_read_b64_tr_b16 a[218:219], v4 offset:51040
    v_mfma_f32_16x16x32_bf16 v[240:243], a[240:243], a[128:131], v[240:243]
    buffer_load_dwordx2 v[130:131], v153, s[32:35], s65 offen sc1
    v_mfma_f32_16x16x32_bf16 v[240:243], a[244:247], a[140:143], v[240:243]
    ds_read_b64_tr_b16 a[220:221], v4 offset:51296
    v_mfma_f32_16x16x32_bf16 v[252:255], a[252:255], a[140:143], v[252:255]
    ds_read_b64_tr_b16 a[222:223], v4 offset:51552
    v_mfma_f32_16x16x32_bf16 v[252:255], a[248:251], a[128:131], v[252:255]
    buffer_store_dwordx4 v[180:183], v152, s[52:55], s43 offen
    v_mfma_f32_16x16x32_bf16 v[248:251], a[248:251], a[124:127], v[248:251]
    s_mov_b32 s65, 36864
    buffer_load_dwordx4 v[144:147], v152, s[32:35], s65 offen sc1
    v_mfma_f32_16x16x32_bf16 v[248:251], a[252:255], a[136:139], v[248:251]
    buffer_store_dwordx2 v[178:179], v153, s[52:55], s43 offen
    v_mfma_f32_16x16x32_bf16 v[244:247], a[252:255], a[132:135], v[244:247]
    s_waitcnt lgkmcnt(0)
    buffer_load_dwordx2 v[150:151], v153, s[32:35], s65 offen sc1
    v_mfma_f32_16x16x32_bf16 v[244:247], a[248:251], a[120:123], v[244:247]
    v_mfma_f32_16x16x32_bf16 v[208:211], a[192:195], a[48:51], v[208:211]
    ds_read_b64_tr_b16 a[224:225], v5 offset:50688
    v_mfma_f32_16x16x32_bf16 v[208:211], a[196:199], a[60:63], v[208:211]
    ds_read_b64_tr_b16 a[226:227], v5 offset:50944
    v_mfma_f32_16x16x32_bf16 v[212:215], a[196:199], a[64:67], v[212:215]
    ds_read_b64_tr_b16 a[228:229], v5 offset:51200
    v_mfma_f32_16x16x32_bf16 v[212:215], a[192:195], a[52:55], v[212:215]
    ds_read_b64_tr_b16 a[230:231], v5 offset:51456
    v_mfma_f32_16x16x32_bf16 v[216:219], a[192:195], a[56:59], v[216:219]
    s_add_u32 s64, s7, 81920
    ds_read_b64_tr_b16 a[232:233], v5 offset:50720
    v_mfma_f32_16x16x32_bf16 v[216:219], a[196:199], a[68:71], v[216:219]
    s_add_u32 m0, s61, 92928
    ds_read_b64_tr_b16 a[234:235], v5 offset:50976
    v_mfma_f32_16x16x32_bf16 v[228:231], a[204:207], a[68:71], v[228:231]
    buffer_load_dwordx4 v155, s[48:51], s64 offen lds
    v_mfma_f32_16x16x32_bf16 v[228:231], a[200:203], a[56:59], v[228:231]
    ds_read_b64_tr_b16 a[236:237], v5 offset:51232
    v_mfma_f32_16x16x32_bf16 v[224:227], a[200:203], a[52:55], v[224:227]
    ds_read_b64_tr_b16 a[238:239], v5 offset:51488
    v_mfma_f32_16x16x32_bf16 v[224:227], a[204:207], a[64:67], v[224:227]
    s_add_u32 s64, s7, 83200
    ds_read_b64_tr_b16 a[240:241], v5 offset:50752
    v_mfma_f32_16x16x32_bf16 v[220:223], a[204:207], a[60:63], v[220:223]
    s_add_u32 m0, s61, 93984
    ds_read_b64_tr_b16 a[242:243], v5 offset:51008
    v_mfma_f32_16x16x32_bf16 v[220:223], a[200:203], a[48:51], v[220:223]
    s_add_u32 s7, s7, s12
    buffer_load_dwordx4 v155, s[48:51], s64 offen lds
    v_mfma_f32_16x16x32_bf16 v[232:235], a[208:211], a[48:51], v[232:235]
    ds_read_b64_tr_b16 a[244:245], v5 offset:51264
    v_mfma_f32_16x16x32_bf16 v[232:235], a[212:215], a[60:63], v[232:235]
    ds_read_b64_tr_b16 a[246:247], v5 offset:51520
    v_mfma_f32_16x16x32_bf16 v[236:239], a[212:215], a[64:67], v[236:239]
    s_add_u32 s64, s4, 0
    ds_read_b64_tr_b16 a[248:249], v5 offset:50784
    v_mfma_f32_16x16x32_bf16 v[236:239], a[208:211], a[52:55], v[236:239]
    s_add_u32 m0, s61, 33792
    ds_read_b64_tr_b16 a[250:251], v5 offset:51040
    v_mfma_f32_16x16x32_bf16 v[240:243], a[208:211], a[56:59], v[240:243]
    buffer_load_dwordx4 v155, s[48:51], s64 offen lds
    v_mfma_f32_16x16x32_bf16 v[240:243], a[212:215], a[68:71], v[240:243]
    s_add_u32 s64, s4, 1280
    ds_read_b64_tr_b16 a[252:253], v5 offset:51296
    v_mfma_f32_16x16x32_bf16 v[252:255], a[220:223], a[68:71], v[252:255]
    s_add_u32 m0, s61, 34848
    ds_read_b64_tr_b16 a[254:255], v5 offset:51552
    v_mfma_f32_16x16x32_bf16 v[252:255], a[216:219], a[56:59], v[252:255]
    buffer_load_dwordx4 v155, s[48:51], s64 offen lds
    v_mfma_f32_16x16x32_bf16 v[248:251], a[216:219], a[52:55], v[248:251]
    v_mfma_f32_16x16x32_bf16 v[248:251], a[220:223], a[64:67], v[248:251]
    v_mfma_f32_16x16x32_bf16 v[244:247], a[220:223], a[60:63], v[244:247]
    s_waitcnt lgkmcnt(0)
    v_mfma_f32_16x16x32_bf16 v[244:247], a[216:219], a[48:51], v[244:247]
    v_mfma_f32_16x16x32_bf16 v[208:211], a[224:227], a[72:75], v[208:211]
    ds_read_b64_tr_b16 a[192:193], v4 offset:59136
    v_mfma_f32_16x16x32_bf16 v[208:211], a[228:231], a[84:87], v[208:211]
    ds_read_b64_tr_b16 a[194:195], v4 offset:59392
    v_mfma_f32_16x16x32_bf16 v[212:215], a[228:231], a[88:91], v[212:215]
    s_waitcnt vmcnt(4)
    ds_read_b64_tr_b16 a[196:197], v4 offset:59648
    v_mfma_f32_16x16x32_bf16 v[212:215], a[224:227], a[76:79], v[212:215]
    ds_read_b64_tr_b16 a[198:199], v4 offset:59904
    v_mfma_f32_16x16x32_bf16 v[216:219], a[224:227], a[80:83], v[216:219]
    ds_read_b64_tr_b16 a[200:201], v4 offset:59168
    v_add_u32 v10, 1, v10
    v_mfma_f32_16x16x32_bf16 v[216:219], a[228:231], a[92:95], v[216:219]
    ds_read_b64_tr_b16 a[202:203], v4 offset:59424
    v_mfma_f32_16x16x32_bf16 v[228:231], a[236:239], a[92:95], v[228:231]
    buffer_store_dword v10, v1, s[8:11], 0 offen
    v_mfma_f32_16x16x32_bf16 v[228:231], a[232:235], a[80:83], v[228:231]
    ds_read_b64_tr_b16 a[204:205], v4 offset:59680
    v_mfma_f32_16x16x32_bf16 v[224:227], a[232:235], a[76:79], v[224:227]
    ds_read_b64_tr_b16 a[206:207], v4 offset:59936
    v_mfma_f32_16x16x32_bf16 v[224:227], a[236:239], a[88:91], v[224:227]
    s_add_u32 s64, s4, 81920
    ds_read_b64_tr_b16 a[208:209], v4 offset:59200
    v_mfma_f32_16x16x32_bf16 v[220:223], a[236:239], a[84:87], v[220:223]
    s_add_u32 m0, s61, 101376
    ds_read_b64_tr_b16 a[210:211], v4 offset:59456
    v_mfma_f32_16x16x32_bf16 v[220:223], a[232:235], a[72:75], v[220:223]
    buffer_load_dwordx4 v155, s[48:51], s64 offen lds
    v_mfma_f32_16x16x32_bf16 v[232:235], a[240:243], a[72:75], v[232:235]
    ds_read_b64_tr_b16 a[212:213], v4 offset:59712
    v_mfma_f32_16x16x32_bf16 v[232:235], a[244:247], a[84:87], v[232:235]
    ds_read_b64_tr_b16 a[214:215], v4 offset:59968
    v_mfma_f32_16x16x32_bf16 v[236:239], a[244:247], a[88:91], v[236:239]
    s_add_u32 s64, s4, 83200
    ds_read_b64_tr_b16 a[216:217], v4 offset:59232
    v_mfma_f32_16x16x32_bf16 v[236:239], a[240:243], a[76:79], v[236:239]
    s_add_u32 m0, s61, 102432
    ds_read_b64_tr_b16 a[218:219], v4 offset:59488
    v_mfma_f32_16x16x32_bf16 v[240:243], a[240:243], a[80:83], v[240:243]
    s_add_u32 s4, s4, s13
    buffer_load_dwordx4 v155, s[48:51], s64 offen lds
    v_mfma_f32_16x16x32_bf16 v[240:243], a[244:247], a[92:95], v[240:243]
    s_add_u32 s64, s5, 0
    ds_read_b64_tr_b16 a[220:221], v4 offset:59744
    v_mfma_f32_16x16x32_bf16 v[252:255], a[252:255], a[92:95], v[252:255]
    s_add_u32 m0, s61, 42240
    ds_read_b64_tr_b16 a[222:223], v4 offset:60000
    v_mfma_f32_16x16x32_bf16 v[252:255], a[248:251], a[80:83], v[252:255]
    buffer_load_dwordx4 v155, s[48:51], s64 offen lds
    v_mfma_f32_16x16x32_bf16 v[248:251], a[248:251], a[76:79], v[248:251]
    s_add_u32 s64, s5, 1280
    v_mfma_f32_16x16x32_bf16 v[248:251], a[252:255], a[88:91], v[248:251]
    s_add_u32 m0, s61, 43296
    v_mfma_f32_16x16x32_bf16 v[244:247], a[252:255], a[84:87], v[244:247]
    s_waitcnt vmcnt(31) lgkmcnt(0)
    buffer_load_dwordx4 v155, s[48:51], s64 offen lds
    v_mfma_f32_16x16x32_bf16 v[244:247], a[248:251], a[72:75], v[244:247]
    s_barrier
    v_mfma_f32_16x16x32_bf16 v[208:211], a[192:195], v[12:15], v[208:211]
    ds_read_b64_tr_b16 a[224:225], v5 offset:59136
    v_mfma_f32_16x16x32_bf16 v[208:211], a[196:199], v[16:19], v[208:211]
    ds_read_b64_tr_b16 a[226:227], v5 offset:59392
    v_mfma_f32_16x16x32_bf16 v[212:215], a[196:199], v[32:35], v[212:215]
    ds_read_b64_tr_b16 a[228:229], v5 offset:59648
    v_mfma_f32_16x16x32_bf16 v[212:215], a[192:195], v[28:31], v[212:215]
    ds_read_b64_tr_b16 a[230:231], v5 offset:59904
    v_mfma_f32_16x16x32_bf16 v[216:219], a[192:195], v[44:47], v[216:219]
    s_add_u32 s64, s5, 81920
    ds_read_b64_tr_b16 a[232:233], v5 offset:59168
    v_mfma_f32_16x16x32_bf16 v[216:219], a[196:199], v[48:51], v[216:219]
    s_add_u32 m0, s61, 109824
    ds_read_b64_tr_b16 a[234:235], v5 offset:59424
    v_mfma_f32_16x16x32_bf16 v[228:231], a[204:207], v[48:51], v[228:231]
    buffer_load_dwordx4 v155, s[48:51], s64 offen lds
    v_mfma_f32_16x16x32_bf16 v[228:231], a[200:203], v[44:47], v[228:231]
    ds_read_b64_tr_b16 a[236:237], v5 offset:59680
    v_mfma_f32_16x16x32_bf16 v[224:227], a[200:203], v[28:31], v[224:227]
    ds_read_b64_tr_b16 a[238:239], v5 offset:59936
    v_mfma_f32_16x16x32_bf16 v[224:227], a[204:207], v[32:35], v[224:227]
    s_add_u32 s64, s5, 83200
    ds_read_b64_tr_b16 a[240:241], v5 offset:59200
    v_mfma_f32_16x16x32_bf16 v[220:223], a[204:207], v[16:19], v[220:223]
    s_add_u32 m0, s61, 110880
    ds_read_b64_tr_b16 a[242:243], v5 offset:59456
    v_mfma_f32_16x16x32_bf16 v[220:223], a[200:203], v[12:15], v[220:223]
    s_add_u32 s5, s5, s13
    buffer_load_dwordx4 v155, s[48:51], s64 offen lds
    v_mfma_f32_16x16x32_bf16 v[232:235], a[208:211], v[12:15], v[232:235]
    ds_read_b64_tr_b16 a[244:245], v5 offset:59712
    v_mfma_f32_16x16x32_bf16 v[232:235], a[212:215], v[16:19], v[232:235]
    ds_read_b64_tr_b16 a[246:247], v5 offset:59968
    v_mfma_f32_16x16x32_bf16 v[236:239], a[212:215], v[32:35], v[236:239]
    ds_read_b64_tr_b16 a[248:249], v5 offset:59232
    v_mfma_f32_16x16x32_bf16 v[236:239], a[208:211], v[28:31], v[236:239]
    ds_read_b64_tr_b16 a[250:251], v5 offset:59488
    v_mfma_f32_16x16x32_bf16 v[240:243], a[208:211], v[44:47], v[240:243]
    s_add_u32 s65, s58, 81920
    buffer_store_dwordx2 v[128:129], v159, s[36:39], s65 offen nt
    v_mfma_f32_16x16x32_bf16 v[240:243], a[212:215], v[48:51], v[240:243]
    ds_read_b64_tr_b16 a[252:253], v5 offset:59744
    v_mfma_f32_16x16x32_bf16 v[252:255], a[220:223], v[48:51], v[252:255]
    ds_read_b64_tr_b16 a[254:255], v5 offset:60000
    v_mfma_f32_16x16x32_bf16 v[252:255], a[216:219], v[44:47], v[252:255]
    v_mfma_f32_16x16x32_bf16 v[248:251], a[216:219], v[28:31], v[248:251]
    v_mfma_f32_16x16x32_bf16 v[248:251], a[220:223], v[32:35], v[248:251]
    v_mfma_f32_16x16x32_bf16 v[244:247], a[220:223], v[16:19], v[244:247]
    s_waitcnt lgkmcnt(0)
    v_mfma_f32_16x16x32_bf16 v[244:247], a[216:219], v[12:15], v[244:247]
    v_mfma_f32_16x16x32_bf16 v[60:63], a[0:3], v[130:133], v[60:63]
    v_mfma_f32_16x16x32_bf16 v[64:67], a[0:3], v[134:137], v[64:67]
    v_mfma_f32_16x16x32_bf16 v[68:71], a[0:3], v[138:141], v[68:71]
    v_mfma_f32_16x16x32_bf16 v[60:63], a[0:3], v[142:145], v[60:63]
    v_mfma_f32_16x16x32_bf16 v[64:67], a[0:3], v[146:149], v[64:67]
    v_mfma_f32_16x16x32_bf16 v[68:71], a[0:3], v[148:151], v[68:71]
    v_mfma_f32_16x16x32_bf16 v[208:211], a[224:227], v[20:23], v[208:211]
    s_cmp_ge_u32 s27, 1
    ds_read_b64_tr_b16 a[192:193], v4 offset:0
    v_mfma_f32_16x16x32_bf16 v[208:211], a[228:231], v[24:27], v[208:211]
    s_cselect_b32 s38, 490016, 0
    ds_read_b64_tr_b16 a[194:195], v4 offset:256
    v_mfma_f32_16x16x32_bf16 v[212:215], a[228:231], v[40:43], v[212:215]
    s_add_u32 s58, s58, 256
    ds_read_b64_tr_b16 a[196:197], v4 offset:512
    v_mfma_f32_16x16x32_bf16 v[212:215], a[224:227], v[36:39], v[212:215]
    s_mov_b32 s34, 1763328
    ds_read_b64_tr_b16 a[198:199], v4 offset:768
    v_mfma_f32_16x16x32_bf16 v[216:219], a[224:227], v[52:55], v[216:219]
    ds_read_b64_tr_b16 a[200:201], v4 offset:32
    v_mfma_f32_16x16x32_bf16 v[216:219], a[228:231], v[56:59], v[216:219]
    ds_read_b64_tr_b16 a[202:203], v4 offset:288
    v_mfma_f32_16x16x32_bf16 v[228:231], a[236:239], v[56:59], v[228:231]
    buffer_load_dword v6, v2, s[8:11], 0 offen sc1
    v_mfma_f32_16x16x32_bf16 v[228:231], a[232:235], v[52:55], v[228:231]
    ds_read_b64_tr_b16 a[204:205], v4 offset:544
    v_cvt_pk_bf16_f32 v124, v60, v61
    v_mfma_f32_16x16x32_bf16 v[224:227], a[232:235], v[36:39], v[224:227]
    ds_read_b64_tr_b16 a[206:207], v4 offset:800
    v_cvt_pk_bf16_f32 v125, v62, v63
    v_mfma_f32_16x16x32_bf16 v[224:227], a[236:239], v[40:43], v[224:227]
    s_add_u32 s64, s6, 0
    ds_read_b64_tr_b16 a[208:209], v4 offset:64
    v_cvt_pk_bf16_f32 v126, v64, v65
    v_mfma_f32_16x16x32_bf16 v[220:223], a[236:239], v[24:27], v[220:223]
    s_add_u32 m0, s61, 50688
    ds_read_b64_tr_b16 a[210:211], v4 offset:320
    v_cvt_pk_bf16_f32 v127, v66, v67
    v_mfma_f32_16x16x32_bf16 v[220:223], a[232:235], v[20:23], v[220:223]
    buffer_load_dwordx4 v155, s[48:51], s64 offen lds
    v_mfma_f32_16x16x32_bf16 v[232:235], a[240:243], v[20:23], v[232:235]
    ds_read_b64_tr_b16 a[212:213], v4 offset:576
    v_cvt_pk_bf16_f32 v128, v68, v69
    v_mfma_f32_16x16x32_bf16 v[232:235], a[244:247], v[24:27], v[232:235]
    ds_read_b64_tr_b16 a[214:215], v4 offset:832
    v_cvt_pk_bf16_f32 v129, v70, v71
    v_mfma_f32_16x16x32_bf16 v[236:239], a[244:247], v[40:43], v[236:239]
    s_add_u32 s64, s6, 1280
    ds_read_b64_tr_b16 a[216:217], v4 offset:96
    v_mfma_f32_16x16x32_bf16 v[236:239], a[240:243], v[36:39], v[236:239]
    s_add_u32 m0, s61, 51744
    ds_read_b64_tr_b16 a[218:219], v4 offset:352
    v_mfma_f32_16x16x32_bf16 v[240:243], a[240:243], v[52:55], v[240:243]
    buffer_load_dwordx4 v155, s[48:51], s64 offen lds
    v_mfma_f32_16x16x32_bf16 v[240:243], a[244:247], v[56:59], v[240:243]
    ds_read_b64_tr_b16 a[220:221], v4 offset:608
    v_mfma_f32_16x16x32_bf16 v[252:255], a[252:255], v[56:59], v[252:255]
    s_add_u32 s27, s27, 1
    ds_read_b64_tr_b16 a[222:223], v4 offset:864
    v_mfma_f32_16x16x32_bf16 v[252:255], a[248:251], v[52:55], v[252:255]
    s_cmp_lt_u32 s27, 5
    v_mfma_f32_16x16x32_bf16 v[248:251], a[248:251], v[36:39], v[248:251]
    v_mfma_f32_16x16x32_bf16 v[248:251], a[252:255], v[40:43], v[248:251]
    v_mfma_f32_16x16x32_bf16 v[244:247], a[252:255], v[24:27], v[244:247]
    s_waitcnt lgkmcnt(0)
    v_mfma_f32_16x16x32_bf16 v[244:247], a[248:251], v[20:23], v[244:247]
    s_cbranch_scc1 L_gl_fast
    v_cvt_pk_bf16_f32 v160, v208, v209
    v_cvt_pk_bf16_f32 v161, v210, v211
    v_cvt_pk_bf16_f32 v162, v212, v213
    v_cvt_pk_bf16_f32 v163, v214, v215
    v_cvt_pk_bf16_f32 v164, v216, v217
    v_cvt_pk_bf16_f32 v165, v218, v219
    v_cvt_pk_bf16_f32 v166, v220, v221
    v_cvt_pk_bf16_f32 v167, v222, v223
    v_cvt_pk_bf16_f32 v168, v224, v225
    v_cvt_pk_bf16_f32 v169, v226, v227
    v_cvt_pk_bf16_f32 v170, v228, v229
    v_cvt_pk_bf16_f32 v171, v230, v231
    v_cvt_pk_bf16_f32 v172, v232, v233
    v_cvt_pk_bf16_f32 v173, v234, v235
    v_cvt_pk_bf16_f32 v174, v236, v237
    v_cvt_pk_bf16_f32 v175, v238, v239
    v_cvt_pk_bf16_f32 v176, v240, v241
    v_cvt_pk_bf16_f32 v177, v242, v243
    s_waitcnt vmcnt(2)
    v_cmp_gt_u32 vcc, v10, v6
    s_nop 4
    s_cbranch_vccnz L_sp_80
L_ok_81:
    buffer_store_dwordx4 v[160:163], v152, s[52:55], s44 offen
    buffer_store_dwordx2 v[164:165], v153, s[52:55], s44 offen
    buffer_store_dwordx4 v[168:171], v152, s[52:55], s45 offen
    buffer_store_dwordx2 v[166:167], v153, s[52:55], s45 offen
    buffer_store_dwordx4 v[172:175], v152, s[52:55], s46 offen
    buffer_store_dwordx2 v[176:177], v153, s[52:55], s46 offen
    s_mov_b32 s65, 0
    buffer_load_dwordx4 v[186:189], v152, s[32:35], s65 offen sc1
    buffer_load_dwordx2 v[194:195], v153, s[32:35], s65 offen sc1
    s_mov_b32 s65, 6144
    buffer_load_dwordx4 v[190:193], v152, s[32:35], s65 offen sc1
    buffer_load_dwordx2 v[184:185], v153, s[32:35], s65 offen sc1
    s_mov_b32 s65, 12288
    buffer_load_dwordx4 v[198:201], v152, s[32:35], s65 offen sc1
    buffer_load_dwordx2 v[206:207], v153, s[32:35], s65 offen sc1
    s_mov_b32 s65, 18432
    buffer_load_dwordx4 v[202:205], v152, s[32:35], s65 offen sc1
    buffer_load_dwordx2 v[196:197], v153, s[32:35], s65 offen sc1
    ds_bpermute_b32 v124, v11, v124
    ds_bpermute_b32 v125, v11, v125
    ds_bpermute_b32 v126, v11, v126
    ds_bpermute_b32 v127, v11, v127
    ds_bpermute_b32 v128, v11, v128
    ds_bpermute_b32 v129, v11, v129
    s_waitcnt vmcnt(8)
    v_add_u32 v10, 1, v10
    buffer_store_dword v10, v1, s[8:11], 0 offen
    s_waitcnt vmcnt(7)
    s_waitcnt vmcnt(5)
    v_mfma_f32_16x16x32_bf16 v[60:63], a[0:3], v[184:187], v[244:247]
    v_mfma_f32_16x16x32_bf16 v[64:67], a[0:3], v[188:191], v[248:251]
    v_mfma_f32_16x16x32_bf16 v[68:71], a[0:3], v[192:195], v[252:255]
    s_waitcnt vmcnt(3)
    s_waitcnt vmcnt(1)
    v_mfma_f32_16x16x32_bf16 v[60:63], a[0:3], v[196:199], v[60:63]
    v_mfma_f32_16x16x32_bf16 v[64:67], a[0:3], v[200:203], v[64:67]
    v_mfma_f32_16x16x32_bf16 v[68:71], a[0:3], v[204:207], v[68:71]
    buffer_load_dword v6, v2, s[8:11], 0 offen sc1
    s_waitcnt vmcnt(0)
    v_cmp_gt_u32 vcc, v10, v6
    s_nop 4
    s_cbranch_vccnz L_sp_82
L_ok_83:
    s_mov_b32 s65, 24576
    buffer_load_dwordx4 v[132:135], v152, s[32:35], s65 offen sc1
    buffer_load_dwordx2 v[140:141], v153, s[32:35], s65 offen sc1
    s_mov_b32 s65, 30720
    buffer_load_dwordx4 v[136:139], v152, s[32:35], s65 offen sc1
    buffer_load_dwordx2 v[130:131], v153, s[32:35], s65 offen sc1
    s_mov_b32 s65, 36864
    buffer_load_dwordx4 v[144:147], v152, s[32:35], s65 offen sc1
    buffer_load_dwordx2 v[150:151], v153, s[32:35], s65 offen sc1
    s_waitcnt lgkmcnt(0)
    s_add_u32 s65, s58, 0
    buffer_store_dwordx2 v[124:125], v159, s[36:39], s65 offen nt
    s_add_u32 s65, s58, 40960
    buffer_store_dwordx2 v[126:127], v159, s[36:39], s65 offen nt
    s_add_u32 s65, s58, 81920
    buffer_store_dwordx2 v[128:129], v159, s[36:39], s65 offen nt
    s_mov_b32 s58, 1024
    s_waitcnt vmcnt(7)
    s_waitcnt vmcnt(5)
    v_mfma_f32_16x16x32_bf16 v[60:63], a[0:3], v[130:133], v[60:63]
    v_mfma_f32_16x16x32_bf16 v[64:67], a[0:3], v[134:137], v[64:67]
    v_mfma_f32_16x16x32_bf16 v[68:71], a[0:3], v[138:141], v[68:71]
    s_waitcnt vmcnt(3)
    v_mfma_f32_16x16x32_bf16 v[60:63], a[0:3], v[142:145], v[60:63]
    v_mfma_f32_16x16x32_bf16 v[64:67], a[0:3], v[146:149], v[64:67]
    v_mfma_f32_16x16x32_bf16 v[68:71], a[0:3], v[148:151], v[68:71]
    s_nop 5
    v_cvt_pk_bf16_f32 v124, v60, v61
    v_cvt_pk_bf16_f32 v125, v62, v63
    v_cvt_pk_bf16_f32 v126, v64, v65
    v_cvt_pk_bf16_f32 v127, v66, v67
    v_cvt_pk_bf16_f32 v128, v68, v69
    v_cvt_pk_bf16_f32 v129, v70, v71
    ds_bpermute_b32 v124, v11, v124
    ds_bpermute_b32 v125, v11, v125
    ds_bpermute_b32 v126, v11, v126
    ds_bpermute_b32 v127, v11, v127
    ds_bpermute_b32 v128, v11, v128
    ds_bpermute_b32 v129, v11, v129
    s_waitcnt lgkmcnt(0)
    s_add_u32 s65, s58, 0
    buffer_store_dwordx2 v[124:125], v159, s[36:39], s65 offen nt
    s_add_u32 s65, s58, 40960
    buffer_store_dwordx2 v[126:127], v159, s[36:39], s65 offen nt
    s_add_u32 s65, s58, 81920
    buffer_store_dwordx2 v[128:129], v159, s[36:39], s65 offen nt
L_fin:
L_end:
    s_endpgm
L_bs_70:
    s_mov_b32 s70, 0
L_spin_84:
    s_add_u32 s70, s70, 1
    s_cmp_ge_u32 s70, 2000000
    s_cbranch_scc1 L_bok_71
    s_sleep 1
    global_load_dword v156, v157, s[18:19] sc1
    s_waitcnt vmcnt(0)
    v_and_b32 v120, 0xff, v156
    v_cmp_gt_u32 vcc, 8, v120
    s_nop 4
    s_cbranch_vccnz L_spin_84
    s_branch L_bok_71
L_sp_76:
    s_mov_b32 s70, 0
L_spin_85:
    s_add_u32 s70, s70, 1
    s_cmp_ge_u32 s70, 2000000
    s_cbranch_scc1 L_ok_77
    s_sleep 1
    buffer_load_dword v6, v2, s[8:11], 0 offen sc1
    s_waitcnt vmcnt(0)
    v_cmp_gt_u32 vcc, v10, v6
    s_nop 4
    s_cbranch_vccnz L_spin_85
    s_branch L_ok_77
L_sp_78:
    s_mov_b32 s70, 0
L_spin_86:
    s_add_u32 s70, s70, 1
    s_cmp_ge_u32 s70, 2000000
    s_cbranch_scc1 L_ok_79
    s_sleep 1
    buffer_load_dword v6, v2, s[8:11], 0 offen sc1
    s_waitcnt vmcnt(0)
    v_cmp_gt_u32 vcc, v10, v6
    s_nop 4
    s_cbranch_vccnz L_spin_86
    s_branch L_ok_79
L_sp_80:
    s_mov_b32 s70, 0
L_spin_87:
    s_add_u32 s70, s70, 1
    s_cmp_ge_u32 s70, 2000000
    s_cbranch_scc1 L_ok_81
    s_sleep 1
    buffer_load_dword v6, v2, s[8:11], 0 offen sc1
    s_waitcnt vmcnt(0)
    v_cmp_gt_u32 vcc, v10, v6
    s_nop 4
    s_cbranch_vccnz L_spin_87
    s_branch L_ok_81
L_sp_82:
    s_mov_b32 s70, 0
L_spin_88:
    s_add_u32 s70, s70, 1
    s_cmp_ge_u32 s70, 2000000
    s_cbranch_scc1 L_ok_83
    s_sleep 1
    buffer_load_dword v6, v2, s[8:11], 0 offen sc1
    s_waitcnt vmcnt(0)
    v_cmp_gt_u32 vcc, v10, v6
    s_nop 4
    s_cbranch_vccnz L_spin_88
    s_branch L_ok_83
L_hot_end:
.p2align 6
L_p0:
    s_getpc_b64 s[14:15]
L_pc_1:
    s_add_u32 s14, s14, L_q-L_pc_1
    s_addc_u32 s15, s15, 0
    s_lshr_b32 s69, s2, 3
    s_lshl_b32 s69, s69, 2
    s_add_u32 s69, s69, s60
    s_lshl_b32 s69, s69, 7
    v_and_b32 v10, 3, v0
    v_lshlrev_b32 v10, 14, v10
    v_add_u32 v10, s69, v10
    v_min_u32 v10, L_p0end-L_q-4, v10
    global_load_dword v11, v10, s[14:15]
    s_mov_b32 s67, 0
    s_lshl_b32 s66, s72, 9
    s_lshl_b32 s69, s60, 7
    s_add_u32 s66, s66, s69
    v_and_b32 v8, 7, v0
    v_lshlrev_b32 v8, 2, v8
    v_mov_b32 v7, 0
    buffer_store_dword v7, v8, s[8:11], s66 offen sc1
    s_xor_b32 s64, s56, 0
    s_add_u32 m0, s61, 0
    s_nop 0
    buffer_load_dwordx4 v1, s[40:43], s64 offen nt lds
    s_add_u32 m0, s61, 32
    s_nop 0
    buffer_load_dwordx4 v1, s[40:43], s64 offen offset:1024 nt lds
    s_add_u32 s52, s32, 983040
    s_addc_u32 s53, s33, 0
    s_mov_b32 s54, 245760
    s_mov_b32 s55, 0x20000
    v_min_u32 v8, 59, v0
    v_lshlrev_b32 v8, 7, v8
    s_lshl_b32 s66, s72, 2
    s_add_u32 s66, s66, s60
    s_mul_i32 s66, s66, 7680
    buffer_load_dword v9, v8, s[52:55], s66 offen
    v_lshrrev_b32 v8, 2, v0
    v_lshlrev_b32 v8, 13, v8
    v_and_b32 v10, 3, v0
    v_lshl_add_u32 v8, v10, 7, v8
    s_lshr_b32 s66, s71, 3
    s_lshl_b32 s66, s66, 2
    s_and_b32 s69, s71, 3
    s_add_u32 s66, s66, s69
    s_lshl_b32 s66, s66, 2
    s_add_u32 s66, s66, s60
    s_mul_i32 s66, s66, 163840
    s_and_b32 s69, s26, 512
    s_add_u32 s66, s66, s69
    buffer_load_dword v9, v8, s[36:39], s66 offen
    s_add_u32 s66, s66, 32768
    buffer_load_dword v9, v8, s[36:39], s66 offen
    s_mov_b32 s30, 15
    s_xor_b32 s64, s26, 512
    s_add_u32 m0, s61, 42240
    s_nop 0
    buffer_load_dwordx4 v6, s[36:39], s64 offen lds
    s_xor_b32 s64, s26, 8704
    s_add_u32 m0, s61, 43272
    s_nop 0
    buffer_load_dwordx4 v6, s[36:39], s64 offen lds
    v_accvgpr_write_b32 a0, 0
    v_accvgpr_write_b32 a1, 0
    v_accvgpr_write_b32 a2, 0
    v_accvgpr_write_b32 a3, 0
    v_accvgpr_write_b32 a4, 0
    v_accvgpr_write_b32 a5, 0
    v_accvgpr_write_b32 a6, 0
    v_accvgpr_write_b32 a7, 0
    v_accvgpr_write_b32 a8, 0
    v_accvgpr_write_b32 a9, 0
    v_accvgpr_write_b32 a10, 0
    v_accvgpr_write_b32 a11, 0
    v_accvgpr_write_b32 a12, 0
    v_accvgpr_write_b32 a13, 0
    v_accvgpr_write_b32 a14, 0
    v_accvgpr_write_b32 a15, 0
    v_accvgpr_write_b32 a16, 0
    v_accvgpr_write_b32 a17, 0
    v_accvgpr_write_b32 a18, 0
    v_accvgpr_write_b32 a19, 0
    v_accvgpr_write_b32 a20, 0
    v_accvgpr_write_b32 a21, 0
    v_accvgpr_write_b32 a22, 0
    v_accvgpr_write_b32 a23, 0
    v_accvgpr_write_b32 a24, 0
    v_accvgpr_write_b32 a25, 0
    v_accvgpr_write_b32 a26, 0
    v_accvgpr_write_b32 a27, 0
    v_accvgpr_write_b32 a28, 0
    v_accvgpr_write_b32 a29, 0
    v_accvgpr_write_b32 a30, 0
    v_accvgpr_write_b32 a31, 0
    v_accvgpr_write_b32 a32, 0
    v_accvgpr_write_b32 a33, 0
    v_accvgpr_write_b32 a34, 0
    v_accvgpr_write_b32 a35, 0
    v_accvgpr_write_b32 a36, 0
    v_accvgpr_write_b32 a37, 0
    v_accvgpr_write_b32 a38, 0
    v_accvgpr_write_b32 a39, 0
    s_xor_b32 s64, s26, 262656
    s_add_u32 m0, s61, 109824
    s_nop 0
    buffer_load_dwordx4 v6, s[36:39], s64 offen lds
    s_xor_b32 s64, s26, 270848
    s_add_u32 m0, s61, 110856
    s_nop 0
    buffer_load_dwordx4 v6, s[36:39], s64 offen lds
    v_accvgpr_write_b32 a40, 0
    v_accvgpr_write_b32 a41, 0
    v_accvgpr_write_b32 a42, 0
    v_accvgpr_write_b32 a43, 0
    v_accvgpr_write_b32 a44, 0
    v_accvgpr_write_b32 a45, 0
    v_accvgpr_write_b32 a46, 0
    v_accvgpr_write_b32 a47, 0
    v_accvgpr_write_b32 a48, 0
    v_accvgpr_write_b32 a49, 0
    v_accvgpr_write_b32 a50, 0
    v_accvgpr_write_b32 a51, 0
    v_accvgpr_write_b32 a52, 0
    v_accvgpr_write_b32 a53, 0
    v_accvgpr_write_b32 a54, 0
    v_accvgpr_write_b32 a55, 0
    v_accvgpr_write_b32 a56, 0
    v_accvgpr_write_b32 a57, 0
    v_accvgpr_write_b32 a58, 0
    v_accvgpr_write_b32 a59, 0
    v_accvgpr_write_b32 a60, 0
    v_accvgpr_write_b32 a61, 0
    v_accvgpr_write_b32 a62, 0
    v_accvgpr_write_b32 a63, 0
    v_accvgpr_write_b32 a64, 0
    v_accvgpr_write_b32 a65, 0
    v_accvgpr_write_b32 a66, 0
    v_accvgpr_write_b32 a67, 0
    v_accvgpr_write_b32 a68, 0
    v_accvgpr_write_b32 a69, 0
    v_accvgpr_write_b32 a70, 0
    v_accvgpr_write_b32 a71, 0
    v_accvgpr_write_b32 a72, 0
    v_accvgpr_write_b32 a73, 0
    v_accvgpr_write_b32 a74, 0
    v_accvgpr_write_b32 a75, 0
    v_accvgpr_write_b32 a76, 0
    v_accvgpr_write_b32 a77, 0
    v_accvgpr_write_b32 a78, 0
    v_accvgpr_write_b32 a79, 0
    s_xor_b32 s64, s26, 256
    s_add_u32 m0, s61, 50688
    s_nop 0
    buffer_load_dwordx4 v6, s[36:39], s64 offen lds
    s_xor_b32 s64, s26, 8448
    s_add_u32 m0, s61, 51720
    s_nop 0
    buffer_load_dwordx4 v6, s[36:39], s64 offen lds
    v_accvgpr_write_b32 a80, 0
    v_accvgpr_write_b32 a81, 0
    v_accvgpr_write_b32 a82, 0
    v_accvgpr_write_b32 a83, 0
    v_accvgpr_write_b32 a84, 0
    v_accvgpr_write_b32 a85, 0
    v_accvgpr_write_b32 a86, 0
    v_accvgpr_write_b32 a87, 0
    v_accvgpr_write_b32 a88, 0
    v_accvgpr_write_b32 a89, 0
    v_accvgpr_write_b32 a90, 0
    v_accvgpr_write_b32 a91, 0
    v_accvgpr_write_b32 a92, 0
    v_accvgpr_write_b32 a93, 0
    v_accvgpr_write_b32 a94, 0
    v_accvgpr_write_b32 a95, 0
    v_accvgpr_write_b32 a96, 0
    v_accvgpr_write_b32 a97, 0
    v_accvgpr_write_b32 a98, 0
    v_accvgpr_write_b32 a99, 0
    v_accvgpr_write_b32 a100, 0
    v_accvgpr_write_b32 a101, 0
    v_accvgpr_write_b32 a102, 0
    v_accvgpr_write_b32 a103, 0
    v_accvgpr_write_b32 a104, 0
    v_accvgpr_write_b32 a105, 0
    v_accvgpr_write_b32 a106, 0
    v_accvgpr_write_b32 a107, 0
    v_accvgpr_write_b32 a108, 0
    v_accvgpr_write_b32 a109, 0
    v_accvgpr_write_b32 a110, 0
    v_accvgpr_write_b32 a111, 0
    v_accvgpr_write_b32 a112, 0
    v_accvgpr_write_b32 a113, 0
    v_accvgpr_write_b32 a114, 0
    v_accvgpr_write_b32 a115, 0
    v_accvgpr_write_b32 a116, 0
    v_accvgpr_write_b32 a117, 0
    v_accvgpr_write_b32 a118, 0
    v_accvgpr_write_b32 a119, 0
    s_xor_b32 s64, s26, 262400
    s_add_u32 m0, s61, 118272
    s_nop 0
    buffer_load_dwordx4 v6, s[36:39], s64 offen lds
    s_xor_b32 s64, s26, 270592
    s_add_u32 m0, s61, 119304
    s_nop 0
    buffer_load_dwordx4 v6, s[36:39], s64 offen lds
    v_accvgpr_write_b32 a120, 0
    v_accvgpr_write_b32 a121, 0
    v_accvgpr_write_b32 a122, 0
    v_accvgpr_write_b32 a123, 0
    v_accvgpr_write_b32 a124, 0
    v_accvgpr_write_b32 a125, 0
    v_accvgpr_write_b32 a126, 0
    v_accvgpr_write_b32 a127, 0
    v_accvgpr_write_b32 a128, 0
    v_accvgpr_write_b32 a129, 0
    v_accvgpr_write_b32 a130, 0
    v_accvgpr_write_b32 a131, 0
    v_accvgpr_write_b32 a132, 0
    v_accvgpr_write_b32 a133, 0
    v_accvgpr_write_b32 a134, 0
    v_accvgpr_write_b32 a135, 0
    v_accvgpr_write_b32 a136, 0
    v_accvgpr_write_b32 a137, 0
    v_accvgpr_write_b32 a138, 0
    v_accvgpr_write_b32 a139, 0
    v_accvgpr_write_b32 a140, 0
    v_accvgpr_write_b32 a141, 0
    v_accvgpr_write_b32 a142, 0
    v_accvgpr_write_b32 a143, 0
    v_accvgpr_write_b32 a144, 0
    v_accvgpr_write_b32 a145, 0
    v_accvgpr_write_b32 a146, 0
    v_accvgpr_write_b32 a147, 0
    v_accvgpr_write_b32 a148, 0
    v_accvgpr_write_b32 a149, 0
    v_accvgpr_write_b32 a150, 0
    v_accvgpr_write_b32 a151, 0
    v_accvgpr_write_b32 a152, 0
    v_accvgpr_write_b32 a153, 0
    v_accvgpr_write_b32 a154, 0
    v_accvgpr_write_b32 a155, 0
    v_accvgpr_write_b32 a156, 0
    v_accvgpr_write_b32 a157, 0
    v_accvgpr_write_b32 a158, 0
    v_accvgpr_write_b32 a159, 0
    s_xor_b32 s64, s26, 0
    s_add_u32 m0, s61, 59136
    s_nop 0
    buffer_load_dwordx4 v6, s[36:39], s64 offen lds
    s_xor_b32 s64, s26, 8192
    s_add_u32 m0, s61, 60168
    s_nop 0
    buffer_load_dwordx4 v6, s[36:39], s64 offen lds
    v_accvgpr_write_b32 a160, 0
    v_accvgpr_write_b32 a161, 0
    v_accvgpr_write_b32 a162, 0
    v_accvgpr_write_b32 a163, 0
    v_accvgpr_write_b32 a164, 0
    v_accvgpr_write_b32 a165, 0
    v_accvgpr_write_b32 a166, 0
    v_accvgpr_write_b32 a167, 0
    v_accvgpr_write_b32 a168, 0
    v_accvgpr_write_b32 a169, 0
    v_accvgpr_write_b32 a170, 0
    v_accvgpr_write_b32 a171, 0
    v_accvgpr_write_b32 a172, 0
    v_accvgpr_write_b32 a173, 0
    v_accvgpr_write_b32 a174, 0
    v_accvgpr_write_b32 a175, 0
    v_accvgpr_write_b32 a176, 0
    v_accvgpr_write_b32 a177, 0
    v_accvgpr_write_b32 a178, 0
    v_accvgpr_write_b32 a179, 0
    v_accvgpr_write_b32 a180, 0
    v_accvgpr_write_b32 a181, 0
    v_accvgpr_write_b32 a182, 0
    v_accvgpr_write_b32 a183, 0
    v_accvgpr_write_b32 a184, 0
    v_accvgpr_write_b32 a185, 0
    v_accvgpr_write_b32 a186, 0
    v_accvgpr_write_b32 a187, 0
    v_accvgpr_write_b32 a188, 0
    v_accvgpr_write_b32 a189, 0
    v_accvgpr_write_b32 a190, 0
    v_accvgpr_write_b32 a191, 0
    v_accvgpr_write_b32 a192, 0
    v_accvgpr_write_b32 a193, 0
    v_accvgpr_write_b32 a194, 0
    v_accvgpr_write_b32 a195, 0
    v_accvgpr_write_b32 a196, 0
    v_accvgpr_write_b32 a197, 0
    v_accvgpr_write_b32 a198, 0
    v_accvgpr_write_b32 a199, 0
    v_accvgpr_write_b32 a200, 0
    v_accvgpr_write_b32 a201, 0
    v_accvgpr_write_b32 a202, 0
    v_accvgpr_write_b32 a203, 0
    v_accvgpr_write_b32 a204, 0
    v_accvgpr_write_b32 a205, 0
    v_accvgpr_write_b32 a206, 0
    v_accvgpr_write_b32 a207, 0
    v_accvgpr_write_b32 a208, 0
    v_accvgpr_write_b32 a209, 0
    v_accvgpr_write_b32 a210, 0
    v_accvgpr_write_b32 a211, 0
    v_accvgpr_write_b32 a212, 0
    v_accvgpr_write_b32 a213, 0
    v_accvgpr_write_b32 a214, 0
    v_accvgpr_write_b32 a215, 0
    v_accvgpr_write_b32 a216, 0
    v_accvgpr_write_b32 a217, 0
    v_accvgpr_write_b32 a218, 0
    v_accvgpr_write_b32 a219, 0
    v_accvgpr_write_b32 a220, 0
    v_accvgpr_write_b32 a221, 0
    v_accvgpr_write_b32 a222, 0
    v_accvgpr_write_b32 a223, 0
    v_accvgpr_write_b32 a224, 0
    v_accvgpr_write_b32 a225, 0
    v_accvgpr_write_b32 a226, 0
    v_accvgpr_write_b32 a227, 0
    v_accvgpr_write_b32 a228, 0
    v_accvgpr_write_b32 a229, 0
    v_accvgpr_write_b32 a230, 0
    v_accvgpr_write_b32 a231, 0
    v_accvgpr_write_b32 a232, 0
    v_accvgpr_write_b32 a233, 0
    v_accvgpr_write_b32 a234, 0
    v_accvgpr_write_b32 a235, 0
    v_accvgpr_write_b32 a236, 0
    v_accvgpr_write_b32 a237, 0
    v_accvgpr_write_b32 a238, 0
    v_accvgpr_write_b32 a239, 0
    v_accvgpr_write_b32 a240, 0
    v_accvgpr_write_b32 a241, 0
    v_accvgpr_write_b32 a242, 0
    v_accvgpr_write_b32 a243, 0
    v_accvgpr_write_b32 a244, 0
    v_accvgpr_write_b32 a245, 0
    v_accvgpr_write_b32 a246, 0
    v_accvgpr_write_b32 a247, 0
    v_accvgpr_write_b32 a248, 0
    v_accvgpr_write_b32 a249, 0
    v_accvgpr_write_b32 a250, 0
    v_accvgpr_write_b32 a251, 0
    v_accvgpr_write_b32 a252, 0
    v_accvgpr_write_b32 a253, 0
    v_accvgpr_write_b32 a254, 0
    v_accvgpr_write_b32 a255, 0
    v_mov_b32 v124, 0
    v_mov_b32 v125, 0
    v_mov_b32 v126, 0
    v_mov_b32 v127, 0
    v_mov_b32 v128, 0
    v_mov_b32 v129, 0
    v_mov_b32 v130, 0
    v_mov_b32 v131, 0
    v_mov_b32 v132, 0
    v_mov_b32 v133, 0
    v_mov_b32 v134, 0
    v_mov_b32 v135, 0
    v_mov_b32 v136, 0
    v_mov_b32 v137, 0
    v_mov_b32 v138, 0
    v_mov_b32 v139, 0
    v_mov_b32 v140, 0
    v_mov_b32 v141, 0
    v_mov_b32 v142, 0
    v_mov_b32 v143, 0
    v_mov_b32 v144, 0
    v_mov_b32 v145, 0
    v_mov_b32 v146, 0
    v_mov_b32 v147, 0
    v_mov_b32 v148, 0
    v_mov_b32 v149, 0
    v_mov_b32 v150, 0
    v_mov_b32 v151, 0
    v_mov_b32 v152, 0
    v_mov_b32 v153, 0
    v_mov_b32 v154, 0
    v_mov_b32 v155, 0
    v_mov_b32 v160, 0
    v_mov_b32 v161, 0
    v_mov_b32 v162, 0
    v_mov_b32 v163, 0
    v_mov_b32 v164, 0
    v_mov_b32 v165, 0
    v_mov_b32 v166, 0
    v_mov_b32 v167, 0
    v_mov_b32 v168, 0
    v_mov_b32 v169, 0
    v_mov_b32 v170, 0
    v_mov_b32 v171, 0
    v_mov_b32 v172, 0
    v_mov_b32 v173, 0
    v_mov_b32 v174, 0
    v_mov_b32 v175, 0
    v_mov_b32 v176, 0
    v_mov_b32 v177, 0
    v_mov_b32 v178, 0
    v_mov_b32 v179, 0
    v_mov_b32 v180, 0
    v_mov_b32 v181, 0
    v_mov_b32 v182, 0
    v_mov_b32 v183, 0
    v_mov_b32 v184, 0
    v_mov_b32 v185, 0
    v_mov_b32 v186, 0
    v_mov_b32 v187, 0
    v_mov_b32 v188, 0
    v_mov_b32 v189, 0
    v_mov_b32 v190, 0
    v_mov_b32 v191, 0
    v_mov_b32 v192, 0
    v_mov_b32 v193, 0
    v_mov_b32 v194, 0
    v_mov_b32 v195, 0
    v_mov_b32 v196, 0
    v_mov_b32 v197, 0
    v_mov_b32 v198, 0
    v_mov_b32 v199, 0
    v_mov_b32 v200, 0
    v_mov_b32 v201, 0
    v_mov_b32 v202, 0
    v_mov_b32 v203, 0
    v_mov_b32 v204, 0
    v_mov_b32 v205, 0
    v_mov_b32 v206, 0
    v_mov_b32 v207, 0
    v_mov_b32 v208, 0
    v_mov_b32 v209, 0
    v_mov_b32 v210, 0
    v_mov_b32 v211, 0
    v_mov_b32 v212, 0
    v_mov_b32 v213, 0
    v_mov_b32 v214, 0
    v_mov_b32 v215, 0
    v_mov_b32 v216, 0
    v_mov_b32 v217, 0
    v_mov_b32 v218, 0
    v_mov_b32 v219, 0
    v_mov_b32 v220, 0
    v_mov_b32 v221, 0
    v_mov_b32 v222, 0
    v_mov_b32 v223, 0
    v_mov_b32 v224, 0
    v_mov_b32 v225, 0
    v_mov_b32 v226, 0
    v_mov_b32 v227, 0
    v_mov_b32 v228, 0
    v_mov_b32 v229, 0
    v_mov_b32 v230, 0
    v_mov_b32 v231, 0
    v_mov_b32 v232, 0
    v_mov_b32 v233, 0
    v_mov_b32 v234, 0
    v_mov_b32 v235, 0
    v_mov_b32 v236, 0
    v_mov_b32 v237, 0
    v_mov_b32 v238, 0
    v_mov_b32 v239, 0
    v_mov_b32 v240, 0
    v_mov_b32 v241, 0
    v_mov_b32 v242, 0
    v_mov_b32 v243, 0
    v_mov_b32 v244, 0
    v_mov_b32 v245, 0
    v_mov_b32 v246, 0
    v_mov_b32 v247, 0
    v_mov_b32 v248, 0
    v_mov_b32 v249, 0
    v_mov_b32 v250, 0
    v_mov_b32 v251, 0
    v_mov_b32 v252, 0
    v_mov_b32 v253, 0
    v_mov_b32 v254, 0
    v_mov_b32 v255, 0
    s_lshr_b32 s66, s71, 3
    s_lshl_b32 s66, s66, 2
    s_and_b32 s69, s71, 3
    s_add_u32 s66, s66, s69
    s_lshl_b32 s66, s66, 2
    s_add_u32 s66, s66, s60
    s_mul_i32 s66, s66, 5120
    v_min_u32 v7, 39, v0
    v_lshl_add_u32 v7, v7, 7, s66
    s_waitcnt vmcnt(10) lgkmcnt(0)
    s_barrier
    ds_read_b128 v[76:79], v158 offset:0
    ds_read_b128 v[84:87], v158 offset:2048
    ds_read_b128 v[92:95], v158 offset:4096
    ds_read_b128 v[80:83], v159 offset:0
    ds_read_b128 v[88:91], v159 offset:2048
    ds_read_b128 v[96:99], v159 offset:4096
    ds_read_b64_tr_b16 v[12:13], v4 offset:33792
    ds_read_b64_tr_b16 v[14:15], v4 offset:34304
    ds_read_b64_tr_b16 v[16:17], v5 offset:33792
    ds_read_b64_tr_b16 v[18:19], v5 offset:34304
    ds_read_b64_tr_b16 v[20:21], v4 offset:33800
    ds_read_b64_tr_b16 v[22:23], v4 offset:34312
    ds_read_b64_tr_b16 v[24:25], v5 offset:33800
    ds_read_b64_tr_b16 v[26:27], v5 offset:34312
    ds_read_b64_tr_b16 v[28:29], v4 offset:33856
    ds_read_b64_tr_b16 v[30:31], v4 offset:34368
    ds_read_b64_tr_b16 v[32:33], v5 offset:33856
    ds_read_b64_tr_b16 v[34:35], v5 offset:34368
    ds_read_b64_tr_b16 v[36:37], v4 offset:33864
    ds_read_b64_tr_b16 v[38:39], v4 offset:34376
    ds_read_b64_tr_b16 v[40:41], v5 offset:33864
    ds_read_b64_tr_b16 v[42:43], v5 offset:34376
    s_waitcnt lgkmcnt(0)
.p2align 6
L_q:
    v_mfma_f32_16x16x32_bf16 a[0:3], v[12:15], v[76:79], a[0:3]
    ds_read_b64_tr_b16 v[44:45], v4 offset:33920
    v_mfma_f32_16x16x32_bf16 a[0:3], v[16:19], v[80:83], a[0:3]
    ds_read_b64_tr_b16 v[46:47], v4 offset:34432
    v_mfma_f32_16x16x32_bf16 a[4:7], v[16:19], v[88:91], a[4:7]
    ds_read_b64_tr_b16 v[48:49], v5 offset:33920
    v_mfma_f32_16x16x32_bf16 a[4:7], v[12:15], v[84:87], a[4:7]
    ds_read_b64_tr_b16 v[50:51], v5 offset:34432
    v_mfma_f32_16x16x32_bf16 a[8:11], v[12:15], v[92:95], a[8:11]
    s_waitcnt lgkmcnt(4)
    s_xor_b32 s64, s26, 262144
    ds_read_b64_tr_b16 v[52:53], v4 offset:33928
    v_mfma_f32_16x16x32_bf16 a[8:11], v[16:19], v[96:99], a[8:11]
    s_add_u32 m0, s61, 126720
    ds_read_b64_tr_b16 v[54:55], v4 offset:34440
    v_mfma_f32_16x16x32_bf16 a[20:23], v[24:27], v[96:99], a[20:23]
    buffer_load_dwordx4 v6, s[36:39], s64 offen lds
    v_mfma_f32_16x16x32_bf16 a[20:23], v[20:23], v[92:95], a[20:23]
    ds_read_b64_tr_b16 v[56:57], v5 offset:33928
    v_mfma_f32_16x16x32_bf16 a[16:19], v[20:23], v[84:87], a[16:19]
    ds_read_b64_tr_b16 v[58:59], v5 offset:34440
    v_mfma_f32_16x16x32_bf16 a[16:19], v[24:27], v[88:91], a[16:19]
    s_xor_b32 s64, s26, 270336
    ds_read_b64_tr_b16 v[60:61], v4 offset:33984
    v_mfma_f32_16x16x32_bf16 a[12:15], v[24:27], v[80:83], a[12:15]
    s_add_u32 m0, s61, 127752
    ds_read_b64_tr_b16 v[62:63], v4 offset:34496
    v_mfma_f32_16x16x32_bf16 a[12:15], v[20:23], v[76:79], a[12:15]
    buffer_load_dwordx4 v6, s[36:39], s64 offen lds
    v_mfma_f32_16x16x32_bf16 a[24:27], v[28:31], v[76:79], a[24:27]
    ds_read_b64_tr_b16 v[64:65], v5 offset:33984
    v_mfma_f32_16x16x32_bf16 a[24:27], v[32:35], v[80:83], a[24:27]
    ds_read_b64_tr_b16 v[66:67], v5 offset:34496
    v_mfma_f32_16x16x32_bf16 a[28:31], v[32:35], v[88:91], a[28:31]
    s_xor_b32 s65, s75, 128
    ds_read_b64_tr_b16 v[68:69], v4 offset:33992
    v_mfma_f32_16x16x32_bf16 a[28:31], v[28:31], v[84:87], a[28:31]
    s_add_u32 m0, s63, 0
    ds_read_b64_tr_b16 v[70:71], v4 offset:34504
    v_mfma_f32_16x16x32_bf16 a[32:35], v[28:31], v[92:95], a[32:35]
    buffer_load_dwordx4 v156, s[32:35], s65 offen lds
    v_mfma_f32_16x16x32_bf16 a[32:35], v[32:35], v[96:99], a[32:35]
    ds_read_b64_tr_b16 v[72:73], v5 offset:33992
    v_mfma_f32_16x16x32_bf16 a[44:47], v[40:43], v[96:99], a[44:47]
    s_add_u32 m0, s63, 1024
    ds_read_b64_tr_b16 v[74:75], v5 offset:34504
    v_mfma_f32_16x16x32_bf16 a[44:47], v[36:39], v[92:95], a[44:47]
    buffer_load_dwordx4 v157, s[32:35], s65 offen lds
    v_mfma_f32_16x16x32_bf16 a[40:43], v[36:39], v[84:87], a[40:43]
    v_mfma_f32_16x16x32_bf16 a[40:43], v[40:43], v[88:91], a[40:43]
    v_mfma_f32_16x16x32_bf16 a[36:39], v[40:43], v[80:83], a[36:39]
    s_waitcnt vmcnt(8) lgkmcnt(0)
    v_mfma_f32_16x16x32_bf16 a[36:39], v[36:39], v[76:79], a[36:39]
    s_barrier
    v_mfma_f32_16x16x32_bf16 a[48:51], v[44:47], v[76:79], a[48:51]
    ds_read_b64_tr_b16 v[12:13], v4 offset:42240
    v_mfma_f32_16x16x32_bf16 a[48:51], v[48:51], v[80:83], a[48:51]
    ds_read_b64_tr_b16 v[14:15], v4 offset:42752
    v_mfma_f32_16x16x32_bf16 a[52:55], v[48:51], v[88:91], a[52:55]
    ds_read_b64_tr_b16 v[16:17], v5 offset:42240
    v_mfma_f32_16x16x32_bf16 a[52:55], v[44:47], v[84:87], a[52:55]
    ds_read_b64_tr_b16 v[18:19], v5 offset:42752
    v_mfma_f32_16x16x32_bf16 a[56:59], v[44:47], v[92:95], a[56:59]
    s_xor_b32 s64, s26, 525056
    ds_read_b64_tr_b16 v[20:21], v4 offset:42248
    v_mfma_f32_16x16x32_bf16 a[56:59], v[48:51], v[96:99], a[56:59]
    s_add_u32 m0, s61, 33792
    ds_read_b64_tr_b16 v[22:23], v4 offset:42760
    v_mfma_f32_16x16x32_bf16 a[68:71], v[56:59], v[96:99], a[68:71]
    buffer_load_dwordx4 v6, s[36:39], s64 offen lds
    v_mfma_f32_16x16x32_bf16 a[68:71], v[52:55], v[92:95], a[68:71]
    ds_read_b64_tr_b16 v[24:25], v5 offset:42248
    v_mfma_f32_16x16x32_bf16 a[64:67], v[52:55], v[84:87], a[64:67]
    ds_read_b64_tr_b16 v[26:27], v5 offset:42760
    v_mfma_f32_16x16x32_bf16 a[64:67], v[56:59], v[88:91], a[64:67]
    s_xor_b32 s64, s26, 533248
    ds_read_b64_tr_b16 v[28:29], v4 offset:42304
    v_mfma_f32_16x16x32_bf16 a[60:63], v[56:59], v[80:83], a[60:63]
    s_add_u32 m0, s61, 34824
    ds_read_b64_tr_b16 v[30:31], v4 offset:42816
    v_mfma_f32_16x16x32_bf16 a[60:63], v[52:55], v[76:79], a[60:63]
    buffer_load_dwordx4 v6, s[36:39], s64 offen lds
    v_mfma_f32_16x16x32_bf16 a[72:75], v[60:63], v[76:79], a[72:75]
    ds_read_b64_tr_b16 v[32:33], v5 offset:42304
    v_mfma_f32_16x16x32_bf16 a[72:75], v[64:67], v[80:83], a[72:75]
    ds_read_b64_tr_b16 v[34:35], v5 offset:42816
    v_mfma_f32_16x16x32_bf16 a[76:79], v[64:67], v[88:91], a[76:79]
    s_xor_b32 s65, s75, 20608
    ds_read_b64_tr_b16 v[36:37], v4 offset:42312
    v_mfma_f32_16x16x32_bf16 a[76:79], v[60:63], v[84:87], a[76:79]
    s_add_u32 m0, s63, 2048
    ds_read_b64_tr_b16 v[38:39], v4 offset:42824
    v_mfma_f32_16x16x32_bf16 a[80:83], v[60:63], v[92:95], a[80:83]
    buffer_load_dwordx4 v156, s[32:35], s65 offen lds
    v_mfma_f32_16x16x32_bf16 a[80:83], v[64:67], v[96:99], a[80:83]
    ds_read_b64_tr_b16 v[40:41], v5 offset:42312
    v_mfma_f32_16x16x32_bf16 a[92:95], v[72:75], v[96:99], a[92:95]
    s_add_u32 m0, s63, 3072
    ds_read_b64_tr_b16 v[42:43], v5 offset:42824
    v_mfma_f32_16x16x32_bf16 a[92:95], v[68:71], v[92:95], a[92:95]
    buffer_load_dwordx4 v157, s[32:35], s65 offen lds
    v_mfma_f32_16x16x32_bf16 a[88:91], v[68:71], v[84:87], a[88:91]
    v_mfma_f32_16x16x32_bf16 a[88:91], v[72:75], v[88:91], a[88:91]
    v_mfma_f32_16x16x32_bf16 a[84:87], v[72:75], v[80:83], a[84:87]
    s_waitcnt lgkmcnt(2)
    v_mfma_f32_16x16x32_bf16 a[84:87], v[68:71], v[76:79], a[84:87]
    v_mfma_f32_16x16x32_bf16 a[96:99], v[12:15], v[76:79], a[96:99]
    ds_read_b64_tr_b16 v[44:45], v4 offset:42368
    v_mfma_f32_16x16x32_bf16 a[96:99], v[16:19], v[80:83], a[96:99]
    ds_read_b64_tr_b16 v[46:47], v4 offset:42880
    v_mfma_f32_16x16x32_bf16 a[100:103], v[16:19], v[88:91], a[100:103]
    ds_read_b64_tr_b16 v[48:49], v5 offset:42368
    v_mfma_f32_16x16x32_bf16 a[100:103], v[12:15], v[84:87], a[100:103]
    ds_read_b64_tr_b16 v[50:51], v5 offset:42880
    v_mfma_f32_16x16x32_bf16 a[104:107], v[12:15], v[92:95], a[104:107]
    s_xor_b32 s64, s26, 787200
    ds_read_b64_tr_b16 v[52:53], v4 offset:42376
    v_mfma_f32_16x16x32_bf16 a[104:107], v[16:19], v[96:99], a[104:107]
    s_add_u32 m0, s61, 101376
    ds_read_b64_tr_b16 v[54:55], v4 offset:42888
    v_mfma_f32_16x16x32_bf16 a[116:119], v[24:27], v[96:99], a[116:119]
    buffer_load_dwordx4 v6, s[36:39], s64 offen lds
    v_mfma_f32_16x16x32_bf16 a[116:119], v[20:23], v[92:95], a[116:119]
    ds_read_b64_tr_b16 v[56:57], v5 offset:42376
    v_mfma_f32_16x16x32_bf16 a[112:115], v[20:23], v[84:87], a[112:115]
    ds_read_b64_tr_b16 v[58:59], v5 offset:42888
    v_mfma_f32_16x16x32_bf16 a[112:115], v[24:27], v[88:91], a[112:115]
    s_xor_b32 s64, s26, 795392
    ds_read_b64_tr_b16 v[60:61], v4 offset:42432
    v_mfma_f32_16x16x32_bf16 a[108:111], v[24:27], v[80:83], a[108:111]
    s_add_u32 m0, s61, 102408
    ds_read_b64_tr_b16 v[62:63], v4 offset:42944
    v_mfma_f32_16x16x32_bf16 a[108:111], v[20:23], v[76:79], a[108:111]
    buffer_load_dwordx4 v6, s[36:39], s64 offen lds
    v_mfma_f32_16x16x32_bf16 a[120:123], v[28:31], v[76:79], a[120:123]
    ds_read_b64_tr_b16 v[64:65], v5 offset:42432
    v_mfma_f32_16x16x32_bf16 a[120:123], v[32:35], v[80:83], a[120:123]
    ds_read_b64_tr_b16 v[66:67], v5 offset:42944
    v_mfma_f32_16x16x32_bf16 a[124:127], v[32:35], v[88:91], a[124:127]
    s_xor_b32 s65, s75, 41088
    ds_read_b64_tr_b16 v[68:69], v4 offset:42440
    v_mfma_f32_16x16x32_bf16 a[124:127], v[28:31], v[84:87], a[124:127]
    s_add_u32 m0, s63, 4096
    ds_read_b64_tr_b16 v[70:71], v4 offset:42952
    v_mfma_f32_16x16x32_bf16 a[128:131], v[28:31], v[92:95], a[128:131]
    buffer_load_dwordx4 v156, s[32:35], s65 offen lds
    v_mfma_f32_16x16x32_bf16 a[128:131], v[32:35], v[96:99], a[128:131]
    s_waitcnt lgkmcnt(14)
    ds_read_b64_tr_b16 v[72:73], v5 offset:42440
    v_mfma_f32_16x16x32_bf16 a[140:143], v[40:43], v[96:99], a[140:143]
    s_add_u32 m0, s63, 5120
    ds_read_b64_tr_b16 v[74:75], v5 offset:42952
    v_mfma_f32_16x16x32_bf16 a[140:143], v[36:39], v[92:95], a[140:143]
    buffer_load_dwordx4 v157, s[32:35], s65 offen lds
    v_mfma_f32_16x16x32_bf16 a[136:139], v[36:39], v[84:87], a[136:139]
    v_mfma_f32_16x16x32_bf16 a[136:139], v[40:43], v[88:91], a[136:139]
    v_mfma_f32_16x16x32_bf16 a[132:135], v[40:43], v[80:83], a[132:135]
    s_waitcnt vmcnt(8) lgkmcnt(0)
    v_mfma_f32_16x16x32_bf16 a[132:135], v[36:39], v[76:79], a[132:135]
    s_barrier
    v_mfma_f32_16x16x32_bf16 a[144:147], v[44:47], v[76:79], a[144:147]
    ds_read_b64_tr_b16 v[12:13], v4 offset:50688
    v_mfma_f32_16x16x32_bf16 a[144:147], v[48:51], v[80:83], a[144:147]
    ds_read_b64_tr_b16 v[14:15], v4 offset:51200
    v_mfma_f32_16x16x32_bf16 a[148:151], v[48:51], v[88:91], a[148:151]
    ds_read_b64_tr_b16 v[16:17], v5 offset:50688
    v_mfma_f32_16x16x32_bf16 a[148:151], v[44:47], v[84:87], a[148:151]
    ds_read_b64_tr_b16 v[18:19], v5 offset:51200
    v_mfma_f32_16x16x32_bf16 a[152:155], v[44:47], v[92:95], a[152:155]
    s_xor_b32 s64, s26, 524800
    ds_read_b64_tr_b16 v[20:21], v4 offset:50696
    v_mfma_f32_16x16x32_bf16 a[152:155], v[48:51], v[96:99], a[152:155]
    s_add_u32 m0, s61, 42240
    ds_read_b64_tr_b16 v[22:23], v4 offset:51208
    v_mfma_f32_16x16x32_bf16 a[164:167], v[56:59], v[96:99], a[164:167]
    buffer_load_dwordx4 v6, s[36:39], s64 offen lds
    v_mfma_f32_16x16x32_bf16 a[164:167], v[52:55], v[92:95], a[164:167]
    ds_read_b64_tr_b16 v[24:25], v5 offset:50696
    v_mfma_f32_16x16x32_bf16 a[160:163], v[52:55], v[84:87], a[160:163]
    ds_read_b64_tr_b16 v[26:27], v5 offset:51208
    v_mfma_f32_16x16x32_bf16 a[160:163], v[56:59], v[88:91], a[160:163]
    s_xor_b32 s64, s26, 532992
    ds_read_b64_tr_b16 v[28:29], v4 offset:50752
    v_mfma_f32_16x16x32_bf16 a[156:159], v[56:59], v[80:83], a[156:159]
    s_add_u32 m0, s61, 43272
    ds_read_b64_tr_b16 v[30:31], v4 offset:51264
    v_mfma_f32_16x16x32_bf16 a[156:159], v[52:55], v[76:79], a[156:159]
    buffer_load_dwordx4 v6, s[36:39], s64 offen lds
    v_mfma_f32_16x16x32_bf16 a[168:171], v[60:63], v[76:79], a[168:171]
    ds_read_b64_tr_b16 v[32:33], v5 offset:50752
    v_mfma_f32_16x16x32_bf16 a[168:171], v[64:67], v[80:83], a[168:171]
    ds_read_b64_tr_b16 v[34:35], v5 offset:51264
    v_mfma_f32_16x16x32_bf16 a[172:175], v[64:67], v[88:91], a[172:175]
    ds_read_b64_tr_b16 v[36:37], v4 offset:50760
    v_mfma_f32_16x16x32_bf16 a[172:175], v[60:63], v[84:87], a[172:175]
    ds_read_b64_tr_b16 v[38:39], v4 offset:51272
    v_mfma_f32_16x16x32_bf16 a[176:179], v[60:63], v[92:95], a[176:179]
    v_mfma_f32_16x16x32_bf16 a[176:179], v[64:67], v[96:99], a[176:179]
    ds_read_b64_tr_b16 v[40:41], v5 offset:50760
    v_mfma_f32_16x16x32_bf16 a[188:191], v[72:75], v[96:99], a[188:191]
    ds_read_b64_tr_b16 v[42:43], v5 offset:51272
    v_mfma_f32_16x16x32_bf16 a[188:191], v[68:71], v[92:95], a[188:191]
    v_mfma_f32_16x16x32_bf16 a[184:187], v[68:71], v[84:87], a[184:187]
    v_mfma_f32_16x16x32_bf16 a[184:187], v[72:75], v[88:91], a[184:187]
    v_mfma_f32_16x16x32_bf16 a[180:183], v[72:75], v[80:83], a[180:183]
    s_waitcnt lgkmcnt(2)
    v_mfma_f32_16x16x32_bf16 a[180:183], v[68:71], v[76:79], a[180:183]
    v_mfma_f32_16x16x32_bf16 a[192:195], v[12:15], v[76:79], a[192:195]
    ds_read_b64_tr_b16 v[44:45], v4 offset:50816
    v_mfma_f32_16x16x32_bf16 a[192:195], v[16:19], v[80:83], a[192:195]
    ds_read_b64_tr_b16 v[46:47], v4 offset:51328
    v_mfma_f32_16x16x32_bf16 a[196:199], v[16:19], v[88:91], a[196:199]
    ds_read_b64_tr_b16 v[48:49], v5 offset:50816
    v_mfma_f32_16x16x32_bf16 a[196:199], v[12:15], v[84:87], a[196:199]
    ds_read_b64_tr_b16 v[50:51], v5 offset:51328
    v_mfma_f32_16x16x32_bf16 a[200:203], v[12:15], v[92:95], a[200:203]
    s_xor_b32 s64, s26, 786944
    ds_read_b64_tr_b16 v[52:53], v4 offset:50824
    v_mfma_f32_16x16x32_bf16 a[200:203], v[16:19], v[96:99], a[200:203]
    s_add_u32 m0, s61, 109824
    ds_read_b64_tr_b16 v[54:55], v4 offset:51336
    v_mfma_f32_16x16x32_bf16 a[212:215], v[24:27], v[96:99], a[212:215]
    buffer_load_dwordx4 v6, s[36:39], s64 offen lds
    v_mfma_f32_16x16x32_bf16 a[212:215], v[20:23], v[92:95], a[212:215]
    ds_read_b64_tr_b16 v[56:57], v5 offset:50824
    v_mfma_f32_16x16x32_bf16 a[208:211], v[20:23], v[84:87], a[208:211]
    ds_read_b64_tr_b16 v[58:59], v5 offset:51336
    v_mfma_f32_16x16x32_bf16 a[208:211], v[24:27], v[88:91], a[208:211]
    s_xor_b32 s64, s26, 795136
    ds_read_b64_tr_b16 v[60:61], v4 offset:50880
    v_mfma_f32_16x16x32_bf16 a[204:207], v[24:27], v[80:83], a[204:207]
    s_add_u32 m0, s61, 110856
    ds_read_b64_tr_b16 v[62:63], v4 offset:51392
    v_mfma_f32_16x16x32_bf16 a[204:207], v[20:23], v[76:79], a[204:207]
    buffer_load_dwordx4 v6, s[36:39], s64 offen lds
    v_mfma_f32_16x16x32_bf16 a[216:219], v[28:31], v[76:79], a[216:219]
    ds_read_b64_tr_b16 v[64:65], v5 offset:50880
    v_mfma_f32_16x16x32_bf16 a[216:219], v[32:35], v[80:83], a[216:219]
    s_lshr_b32 s65, s75, 8
    ds_read_b64_tr_b16 v[66:67], v5 offset:51392
    v_mfma_f32_16x16x32_bf16 a[220:223], v[32:35], v[88:91], a[220:223]
    s_mul_i32 s65, s65, 163840
    ds_read_b64_tr_b16 v[68:69], v4 offset:50888
    v_mfma_f32_16x16x32_bf16 a[220:223], v[28:31], v[84:87], a[220:223]
    ds_read_b64_tr_b16 v[70:71], v4 offset:51400
    v_mfma_f32_16x16x32_bf16 a[224:227], v[28:31], v[92:95], a[224:227]
    buffer_load_dword v9, v7, s[48:51], s65 offen
    v_mfma_f32_16x16x32_bf16 a[224:227], v[32:35], v[96:99], a[224:227]
    s_waitcnt lgkmcnt(14)
    ds_read_b64_tr_b16 v[72:73], v5 offset:50888
    v_mfma_f32_16x16x32_bf16 a[236:239], v[40:43], v[96:99], a[236:239]
    ds_read_b64_tr_b16 v[74:75], v5 offset:51400
    v_mfma_f32_16x16x32_bf16 a[236:239], v[36:39], v[92:95], a[236:239]
    v_mfma_f32_16x16x32_bf16 a[232:235], v[36:39], v[84:87], a[232:235]
    v_mfma_f32_16x16x32_bf16 a[232:235], v[40:43], v[88:91], a[232:235]
    v_mfma_f32_16x16x32_bf16 a[228:231], v[40:43], v[80:83], a[228:231]
    s_waitcnt vmcnt(8) lgkmcnt(0)
    v_mfma_f32_16x16x32_bf16 a[228:231], v[36:39], v[76:79], a[228:231]
    s_barrier
    v_mfma_f32_16x16x32_bf16 a[240:243], v[44:47], v[76:79], a[240:243]
    ds_read_b64_tr_b16 v[12:13], v4 offset:59136
    v_mfma_f32_16x16x32_bf16 a[240:243], v[48:51], v[80:83], a[240:243]
    ds_read_b64_tr_b16 v[14:15], v4 offset:59648
    v_mfma_f32_16x16x32_bf16 a[244:247], v[48:51], v[88:91], a[244:247]
    ds_read_b64_tr_b16 v[16:17], v5 offset:59136
    v_mfma_f32_16x16x32_bf16 a[244:247], v[44:47], v[84:87], a[244:247]
    ds_read_b64_tr_b16 v[18:19], v5 offset:59648
    v_mfma_f32_16x16x32_bf16 a[248:251], v[44:47], v[92:95], a[248:251]
    s_xor_b32 s64, s26, 524544
    ds_read_b64_tr_b16 v[20:21], v4 offset:59144
    v_mfma_f32_16x16x32_bf16 a[248:251], v[48:51], v[96:99], a[248:251]
    s_add_u32 m0, s61, 50688
    ds_read_b64_tr_b16 v[22:23], v4 offset:59656
    v_mfma_f32_16x16x32_bf16 v[128:131], v[56:59], v[96:99], v[128:131]
    buffer_load_dwordx4 v6, s[36:39], s64 offen lds
    v_mfma_f32_16x16x32_bf16 v[128:131], v[52:55], v[92:95], v[128:131]
    ds_read_b64_tr_b16 v[24:25], v5 offset:59144
    v_mfma_f32_16x16x32_bf16 v[124:127], v[52:55], v[84:87], v[124:127]
    ds_read_b64_tr_b16 v[26:27], v5 offset:59656
    v_mfma_f32_16x16x32_bf16 v[124:127], v[56:59], v[88:91], v[124:127]
    s_xor_b32 s64, s26, 532736
    ds_read_b64_tr_b16 v[28:29], v4 offset:59200
    v_mfma_f32_16x16x32_bf16 a[252:255], v[56:59], v[80:83], a[252:255]
    s_add_u32 m0, s61, 51720
    ds_read_b64_tr_b16 v[30:31], v4 offset:59712
    v_mfma_f32_16x16x32_bf16 a[252:255], v[52:55], v[76:79], a[252:255]
    buffer_load_dwordx4 v6, s[36:39], s64 offen lds
    v_mfma_f32_16x16x32_bf16 v[132:135], v[60:63], v[76:79], v[132:135]
    ds_read_b64_tr_b16 v[32:33], v5 offset:59200
    v_mfma_f32_16x16x32_bf16 v[132:135], v[64:67], v[80:83], v[132:135]
    ds_read_b64_tr_b16 v[34:35], v5 offset:59712
    v_mfma_f32_16x16x32_bf16 v[136:139], v[64:67], v[88:91], v[136:139]
    ds_read_b64_tr_b16 v[36:37], v4 offset:59208
    v_mfma_f32_16x16x32_bf16 v[136:139], v[60:63], v[84:87], v[136:139]
    ds_read_b64_tr_b16 v[38:39], v4 offset:59720
    v_mfma_f32_16x16x32_bf16 v[140:143], v[60:63], v[92:95], v[140:143]
    v_mfma_f32_16x16x32_bf16 v[140:143], v[64:67], v[96:99], v[140:143]
    ds_read_b64_tr_b16 v[40:41], v5 offset:59208
    v_mfma_f32_16x16x32_bf16 v[152:155], v[72:75], v[96:99], v[152:155]
    ds_read_b64_tr_b16 v[42:43], v5 offset:59720
    v_mfma_f32_16x16x32_bf16 v[152:155], v[68:71], v[92:95], v[152:155]
    v_mfma_f32_16x16x32_bf16 v[148:151], v[68:71], v[84:87], v[148:151]
    v_mfma_f32_16x16x32_bf16 v[148:151], v[72:75], v[88:91], v[148:151]
    v_mfma_f32_16x16x32_bf16 v[144:147], v[72:75], v[80:83], v[144:147]
    s_waitcnt lgkmcnt(2)
    v_mfma_f32_16x16x32_bf16 v[144:147], v[68:71], v[76:79], v[144:147]
    v_mfma_f32_16x16x32_bf16 v[160:163], v[12:15], v[76:79], v[160:163]
    ds_read_b64_tr_b16 v[44:45], v4 offset:59264
    v_mfma_f32_16x16x32_bf16 v[160:163], v[16:19], v[80:83], v[160:163]
    ds_read_b64_tr_b16 v[46:47], v4 offset:59776
    v_mfma_f32_16x16x32_bf16 v[164:167], v[16:19], v[88:91], v[164:167]
    ds_read_b64_tr_b16 v[48:49], v5 offset:59264
    v_mfma_f32_16x16x32_bf16 v[164:167], v[12:15], v[84:87], v[164:167]
    ds_read_b64_tr_b16 v[50:51], v5 offset:59776
    v_mfma_f32_16x16x32_bf16 v[168:171], v[12:15], v[92:95], v[168:171]
    s_xor_b32 s64, s26, 786688
    ds_read_b64_tr_b16 v[52:53], v4 offset:59272
    v_mfma_f32_16x16x32_bf16 v[168:171], v[16:19], v[96:99], v[168:171]
    s_add_u32 m0, s61, 118272
    ds_read_b64_tr_b16 v[54:55], v4 offset:59784
    v_mfma_f32_16x16x32_bf16 v[180:183], v[24:27], v[96:99], v[180:183]
    buffer_load_dwordx4 v6, s[36:39], s64 offen lds
    v_mfma_f32_16x16x32_bf16 v[180:183], v[20:23], v[92:95], v[180:183]
    ds_read_b64_tr_b16 v[56:57], v5 offset:59272
    v_mfma_f32_16x16x32_bf16 v[176:179], v[20:23], v[84:87], v[176:179]
    ds_read_b64_tr_b16 v[58:59], v5 offset:59784
    v_mfma_f32_16x16x32_bf16 v[176:179], v[24:27], v[88:91], v[176:179]
    s_xor_b32 s64, s26, 794880
    ds_read_b64_tr_b16 v[60:61], v4 offset:59328
    v_mfma_f32_16x16x32_bf16 v[172:175], v[24:27], v[80:83], v[172:175]
    s_add_u32 m0, s61, 119304
    ds_read_b64_tr_b16 v[62:63], v4 offset:59840
    v_mfma_f32_16x16x32_bf16 v[172:175], v[20:23], v[76:79], v[172:175]
    buffer_load_dwordx4 v6, s[36:39], s64 offen lds
    v_mfma_f32_16x16x32_bf16 v[184:187], v[28:31], v[76:79], v[184:187]
    ds_read_b64_tr_b16 v[64:65], v5 offset:59328
    v_mfma_f32_16x16x32_bf16 v[184:187], v[32:35], v[80:83], v[184:187]
    ds_read_b64_tr_b16 v[66:67], v5 offset:59840
    v_mfma_f32_16x16x32_bf16 v[188:191], v[32:35], v[88:91], v[188:191]
    ds_read_b64_tr_b16 v[68:69], v4 offset:59336
    v_mfma_f32_16x16x32_bf16 v[188:191], v[28:31], v[84:87], v[188:191]
    s_waitcnt vmcnt(8)
    ds_read_b64_tr_b16 v[70:71], v4 offset:59848
    v_mfma_f32_16x16x32_bf16 v[192:195], v[28:31], v[92:95], v[192:195]
    ds_read_b128 v[100:103], v158 offset:0
    v_mfma_f32_16x16x32_bf16 v[192:195], v[32:35], v[96:99], v[192:195]
    s_waitcnt lgkmcnt(14)
    ds_read_b64_tr_b16 v[72:73], v5 offset:59336
    v_mfma_f32_16x16x32_bf16 v[204:207], v[40:43], v[96:99], v[204:207]
    ds_read_b64_tr_b16 v[74:75], v5 offset:59848
    v_mfma_f32_16x16x32_bf16 v[204:207], v[36:39], v[92:95], v[204:207]
    ds_read_b128 v[104:107], v159 offset:0
    v_mfma_f32_16x16x32_bf16 v[200:203], v[36:39], v[84:87], v[200:203]
    ds_read_b128 v[108:111], v158 offset:2048
    v_mfma_f32_16x16x32_bf16 v[200:203], v[40:43], v[88:91], v[200:203]
    ds_read_b128 v[112:115], v159 offset:2048
    v_mfma_f32_16x16x32_bf16 v[196:199], v[40:43], v[80:83], v[196:199]
    s_waitcnt vmcnt(8) lgkmcnt(3)
    v_mfma_f32_16x16x32_bf16 v[196:199], v[36:39], v[76:79], v[196:199]
    s_barrier
    v_mfma_f32_16x16x32_bf16 v[208:211], v[44:47], v[76:79], v[208:211]
    ds_read_b64_tr_b16 v[12:13], v4 offset:33792
    v_mfma_f32_16x16x32_bf16 v[208:211], v[48:51], v[80:83], v[208:211]
    ds_read_b64_tr_b16 v[14:15], v4 offset:34304
    v_mfma_f32_16x16x32_bf16 v[212:215], v[48:51], v[88:91], v[212:215]
    ds_read_b64_tr_b16 v[16:17], v5 offset:33792
    v_mfma_f32_16x16x32_bf16 v[212:215], v[44:47], v[84:87], v[212:215]
    ds_read_b64_tr_b16 v[18:19], v5 offset:34304
    v_mfma_f32_16x16x32_bf16 v[216:219], v[44:47], v[92:95], v[216:219]
    s_xor_b32 s64, s26, 524288
    ds_read_b64_tr_b16 v[20:21], v4 offset:33800
    v_mfma_f32_16x16x32_bf16 v[216:219], v[48:51], v[96:99], v[216:219]
    s_add_u32 m0, s61, 59136
    ds_read_b64_tr_b16 v[22:23], v4 offset:34312
    v_mfma_f32_16x16x32_bf16 v[228:231], v[56:59], v[96:99], v[228:231]
    buffer_load_dwordx4 v6, s[36:39], s64 offen lds
    v_mfma_f32_16x16x32_bf16 v[228:231], v[52:55], v[92:95], v[228:231]
    ds_read_b64_tr_b16 v[24:25], v5 offset:33800
    v_mfma_f32_16x16x32_bf16 v[224:227], v[52:55], v[84:87], v[224:227]
    ds_read_b64_tr_b16 v[26:27], v5 offset:34312
    v_mfma_f32_16x16x32_bf16 v[224:227], v[56:59], v[88:91], v[224:227]
    s_xor_b32 s64, s26, 532480
    ds_read_b64_tr_b16 v[28:29], v4 offset:33856
    v_mfma_f32_16x16x32_bf16 v[220:223], v[56:59], v[80:83], v[220:223]
    s_add_u32 m0, s61, 60168
    ds_read_b64_tr_b16 v[30:31], v4 offset:34368
    v_mfma_f32_16x16x32_bf16 v[220:223], v[52:55], v[76:79], v[220:223]
    buffer_load_dwordx4 v6, s[36:39], s64 offen lds
    v_mfma_f32_16x16x32_bf16 v[232:235], v[60:63], v[76:79], v[232:235]
    ds_read_b64_tr_b16 v[32:33], v5 offset:33856
    v_mfma_f32_16x16x32_bf16 v[232:235], v[64:67], v[80:83], v[232:235]
    ds_read_b64_tr_b16 v[34:35], v5 offset:34368
    v_mfma_f32_16x16x32_bf16 v[236:239], v[64:67], v[88:91], v[236:239]
    ds_read_b64_tr_b16 v[36:37], v4 offset:33864
    v_mfma_f32_16x16x32_bf16 v[236:239], v[60:63], v[84:87], v[236:239]
    ds_read_b64_tr_b16 v[38:39], v4 offset:34376
    v_mfma_f32_16x16x32_bf16 v[240:243], v[60:63], v[92:95], v[240:243]
    ds_read_b128 v[116:119], v158 offset:4096
    v_mfma_f32_16x16x32_bf16 v[240:243], v[64:67], v[96:99], v[240:243]
    ds_read_b64_tr_b16 v[40:41], v5 offset:33864
    v_mfma_f32_16x16x32_bf16 v[252:255], v[72:75], v[96:99], v[252:255]
    ds_read_b64_tr_b16 v[42:43], v5 offset:34376
    v_mfma_f32_16x16x32_bf16 v[252:255], v[68:71], v[92:95], v[252:255]
    ds_read_b128 v[120:123], v159 offset:4096
    v_mfma_f32_16x16x32_bf16 v[248:251], v[68:71], v[84:87], v[248:251]
    v_mfma_f32_16x16x32_bf16 v[248:251], v[72:75], v[88:91], v[248:251]
    v_mfma_f32_16x16x32_bf16 v[244:247], v[72:75], v[80:83], v[244:247]
    s_waitcnt lgkmcnt(3)
    v_mfma_f32_16x16x32_bf16 v[244:247], v[68:71], v[76:79], v[244:247]
    v_mfma_f32_16x16x32_bf16 a[0:3], v[12:15], v[100:103], a[0:3]
    ds_read_b64_tr_b16 v[44:45], v4 offset:33920
    v_mfma_f32_16x16x32_bf16 a[0:3], v[16:19], v[104:107], a[0:3]
    ds_read_b64_tr_b16 v[46:47], v4 offset:34432
    v_mfma_f32_16x16x32_bf16 a[4:7], v[16:19], v[112:115], a[4:7]
    ds_read_b64_tr_b16 v[48:49], v5 offset:33920
    v_mfma_f32_16x16x32_bf16 a[4:7], v[12:15], v[108:111], a[4:7]
    ds_read_b64_tr_b16 v[50:51], v5 offset:34432
    v_mfma_f32_16x16x32_bf16 a[8:11], v[12:15], v[116:119], a[8:11]
    s_waitcnt lgkmcnt(4)
    s_xor_b32 s64, s26, 786432
    ds_read_b64_tr_b16 v[52:53], v4 offset:33928
    v_mfma_f32_16x16x32_bf16 a[8:11], v[16:19], v[120:123], a[8:11]
    s_add_u32 m0, s61, 126720
    ds_read_b64_tr_b16 v[54:55], v4 offset:34440
    v_mfma_f32_16x16x32_bf16 a[20:23], v[24:27], v[120:123], a[20:23]
    buffer_load_dwordx4 v6, s[36:39], s64 offen lds
    v_mfma_f32_16x16x32_bf16 a[20:23], v[20:23], v[116:119], a[20:23]
    ds_read_b64_tr_b16 v[56:57], v5 offset:33928
    v_mfma_f32_16x16x32_bf16 a[16:19], v[20:23], v[108:111], a[16:19]
    ds_read_b64_tr_b16 v[58:59], v5 offset:34440
    v_mfma_f32_16x16x32_bf16 a[16:19], v[24:27], v[112:115], a[16:19]
    s_xor_b32 s64, s26, 794624
    ds_read_b64_tr_b16 v[60:61], v4 offset:33984
    v_mfma_f32_16x16x32_bf16 a[12:15], v[24:27], v[104:107], a[12:15]
    s_add_u32 m0, s61, 127752
    ds_read_b64_tr_b16 v[62:63], v4 offset:34496
    v_mfma_f32_16x16x32_bf16 a[12:15], v[20:23], v[100:103], a[12:15]
    buffer_load_dwordx4 v6, s[36:39], s64 offen lds
    v_mfma_f32_16x16x32_bf16 a[24:27], v[28:31], v[100:103], a[24:27]
    ds_read_b64_tr_b16 v[64:65], v5 offset:33984
    v_mfma_f32_16x16x32_bf16 a[24:27], v[32:35], v[104:107], a[24:27]
    ds_read_b64_tr_b16 v[66:67], v5 offset:34496
    v_mfma_f32_16x16x32_bf16 a[28:31], v[32:35], v[112:115], a[28:31]
    s_add_u32 s65, s75, 256
    ds_read_b64_tr_b16 v[68:69], v4 offset:33992
    v_mfma_f32_16x16x32_bf16 a[28:31], v[28:31], v[108:111], a[28:31]
    s_add_u32 m0, s63, 0
    ds_read_b64_tr_b16 v[70:71], v4 offset:34504
    v_mfma_f32_16x16x32_bf16 a[32:35], v[28:31], v[116:119], a[32:35]
    buffer_load_dwordx4 v156, s[32:35], s65 offen lds
    v_mfma_f32_16x16x32_bf16 a[32:35], v[32:35], v[120:123], a[32:35]
    ds_read_b64_tr_b16 v[72:73], v5 offset:33992
    v_mfma_f32_16x16x32_bf16 a[44:47], v[40:43], v[120:123], a[44:47]
    s_add_u32 m0, s63, 1024
    ds_read_b64_tr_b16 v[74:75], v5 offset:34504
    v_mfma_f32_16x16x32_bf16 a[44:47], v[36:39], v[116:119], a[44:47]
    buffer_load_dwordx4 v157, s[32:35], s65 offen lds
    v_mfma_f32_16x16x32_bf16 a[40:43], v[36:39], v[108:111], a[40:43]
    v_mfma_f32_16x16x32_bf16 a[40:43], v[40:43], v[112:115], a[40:43]
    v_mfma_f32_16x16x32_bf16 a[36:39], v[40:43], v[104:107], a[36:39]
    s_waitcnt vmcnt(8) lgkmcnt(0)
    v_mfma_f32_16x16x32_bf16 a[36:39], v[36:39], v[100:103], a[36:39]
    s_barrier
    v_mfma_f32_16x16x32_bf16 a[48:51], v[44:47], v[100:103], a[48:51]
    ds_read_b64_tr_b16 v[12:13], v4 offset:42240
    v_mfma_f32_16x16x32_bf16 a[48:51], v[48:51], v[104:107], a[48:51]
    ds_read_b64_tr_b16 v[14:15], v4 offset:42752
    v_mfma_f32_16x16x32_bf16 a[52:55], v[48:51], v[112:115], a[52:55]
    ds_read_b64_tr_b16 v[16:17], v5 offset:42240
    v_mfma_f32_16x16x32_bf16 a[52:55], v[44:47], v[108:111], a[52:55]
    ds_read_b64_tr_b16 v[18:19], v5 offset:42752
    v_mfma_f32_16x16x32_bf16 a[56:59], v[44:47], v[116:119], a[56:59]
    s_xor_b32 s64, s20, 768
    ds_read_b64_tr_b16 v[20:21], v4 offset:42248
    v_mfma_f32_16x16x32_bf16 a[56:59], v[48:51], v[120:123], a[56:59]
    s_add_u32 m0, s61, 33792
    ds_read_b64_tr_b16 v[22:23], v4 offset:42760
    v_mfma_f32_16x16x32_bf16 a[68:71], v[56:59], v[120:123], a[68:71]
    buffer_load_dwordx4 v6, s[36:39], s64 offen lds
    v_mfma_f32_16x16x32_bf16 a[68:71], v[52:55], v[116:119], a[68:71]
    ds_read_b64_tr_b16 v[24:25], v5 offset:42248
    v_mfma_f32_16x16x32_bf16 a[64:67], v[52:55], v[108:111], a[64:67]
    ds_read_b64_tr_b16 v[26:27], v5 offset:42760
    v_mfma_f32_16x16x32_bf16 a[64:67], v[56:59], v[112:115], a[64:67]
    s_xor_b32 s64, s20, 8960
    ds_read_b64_tr_b16 v[28:29], v4 offset:42304
    v_mfma_f32_16x16x32_bf16 a[60:63], v[56:59], v[104:107], a[60:63]
    s_add_u32 m0, s61, 34824
    ds_read_b64_tr_b16 v[30:31], v4 offset:42816
    v_mfma_f32_16x16x32_bf16 a[60:63], v[52:55], v[100:103], a[60:63]
    buffer_load_dwordx4 v6, s[36:39], s64 offen lds
    v_mfma_f32_16x16x32_bf16 a[72:75], v[60:63], v[100:103], a[72:75]
    ds_read_b64_tr_b16 v[32:33], v5 offset:42304
    v_mfma_f32_16x16x32_bf16 a[72:75], v[64:67], v[104:107], a[72:75]
    ds_read_b64_tr_b16 v[34:35], v5 offset:42816
    v_mfma_f32_16x16x32_bf16 a[76:79], v[64:67], v[112:115], a[76:79]
    s_add_u32 s65, s75, 20736
    ds_read_b64_tr_b16 v[36:37], v4 offset:42312
    v_mfma_f32_16x16x32_bf16 a[76:79], v[60:63], v[108:111], a[76:79]
    s_add_u32 m0, s63, 2048
    ds_read_b64_tr_b16 v[38:39], v4 offset:42824
    v_mfma_f32_16x16x32_bf16 a[80:83], v[60:63], v[116:119], a[80:83]
    buffer_load_dwordx4 v156, s[32:35], s65 offen lds
    v_mfma_f32_16x16x32_bf16 a[80:83], v[64:67], v[120:123], a[80:83]
    ds_read_b64_tr_b16 v[40:41], v5 offset:42312
    v_mfma_f32_16x16x32_bf16 a[92:95], v[72:75], v[120:123], a[92:95]
    s_add_u32 m0, s63, 3072
    ds_read_b64_tr_b16 v[42:43], v5 offset:42824
    v_mfma_f32_16x16x32_bf16 a[92:95], v[68:71], v[116:119], a[92:95]
    buffer_load_dwordx4 v157, s[32:35], s65 offen lds
    v_mfma_f32_16x16x32_bf16 a[88:91], v[68:71], v[108:111], a[88:91]
    v_mfma_f32_16x16x32_bf16 a[88:91], v[72:75], v[112:115], a[88:91]
    v_mfma_f32_16x16x32_bf16 a[84:87], v[72:75], v[104:107], a[84:87]
    s_waitcnt lgkmcnt(2)
    v_mfma_f32_16x16x32_bf16 a[84:87], v[68:71], v[100:103], a[84:87]
    v_mfma_f32_16x16x32_bf16 a[96:99], v[12:15], v[100:103], a[96:99]
    ds_read_b64_tr_b16 v[44:45], v4 offset:42368
    v_mfma_f32_16x16x32_bf16 a[96:99], v[16:19], v[104:107], a[96:99]
    ds_read_b64_tr_b16 v[46:47], v4 offset:42880
    v_mfma_f32_16x16x32_bf16 a[100:103], v[16:19], v[112:115], a[100:103]
    ds_read_b64_tr_b16 v[48:49], v5 offset:42368
    v_mfma_f32_16x16x32_bf16 a[100:103], v[12:15], v[108:111], a[100:103]
    ds_read_b64_tr_b16 v[50:51], v5 offset:42880
    v_mfma_f32_16x16x32_bf16 a[104:107], v[12:15], v[116:119], a[104:107]
    s_xor_b32 s64, s20, 262912
    ds_read_b64_tr_b16 v[52:53], v4 offset:42376
    v_mfma_f32_16x16x32_bf16 a[104:107], v[16:19], v[120:123], a[104:107]
    s_add_u32 m0, s61, 101376
    ds_read_b64_tr_b16 v[54:55], v4 offset:42888
    v_mfma_f32_16x16x32_bf16 a[116:119], v[24:27], v[120:123], a[116:119]
    buffer_load_dwordx4 v6, s[36:39], s64 offen lds
    v_mfma_f32_16x16x32_bf16 a[116:119], v[20:23], v[116:119], a[116:119]
    ds_read_b64_tr_b16 v[56:57], v5 offset:42376
    v_mfma_f32_16x16x32_bf16 a[112:115], v[20:23], v[108:111], a[112:115]
    ds_read_b64_tr_b16 v[58:59], v5 offset:42888
    v_mfma_f32_16x16x32_bf16 a[112:115], v[24:27], v[112:115], a[112:115]
    s_xor_b32 s64, s20, 271104
    ds_read_b64_tr_b16 v[60:61], v4 offset:42432
    v_mfma_f32_16x16x32_bf16 a[108:111], v[24:27], v[104:107], a[108:111]
    s_add_u32 m0, s61, 102408
    ds_read_b64_tr_b16 v[62:63], v4 offset:42944
    v_mfma_f32_16x16x32_bf16 a[108:111], v[20:23], v[100:103], a[108:111]
    buffer_load_dwordx4 v6, s[36:39], s64 offen lds
    v_mfma_f32_16x16x32_bf16 a[120:123], v[28:31], v[100:103], a[120:123]
    ds_read_b64_tr_b16 v[64:65], v5 offset:42432
    v_mfma_f32_16x16x32_bf16 a[120:123], v[32:35], v[104:107], a[120:123]
    ds_read_b64_tr_b16 v[66:67], v5 offset:42944
    v_mfma_f32_16x16x32_bf16 a[124:127], v[32:35], v[112:115], a[124:127]
    s_add_u32 s65, s75, 41216
    ds_read_b64_tr_b16 v[68:69], v4 offset:42440
    v_mfma_f32_16x16x32_bf16 a[124:127], v[28:31], v[108:111], a[124:127]
    s_add_u32 m0, s63, 4096
    ds_read_b64_tr_b16 v[70:71], v4 offset:42952
    v_mfma_f32_16x16x32_bf16 a[128:131], v[28:31], v[116:119], a[128:131]
    buffer_load_dwordx4 v156, s[32:35], s65 offen lds
    v_mfma_f32_16x16x32_bf16 a[128:131], v[32:35], v[120:123], a[128:131]
    s_waitcnt lgkmcnt(14)
    ds_read_b64_tr_b16 v[72:73], v5 offset:42440
    v_mfma_f32_16x16x32_bf16 a[140:143], v[40:43], v[120:123], a[140:143]
    s_add_u32 m0, s63, 5120
    ds_read_b64_tr_b16 v[74:75], v5 offset:42952
    v_mfma_f32_16x16x32_bf16 a[140:143], v[36:39], v[116:119], a[140:143]
    buffer_load_dwordx4 v157, s[32:35], s65 offen lds
    v_mfma_f32_16x16x32_bf16 a[136:139], v[36:39], v[108:111], a[136:139]
    v_mfma_f32_16x16x32_bf16 a[136:139], v[40:43], v[112:115], a[136:139]
    v_mfma_f32_16x16x32_bf16 a[132:135], v[40:43], v[104:107], a[132:135]
    s_waitcnt vmcnt(8) lgkmcnt(0)
    v_mfma_f32_16x16x32_bf16 a[132:135], v[36:39], v[100:103], a[132:135]
    s_barrier
    v_mfma_f32_16x16x32_bf16 a[144:147], v[44:47], v[100:103], a[144:147]
    s_cmp_ge_u32 s23, s76
    ds_read_b64_tr_b16 v[12:13], v4 offset:50688
    v_mfma_f32_16x16x32_bf16 a[144:147], v[48:51], v[104:107], a[144:147]
    s_cselect_b64 vcc, -1, 0
    ds_read_b64_tr_b16 v[14:15], v4 offset:51200
    v_mfma_f32_16x16x32_bf16 a[148:151], v[48:51], v[112:115], a[148:151]
    s_cselect_b32 s25, 0, 8192
    ds_read_b64_tr_b16 v[16:17], v5 offset:50688
    v_mfma_f32_16x16x32_bf16 a[148:151], v[44:47], v[108:111], a[148:151]
    s_add_u32 s58, s23, 0
    ds_read_b64_tr_b16 v[18:19], v5 offset:51200
    v_mfma_f32_16x16x32_bf16 a[152:155], v[44:47], v[116:119], a[152:155]
    s_xor_b32 s64, s20, 512
    ds_read_b64_tr_b16 v[20:21], v4 offset:50696
    v_mfma_f32_16x16x32_bf16 a[152:155], v[48:51], v[120:123], a[152:155]
    s_add_u32 m0, s61, 42240
    ds_read_b64_tr_b16 v[22:23], v4 offset:51208
    v_mfma_f32_16x16x32_bf16 a[164:167], v[56:59], v[120:123], a[164:167]
    buffer_load_dwordx4 v6, s[36:39], s64 offen lds
    v_mfma_f32_16x16x32_bf16 a[164:167], v[52:55], v[116:119], a[164:167]
    s_xor_b32 s65, s58, s22
    ds_read_b64_tr_b16 v[24:25], v5 offset:50696
    v_mfma_f32_16x16x32_bf16 a[160:163], v[52:55], v[108:111], a[160:163]
    s_bfe_u32 s58, s58, 0x3000d
    ds_read_b64_tr_b16 v[26:27], v5 offset:51208
    v_mfma_f32_16x16x32_bf16 a[160:163], v[56:59], v[112:115], a[160:163]
    s_xor_b32 s64, s20, 8704
    ds_read_b64_tr_b16 v[28:29], v4 offset:50752
    v_mfma_f32_16x16x32_bf16 a[156:159], v[56:59], v[104:107], a[156:159]
    s_add_u32 m0, s61, 43272
    ds_read_b64_tr_b16 v[30:31], v4 offset:51264
    v_mfma_f32_16x16x32_bf16 a[156:159], v[52:55], v[100:103], a[156:159]
    buffer_load_dwordx4 v6, s[36:39], s64 offen lds
    v_mfma_f32_16x16x32_bf16 a[168:171], v[60:63], v[100:103], a[168:171]
    s_mul_i32 s58, s58, 8448
    ds_read_b64_tr_b16 v[32:33], v5 offset:50752
    v_mfma_f32_16x16x32_bf16 a[168:171], v[64:67], v[104:107], a[168:171]
    ds_read_b64_tr_b16 v[34:35], v5 offset:51264
    v_mfma_f32_16x16x32_bf16 a[172:175], v[64:67], v[112:115], a[172:175]
    ds_read_b64_tr_b16 v[36:37], v4 offset:50760
    v_mfma_f32_16x16x32_bf16 a[172:175], v[60:63], v[108:111], a[172:175]
    s_add_u32 m0, s58, s3
    ds_read_b64_tr_b16 v[38:39], v4 offset:51272
    v_mfma_f32_16x16x32_bf16 a[176:179], v[60:63], v[116:119], a[176:179]
    s_cbranch_vccnz L_sk_6
    buffer_load_dwordx4 v1, s[44:47], s65 offen nt lds
L_sk_6:
    v_mfma_f32_16x16x32_bf16 a[176:179], v[64:67], v[120:123], a[176:179]
    ds_read_b64_tr_b16 v[40:41], v5 offset:50760
    v_mfma_f32_16x16x32_bf16 a[188:191], v[72:75], v[120:123], a[188:191]
    s_add_u32 m0, m0, 32
    ds_read_b64_tr_b16 v[42:43], v5 offset:51272
    v_mfma_f32_16x16x32_bf16 a[188:191], v[68:71], v[116:119], a[188:191]
    s_cbranch_vccnz L_sk_7
    buffer_load_dwordx4 v1, s[44:47], s65 offen offset:1024 nt lds
L_sk_7:
    v_mfma_f32_16x16x32_bf16 a[184:187], v[68:71], v[108:111], a[184:187]
    v_mfma_f32_16x16x32_bf16 a[184:187], v[72:75], v[112:115], a[184:187]
    v_mfma_f32_16x16x32_bf16 a[180:183], v[72:75], v[104:107], a[180:183]
    s_waitcnt lgkmcnt(2)
    v_mfma_f32_16x16x32_bf16 a[180:183], v[68:71], v[100:103], a[180:183]
    v_mfma_f32_16x16x32_bf16 a[192:195], v[12:15], v[100:103], a[192:195]
    s_add_u32 s59, s23, 8192
    ds_read_b64_tr_b16 v[44:45], v4 offset:50816
    v_mfma_f32_16x16x32_bf16 a[192:195], v[16:19], v[104:107], a[192:195]
    s_xor_b32 s65, s59, s22
    ds_read_b64_tr_b16 v[46:47], v4 offset:51328
    v_mfma_f32_16x16x32_bf16 a[196:199], v[16:19], v[112:115], a[196:199]
    s_bfe_u32 s59, s59, 0x3000d
    ds_read_b64_tr_b16 v[48:49], v5 offset:50816
    v_mfma_f32_16x16x32_bf16 a[196:199], v[12:15], v[108:111], a[196:199]
    s_mul_i32 s59, s59, 8448
    ds_read_b64_tr_b16 v[50:51], v5 offset:51328
    v_mfma_f32_16x16x32_bf16 a[200:203], v[12:15], v[116:119], a[200:203]
    s_xor_b32 s64, s20, 262656
    ds_read_b64_tr_b16 v[52:53], v4 offset:50824
    v_mfma_f32_16x16x32_bf16 a[200:203], v[16:19], v[120:123], a[200:203]
    s_add_u32 m0, s61, 109824
    ds_read_b64_tr_b16 v[54:55], v4 offset:51336
    v_mfma_f32_16x16x32_bf16 a[212:215], v[24:27], v[120:123], a[212:215]
    buffer_load_dwordx4 v6, s[36:39], s64 offen lds
    v_mfma_f32_16x16x32_bf16 a[212:215], v[20:23], v[116:119], a[212:215]
    s_add_u32 s23, s23, s25
    ds_read_b64_tr_b16 v[56:57], v5 offset:50824
    v_mfma_f32_16x16x32_bf16 a[208:211], v[20:23], v[108:111], a[208:211]
    ds_read_b64_tr_b16 v[58:59], v5 offset:51336
    v_mfma_f32_16x16x32_bf16 a[208:211], v[24:27], v[112:115], a[208:211]
    s_xor_b32 s64, s20, 270848
    ds_read_b64_tr_b16 v[60:61], v4 offset:50880
    v_mfma_f32_16x16x32_bf16 a[204:207], v[24:27], v[104:107], a[204:207]
    s_add_u32 m0, s61, 110856
    ds_read_b64_tr_b16 v[62:63], v4 offset:51392
    v_mfma_f32_16x16x32_bf16 a[204:207], v[20:23], v[100:103], a[204:207]
    buffer_load_dwordx4 v6, s[36:39], s64 offen lds
    v_mfma_f32_16x16x32_bf16 a[216:219], v[28:31], v[100:103], a[216:219]
    ds_read_b64_tr_b16 v[64:65], v5 offset:50880
    v_mfma_f32_16x16x32_bf16 a[216:219], v[32:35], v[104:107], a[216:219]
    ds_read_b64_tr_b16 v[66:67], v5 offset:51392
    v_mfma_f32_16x16x32_bf16 a[220:223], v[32:35], v[112:115], a[220:223]
    ds_read_b64_tr_b16 v[68:69], v4 offset:50888
    v_mfma_f32_16x16x32_bf16 a[220:223], v[28:31], v[108:111], a[220:223]
    s_add_u32 m0, s59, s61
    ds_read_b64_tr_b16 v[70:71], v4 offset:51400
    v_mfma_f32_16x16x32_bf16 a[224:227], v[28:31], v[116:119], a[224:227]
    s_cbranch_vccnz L_sk_8
    buffer_load_dwordx4 v1, s[40:43], s65 offen nt lds
L_sk_8:
    v_mfma_f32_16x16x32_bf16 a[224:227], v[32:35], v[120:123], a[224:227]
    s_waitcnt lgkmcnt(14)
    ds_read_b64_tr_b16 v[72:73], v5 offset:50888
    v_mfma_f32_16x16x32_bf16 a[236:239], v[40:43], v[120:123], a[236:239]
    s_add_u32 m0, m0, 32
    ds_read_b64_tr_b16 v[74:75], v5 offset:51400
    v_mfma_f32_16x16x32_bf16 a[236:239], v[36:39], v[116:119], a[236:239]
    s_cbranch_vccnz L_sk_9
    buffer_load_dwordx4 v1, s[40:43], s65 offen offset:1024 nt lds
L_sk_9:
    v_mfma_f32_16x16x32_bf16 a[232:235], v[36:39], v[108:111], a[232:235]
    v_mfma_f32_16x16x32_bf16 a[232:235], v[40:43], v[112:115], a[232:235]
    v_mfma_f32_16x16x32_bf16 a[228:231], v[40:43], v[104:107], a[228:231]
    s_waitcnt vmcnt(8) lgkmcnt(0)
    v_mfma_f32_16x16x32_bf16 a[228:231], v[36:39], v[100:103], a[228:231]
    s_barrier
    v_mfma_f32_16x16x32_bf16 a[240:243], v[44:47], v[100:103], a[240:243]
    ds_read_b64_tr_b16 v[12:13], v4 offset:59136
    v_mfma_f32_16x16x32_bf16 a[240:243], v[48:51], v[104:107], a[240:243]
    ds_read_b64_tr_b16 v[14:15], v4 offset:59648
    v_mfma_f32_16x16x32_bf16 a[244:247], v[48:51], v[112:115], a[244:247]
    ds_read_b64_tr_b16 v[16:17], v5 offset:59136
    v_mfma_f32_16x16x32_bf16 a[244:247], v[44:47], v[108:111], a[244:247]
    ds_read_b64_tr_b16 v[18:19], v5 offset:59648
    v_mfma_f32_16x16x32_bf16 a[248:251], v[44:47], v[116:119], a[248:251]
    s_xor_b32 s64, s20, 256
    ds_read_b64_tr_b16 v[20:21], v4 offset:59144
    v_mfma_f32_16x16x32_bf16 a[248:251], v[48:51], v[120:123], a[248:251]
    s_add_u32 m0, s61, 50688
    ds_read_b64_tr_b16 v[22:23], v4 offset:59656
    v_mfma_f32_16x16x32_bf16 v[128:131], v[56:59], v[120:123], v[128:131]
    buffer_load_dwordx4 v6, s[36:39], s64 offen lds
    v_mfma_f32_16x16x32_bf16 v[128:131], v[52:55], v[116:119], v[128:131]
    ds_read_b64_tr_b16 v[24:25], v5 offset:59144
    v_mfma_f32_16x16x32_bf16 v[124:127], v[52:55], v[108:111], v[124:127]
    ds_read_b64_tr_b16 v[26:27], v5 offset:59656
    v_mfma_f32_16x16x32_bf16 v[124:127], v[56:59], v[112:115], v[124:127]
    s_xor_b32 s64, s20, 8448
    ds_read_b64_tr_b16 v[28:29], v4 offset:59200
    v_mfma_f32_16x16x32_bf16 a[252:255], v[56:59], v[104:107], a[252:255]
    s_add_u32 m0, s61, 51720
    ds_read_b64_tr_b16 v[30:31], v4 offset:59712
    v_mfma_f32_16x16x32_bf16 a[252:255], v[52:55], v[100:103], a[252:255]
    buffer_load_dwordx4 v6, s[36:39], s64 offen lds
    v_mfma_f32_16x16x32_bf16 v[132:135], v[60:63], v[100:103], v[132:135]
    ds_read_b64_tr_b16 v[32:33], v5 offset:59200
    v_mfma_f32_16x16x32_bf16 v[132:135], v[64:67], v[104:107], v[132:135]
    ds_read_b64_tr_b16 v[34:35], v5 offset:59712
    v_mfma_f32_16x16x32_bf16 v[136:139], v[64:67], v[112:115], v[136:139]
    ds_read_b64_tr_b16 v[36:37], v4 offset:59208
    v_mfma_f32_16x16x32_bf16 v[136:139], v[60:63], v[108:111], v[136:139]
    ds_read_b64_tr_b16 v[38:39], v4 offset:59720
    v_mfma_f32_16x16x32_bf16 v[140:143], v[60:63], v[116:119], v[140:143]
    v_mfma_f32_16x16x32_bf16 v[140:143], v[64:67], v[120:123], v[140:143]
    ds_read_b64_tr_b16 v[40:41], v5 offset:59208
    v_mfma_f32_16x16x32_bf16 v[152:155], v[72:75], v[120:123], v[152:155]
    ds_read_b64_tr_b16 v[42:43], v5 offset:59720
    v_mfma_f32_16x16x32_bf16 v[152:155], v[68:71], v[116:119], v[152:155]
    v_mfma_f32_16x16x32_bf16 v[148:151], v[68:71], v[108:111], v[148:151]
    v_mfma_f32_16x16x32_bf16 v[148:151], v[72:75], v[112:115], v[148:151]
    v_mfma_f32_16x16x32_bf16 v[144:147], v[72:75], v[104:107], v[144:147]
    s_waitcnt lgkmcnt(2)
    v_mfma_f32_16x16x32_bf16 v[144:147], v[68:71], v[100:103], v[144:147]
    v_mfma_f32_16x16x32_bf16 v[160:163], v[12:15], v[100:103], v[160:163]
    ds_read_b64_tr_b16 v[44:45], v4 offset:59264
    v_mfma_f32_16x16x32_bf16 v[160:163], v[16:19], v[104:107], v[160:163]
    ds_read_b64_tr_b16 v[46:47], v4 offset:59776
    v_mfma_f32_16x16x32_bf16 v[164:167], v[16:19], v[112:115], v[164:167]
    ds_read_b64_tr_b16 v[48:49], v5 offset:59264
    v_mfma_f32_16x16x32_bf16 v[164:167], v[12:15], v[108:111], v[164:167]
    ds_read_b64_tr_b16 v[50:51], v5 offset:59776
    v_mfma_f32_16x16x32_bf16 v[168:171], v[12:15], v[116:119], v[168:171]
    s_xor_b32 s64, s20, 262400
    ds_read_b64_tr_b16 v[52:53], v4 offset:59272
    v_mfma_f32_16x16x32_bf16 v[168:171], v[16:19], v[120:123], v[168:171]
    s_add_u32 m0, s61, 118272
    ds_read_b64_tr_b16 v[54:55], v4 offset:59784
    v_mfma_f32_16x16x32_bf16 v[180:183], v[24:27], v[120:123], v[180:183]
    buffer_load_dwordx4 v6, s[36:39], s64 offen lds
    v_mfma_f32_16x16x32_bf16 v[180:183], v[20:23], v[116:119], v[180:183]
    ds_read_b64_tr_b16 v[56:57], v5 offset:59272
    v_mfma_f32_16x16x32_bf16 v[176:179], v[20:23], v[108:111], v[176:179]
    ds_read_b64_tr_b16 v[58:59], v5 offset:59784
    v_mfma_f32_16x16x32_bf16 v[176:179], v[24:27], v[112:115], v[176:179]
    s_xor_b32 s64, s20, 270592
    ds_read_b64_tr_b16 v[60:61], v4 offset:59328
    v_mfma_f32_16x16x32_bf16 v[172:175], v[24:27], v[104:107], v[172:175]
    s_add_u32 m0, s61, 119304
    ds_read_b64_tr_b16 v[62:63], v4 offset:59840
    v_mfma_f32_16x16x32_bf16 v[172:175], v[20:23], v[100:103], v[172:175]
    buffer_load_dwordx4 v6, s[36:39], s64 offen lds
    v_mfma_f32_16x16x32_bf16 v[184:187], v[28:31], v[100:103], v[184:187]
    ds_read_b64_tr_b16 v[64:65], v5 offset:59328
    v_mfma_f32_16x16x32_bf16 v[184:187], v[32:35], v[104:107], v[184:187]
    ds_read_b64_tr_b16 v[66:67], v5 offset:59840
    v_mfma_f32_16x16x32_bf16 v[188:191], v[32:35], v[112:115], v[188:191]
    ds_read_b64_tr_b16 v[68:69], v4 offset:59336
    v_mfma_f32_16x16x32_bf16 v[188:191], v[28:31], v[108:111], v[188:191]
    s_waitcnt vmcnt(8)
    ds_read_b64_tr_b16 v[70:71], v4 offset:59848
    v_mfma_f32_16x16x32_bf16 v[192:195], v[28:31], v[116:119], v[192:195]
    ds_read_b128 v[76:79], v158 offset:0
    v_mfma_f32_16x16x32_bf16 v[192:195], v[32:35], v[120:123], v[192:195]
    s_waitcnt lgkmcnt(14)
    ds_read_b64_tr_b16 v[72:73], v5 offset:59336
    v_mfma_f32_16x16x32_bf16 v[204:207], v[40:43], v[120:123], v[204:207]
    ds_read_b64_tr_b16 v[74:75], v5 offset:59848
    v_mfma_f32_16x16x32_bf16 v[204:207], v[36:39], v[116:119], v[204:207]
    ds_read_b128 v[80:83], v159 offset:0
    v_mfma_f32_16x16x32_bf16 v[200:203], v[36:39], v[108:111], v[200:203]
    ds_read_b128 v[84:87], v158 offset:2048
    v_mfma_f32_16x16x32_bf16 v[200:203], v[40:43], v[112:115], v[200:203]
    ds_read_b128 v[88:91], v159 offset:2048
    v_mfma_f32_16x16x32_bf16 v[196:199], v[40:43], v[104:107], v[196:199]
    s_waitcnt vmcnt(8) lgkmcnt(3)
    v_mfma_f32_16x16x32_bf16 v[196:199], v[36:39], v[100:103], v[196:199]
    s_barrier
    v_mfma_f32_16x16x32_bf16 v[208:211], v[44:47], v[100:103], v[208:211]
    ds_read_b64_tr_b16 v[12:13], v4 offset:33792
    v_mfma_f32_16x16x32_bf16 v[208:211], v[48:51], v[104:107], v[208:211]
    ds_read_b64_tr_b16 v[14:15], v4 offset:34304
    v_mfma_f32_16x16x32_bf16 v[212:215], v[48:51], v[112:115], v[212:215]
    ds_read_b64_tr_b16 v[16:17], v5 offset:33792
    v_mfma_f32_16x16x32_bf16 v[212:215], v[44:47], v[108:111], v[212:215]
    ds_read_b64_tr_b16 v[18:19], v5 offset:34304
    v_mfma_f32_16x16x32_bf16 v[216:219], v[44:47], v[116:119], v[216:219]
    s_xor_b32 s64, s20, 0
    ds_read_b64_tr_b16 v[20:21], v4 offset:33800
    v_mfma_f32_16x16x32_bf16 v[216:219], v[48:51], v[120:123], v[216:219]
    s_add_u32 m0, s61, 59136
    ds_read_b64_tr_b16 v[22:23], v4 offset:34312
    v_mfma_f32_16x16x32_bf16 v[228:231], v[56:59], v[120:123], v[228:231]
    buffer_load_dwordx4 v6, s[36:39], s64 offen lds
    v_mfma_f32_16x16x32_bf16 v[228:231], v[52:55], v[116:119], v[228:231]
    ds_read_b64_tr_b16 v[24:25], v5 offset:33800
    v_mfma_f32_16x16x32_bf16 v[224:227], v[52:55], v[108:111], v[224:227]
    ds_read_b64_tr_b16 v[26:27], v5 offset:34312
    v_mfma_f32_16x16x32_bf16 v[224:227], v[56:59], v[112:115], v[224:227]
    s_xor_b32 s64, s20, 8192
    ds_read_b64_tr_b16 v[28:29], v4 offset:33856
    v_mfma_f32_16x16x32_bf16 v[220:223], v[56:59], v[104:107], v[220:223]
    s_add_u32 m0, s61, 60168
    ds_read_b64_tr_b16 v[30:31], v4 offset:34368
    v_mfma_f32_16x16x32_bf16 v[220:223], v[52:55], v[100:103], v[220:223]
    buffer_load_dwordx4 v6, s[36:39], s64 offen lds
    v_mfma_f32_16x16x32_bf16 v[232:235], v[60:63], v[100:103], v[232:235]
    s_mov_b32 s26, s20
    ds_read_b64_tr_b16 v[32:33], v5 offset:33856
    v_mfma_f32_16x16x32_bf16 v[232:235], v[64:67], v[104:107], v[232:235]
    s_add_u32 s20, s20, 1048576
    ds_read_b64_tr_b16 v[34:35], v5 offset:34368
    v_mfma_f32_16x16x32_bf16 v[236:239], v[64:67], v[112:115], v[236:239]
    s_add_u32 s75, s75, 256
    ds_read_b64_tr_b16 v[36:37], v4 offset:33864
    v_mfma_f32_16x16x32_bf16 v[236:239], v[60:63], v[108:111], v[236:239]
    s_cmp_lt_u32 s75, 1024
    ds_read_b64_tr_b16 v[38:39], v4 offset:34376
    v_mfma_f32_16x16x32_bf16 v[240:243], v[60:63], v[116:119], v[240:243]
    ds_read_b128 v[92:95], v158 offset:4096
    v_mfma_f32_16x16x32_bf16 v[240:243], v[64:67], v[120:123], v[240:243]
    ds_read_b64_tr_b16 v[40:41], v5 offset:33864
    v_mfma_f32_16x16x32_bf16 v[252:255], v[72:75], v[120:123], v[252:255]
    ds_read_b64_tr_b16 v[42:43], v5 offset:34376
    v_mfma_f32_16x16x32_bf16 v[252:255], v[68:71], v[116:119], v[252:255]
    ds_read_b128 v[96:99], v159 offset:4096
    v_mfma_f32_16x16x32_bf16 v[248:251], v[68:71], v[108:111], v[248:251]
    v_mfma_f32_16x16x32_bf16 v[248:251], v[72:75], v[112:115], v[248:251]
    v_mfma_f32_16x16x32_bf16 v[244:247], v[72:75], v[104:107], v[244:247]
    s_waitcnt lgkmcnt(3)
    v_mfma_f32_16x16x32_bf16 v[244:247], v[68:71], v[100:103], v[244:247]
    s_cbranch_scc1 L_q
    s_getpc_b64 s[14:15]
L_pc_10:
    s_sub_u32 s14, s14, L_pc_10-L_enter
    s_subb_u32 s15, s15, 0
    s_lshr_b32 s69, s2, 3
    s_lshl_b32 s69, s69, 2
    s_add_u32 s69, s69, s60
    s_lshl_b32 s69, s69, 7
    v_and_b32 v10, 3, v0
    v_lshlrev_b32 v10, 14, v10
    v_add_u32 v10, s69, v10
    v_min_u32 v10, L_q2b-L_enter-4, v10
    global_load_dword v11, v10, s[14:15]
    v_mfma_f32_16x16x32_bf16 a[0:3], v[12:15], v[76:79], a[0:3]
    ds_read_b64_tr_b16 v[44:45], v4 offset:33920
    v_mfma_f32_16x16x32_bf16 a[0:3], v[16:19], v[80:83], a[0:3]
    ds_read_b64_tr_b16 v[46:47], v4 offset:34432
    v_mfma_f32_16x16x32_bf16 a[4:7], v[16:19], v[88:91], a[4:7]
    ds_read_b64_tr_b16 v[48:49], v5 offset:33920
    v_mfma_f32_16x16x32_bf16 a[4:7], v[12:15], v[84:87], a[4:7]
    ds_read_b64_tr_b16 v[50:51], v5 offset:34432
    v_mfma_f32_16x16x32_bf16 a[8:11], v[12:15], v[92:95], a[8:11]
    s_waitcnt lgkmcnt(4)
    s_xor_b32 s64, s26, 262144
    ds_read_b64_tr_b16 v[52:53], v4 offset:33928
    v_mfma_f32_16x16x32_bf16 a[8:11], v[16:19], v[96:99], a[8:11]
    s_add_u32 m0, s61, 126720
    ds_read_b64_tr_b16 v[54:55], v4 offset:34440
    v_mfma_f32_16x16x32_bf16 a[20:23], v[24:27], v[96:99], a[20:23]
    buffer_load_dwordx4 v6, s[36:39], s64 offen lds
    v_mfma_f32_16x16x32_bf16 a[20:23], v[20:23], v[92:95], a[20:23]
    ds_read_b64_tr_b16 v[56:57], v5 offset:33928
    v_mfma_f32_16x16x32_bf16 a[16:19], v[20:23], v[84:87], a[16:19]
    ds_read_b64_tr_b16 v[58:59], v5 offset:34440
    v_mfma_f32_16x16x32_bf16 a[16:19], v[24:27], v[88:91], a[16:19]
    s_xor_b32 s64, s26, 270336
    ds_read_b64_tr_b16 v[60:61], v4 offset:33984
    v_mfma_f32_16x16x32_bf16 a[12:15], v[24:27], v[80:83], a[12:15]
    s_add_u32 m0, s61, 127752
    ds_read_b64_tr_b16 v[62:63], v4 offset:34496
    v_mfma_f32_16x16x32_bf16 a[12:15], v[20:23], v[76:79], a[12:15]
    buffer_load_dwordx4 v6, s[36:39], s64 offen lds
    v_mfma_f32_16x16x32_bf16 a[24:27], v[28:31], v[76:79], a[24:27]
    ds_read_b64_tr_b16 v[64:65], v5 offset:33984
    v_mfma_f32_16x16x32_bf16 a[24:27], v[32:35], v[80:83], a[24:27]
    ds_read_b64_tr_b16 v[66:67], v5 offset:34496
    v_mfma_f32_16x16x32_bf16 a[28:31], v[32:35], v[88:91], a[28:31]
    s_xor_b32 s65, s75, 128
    ds_read_b64_tr_b16 v[68:69], v4 offset:33992
    v_mfma_f32_16x16x32_bf16 a[28:31], v[28:31], v[84:87], a[28:31]
    s_add_u32 m0, s63, 0
    ds_read_b64_tr_b16 v[70:71], v4 offset:34504
    v_mfma_f32_16x16x32_bf16 a[32:35], v[28:31], v[92:95], a[32:35]
    buffer_load_dwordx4 v156, s[32:35], s65 offen lds
    v_mfma_f32_16x16x32_bf16 a[32:35], v[32:35], v[96:99], a[32:35]
    ds_read_b64_tr_b16 v[72:73], v5 offset:33992
    v_mfma_f32_16x16x32_bf16 a[44:47], v[40:43], v[96:99], a[44:47]
    s_add_u32 m0, s63, 1024
    ds_read_b64_tr_b16 v[74:75], v5 offset:34504
    v_mfma_f32_16x16x32_bf16 a[44:47], v[36:39], v[92:95], a[44:47]
    buffer_load_dwordx4 v157, s[32:35], s65 offen lds
    v_mfma_f32_16x16x32_bf16 a[40:43], v[36:39], v[84:87], a[40:43]
    v_mfma_f32_16x16x32_bf16 a[40:43], v[40:43], v[88:91], a[40:43]
    v_mfma_f32_16x16x32_bf16 a[36:39], v[40:43], v[80:83], a[36:39]
    s_waitcnt vmcnt(8) lgkmcnt(0)
    v_mfma_f32_16x16x32_bf16 a[36:39], v[36:39], v[76:79], a[36:39]
    s_barrier
    v_mfma_f32_16x16x32_bf16 a[48:51], v[44:47], v[76:79], a[48:51]
    ds_read_b64_tr_b16 v[12:13], v4 offset:42240
    v_mfma_f32_16x16x32_bf16 a[48:51], v[48:51], v[80:83], a[48:51]
    ds_read_b64_tr_b16 v[14:15], v4 offset:42752
    v_mfma_f32_16x16x32_bf16 a[52:55], v[48:51], v[88:91], a[52:55]
    ds_read_b64_tr_b16 v[16:17], v5 offset:42240
    v_mfma_f32_16x16x32_bf16 a[52:55], v[44:47], v[84:87], a[52:55]
    ds_read_b64_tr_b16 v[18:19], v5 offset:42752
    v_mfma_f32_16x16x32_bf16 a[56:59], v[44:47], v[92:95], a[56:59]
    s_xor_b32 s64, s26, 525056
    ds_read_b64_tr_b16 v[20:21], v4 offset:42248
    v_mfma_f32_16x16x32_bf16 a[56:59], v[48:51], v[96:99], a[56:59]
    s_add_u32 m0, s61, 33792
    ds_read_b64_tr_b16 v[22:23], v4 offset:42760
    v_mfma_f32_16x16x32_bf16 a[68:71], v[56:59], v[96:99], a[68:71]
    buffer_load_dwordx4 v6, s[36:39], s64 offen lds
    v_mfma_f32_16x16x32_bf16 a[68:71], v[52:55], v[92:95], a[68:71]
    ds_read_b64_tr_b16 v[24:25], v5 offset:42248
    v_mfma_f32_16x16x32_bf16 a[64:67], v[52:55], v[84:87], a[64:67]
    ds_read_b64_tr_b16 v[26:27], v5 offset:42760
    v_mfma_f32_16x16x32_bf16 a[64:67], v[56:59], v[88:91], a[64:67]
    s_xor_b32 s64, s26, 533248
    ds_read_b64_tr_b16 v[28:29], v4 offset:42304
    v_mfma_f32_16x16x32_bf16 a[60:63], v[56:59], v[80:83], a[60:63]
    s_add_u32 m0, s61, 34824
    ds_read_b64_tr_b16 v[30:31], v4 offset:42816
    v_mfma_f32_16x16x32_bf16 a[60:63], v[52:55], v[76:79], a[60:63]
    buffer_load_dwordx4 v6, s[36:39], s64 offen lds
    v_mfma_f32_16x16x32_bf16 a[72:75], v[60:63], v[76:79], a[72:75]
    ds_read_b64_tr_b16 v[32:33], v5 offset:42304
    v_mfma_f32_16x16x32_bf16 a[72:75], v[64:67], v[80:83], a[72:75]
    ds_read_b64_tr_b16 v[34:35], v5 offset:42816
    v_mfma_f32_16x16x32_bf16 a[76:79], v[64:67], v[88:91], a[76:79]
    s_xor_b32 s65, s75, 20608
    ds_read_b64_tr_b16 v[36:37], v4 offset:42312
    v_mfma_f32_16x16x32_bf16 a[76:79], v[60:63], v[84:87], a[76:79]
    s_add_u32 m0, s63, 2048
    ds_read_b64_tr_b16 v[38:39], v4 offset:42824
    v_mfma_f32_16x16x32_bf16 a[80:83], v[60:63], v[92:95], a[80:83]
    buffer_load_dwordx4 v156, s[32:35], s65 offen lds
    v_mfma_f32_16x16x32_bf16 a[80:83], v[64:67], v[96:99], a[80:83]
    ds_read_b64_tr_b16 v[40:41], v5 offset:42312
    v_mfma_f32_16x16x32_bf16 a[92:95], v[72:75], v[96:99], a[92:95]
    s_add_u32 m0, s63, 3072
    ds_read_b64_tr_b16 v[42:43], v5 offset:42824
    v_mfma_f32_16x16x32_bf16 a[92:95], v[68:71], v[92:95], a[92:95]
    buffer_load_dwordx4 v157, s[32:35], s65 offen lds
    v_mfma_f32_16x16x32_bf16 a[88:91], v[68:71], v[84:87], a[88:91]
    v_mfma_f32_16x16x32_bf16 a[88:91], v[72:75], v[88:91], a[88:91]
    v_mfma_f32_16x16x32_bf16 a[84:87], v[72:75], v[80:83], a[84:87]
    s_waitcnt lgkmcnt(2)
    v_mfma_f32_16x16x32_bf16 a[84:87], v[68:71], v[76:79], a[84:87]
    v_mfma_f32_16x16x32_bf16 a[96:99], v[12:15], v[76:79], a[96:99]
    ds_read_b64_tr_b16 v[44:45], v4 offset:42368
    v_mfma_f32_16x16x32_bf16 a[96:99], v[16:19], v[80:83], a[96:99]
    ds_read_b64_tr_b16 v[46:47], v4 offset:42880
    v_mfma_f32_16x16x32_bf16 a[100:103], v[16:19], v[88:91], a[100:103]
    ds_read_b64_tr_b16 v[48:49], v5 offset:42368
    v_mfma_f32_16x16x32_bf16 a[100:103], v[12:15], v[84:87], a[100:103]
    ds_read_b64_tr_b16 v[50:51], v5 offset:42880
    v_mfma_f32_16x16x32_bf16 a[104:107], v[12:15], v[92:95], a[104:107]
    s_xor_b32 s64, s26, 787200
    ds_read_b64_tr_b16 v[52:53], v4 offset:42376
    v_mfma_f32_16x16x32_bf16 a[104:107], v[16:19], v[96:99], a[104:107]
    s_add_u32 m0, s61, 101376
    ds_read_b64_tr_b16 v[54:55], v4 offset:42888
    v_mfma_f32_16x16x32_bf16 a[116:119], v[24:27], v[96:99], a[116:119]
    buffer_load_dwordx4 v6, s[36:39], s64 offen lds
    v_mfma_f32_16x16x32_bf16 a[116:119], v[20:23], v[92:95], a[116:119]
    ds_read_b64_tr_b16 v[56:57], v5 offset:42376
    v_mfma_f32_16x16x32_bf16 a[112:115], v[20:23], v[84:87], a[112:115]
    ds_read_b64_tr_b16 v[58:59], v5 offset:42888
    v_mfma_f32_16x16x32_bf16 a[112:115], v[24:27], v[88:91], a[112:115]
    s_xor_b32 s64, s26, 795392
    ds_read_b64_tr_b16 v[60:61], v4 offset:42432
    v_mfma_f32_16x16x32_bf16 a[108:111], v[24:27], v[80:83], a[108:111]
    s_add_u32 m0, s61, 102408
    ds_read_b64_tr_b16 v[62:63], v4 offset:42944
    v_mfma_f32_16x16x32_bf16 a[108:111], v[20:23], v[76:79], a[108:111]
    buffer_load_dwordx4 v6, s[36:39], s64 offen lds
    v_mfma_f32_16x16x32_bf16 a[120:123], v[28:31], v[76:79], a[120:123]
    ds_read_b64_tr_b16 v[64:65], v5 offset:42432
    v_mfma_f32_16x16x32_bf16 a[120:123], v[32:35], v[80:83], a[120:123]
    ds_read_b64_tr_b16 v[66:67], v5 offset:42944
    v_mfma_f32_16x16x32_bf16 a[124:127], v[32:35], v[88:91], a[124:127]
    s_xor_b32 s65, s75, 41088
    ds_read_b64_tr_b16 v[68:69], v4 offset:42440
    v_mfma_f32_16x16x32_bf16 a[124:127], v[28:31], v[84:87], a[124:127]
    s_add_u32 m0, s63, 4096
    ds_read_b64_tr_b16 v[70:71], v4 offset:42952
    v_mfma_f32_16x16x32_bf16 a[128:131], v[28:31], v[92:95], a[128:131]
    buffer_load_dwordx4 v156, s[32:35], s65 offen lds
    v_mfma_f32_16x16x32_bf16 a[128:131], v[32:35], v[96:99], a[128:131]
    s_waitcnt lgkmcnt(14)
    ds_read_b64_tr_b16 v[72:73], v5 offset:42440
    v_mfma_f32_16x16x32_bf16 a[140:143], v[40:43], v[96:99], a[140:143]
    s_add_u32 m0, s63, 5120
    ds_read_b64_tr_b16 v[74:75], v5 offset:42952
    v_mfma_f32_16x16x32_bf16 a[140:143], v[36:39], v[92:95], a[140:143]
    buffer_load_dwordx4 v157, s[32:35], s65 offen lds
    v_mfma_f32_16x16x32_bf16 a[136:139], v[36:39], v[84:87], a[136:139]
    v_mfma_f32_16x16x32_bf16 a[136:139], v[40:43], v[88:91], a[136:139]
    v_mfma_f32_16x16x32_bf16 a[132:135], v[40:43], v[80:83], a[132:135]
    s_waitcnt vmcnt(8) lgkmcnt(0)
    v_mfma_f32_16x16x32_bf16 a[132:135], v[36:39], v[76:79], a[132:135]
    s_barrier
    v_mfma_f32_16x16x32_bf16 a[144:147], v[44:47], v[76:79], a[144:147]
    ds_read_b64_tr_b16 v[12:13], v4 offset:50688
    v_mfma_f32_16x16x32_bf16 a[144:147], v[48:51], v[80:83], a[144:147]
    s_mov_b32 s14, 0x3e0293ee
    ds_read_b64_tr_b16 v[14:15], v4 offset:51200
    v_mfma_f32_16x16x32_bf16 a[148:151], v[48:51], v[88:91], a[148:151]
    ds_read_b64_tr_b16 v[16:17], v5 offset:50688
    v_mfma_f32_16x16x32_bf16 a[148:151], v[44:47], v[84:87], a[148:151]
    ds_read_b64_tr_b16 v[18:19], v5 offset:51200
    v_mfma_f32_16x16x32_bf16 a[152:155], v[44:47], v[92:95], a[152:155]
    s_xor_b32 s64, s26, 524800
    ds_read_b64_tr_b16 v[20:21], v4 offset:50696
    v_mfma_f32_16x16x32_bf16 a[152:155], v[48:51], v[96:99], a[152:155]
    s_add_u32 m0, s61, 42240
    ds_read_b64_tr_b16 v[22:23], v4 offset:51208
    v_mfma_f32_16x16x32_bf16 a[164:167], v[56:59], v[96:99], a[164:167]
    buffer_load_dwordx4 v6, s[36:39], s64 offen lds
    v_mfma_f32_16x16x32_bf16 a[164:167], v[52:55], v[92:95], a[164:167]
    ds_read_b64_tr_b16 v[24:25], v5 offset:50696
    v_mfma_f32_16x16x32_bf16 a[160:163], v[52:55], v[84:87], a[160:163]
    ds_read_b64_tr_b16 v[26:27], v5 offset:51208
    v_mfma_f32_16x16x32_bf16 a[160:163], v[56:59], v[88:91], a[160:163]
    s_xor_b32 s64, s26, 532992
    ds_read_b64_tr_b16 v[28:29], v4 offset:50752
    v_mfma_f32_16x16x32_bf16 a[156:159], v[56:59], v[80:83], a[156:159]
    s_add_u32 m0, s61, 43272
    ds_read_b64_tr_b16 v[30:31], v4 offset:51264
    v_mfma_f32_16x16x32_bf16 a[156:159], v[52:55], v[76:79], a[156:159]
    buffer_load_dwordx4 v6, s[36:39], s64 offen lds
    v_mfma_f32_16x16x32_bf16 a[168:171], v[60:63], v[76:79], a[168:171]
    ds_read_b64_tr_b16 v[32:33], v5 offset:50752
    v_mfma_f32_16x16x32_bf16 a[168:171], v[64:67], v[80:83], a[168:171]
    ds_read_b64_tr_b16 v[34:35], v5 offset:51264
    v_mfma_f32_16x16x32_bf16 a[172:175], v[64:67], v[88:91], a[172:175]
    ds_read_b64_tr_b16 v[36:37], v4 offset:50760
    v_mfma_f32_16x16x32_bf16 a[172:175], v[60:63], v[84:87], a[172:175]
    ds_read_b64_tr_b16 v[38:39], v4 offset:51272
    v_mfma_f32_16x16x32_bf16 a[176:179], v[60:63], v[92:95], a[176:179]
    v_mfma_f32_16x16x32_bf16 a[176:179], v[64:67], v[96:99], a[176:179]
    ds_read_b64_tr_b16 v[40:41], v5 offset:50760
    v_mfma_f32_16x16x32_bf16 a[188:191], v[72:75], v[96:99], a[188:191]
    ds_read_b64_tr_b16 v[42:43], v5 offset:51272
    v_mfma_f32_16x16x32_bf16 a[188:191], v[68:71], v[92:95], a[188:191]
    v_mfma_f32_16x16x32_bf16 a[184:187], v[68:71], v[84:87], a[184:187]
    v_mfma_f32_16x16x32_bf16 a[184:187], v[72:75], v[88:91], a[184:187]
    v_mfma_f32_16x16x32_bf16 a[180:183], v[72:75], v[80:83], a[180:183]
    s_waitcnt lgkmcnt(2)
    v_mfma_f32_16x16x32_bf16 a[180:183], v[68:71], v[76:79], a[180:183]
    v_mfma_f32_16x16x32_bf16 a[192:195], v[12:15], v[76:79], a[192:195]
    ds_read_b64_tr_b16 v[44:45], v4 offset:50816
    v_mfma_f32_16x16x32_bf16 a[192:195], v[16:19], v[80:83], a[192:195]
    ds_read_b64_tr_b16 v[46:47], v4 offset:51328
    v_mfma_f32_16x16x32_bf16 a[196:199], v[16:19], v[88:91], a[196:199]
    ds_read_b64_tr_b16 v[48:49], v5 offset:50816
    v_mfma_f32_16x16x32_bf16 a[196:199], v[12:15], v[84:87], a[196:199]
    ds_read_b64_tr_b16 v[50:51], v5 offset:51328
    v_mfma_f32_16x16x32_bf16 a[200:203], v[12:15], v[92:95], a[200:203]
    s_xor_b32 s64, s26, 786944
    ds_read_b64_tr_b16 v[52:53], v4 offset:50824
    v_mfma_f32_16x16x32_bf16 a[200:203], v[16:19], v[96:99], a[200:203]
    s_add_u32 m0, s61, 109824
    ds_read_b64_tr_b16 v[54:55], v4 offset:51336
    v_mfma_f32_16x16x32_bf16 a[212:215], v[24:27], v[96:99], a[212:215]
    buffer_load_dwordx4 v6, s[36:39], s64 offen lds
    v_mfma_f32_16x16x32_bf16 a[212:215], v[20:23], v[92:95], a[212:215]
    ds_read_b64_tr_b16 v[56:57], v5 offset:50824
    v_mfma_f32_16x16x32_bf16 a[208:211], v[20:23], v[84:87], a[208:211]
    ds_read_b64_tr_b16 v[58:59], v5 offset:51336
    v_mfma_f32_16x16x32_bf16 a[208:211], v[24:27], v[88:91], a[208:211]
    s_xor_b32 s64, s26, 795136
    ds_read_b64_tr_b16 v[60:61], v4 offset:50880
    v_mfma_f32_16x16x32_bf16 a[204:207], v[24:27], v[80:83], a[204:207]
    s_add_u32 m0, s61, 110856
    ds_read_b64_tr_b16 v[62:63], v4 offset:51392
    v_mfma_f32_16x16x32_bf16 a[204:207], v[20:23], v[76:79], a[204:207]
    buffer_load_dwordx4 v6, s[36:39], s64 offen lds
    v_mfma_f32_16x16x32_bf16 a[216:219], v[28:31], v[76:79], a[216:219]
    ds_read_b64_tr_b16 v[64:65], v5 offset:50880
    v_mfma_f32_16x16x32_bf16 a[216:219], v[32:35], v[80:83], a[216:219]
    ds_read_b64_tr_b16 v[66:67], v5 offset:51392
    v_mfma_f32_16x16x32_bf16 a[220:223], v[32:35], v[88:91], a[220:223]
    s_xor_b32 s64, s56, 24576
    ds_read_b64_tr_b16 v[68:69], v4 offset:50888
    v_mfma_f32_16x16x32_bf16 a[220:223], v[28:31], v[84:87], a[220:223]
    s_add_u32 m0, s61, 92928
    ds_read_b64_tr_b16 v[70:71], v4 offset:51400
    v_mfma_f32_16x16x32_bf16 a[224:227], v[28:31], v[92:95], a[224:227]
    buffer_load_dwordx4 v1, s[44:47], s64 offen nt lds
    v_mfma_f32_16x16x32_bf16 a[224:227], v[32:35], v[96:99], a[224:227]
    s_waitcnt lgkmcnt(14)
    ds_read_b64_tr_b16 v[72:73], v5 offset:50888
    v_mfma_f32_16x16x32_bf16 a[236:239], v[40:43], v[96:99], a[236:239]
    s_add_u32 m0, s61, 92960
    ds_read_b64_tr_b16 v[74:75], v5 offset:51400
    v_mfma_f32_16x16x32_bf16 a[236:239], v[36:39], v[92:95], a[236:239]
    buffer_load_dwordx4 v1, s[44:47], s64 offen offset:1024 nt lds
    v_mfma_f32_16x16x32_bf16 a[232:235], v[36:39], v[84:87], a[232:235]
    v_mfma_f32_16x16x32_bf16 a[232:235], v[40:43], v[88:91], a[232:235]
    v_mfma_f32_16x16x32_bf16 a[228:231], v[40:43], v[80:83], a[228:231]
    s_waitcnt vmcnt(10) lgkmcnt(0)
    v_mfma_f32_16x16x32_bf16 a[228:231], v[36:39], v[76:79], a[228:231]
    s_barrier
    v_mfma_f32_16x16x32_bf16 a[240:243], v[44:47], v[76:79], a[240:243]
    ds_read_b64_tr_b16 v[12:13], v4 offset:59136
    v_mfma_f32_16x16x32_bf16 a[240:243], v[48:51], v[80:83], a[240:243]
    ds_read_b64_tr_b16 v[14:15], v4 offset:59648
    v_mfma_f32_16x16x32_bf16 a[244:247], v[48:51], v[88:91], a[244:247]
    ds_read_b64_tr_b16 v[16:17], v5 offset:59136
    v_mfma_f32_16x16x32_bf16 a[244:247], v[44:47], v[84:87], a[244:247]
    ds_read_b64_tr_b16 v[18:19], v5 offset:59648
    v_mfma_f32_16x16x32_bf16 a[248:251], v[44:47], v[92:95], a[248:251]
    s_xor_b32 s64, s26, 524544
    ds_read_b64_tr_b16 v[20:21], v4 offset:59144
    v_mfma_f32_16x16x32_bf16 a[248:251], v[48:51], v[96:99], a[248:251]
    s_add_u32 m0, s61, 50688
    ds_read_b64_tr_b16 v[22:23], v4 offset:59656
    v_mfma_f32_16x16x32_bf16 v[128:131], v[56:59], v[96:99], v[128:131]
    buffer_load_dwordx4 v6, s[36:39], s64 offen lds
    v_mfma_f32_16x16x32_bf16 v[128:131], v[52:55], v[92:95], v[128:131]
    ds_read_b64_tr_b16 v[24:25], v5 offset:59144
    v_mfma_f32_16x16x32_bf16 v[124:127], v[52:55], v[84:87], v[124:127]
    ds_read_b64_tr_b16 v[26:27], v5 offset:59656
    v_mfma_f32_16x16x32_bf16 v[124:127], v[56:59], v[88:91], v[124:127]
    s_xor_b32 s64, s26, 532736
    ds_read_b64_tr_b16 v[28:29], v4 offset:59200
    v_mfma_f32_16x16x32_bf16 a[252:255], v[56:59], v[80:83], a[252:255]
    s_add_u32 m0, s61, 51720
    ds_read_b64_tr_b16 v[30:31], v4 offset:59712
    v_mfma_f32_16x16x32_bf16 a[252:255], v[52:55], v[76:79], a[252:255]
    buffer_load_dwordx4 v6, s[36:39], s64 offen lds
    v_mfma_f32_16x16x32_bf16 v[132:135], v[60:63], v[76:79], v[132:135]
    ds_read_b64_tr_b16 v[32:33], v5 offset:59200
    v_mfma_f32_16x16x32_bf16 v[132:135], v[64:67], v[80:83], v[132:135]
    ds_read_b64_tr_b16 v[34:35], v5 offset:59712
    v_mfma_f32_16x16x32_bf16 v[136:139], v[64:67], v[88:91], v[136:139]
    ds_read_b64_tr_b16 v[36:37], v4 offset:59208
    v_mfma_f32_16x16x32_bf16 v[136:139], v[60:63], v[84:87], v[136:139]
    ds_read_b64_tr_b16 v[38:39], v4 offset:59720
    v_mfma_f32_16x16x32_bf16 v[140:143], v[60:63], v[92:95], v[140:143]
    v_mfma_f32_16x16x32_bf16 v[140:143], v[64:67], v[96:99], v[140:143]
    ds_read_b64_tr_b16 v[40:41], v5 offset:59208
    v_mfma_f32_16x16x32_bf16 v[152:155], v[72:75], v[96:99], v[152:155]
    ds_read_b64_tr_b16 v[42:43], v5 offset:59720
    v_mfma_f32_16x16x32_bf16 v[152:155], v[68:71], v[92:95], v[152:155]
    v_mfma_f32_16x16x32_bf16 v[148:151], v[68:71], v[84:87], v[148:151]
    v_mfma_f32_16x16x32_bf16 v[148:151], v[72:75], v[88:91], v[148:151]
    v_mfma_f32_16x16x32_bf16 v[144:147], v[72:75], v[80:83], v[144:147]
    s_waitcnt lgkmcnt(2)
    v_mfma_f32_16x16x32_bf16 v[144:147], v[68:71], v[76:79], v[144:147]
    v_mfma_f32_16x16x32_bf16 v[160:163], v[12:15], v[76:79], v[160:163]
    ds_read_b64_tr_b16 v[44:45], v4 offset:59264
    v_mfma_f32_16x16x32_bf16 v[160:163], v[16:19], v[80:83], v[160:163]
    ds_read_b64_tr_b16 v[46:47], v4 offset:59776
    v_mfma_f32_16x16x32_bf16 v[164:167], v[16:19], v[88:91], v[164:167]
    ds_read_b64_tr_b16 v[48:49], v5 offset:59264
    v_mfma_f32_16x16x32_bf16 v[164:167], v[12:15], v[84:87], v[164:167]
    ds_read_b64_tr_b16 v[50:51], v5 offset:59776
    v_mfma_f32_16x16x32_bf16 v[168:171], v[12:15], v[92:95], v[168:171]
    s_xor_b32 s64, s26, 786688
    ds_read_b64_tr_b16 v[52:53], v4 offset:59272
    v_mfma_f32_16x16x32_bf16 v[168:171], v[16:19], v[96:99], v[168:171]
    s_add_u32 m0, s61, 118272
    ds_read_b64_tr_b16 v[54:55], v4 offset:59784
    v_mfma_f32_16x16x32_bf16 v[180:183], v[24:27], v[96:99], v[180:183]
    buffer_load_dwordx4 v6, s[36:39], s64 offen lds
    v_mfma_f32_16x16x32_bf16 v[180:183], v[20:23], v[92:95], v[180:183]
    ds_read_b64_tr_b16 v[56:57], v5 offset:59272
    v_mfma_f32_16x16x32_bf16 v[176:179], v[20:23], v[84:87], v[176:179]
    ds_read_b64_tr_b16 v[58:59], v5 offset:59784
    v_mfma_f32_16x16x32_bf16 v[176:179], v[24:27], v[88:91], v[176:179]
    s_xor_b32 s64, s26, 794880
    ds_read_b64_tr_b16 v[60:61], v4 offset:59328
    v_mfma_f32_16x16x32_bf16 v[172:175], v[24:27], v[80:83], v[172:175]
    s_add_u32 m0, s61, 119304
    ds_read_b64_tr_b16 v[62:63], v4 offset:59840
    v_mfma_f32_16x16x32_bf16 v[172:175], v[20:23], v[76:79], v[172:175]
    buffer_load_dwordx4 v6, s[36:39], s64 offen lds
    v_mfma_f32_16x16x32_bf16 v[184:187], v[28:31], v[76:79], v[184:187]
    ds_read_b64_tr_b16 v[64:65], v5 offset:59328
    v_mfma_f32_16x16x32_bf16 v[184:187], v[32:35], v[80:83], v[184:187]
    ds_read_b64_tr_b16 v[66:67], v5 offset:59840
    v_mfma_f32_16x16x32_bf16 v[188:191], v[32:35], v[88:91], v[188:191]
    ds_read_b64_tr_b16 v[68:69], v4 offset:59336
    v_mfma_f32_16x16x32_bf16 v[188:191], v[28:31], v[84:87], v[188:191]
    s_waitcnt vmcnt(8)
    ds_read_b64_tr_b16 v[70:71], v4 offset:59848
    v_mfma_f32_16x16x32_bf16 v[192:195], v[28:31], v[92:95], v[192:195]
    ds_read_b128 v[100:103], v158 offset:0
    v_mfma_f32_16x16x32_bf16 v[192:195], v[32:35], v[96:99], v[192:195]
    s_waitcnt lgkmcnt(14)
    ds_read_b64_tr_b16 v[72:73], v5 offset:59336
    v_mfma_f32_16x16x32_bf16 v[204:207], v[40:43], v[96:99], v[204:207]
    ds_read_b64_tr_b16 v[74:75], v5 offset:59848
    v_mfma_f32_16x16x32_bf16 v[204:207], v[36:39], v[92:95], v[204:207]
    ds_read_b128 v[104:107], v159 offset:0
    v_mfma_f32_16x16x32_bf16 v[200:203], v[36:39], v[84:87], v[200:203]
    ds_read_b128 v[108:111], v158 offset:2048
    v_mfma_f32_16x16x32_bf16 v[200:203], v[40:43], v[88:91], v[200:203]
    ds_read_b128 v[112:115], v159 offset:2048
    v_mfma_f32_16x16x32_bf16 v[196:199], v[40:43], v[80:83], v[196:199]
    s_waitcnt vmcnt(10) lgkmcnt(3)
    v_mfma_f32_16x16x32_bf16 v[196:199], v[36:39], v[76:79], v[196:199]
    s_barrier
    v_mfma_f32_16x16x32_bf16 v[208:211], v[44:47], v[76:79], v[208:211]
    ds_read_b64_tr_b16 v[12:13], v4 offset:33792
    v_mfma_f32_16x16x32_bf16 v[208:211], v[48:51], v[80:83], v[208:211]
    ds_read_b64_tr_b16 v[14:15], v4 offset:34304
    v_mfma_f32_16x16x32_bf16 v[212:215], v[48:51], v[88:91], v[212:215]
    ds_read_b64_tr_b16 v[16:17], v5 offset:33792
    v_mfma_f32_16x16x32_bf16 v[212:215], v[44:47], v[84:87], v[212:215]
    ds_read_b64_tr_b16 v[18:19], v5 offset:34304
    v_mfma_f32_16x16x32_bf16 v[216:219], v[44:47], v[92:95], v[216:219]
    s_xor_b32 s64, s26, 524288
    ds_read_b64_tr_b16 v[20:21], v4 offset:33800
    v_mfma_f32_16x16x32_bf16 v[216:219], v[48:51], v[96:99], v[216:219]
    s_add_u32 m0, s61, 59136
    ds_read_b64_tr_b16 v[22:23], v4 offset:34312
    v_mfma_f32_16x16x32_bf16 v[228:231], v[56:59], v[96:99], v[228:231]
    buffer_load_dwordx4 v6, s[36:39], s64 offen lds
    v_mfma_f32_16x16x32_bf16 v[228:231], v[52:55], v[92:95], v[228:231]
    ds_read_b64_tr_b16 v[24:25], v5 offset:33800
    v_mfma_f32_16x16x32_bf16 v[224:227], v[52:55], v[84:87], v[224:227]
    ds_read_b64_tr_b16 v[26:27], v5 offset:34312
    v_mfma_f32_16x16x32_bf16 v[224:227], v[56:59], v[88:91], v[224:227]
    s_xor_b32 s64, s26, 532480
    ds_read_b64_tr_b16 v[28:29], v4 offset:33856
    v_mfma_f32_16x16x32_bf16 v[220:223], v[56:59], v[80:83], v[220:223]
    s_add_u32 m0, s61, 60168
    ds_read_b64_tr_b16 v[30:31], v4 offset:34368
    v_mfma_f32_16x16x32_bf16 v[220:223], v[52:55], v[76:79], v[220:223]
    buffer_load_dwordx4 v6, s[36:39], s64 offen lds
    v_mfma_f32_16x16x32_bf16 v[232:235], v[60:63], v[76:79], v[232:235]
    ds_read_b64_tr_b16 v[32:33], v5 offset:33856
    v_mfma_f32_16x16x32_bf16 v[232:235], v[64:67], v[80:83], v[232:235]
    ds_read_b64_tr_b16 v[34:35], v5 offset:34368
    v_mfma_f32_16x16x32_bf16 v[236:239], v[64:67], v[88:91], v[236:239]
    ds_read_b64_tr_b16 v[36:37], v4 offset:33864
    v_mfma_f32_16x16x32_bf16 v[236:239], v[60:63], v[84:87], v[236:239]
    ds_read_b64_tr_b16 v[38:39], v4 offset:34376
    v_mfma_f32_16x16x32_bf16 v[240:243], v[60:63], v[92:95], v[240:243]
    ds_read_b128 v[116:119], v158 offset:4096
    v_mfma_f32_16x16x32_bf16 v[240:243], v[64:67], v[96:99], v[240:243]
    ds_read_b64_tr_b16 v[40:41], v5 offset:33864
    v_mfma_f32_16x16x32_bf16 v[252:255], v[72:75], v[96:99], v[252:255]
    ds_read_b64_tr_b16 v[42:43], v5 offset:34376
    v_mfma_f32_16x16x32_bf16 v[252:255], v[68:71], v[92:95], v[252:255]
    ds_read_b128 v[120:123], v159 offset:4096
    v_mfma_f32_16x16x32_bf16 v[248:251], v[68:71], v[84:87], v[248:251]
    v_mfma_f32_16x16x32_bf16 v[248:251], v[72:75], v[88:91], v[248:251]
    v_mfma_f32_16x16x32_bf16 v[244:247], v[72:75], v[80:83], v[244:247]
    s_waitcnt lgkmcnt(3)
    v_mfma_f32_16x16x32_bf16 v[244:247], v[68:71], v[76:79], v[244:247]
    v_mfma_f32_16x16x32_bf16 a[0:3], v[12:15], v[100:103], a[0:3]
    ds_read_b64_tr_b16 v[44:45], v4 offset:33920
    v_mfma_f32_16x16x32_bf16 a[0:3], v[16:19], v[104:107], a[0:3]
    ds_read_b64_tr_b16 v[46:47], v4 offset:34432
    v_mfma_f32_16x16x32_bf16 a[4:7], v[16:19], v[112:115], a[4:7]
    ds_read_b64_tr_b16 v[48:49], v5 offset:33920
    v_mfma_f32_16x16x32_bf16 a[4:7], v[12:15], v[108:111], a[4:7]
    ds_read_b64_tr_b16 v[50:51], v5 offset:34432
    v_mfma_f32_16x16x32_bf16 a[8:11], v[12:15], v[116:119], a[8:11]
    s_waitcnt lgkmcnt(4)
    s_xor_b32 s64, s26, 786432
    ds_read_b64_tr_b16 v[52:53], v4 offset:33928
    v_mfma_f32_16x16x32_bf16 a[8:11], v[16:19], v[120:123], a[8:11]
    s_add_u32 m0, s61, 126720
    ds_read_b64_tr_b16 v[54:55], v4 offset:34440
    v_mfma_f32_16x16x32_bf16 a[20:23], v[24:27], v[120:123], a[20:23]
    buffer_load_dwordx4 v6, s[36:39], s64 offen lds
    v_mfma_f32_16x16x32_bf16 a[20:23], v[20:23], v[116:119], a[20:23]
    ds_read_b64_tr_b16 v[56:57], v5 offset:33928
    v_mfma_f32_16x16x32_bf16 a[16:19], v[20:23], v[108:111], a[16:19]
    ds_read_b64_tr_b16 v[58:59], v5 offset:34440
    v_mfma_f32_16x16x32_bf16 a[16:19], v[24:27], v[112:115], a[16:19]
    s_xor_b32 s64, s26, 794624
    ds_read_b64_tr_b16 v[60:61], v4 offset:33984
    v_mfma_f32_16x16x32_bf16 a[12:15], v[24:27], v[104:107], a[12:15]
    s_add_u32 m0, s61, 127752
    ds_read_b64_tr_b16 v[62:63], v4 offset:34496
    v_mfma_f32_16x16x32_bf16 a[12:15], v[20:23], v[100:103], a[12:15]
    buffer_load_dwordx4 v6, s[36:39], s64 offen lds
    v_mfma_f32_16x16x32_bf16 a[24:27], v[28:31], v[100:103], a[24:27]
    ds_read_b64_tr_b16 v[64:65], v5 offset:33984
    v_mfma_f32_16x16x32_bf16 a[24:27], v[32:35], v[104:107], a[24:27]
    ds_read_b64_tr_b16 v[66:67], v5 offset:34496
    v_mfma_f32_16x16x32_bf16 a[28:31], v[32:35], v[112:115], a[28:31]
    ds_read_b64_tr_b16 v[68:69], v4 offset:33992
    v_mfma_f32_16x16x32_bf16 a[28:31], v[28:31], v[108:111], a[28:31]
    ds_read_b64_tr_b16 v[70:71], v4 offset:34504
    v_mfma_f32_16x16x32_bf16 a[32:35], v[28:31], v[116:119], a[32:35]
    v_mfma_f32_16x16x32_bf16 a[32:35], v[32:35], v[120:123], a[32:35]
    ds_read_b64_tr_b16 v[72:73], v5 offset:33992
    v_mfma_f32_16x16x32_bf16 a[44:47], v[40:43], v[120:123], a[44:47]
    ds_read_b64_tr_b16 v[74:75], v5 offset:34504
    v_mfma_f32_16x16x32_bf16 a[44:47], v[36:39], v[116:119], a[44:47]
    v_mfma_f32_16x16x32_bf16 a[40:43], v[36:39], v[108:111], a[40:43]
    v_mfma_f32_16x16x32_bf16 a[40:43], v[40:43], v[112:115], a[40:43]
    v_mfma_f32_16x16x32_bf16 a[36:39], v[40:43], v[104:107], a[36:39]
    s_waitcnt vmcnt(10) lgkmcnt(0)
    v_mfma_f32_16x16x32_bf16 a[36:39], v[36:39], v[100:103], a[36:39]
    s_barrier
    v_mfma_f32_16x16x32_bf16 a[48:51], v[44:47], v[100:103], a[48:51]
    ds_read_b64_tr_b16 v[12:13], v4 offset:42240
    v_mfma_f32_16x16x32_bf16 a[48:51], v[48:51], v[104:107], a[48:51]
    ds_read_b64_tr_b16 v[14:15], v4 offset:42752
    v_mfma_f32_16x16x32_bf16 a[52:55], v[48:51], v[112:115], a[52:55]
    ds_read_b64_tr_b16 v[16:17], v5 offset:42240
    v_mfma_f32_16x16x32_bf16 a[52:55], v[44:47], v[108:111], a[52:55]
    ds_read_b64_tr_b16 v[18:19], v5 offset:42752
    v_mfma_f32_16x16x32_bf16 a[56:59], v[44:47], v[116:119], a[56:59]
    ds_read_b64_tr_b16 v[20:21], v4 offset:42248
    v_mfma_f32_16x16x32_bf16 a[56:59], v[48:51], v[120:123], a[56:59]
    ds_read_b64_tr_b16 v[22:23], v4 offset:42760
    v_mfma_f32_16x16x32_bf16 a[68:71], v[56:59], v[120:123], a[68:71]
    v_mfma_f32_16x16x32_bf16 a[68:71], v[52:55], v[116:119], a[68:71]
    ds_read_b64_tr_b16 v[24:25], v5 offset:42248
    v_mfma_f32_16x16x32_bf16 a[64:67], v[52:55], v[108:111], a[64:67]
    ds_read_b64_tr_b16 v[26:27], v5 offset:42760
    v_mfma_f32_16x16x32_bf16 a[64:67], v[56:59], v[112:115], a[64:67]
    ds_read_b64_tr_b16 v[28:29], v4 offset:42304
    v_mfma_f32_16x16x32_bf16 a[60:63], v[56:59], v[104:107], a[60:63]
    ds_read_b64_tr_b16 v[30:31], v4 offset:42816
    v_mfma_f32_16x16x32_bf16 a[60:63], v[52:55], v[100:103], a[60:63]
    v_mfma_f32_16x16x32_bf16 a[72:75], v[60:63], v[100:103], a[72:75]
    ds_read_b64_tr_b16 v[32:33], v5 offset:42304
    v_mfma_f32_16x16x32_bf16 a[72:75], v[64:67], v[104:107], a[72:75]
    ds_read_b64_tr_b16 v[34:35], v5 offset:42816
    v_mfma_f32_16x16x32_bf16 a[76:79], v[64:67], v[112:115], a[76:79]
    ds_read_b64_tr_b16 v[36:37], v4 offset:42312
    v_mfma_f32_16x16x32_bf16 a[76:79], v[60:63], v[108:111], a[76:79]
    ds_read_b64_tr_b16 v[38:39], v4 offset:42824
    v_mfma_f32_16x16x32_bf16 a[80:83], v[60:63], v[116:119], a[80:83]
    v_mfma_f32_16x16x32_bf16 a[80:83], v[64:67], v[120:123], a[80:83]
    ds_read_b64_tr_b16 v[40:41], v5 offset:42312
    v_mfma_f32_16x16x32_bf16 a[92:95], v[72:75], v[120:123], a[92:95]
    ds_read_b64_tr_b16 v[42:43], v5 offset:42824
    v_mfma_f32_16x16x32_bf16 a[92:95], v[68:71], v[116:119], a[92:95]
    v_mfma_f32_16x16x32_bf16 a[88:91], v[68:71], v[108:111], a[88:91]
    v_mfma_f32_16x16x32_bf16 a[88:91], v[72:75], v[112:115], a[88:91]
    v_mfma_f32_16x16x32_bf16 a[84:87], v[72:75], v[104:107], a[84:87]
    s_waitcnt lgkmcnt(2)
    v_mfma_f32_16x16x32_bf16 a[84:87], v[68:71], v[100:103], a[84:87]
    v_mfma_f32_16x16x32_bf16 a[96:99], v[12:15], v[100:103], a[96:99]
    ds_read_b64_tr_b16 v[44:45], v4 offset:42368
    v_mfma_f32_16x16x32_bf16 a[96:99], v[16:19], v[104:107], a[96:99]
    ds_read_b64_tr_b16 v[46:47], v4 offset:42880
    v_mfma_f32_16x16x32_bf16 a[100:103], v[16:19], v[112:115], a[100:103]
    ds_read_b64_tr_b16 v[48:49], v5 offset:42368
    v_mfma_f32_16x16x32_bf16 a[100:103], v[12:15], v[108:111], a[100:103]
    ds_read_b64_tr_b16 v[50:51], v5 offset:42880
    v_mfma_f32_16x16x32_bf16 a[104:107], v[12:15], v[116:119], a[104:107]
    ds_read_b64_tr_b16 v[52:53], v4 offset:42376
    v_accvgpr_read_b32 v76, a0
    v_mfma_f32_16x16x32_bf16 a[104:107], v[16:19], v[120:123], a[104:107]
    ds_read_b64_tr_b16 v[54:55], v4 offset:42888
    v_accvgpr_read_b32 v77, a1
    v_mfma_f32_16x16x32_bf16 a[116:119], v[24:27], v[120:123], a[116:119]
    v_accvgpr_read_b32 v78, a2
    v_accvgpr_read_b32 v79, a3
    v_mfma_f32_16x16x32_bf16 a[116:119], v[20:23], v[116:119], a[116:119]
    ds_read_b64_tr_b16 v[56:57], v5 offset:42376
    v_accvgpr_read_b32 v80, a12
    v_mfma_f32_16x16x32_bf16 a[112:115], v[20:23], v[108:111], a[112:115]
    ds_read_b64_tr_b16 v[58:59], v5 offset:42888
    v_accvgpr_read_b32 v81, a13
    v_mfma_f32_16x16x32_bf16 a[112:115], v[24:27], v[112:115], a[112:115]
    ds_read_b64_tr_b16 v[60:61], v4 offset:42432
    v_accvgpr_read_b32 v82, a14
    v_mfma_f32_16x16x32_bf16 a[108:111], v[24:27], v[104:107], a[108:111]
    ds_read_b64_tr_b16 v[62:63], v4 offset:42944
    v_accvgpr_read_b32 v83, a15
    v_mfma_f32_16x16x32_bf16 a[108:111], v[20:23], v[100:103], a[108:111]
    v_mul_f32 v76, s14, v76
    v_mul_f32 v77, s14, v77
    v_mfma_f32_16x16x32_bf16 a[120:123], v[28:31], v[100:103], a[120:123]
    ds_read_b64_tr_b16 v[64:65], v5 offset:42432
    v_mul_f32 v78, s14, v78
    v_mfma_f32_16x16x32_bf16 a[120:123], v[32:35], v[104:107], a[120:123]
    ds_read_b64_tr_b16 v[66:67], v5 offset:42944
    v_mul_f32 v79, s14, v79
    v_mfma_f32_16x16x32_bf16 a[124:127], v[32:35], v[112:115], a[124:127]
    ds_read_b64_tr_b16 v[68:69], v4 offset:42440
    v_mul_f32 v80, s14, v80
    v_mfma_f32_16x16x32_bf16 a[124:127], v[28:31], v[108:111], a[124:127]
    ds_read_b64_tr_b16 v[70:71], v4 offset:42952
    v_mul_f32 v81, s14, v81
    v_mfma_f32_16x16x32_bf16 a[128:131], v[28:31], v[116:119], a[128:131]
    v_mul_f32 v82, s14, v82
    v_mul_f32 v83, s14, v83
    v_mfma_f32_16x16x32_bf16 a[128:131], v[32:35], v[120:123], a[128:131]
    s_waitcnt lgkmcnt(14)
    ds_read_b64_tr_b16 v[72:73], v5 offset:42440
    v_cvt_pk_bf16_f32 v76, v76, v77
    v_mfma_f32_16x16x32_bf16 a[140:143], v[40:43], v[120:123], a[140:143]
    ds_read_b64_tr_b16 v[74:75], v5 offset:42952
    v_cvt_pk_bf16_f32 v77, v78, v79
    v_mfma_f32_16x16x32_bf16 a[140:143], v[36:39], v[116:119], a[140:143]
    v_cvt_pk_bf16_f32 v78, v80, v81
    v_cvt_pk_bf16_f32 v79, v82, v83
    v_mfma_f32_16x16x32_bf16 a[136:139], v[36:39], v[108:111], a[136:139]
    v_accvgpr_write_b32 a0, v76
    v_mfma_f32_16x16x32_bf16 a[136:139], v[40:43], v[112:115], a[136:139]
    v_accvgpr_write_b32 a1, v77
    v_accvgpr_write_b32 a2, v78
    v_mfma_f32_16x16x32_bf16 a[132:135], v[40:43], v[104:107], a[132:135]
    s_waitcnt vmcnt(4) lgkmcnt(0)
    v_accvgpr_write_b32 a3, v79
    v_mfma_f32_16x16x32_bf16 a[132:135], v[36:39], v[100:103], a[132:135]
    s_barrier
    v_mfma_f32_16x16x32_bf16 a[144:147], v[44:47], v[100:103], a[144:147]
    ds_read_b64_tr_b16 v[12:13], v4 offset:50688
    v_accvgpr_read_b32 v84, a4
    v_mfma_f32_16x16x32_bf16 a[144:147], v[48:51], v[104:107], a[144:147]
    ds_read_b64_tr_b16 v[14:15], v4 offset:51200
    v_accvgpr_read_b32 v85, a5
    v_mfma_f32_16x16x32_bf16 a[148:151], v[48:51], v[112:115], a[148:151]
    ds_read_b64_tr_b16 v[16:17], v5 offset:50688
    v_accvgpr_read_b32 v86, a6
    v_mfma_f32_16x16x32_bf16 a[148:151], v[44:47], v[108:111], a[148:151]
    ds_read_b64_tr_b16 v[18:19], v5 offset:51200
    v_accvgpr_read_b32 v87, a7
    v_mfma_f32_16x16x32_bf16 a[152:155], v[44:47], v[116:119], a[152:155]
    ds_read_b64_tr_b16 v[20:21], v4 offset:50696
    v_accvgpr_read_b32 v88, a16
    v_mfma_f32_16x16x32_bf16 a[152:155], v[48:51], v[120:123], a[152:155]
    ds_read_b64_tr_b16 v[22:23], v4 offset:51208
    v_accvgpr_read_b32 v89, a17
    v_mfma_f32_16x16x32_bf16 a[164:167], v[56:59], v[120:123], a[164:167]
    v_accvgpr_read_b32 v90, a18
    v_accvgpr_read_b32 v91, a19
    v_mfma_f32_16x16x32_bf16 a[164:167], v[52:55], v[116:119], a[164:167]
    ds_read_b64_tr_b16 v[24:25], v5 offset:50696
    v_mul_f32 v84, s14, v84
    v_mfma_f32_16x16x32_bf16 a[160:163], v[52:55], v[108:111], a[160:163]
    ds_read_b64_tr_b16 v[26:27], v5 offset:51208
    v_mul_f32 v85, s14, v85
    v_mfma_f32_16x16x32_bf16 a[160:163], v[56:59], v[112:115], a[160:163]
    ds_read_b64_tr_b16 v[28:29], v4 offset:50752
    v_mul_f32 v86, s14, v86
    v_mfma_f32_16x16x32_bf16 a[156:159], v[56:59], v[104:107], a[156:159]
    ds_read_b64_tr_b16 v[30:31], v4 offset:51264
    v_mul_f32 v87, s14, v87
    v_mfma_f32_16x16x32_bf16 a[156:159], v[52:55], v[100:103], a[156:159]
    v_mul_f32 v88, s14, v88
    v_mul_f32 v89, s14, v89
    v_mfma_f32_16x16x32_bf16 a[168:171], v[60:63], v[100:103], a[168:171]
    ds_read_b64_tr_b16 v[32:33], v5 offset:50752
    v_mul_f32 v90, s14, v90
    v_mfma_f32_16x16x32_bf16 a[168:171], v[64:67], v[104:107], a[168:171]
    ds_read_b64_tr_b16 v[34:35], v5 offset:51264
    v_mul_f32 v91, s14, v91
    v_mfma_f32_16x16x32_bf16 a[172:175], v[64:67], v[112:115], a[172:175]
    s_xor_b32 s64, s56, 32768
    ds_read_b64_tr_b16 v[36:37], v4 offset:50760
    v_cvt_pk_bf16_f32 v84, v84, v85
    v_mfma_f32_16x16x32_bf16 a[172:175], v[60:63], v[108:111], a[172:175]
    s_add_u32 m0, s61, 33792
    ds_read_b64_tr_b16 v[38:39], v4 offset:51272
    v_cvt_pk_bf16_f32 v85, v86, v87
    v_mfma_f32_16x16x32_bf16 a[176:179], v[60:63], v[116:119], a[176:179]
    buffer_load_dwordx4 v1, s[40:43], s64 offen nt lds
    v_mfma_f32_16x16x32_bf16 a[176:179], v[64:67], v[120:123], a[176:179]
    ds_read_b64_tr_b16 v[40:41], v5 offset:50760
    v_cvt_pk_bf16_f32 v86, v88, v89
    v_mfma_f32_16x16x32_bf16 a[188:191], v[72:75], v[120:123], a[188:191]
    s_add_u32 m0, s61, 33824
    ds_read_b64_tr_b16 v[42:43], v5 offset:51272
    v_cvt_pk_bf16_f32 v87, v90, v91
    v_mfma_f32_16x16x32_bf16 a[188:191], v[68:71], v[116:119], a[188:191]
    buffer_load_dwordx4 v1, s[40:43], s64 offen offset:1024 nt lds
    v_mfma_f32_16x16x32_bf16 a[184:187], v[68:71], v[108:111], a[184:187]
    v_accvgpr_write_b32 a4, v84
    v_accvgpr_write_b32 a5, v85
    v_mfma_f32_16x16x32_bf16 a[184:187], v[72:75], v[112:115], a[184:187]
    v_accvgpr_write_b32 a6, v86
    v_mfma_f32_16x16x32_bf16 a[180:183], v[72:75], v[104:107], a[180:183]
    s_waitcnt lgkmcnt(2)
    v_accvgpr_write_b32 a7, v87
    v_accvgpr_read_b32 v92, a8
    v_mfma_f32_16x16x32_bf16 a[180:183], v[68:71], v[100:103], a[180:183]
    v_accvgpr_read_b32 v93, a9
    v_mfma_f32_16x16x32_bf16 a[192:195], v[12:15], v[100:103], a[192:195]
    ds_read_b64_tr_b16 v[44:45], v4 offset:50816
    v_accvgpr_read_b32 v94, a10
    v_mfma_f32_16x16x32_bf16 a[192:195], v[16:19], v[104:107], a[192:195]
    ds_read_b64_tr_b16 v[46:47], v4 offset:51328
    v_accvgpr_read_b32 v95, a11
    v_mfma_f32_16x16x32_bf16 a[196:199], v[16:19], v[112:115], a[196:199]
    ds_read_b64_tr_b16 v[48:49], v5 offset:50816
    v_accvgpr_read_b32 v96, a20
    v_mfma_f32_16x16x32_bf16 a[196:199], v[12:15], v[108:111], a[196:199]
    ds_read_b64_tr_b16 v[50:51], v5 offset:51328
    v_accvgpr_read_b32 v97, a21
    v_mfma_f32_16x16x32_bf16 a[200:203], v[12:15], v[116:119], a[200:203]
    ds_read_b64_tr_b16 v[52:53], v4 offset:50824
    v_accvgpr_read_b32 v98, a22
    v_mfma_f32_16x16x32_bf16 a[200:203], v[16:19], v[120:123], a[200:203]
    ds_read_b64_tr_b16 v[54:55], v4 offset:51336
    v_accvgpr_read_b32 v99, a23
    v_mfma_f32_16x16x32_bf16 a[212:215], v[24:27], v[120:123], a[212:215]
    v_mul_f32 v92, s14, v92
    v_mul_f32 v93, s14, v93
    v_mfma_f32_16x16x32_bf16 a[212:215], v[20:23], v[116:119], a[212:215]
    ds_read_b64_tr_b16 v[56:57], v5 offset:50824
    v_mul_f32 v94, s14, v94
    v_mfma_f32_16x16x32_bf16 a[208:211], v[20:23], v[108:111], a[208:211]
    ds_read_b64_tr_b16 v[58:59], v5 offset:51336
    v_mul_f32 v95, s14, v95
    v_mfma_f32_16x16x32_bf16 a[208:211], v[24:27], v[112:115], a[208:211]
    ds_read_b64_tr_b16 v[60:61], v4 offset:50880
    v_mul_f32 v96, s14, v96
    v_mfma_f32_16x16x32_bf16 a[204:207], v[24:27], v[104:107], a[204:207]
    ds_read_b64_tr_b16 v[62:63], v4 offset:51392
    v_mul_f32 v97, s14, v97
    v_mfma_f32_16x16x32_bf16 a[204:207], v[20:23], v[100:103], a[204:207]
    v_mul_f32 v98, s14, v98
    v_mul_f32 v99, s14, v99
    v_mfma_f32_16x16x32_bf16 a[216:219], v[28:31], v[100:103], a[216:219]
    ds_read_b64_tr_b16 v[64:65], v5 offset:50880
    v_cvt_pk_bf16_f32 v92, v92, v93
    v_mfma_f32_16x16x32_bf16 a[216:219], v[32:35], v[104:107], a[216:219]
    ds_read_b64_tr_b16 v[66:67], v5 offset:51392
    v_cvt_pk_bf16_f32 v93, v94, v95
    v_mfma_f32_16x16x32_bf16 a[220:223], v[32:35], v[112:115], a[220:223]
    ds_read_b64_tr_b16 v[68:69], v4 offset:50888
    v_cvt_pk_bf16_f32 v94, v96, v97
    v_mfma_f32_16x16x32_bf16 a[220:223], v[28:31], v[108:111], a[220:223]
    ds_read_b64_tr_b16 v[70:71], v4 offset:51400
    v_cvt_pk_bf16_f32 v95, v98, v99
    v_mfma_f32_16x16x32_bf16 a[224:227], v[28:31], v[116:119], a[224:227]
    v_accvgpr_write_b32 a8, v92
    v_accvgpr_write_b32 a9, v93
    v_mfma_f32_16x16x32_bf16 a[224:227], v[32:35], v[120:123], a[224:227]
    s_waitcnt lgkmcnt(14)
    ds_read_b64_tr_b16 v[72:73], v5 offset:50888
    v_accvgpr_write_b32 a10, v94
    v_mfma_f32_16x16x32_bf16 a[236:239], v[40:43], v[120:123], a[236:239]
    ds_read_b64_tr_b16 v[74:75], v5 offset:51400
    v_accvgpr_write_b32 a11, v95
    v_mfma_f32_16x16x32_bf16 a[236:239], v[36:39], v[116:119], a[236:239]
    v_accvgpr_read_b32 v76, a24
    v_accvgpr_read_b32 v77, a25
    v_mfma_f32_16x16x32_bf16 a[232:235], v[36:39], v[108:111], a[232:235]
    v_accvgpr_read_b32 v78, a26
    v_mfma_f32_16x16x32_bf16 a[232:235], v[40:43], v[112:115], a[232:235]
    v_accvgpr_read_b32 v79, a27
    v_accvgpr_read_b32 v80, a36
    v_mfma_f32_16x16x32_bf16 a[228:231], v[40:43], v[104:107], a[228:231]
    s_waitcnt vmcnt(2) lgkmcnt(0)
    v_accvgpr_read_b32 v81, a37
    v_mfma_f32_16x16x32_bf16 a[228:231], v[36:39], v[100:103], a[228:231]
    s_barrier
    v_mfma_f32_16x16x32_bf16 a[240:243], v[44:47], v[100:103], a[240:243]
    ds_read_b64_tr_b16 v[12:13], v4 offset:59136
    v_accvgpr_read_b32 v82, a38
    v_mfma_f32_16x16x32_bf16 a[240:243], v[48:51], v[104:107], a[240:243]
    ds_read_b64_tr_b16 v[14:15], v4 offset:59648
    v_accvgpr_read_b32 v83, a39
    v_mfma_f32_16x16x32_bf16 a[244:247], v[48:51], v[112:115], a[244:247]
    ds_read_b64_tr_b16 v[16:17], v5 offset:59136
    v_mul_f32 v76, s14, v76
    v_mfma_f32_16x16x32_bf16 a[244:247], v[44:47], v[108:111], a[244:247]
    ds_read_b64_tr_b16 v[18:19], v5 offset:59648
    v_mul_f32 v77, s14, v77
    v_mfma_f32_16x16x32_bf16 a[248:251], v[44:47], v[116:119], a[248:251]
    ds_read_b64_tr_b16 v[20:21], v4 offset:59144
    v_mul_f32 v78, s14, v78
    v_mfma_f32_16x16x32_bf16 a[248:251], v[48:51], v[120:123], a[248:251]
    ds_read_b64_tr_b16 v[22:23], v4 offset:59656
    v_mul_f32 v79, s14, v79
    v_mfma_f32_16x16x32_bf16 v[128:131], v[56:59], v[120:123], v[128:131]
    v_mul_f32 v80, s14, v80
    v_mul_f32 v81, s14, v81
    v_mfma_f32_16x16x32_bf16 v[128:131], v[52:55], v[116:119], v[128:131]
    ds_read_b64_tr_b16 v[24:25], v5 offset:59144
    v_mul_f32 v82, s14, v82
    v_mfma_f32_16x16x32_bf16 v[124:127], v[52:55], v[108:111], v[124:127]
    ds_read_b64_tr_b16 v[26:27], v5 offset:59656
    v_mul_f32 v83, s14, v83
    v_mfma_f32_16x16x32_bf16 v[124:127], v[56:59], v[112:115], v[124:127]
    ds_read_b64_tr_b16 v[28:29], v4 offset:59200
    v_cvt_pk_bf16_f32 v76, v76, v77
    v_mfma_f32_16x16x32_bf16 a[252:255], v[56:59], v[104:107], a[252:255]
    ds_read_b64_tr_b16 v[30:31], v4 offset:59712
    v_cvt_pk_bf16_f32 v77, v78, v79
    v_mfma_f32_16x16x32_bf16 a[252:255], v[52:55], v[100:103], a[252:255]
    v_cvt_pk_bf16_f32 v78, v80, v81
    v_cvt_pk_bf16_f32 v79, v82, v83
    v_mfma_f32_16x16x32_bf16 v[132:135], v[60:63], v[100:103], v[132:135]
    ds_read_b64_tr_b16 v[32:33], v5 offset:59200
    v_accvgpr_write_b32 a12, v76
    v_mfma_f32_16x16x32_bf16 v[132:135], v[64:67], v[104:107], v[132:135]
    ds_read_b64_tr_b16 v[34:35], v5 offset:59712
    v_accvgpr_write_b32 a13, v77
    v_mfma_f32_16x16x32_bf16 v[136:139], v[64:67], v[112:115], v[136:139]
    ds_read_b64_tr_b16 v[36:37], v4 offset:59208
    v_accvgpr_write_b32 a14, v78
    v_mfma_f32_16x16x32_bf16 v[136:139], v[60:63], v[108:111], v[136:139]
    ds_read_b64_tr_b16 v[38:39], v4 offset:59720
    v_accvgpr_write_b32 a15, v79
    v_mfma_f32_16x16x32_bf16 v[140:143], v[60:63], v[116:119], v[140:143]
    v_accvgpr_read_b32 v84, a28
    v_accvgpr_read_b32 v85, a29
    v_mfma_f32_16x16x32_bf16 v[140:143], v[64:67], v[120:123], v[140:143]
    ds_read_b64_tr_b16 v[40:41], v5 offset:59208
    v_accvgpr_read_b32 v86, a30
    v_mfma_f32_16x16x32_bf16 v[152:155], v[72:75], v[120:123], v[152:155]
    ds_read_b64_tr_b16 v[42:43], v5 offset:59720
    v_accvgpr_read_b32 v87, a31
    v_mfma_f32_16x16x32_bf16 v[152:155], v[68:71], v[116:119], v[152:155]
    v_accvgpr_read_b32 v88, a40
    v_accvgpr_read_b32 v89, a41
    v_mfma_f32_16x16x32_bf16 v[148:151], v[68:71], v[108:111], v[148:151]
    v_accvgpr_read_b32 v90, a42
    v_mfma_f32_16x16x32_bf16 v[148:151], v[72:75], v[112:115], v[148:151]
    v_accvgpr_read_b32 v91, a43
    v_mul_f32 v84, s14, v84
    v_mfma_f32_16x16x32_bf16 v[144:147], v[72:75], v[104:107], v[144:147]
    s_waitcnt lgkmcnt(2)
    v_mul_f32 v85, s14, v85
    v_mfma_f32_16x16x32_bf16 v[144:147], v[68:71], v[100:103], v[144:147]
    v_mul_f32 v86, s14, v86
    v_mul_f32 v87, s14, v87
    v_mfma_f32_16x16x32_bf16 v[160:163], v[12:15], v[100:103], v[160:163]
    ds_read_b64_tr_b16 v[44:45], v4 offset:59264
    v_mul_f32 v88, s14, v88
    v_mfma_f32_16x16x32_bf16 v[160:163], v[16:19], v[104:107], v[160:163]
    ds_read_b64_tr_b16 v[46:47], v4 offset:59776
    v_mul_f32 v89, s14, v89
    v_mfma_f32_16x16x32_bf16 v[164:167], v[16:19], v[112:115], v[164:167]
    ds_read_b64_tr_b16 v[48:49], v5 offset:59264
    v_mul_f32 v90, s14, v90
    v_mfma_f32_16x16x32_bf16 v[164:167], v[12:15], v[108:111], v[164:167]
    ds_read_b64_tr_b16 v[50:51], v5 offset:59776
    v_mul_f32 v91, s14, v91
    v_mfma_f32_16x16x32_bf16 v[168:171], v[12:15], v[116:119], v[168:171]
    ds_read_b64_tr_b16 v[52:53], v4 offset:59272
    v_cvt_pk_bf16_f32 v84, v84, v85
    v_mfma_f32_16x16x32_bf16 v[168:171], v[16:19], v[120:123], v[168:171]
    ds_read_b64_tr_b16 v[54:55], v4 offset:59784
    v_cvt_pk_bf16_f32 v85, v86, v87
    v_mfma_f32_16x16x32_bf16 v[180:183], v[24:27], v[120:123], v[180:183]
    v_cvt_pk_bf16_f32 v86, v88, v89
    v_cvt_pk_bf16_f32 v87, v90, v91
    v_mfma_f32_16x16x32_bf16 v[180:183], v[20:23], v[116:119], v[180:183]
    ds_read_b64_tr_b16 v[56:57], v5 offset:59272
    v_accvgpr_write_b32 a16, v84
    v_mfma_f32_16x16x32_bf16 v[176:179], v[20:23], v[108:111], v[176:179]
    ds_read_b64_tr_b16 v[58:59], v5 offset:59784
    v_accvgpr_write_b32 a17, v85
    v_mfma_f32_16x16x32_bf16 v[176:179], v[24:27], v[112:115], v[176:179]
    ds_read_b64_tr_b16 v[60:61], v4 offset:59328
    v_accvgpr_write_b32 a18, v86
    v_mfma_f32_16x16x32_bf16 v[172:175], v[24:27], v[104:107], v[172:175]
    ds_read_b64_tr_b16 v[62:63], v4 offset:59840
    v_accvgpr_write_b32 a19, v87
    v_mfma_f32_16x16x32_bf16 v[172:175], v[20:23], v[100:103], v[172:175]
    v_accvgpr_read_b32 v92, a32
    v_accvgpr_read_b32 v93, a33
    v_mfma_f32_16x16x32_bf16 v[184:187], v[28:31], v[100:103], v[184:187]
    ds_read_b64_tr_b16 v[64:65], v5 offset:59328
    v_accvgpr_read_b32 v94, a34
    v_mfma_f32_16x16x32_bf16 v[184:187], v[32:35], v[104:107], v[184:187]
    ds_read_b64_tr_b16 v[66:67], v5 offset:59840
    v_accvgpr_read_b32 v95, a35
    v_mfma_f32_16x16x32_bf16 v[188:191], v[32:35], v[112:115], v[188:191]
    ds_read_b64_tr_b16 v[68:69], v4 offset:59336
    v_accvgpr_read_b32 v96, a44
    v_mfma_f32_16x16x32_bf16 v[188:191], v[28:31], v[108:111], v[188:191]
    ds_read_b64_tr_b16 v[70:71], v4 offset:59848
    v_accvgpr_read_b32 v97, a45
    v_mfma_f32_16x16x32_bf16 v[192:195], v[28:31], v[116:119], v[192:195]
    v_accvgpr_read_b32 v98, a46
    v_accvgpr_read_b32 v99, a47
    v_mfma_f32_16x16x32_bf16 v[192:195], v[32:35], v[120:123], v[192:195]
    s_waitcnt lgkmcnt(14)
    ds_read_b64_tr_b16 v[72:73], v5 offset:59336
    v_mul_f32 v92, s14, v92
    v_mfma_f32_16x16x32_bf16 v[204:207], v[40:43], v[120:123], v[204:207]
    ds_read_b64_tr_b16 v[74:75], v5 offset:59848
    v_mul_f32 v93, s14, v93
    v_mfma_f32_16x16x32_bf16 v[204:207], v[36:39], v[116:119], v[204:207]
    v_mul_f32 v94, s14, v94
    v_mul_f32 v95, s14, v95
    v_mfma_f32_16x16x32_bf16 v[200:203], v[36:39], v[108:111], v[200:203]
    v_mul_f32 v96, s14, v96
    v_mfma_f32_16x16x32_bf16 v[200:203], v[40:43], v[112:115], v[200:203]
    v_mul_f32 v97, s14, v97
    v_mul_f32 v98, s14, v98
    v_mfma_f32_16x16x32_bf16 v[196:199], v[40:43], v[104:107], v[196:199]
    v_mul_f32 v99, s14, v99
    v_mfma_f32_16x16x32_bf16 v[196:199], v[36:39], v[100:103], v[196:199]
    s_waitcnt lgkmcnt(14)
    v_cvt_pk_bf16_f32 v92, v92, v93
    v_cvt_pk_bf16_f32 v93, v94, v95
    v_mfma_f32_16x16x32_bf16 v[208:211], v[44:47], v[100:103], v[208:211]
    s_waitcnt lgkmcnt(12)
    v_cvt_pk_bf16_f32 v94, v96, v97
    v_cvt_pk_bf16_f32 v95, v98, v99
    v_mfma_f32_16x16x32_bf16 v[208:211], v[48:51], v[104:107], v[208:211]
    v_accvgpr_write_b32 a20, v92
    v_mfma_f32_16x16x32_bf16 v[212:215], v[48:51], v[112:115], v[212:215]
    v_accvgpr_write_b32 a21, v93
    v_accvgpr_write_b32 a22, v94
    v_mfma_f32_16x16x32_bf16 v[212:215], v[44:47], v[108:111], v[212:215]
    v_accvgpr_write_b32 a23, v95
    v_mfma_f32_16x16x32_bf16 v[216:219], v[44:47], v[116:119], v[216:219]
    v_accvgpr_read_b32 v76, a48
    v_accvgpr_read_b32 v77, a49
    v_mfma_f32_16x16x32_bf16 v[216:219], v[48:51], v[120:123], v[216:219]
    s_waitcnt lgkmcnt(8)
    v_accvgpr_read_b32 v78, a50
    v_mfma_f32_16x16x32_bf16 v[228:231], v[56:59], v[120:123], v[228:231]
    v_accvgpr_read_b32 v79, a51
    v_accvgpr_read_b32 v80, a60
    v_mfma_f32_16x16x32_bf16 v[228:231], v[52:55], v[116:119], v[228:231]
    v_accvgpr_read_b32 v81, a61
    v_mfma_f32_16x16x32_bf16 v[224:227], v[52:55], v[108:111], v[224:227]
    v_accvgpr_read_b32 v82, a62
    v_accvgpr_read_b32 v83, a63
    v_mfma_f32_16x16x32_bf16 v[224:227], v[56:59], v[112:115], v[224:227]
    v_mul_f32 v76, s14, v76
    v_mfma_f32_16x16x32_bf16 v[220:223], v[56:59], v[104:107], v[220:223]
    v_mul_f32 v77, s14, v77
    v_mul_f32 v78, s14, v78
    v_mfma_f32_16x16x32_bf16 v[220:223], v[52:55], v[100:103], v[220:223]
    s_waitcnt lgkmcnt(6)
    v_mul_f32 v79, s14, v79
    v_mfma_f32_16x16x32_bf16 v[232:235], v[60:63], v[100:103], v[232:235]
    s_waitcnt lgkmcnt(4)
    v_mul_f32 v80, s14, v80
    v_mul_f32 v81, s14, v81
    v_mfma_f32_16x16x32_bf16 v[232:235], v[64:67], v[104:107], v[232:235]
    v_mul_f32 v82, s14, v82
    v_mfma_f32_16x16x32_bf16 v[236:239], v[64:67], v[112:115], v[236:239]
    v_mul_f32 v83, s14, v83
    v_cvt_pk_bf16_f32 v76, v76, v77
    v_mfma_f32_16x16x32_bf16 v[236:239], v[60:63], v[108:111], v[236:239]
    v_cvt_pk_bf16_f32 v77, v78, v79
    v_mfma_f32_16x16x32_bf16 v[240:243], v[60:63], v[116:119], v[240:243]
    v_cvt_pk_bf16_f32 v78, v80, v81
    v_cvt_pk_bf16_f32 v79, v82, v83
    v_mfma_f32_16x16x32_bf16 v[240:243], v[64:67], v[120:123], v[240:243]
    s_waitcnt lgkmcnt(0)
    v_accvgpr_write_b32 a24, v76
    v_mfma_f32_16x16x32_bf16 v[252:255], v[72:75], v[120:123], v[252:255]
    v_accvgpr_write_b32 a25, v77
    v_accvgpr_write_b32 a26, v78
    v_mfma_f32_16x16x32_bf16 v[252:255], v[68:71], v[116:119], v[252:255]
    v_accvgpr_write_b32 a27, v79
    v_mfma_f32_16x16x32_bf16 v[248:251], v[68:71], v[108:111], v[248:251]
    v_accvgpr_read_b32 v84, a52
    v_accvgpr_read_b32 v85, a53
    v_mfma_f32_16x16x32_bf16 v[248:251], v[72:75], v[112:115], v[248:251]
    v_accvgpr_read_b32 v86, a54
    v_mfma_f32_16x16x32_bf16 v[244:247], v[72:75], v[104:107], v[244:247]
    v_accvgpr_read_b32 v87, a55
    v_accvgpr_read_b32 v88, a64
    v_mfma_f32_16x16x32_bf16 v[244:247], v[68:71], v[100:103], v[244:247]
    v_accvgpr_read_b32 v89, a65
    v_accvgpr_read_b32 v90, a66
    v_accvgpr_read_b32 v91, a67
    v_pk_mul_f32 v[84:85], v[84:85], s[14:15] op_sel:[0,0] op_sel_hi:[1,0]
    v_pk_mul_f32 v[86:87], v[86:87], s[14:15] op_sel:[0,0] op_sel_hi:[1,0]
    v_pk_mul_f32 v[88:89], v[88:89], s[14:15] op_sel:[0,0] op_sel_hi:[1,0]
    v_pk_mul_f32 v[90:91], v[90:91], s[14:15] op_sel:[0,0] op_sel_hi:[1,0]
    v_cvt_pk_bf16_f32 v84, v84, v85
    v_cvt_pk_bf16_f32 v85, v86, v87
    v_cvt_pk_bf16_f32 v86, v88, v89
    v_cvt_pk_bf16_f32 v87, v90, v91
    v_accvgpr_write_b32 a28, v84
    v_accvgpr_write_b32 a29, v85
    v_accvgpr_write_b32 a30, v86
    v_accvgpr_write_b32 a31, v87
    v_accvgpr_read_b32 v92, a56
    v_accvgpr_read_b32 v93, a57
    v_accvgpr_read_b32 v94, a58
    v_accvgpr_read_b32 v95, a59
    v_accvgpr_read_b32 v96, a68
    v_accvgpr_read_b32 v97, a69
    v_accvgpr_read_b32 v98, a70
    v_accvgpr_read_b32 v99, a71
    v_pk_mul_f32 v[92:93], v[92:93], s[14:15] op_sel:[0,0] op_sel_hi:[1,0]
    s_xor_b32 s64, s56, 32768
    s_add_u32 m0, s61, 101376
    v_pk_mul_f32 v[94:95], v[94:95], s[14:15] op_sel:[0,0] op_sel_hi:[1,0]
    buffer_load_dwordx4 v1, s[44:47], s64 offen nt lds
    v_pk_mul_f32 v[96:97], v[96:97], s[14:15] op_sel:[0,0] op_sel_hi:[1,0]
    v_pk_mul_f32 v[98:99], v[98:99], s[14:15] op_sel:[0,0] op_sel_hi:[1,0]
    v_cvt_pk_bf16_f32 v92, v92, v93
    v_cvt_pk_bf16_f32 v93, v94, v95
    v_cvt_pk_bf16_f32 v94, v96, v97
    v_cvt_pk_bf16_f32 v95, v98, v99
    v_accvgpr_write_b32 a32, v92
    v_accvgpr_write_b32 a33, v93
    v_accvgpr_write_b32 a34, v94
    v_accvgpr_write_b32 a35, v95
    v_accvgpr_read_b32 v76, a72
    v_accvgpr_read_b32 v77, a73
    v_accvgpr_read_b32 v78, a74
    v_accvgpr_read_b32 v79, a75
    v_accvgpr_read_b32 v80, a84
    v_accvgpr_read_b32 v81, a85
    v_accvgpr_read_b32 v82, a86
    v_accvgpr_read_b32 v83, a87
    v_pk_mul_f32 v[76:77], v[76:77], s[14:15] op_sel:[0,0] op_sel_hi:[1,0]
    v_pk_mul_f32 v[78:79], v[78:79], s[14:15] op_sel:[0,0] op_sel_hi:[1,0]
    v_pk_mul_f32 v[80:81], v[80:81], s[14:15] op_sel:[0,0] op_sel_hi:[1,0]
    v_pk_mul_f32 v[82:83], v[82:83], s[14:15] op_sel:[0,0] op_sel_hi:[1,0]
    v_cvt_pk_bf16_f32 v76, v76, v77
    v_cvt_pk_bf16_f32 v77, v78, v79
    v_cvt_pk_bf16_f32 v78, v80, v81
    v_cvt_pk_bf16_f32 v79, v82, v83
    v_accvgpr_write_b32 a36, v76
    v_accvgpr_write_b32 a37, v77
    v_accvgpr_write_b32 a38, v78
    v_accvgpr_write_b32 a39, v79
    v_accvgpr_read_b32 v84, a76
    v_accvgpr_read_b32 v85, a77
    v_accvgpr_read_b32 v86, a78
    v_accvgpr_read_b32 v87, a79
    v_accvgpr_read_b32 v88, a88
    v_accvgpr_read_b32 v89, a89
    v_accvgpr_read_b32 v90, a90
    v_accvgpr_read_b32 v91, a91
    v_pk_mul_f32 v[84:85], v[84:85], s[14:15] op_sel:[0,0] op_sel_hi:[1,0]
    v_pk_mul_f32 v[86:87], v[86:87], s[14:15] op_sel:[0,0] op_sel_hi:[1,0]
    v_pk_mul_f32 v[88:89], v[88:89], s[14:15] op_sel:[0,0] op_sel_hi:[1,0]
    v_pk_mul_f32 v[90:91], v[90:91], s[14:15] op_sel:[0,0] op_sel_hi:[1,0]
    v_cvt_pk_bf16_f32 v84, v84, v85
    v_cvt_pk_bf16_f32 v85, v86, v87
    v_cvt_pk_bf16_f32 v86, v88, v89
    v_cvt_pk_bf16_f32 v87, v90, v91
    v_accvgpr_write_b32 a40, v84
    v_accvgpr_write_b32 a41, v85
    v_accvgpr_write_b32 a42, v86
    v_accvgpr_write_b32 a43, v87
    v_accvgpr_read_b32 v92, a80
    v_accvgpr_read_b32 v93, a81
    v_accvgpr_read_b32 v94, a82
    v_accvgpr_read_b32 v95, a83
    v_accvgpr_read_b32 v96, a92
    v_accvgpr_read_b32 v97, a93
    v_accvgpr_read_b32 v98, a94
    v_accvgpr_read_b32 v99, a95
    v_pk_mul_f32 v[92:93], v[92:93], s[14:15] op_sel:[0,0] op_sel_hi:[1,0]
    v_pk_mul_f32 v[94:95], v[94:95], s[14:15] op_sel:[0,0] op_sel_hi:[1,0]
    v_pk_mul_f32 v[96:97], v[96:97], s[14:15] op_sel:[0,0] op_sel_hi:[1,0]
    v_pk_mul_f32 v[98:99], v[98:99], s[14:15] op_sel:[0,0] op_sel_hi:[1,0]
    v_cvt_pk_bf16_f32 v92, v92, v93
    v_cvt_pk_bf16_f32 v93, v94, v95
    v_cvt_pk_bf16_f32 v94, v96, v97
    v_cvt_pk_bf16_f32 v95, v98, v99
    v_accvgpr_write_b32 a44, v92
    v_accvgpr_write_b32 a45, v93
    v_accvgpr_write_b32 a46, v94
    v_accvgpr_write_b32 a47, v95
    v_accvgpr_read_b32 v60, a96
    v_accvgpr_read_b32 v61, a97
    v_accvgpr_read_b32 v62, a98
    v_accvgpr_read_b32 v63, a99
    v_accvgpr_read_b32 v64, a108
    v_accvgpr_read_b32 v65, a109
    v_accvgpr_read_b32 v66, a110
    v_accvgpr_read_b32 v67, a111
    v_pk_mul_f32 v[60:61], v[60:61], s[14:15] op_sel:[0,0] op_sel_hi:[1,0]
    s_add_u32 m0, s61, 101408
    v_pk_mul_f32 v[62:63], v[62:63], s[14:15] op_sel:[0,0] op_sel_hi:[1,0]
    buffer_load_dwordx4 v1, s[44:47], s64 offen offset:1024 nt lds
    v_pk_mul_f32 v[64:65], v[64:65], s[14:15] op_sel:[0,0] op_sel_hi:[1,0]
    v_pk_mul_f32 v[66:67], v[66:67], s[14:15] op_sel:[0,0] op_sel_hi:[1,0]
    v_cvt_pk_bf16_f32 v60, v60, v61
    v_cvt_pk_bf16_f32 v61, v62, v63
    v_cvt_pk_bf16_f32 v62, v64, v65
    v_cvt_pk_bf16_f32 v63, v66, v67
    v_accvgpr_write_b32 a48, v60
    v_accvgpr_write_b32 a49, v61
    v_accvgpr_write_b32 a50, v62
    v_accvgpr_write_b32 a51, v63
    v_accvgpr_read_b32 v68, a100
    v_accvgpr_read_b32 v69, a101
    v_accvgpr_read_b32 v70, a102
    v_accvgpr_read_b32 v71, a103
    v_accvgpr_read_b32 v72, a112
    v_accvgpr_read_b32 v73, a113
    v_accvgpr_read_b32 v74, a114
    v_accvgpr_read_b32 v75, a115
    v_pk_mul_f32 v[68:69], v[68:69], s[14:15] op_sel:[0,0] op_sel_hi:[1,0]
    v_pk_mul_f32 v[70:71], v[70:71], s[14:15] op_sel:[0,0] op_sel_hi:[1,0]
    v_pk_mul_f32 v[72:73], v[72:73], s[14:15] op_sel:[0,0] op_sel_hi:[1,0]
    v_pk_mul_f32 v[74:75], v[74:75], s[14:15] op_sel:[0,0] op_sel_hi:[1,0]
    v_cvt_pk_bf16_f32 v68, v68, v69
    v_cvt_pk_bf16_f32 v69, v70, v71
    v_cvt_pk_bf16_f32 v70, v72, v73
    v_cvt_pk_bf16_f32 v71, v74, v75
    v_accvgpr_write_b32 a52, v68
    v_accvgpr_write_b32 a53, v69
    v_accvgpr_write_b32 a54, v70
    v_accvgpr_write_b32 a55, v71
    v_accvgpr_read_b32 v76, a104
    v_accvgpr_read_b32 v77, a105
    v_accvgpr_read_b32 v78, a106
    v_accvgpr_read_b32 v79, a107
    v_accvgpr_read_b32 v80, a116
    v_accvgpr_read_b32 v81, a117
    v_accvgpr_read_b32 v82, a118
    v_accvgpr_read_b32 v83, a119
    v_pk_mul_f32 v[76:77], v[76:77], s[14:15] op_sel:[0,0] op_sel_hi:[1,0]
    v_pk_mul_f32 v[78:79], v[78:79], s[14:15] op_sel:[0,0] op_sel_hi:[1,0]
    v_pk_mul_f32 v[80:81], v[80:81], s[14:15] op_sel:[0,0] op_sel_hi:[1,0]
    v_pk_mul_f32 v[82:83], v[82:83], s[14:15] op_sel:[0,0] op_sel_hi:[1,0]
    v_cvt_pk_bf16_f32 v76, v76, v77
    v_cvt_pk_bf16_f32 v77, v78, v79
    v_cvt_pk_bf16_f32 v78, v80, v81
    v_cvt_pk_bf16_f32 v79, v82, v83
    v_accvgpr_write_b32 a56, v76
    v_accvgpr_write_b32 a57, v77
    v_accvgpr_write_b32 a58, v78
    v_accvgpr_write_b32 a59, v79
    v_accvgpr_read_b32 v84, a120
    v_accvgpr_read_b32 v85, a121
    v_accvgpr_read_b32 v86, a122
    v_accvgpr_read_b32 v87, a123
    v_accvgpr_read_b32 v88, a132
    v_accvgpr_read_b32 v89, a133
    v_accvgpr_read_b32 v90, a134
    v_accvgpr_read_b32 v91, a135
    v_pk_mul_f32 v[84:85], v[84:85], s[14:15] op_sel:[0,0] op_sel_hi:[1,0]
    v_pk_mul_f32 v[86:87], v[86:87], s[14:15] op_sel:[0,0] op_sel_hi:[1,0]
    v_pk_mul_f32 v[88:89], v[88:89], s[14:15] op_sel:[0,0] op_sel_hi:[1,0]
    v_pk_mul_f32 v[90:91], v[90:91], s[14:15] op_sel:[0,0] op_sel_hi:[1,0]
    v_cvt_pk_bf16_f32 v84, v84, v85
    v_cvt_pk_bf16_f32 v85, v86, v87
    v_cvt_pk_bf16_f32 v86, v88, v89
    v_cvt_pk_bf16_f32 v87, v90, v91
    v_accvgpr_write_b32 a60, v84
    v_accvgpr_write_b32 a61, v85
    v_accvgpr_write_b32 a62, v86
    v_accvgpr_write_b32 a63, v87
    v_accvgpr_read_b32 v92, a124
    v_accvgpr_read_b32 v93, a125
    v_accvgpr_read_b32 v94, a126
    v_accvgpr_read_b32 v95, a127
    v_accvgpr_read_b32 v96, a136
    v_accvgpr_read_b32 v97, a137
    v_accvgpr_read_b32 v98, a138
    v_accvgpr_read_b32 v99, a139
    v_pk_mul_f32 v[92:93], v[92:93], s[14:15] op_sel:[0,0] op_sel_hi:[1,0]
    s_xor_b32 s64, s56, 40960
    s_add_u32 m0, s61, 42240
    v_pk_mul_f32 v[94:95], v[94:95], s[14:15] op_sel:[0,0] op_sel_hi:[1,0]
    buffer_load_dwordx4 v1, s[40:43], s64 offen nt lds
    v_pk_mul_f32 v[96:97], v[96:97], s[14:15] op_sel:[0,0] op_sel_hi:[1,0]
    v_pk_mul_f32 v[98:99], v[98:99], s[14:15] op_sel:[0,0] op_sel_hi:[1,0]
    v_cvt_pk_bf16_f32 v92, v92, v93
    v_cvt_pk_bf16_f32 v93, v94, v95
    v_cvt_pk_bf16_f32 v94, v96, v97
    v_cvt_pk_bf16_f32 v95, v98, v99
    v_accvgpr_write_b32 a64, v92
    v_accvgpr_write_b32 a65, v93
    v_accvgpr_write_b32 a66, v94
    v_accvgpr_write_b32 a67, v95
    v_accvgpr_read_b32 v100, a128
    v_accvgpr_read_b32 v101, a129
    v_accvgpr_read_b32 v102, a130
    v_accvgpr_read_b32 v103, a131
    v_accvgpr_read_b32 v104, a140
    v_accvgpr_read_b32 v105, a141
    v_accvgpr_read_b32 v106, a142
    v_accvgpr_read_b32 v107, a143
    v_pk_mul_f32 v[100:101], v[100:101], s[14:15] op_sel:[0,0] op_sel_hi:[1,0]
    v_pk_mul_f32 v[102:103], v[102:103], s[14:15] op_sel:[0,0] op_sel_hi:[1,0]
    v_pk_mul_f32 v[104:105], v[104:105], s[14:15] op_sel:[0,0] op_sel_hi:[1,0]
    v_pk_mul_f32 v[106:107], v[106:107], s[14:15] op_sel:[0,0] op_sel_hi:[1,0]
    v_cvt_pk_bf16_f32 v100, v100, v101
    v_cvt_pk_bf16_f32 v101, v102, v103
    v_cvt_pk_bf16_f32 v102, v104, v105
    v_cvt_pk_bf16_f32 v103, v106, v107
    v_accvgpr_write_b32 a68, v100
    v_accvgpr_write_b32 a69, v101
    v_accvgpr_write_b32 a70, v102
    v_accvgpr_write_b32 a71, v103
    v_accvgpr_read_b32 v108, a144
    v_accvgpr_read_b32 v109, a145
    v_accvgpr_read_b32 v110, a146
    v_accvgpr_read_b32 v111, a147
    v_accvgpr_read_b32 v112, a156
    v_accvgpr_read_b32 v113, a157
    v_accvgpr_read_b32 v114, a158
    v_accvgpr_read_b32 v115, a159
    v_pk_mul_f32 v[108:109], v[108:109], s[14:15] op_sel:[0,0] op_sel_hi:[1,0]
    v_pk_mul_f32 v[110:111], v[110:111], s[14:15] op_sel:[0,0] op_sel_hi:[1,0]
    v_pk_mul_f32 v[112:113], v[112:113], s[14:15] op_sel:[0,0] op_sel_hi:[1,0]
    v_pk_mul_f32 v[114:115], v[114:115], s[14:15] op_sel:[0,0] op_sel_hi:[1,0]
    v_cvt_pk_bf16_f32 v108, v108, v109
    v_cvt_pk_bf16_f32 v109, v110, v111
    v_cvt_pk_bf16_f32 v110, v112, v113
    v_cvt_pk_bf16_f32 v111, v114, v115
    v_accvgpr_write_b32 a72, v108
    v_accvgpr_write_b32 a73, v109
    v_accvgpr_write_b32 a74, v110
    v_accvgpr_write_b32 a75, v111
    v_accvgpr_read_b32 v116, a148
    v_accvgpr_read_b32 v117, a149
    v_accvgpr_read_b32 v118, a150
    v_accvgpr_read_b32 v119, a151
    v_accvgpr_read_b32 v120, a160
    v_accvgpr_read_b32 v121, a161
    v_accvgpr_read_b32 v122, a162
    v_accvgpr_read_b32 v123, a163
    v_pk_mul_f32 v[116:117], v[116:117], s[14:15] op_sel:[0,0] op_sel_hi:[1,0]
    v_pk_mul_f32 v[118:119], v[118:119], s[14:15] op_sel:[0,0] op_sel_hi:[1,0]
    v_pk_mul_f32 v[120:121], v[120:121], s[14:15] op_sel:[0,0] op_sel_hi:[1,0]
    v_pk_mul_f32 v[122:123], v[122:123], s[14:15] op_sel:[0,0] op_sel_hi:[1,0]
    v_cvt_pk_bf16_f32 v116, v116, v117
    v_cvt_pk_bf16_f32 v117, v118, v119
    v_cvt_pk_bf16_f32 v118, v120, v121
    v_cvt_pk_bf16_f32 v119, v122, v123
    v_accvgpr_write_b32 a76, v116
    v_accvgpr_write_b32 a77, v117
    v_accvgpr_write_b32 a78, v118
    v_accvgpr_write_b32 a79, v119
    v_accvgpr_read_b32 v60, a152
    v_accvgpr_read_b32 v61, a153
    v_accvgpr_read_b32 v62, a154
    v_accvgpr_read_b32 v63, a155
    v_accvgpr_read_b32 v64, a164
    v_accvgpr_read_b32 v65, a165
    v_accvgpr_read_b32 v66, a166
    v_accvgpr_read_b32 v67, a167
    v_pk_mul_f32 v[60:61], v[60:61], s[14:15] op_sel:[0,0] op_sel_hi:[1,0]
    s_add_u32 m0, s61, 42272
    v_pk_mul_f32 v[62:63], v[62:63], s[14:15] op_sel:[0,0] op_sel_hi:[1,0]
    buffer_load_dwordx4 v1, s[40:43], s64 offen offset:1024 nt lds
    v_pk_mul_f32 v[64:65], v[64:65], s[14:15] op_sel:[0,0] op_sel_hi:[1,0]
    v_pk_mul_f32 v[66:67], v[66:67], s[14:15] op_sel:[0,0] op_sel_hi:[1,0]
    v_cvt_pk_bf16_f32 v60, v60, v61
    v_cvt_pk_bf16_f32 v61, v62, v63
    v_cvt_pk_bf16_f32 v62, v64, v65
    v_cvt_pk_bf16_f32 v63, v66, v67
    v_accvgpr_write_b32 a80, v60
    v_accvgpr_write_b32 a81, v61
    v_accvgpr_write_b32 a82, v62
    v_accvgpr_write_b32 a83, v63
    v_accvgpr_read_b32 v68, a168
    v_accvgpr_read_b32 v69, a169
    v_accvgpr_read_b32 v70, a170
    v_accvgpr_read_b32 v71, a171
    v_accvgpr_read_b32 v72, a180
    v_accvgpr_read_b32 v73, a181
    v_accvgpr_read_b32 v74, a182
    v_accvgpr_read_b32 v75, a183
    v_pk_mul_f32 v[68:69], v[68:69], s[14:15] op_sel:[0,0] op_sel_hi:[1,0]
    v_pk_mul_f32 v[70:71], v[70:71], s[14:15] op_sel:[0,0] op_sel_hi:[1,0]
    v_pk_mul_f32 v[72:73], v[72:73], s[14:15] op_sel:[0,0] op_sel_hi:[1,0]
    v_pk_mul_f32 v[74:75], v[74:75], s[14:15] op_sel:[0,0] op_sel_hi:[1,0]
    v_cvt_pk_bf16_f32 v68, v68, v69
    v_cvt_pk_bf16_f32 v69, v70, v71
    v_cvt_pk_bf16_f32 v70, v72, v73
    v_cvt_pk_bf16_f32 v71, v74, v75
    v_accvgpr_write_b32 a84, v68
    v_accvgpr_write_b32 a85, v69
    v_accvgpr_write_b32 a86, v70
    v_accvgpr_write_b32 a87, v71
    v_accvgpr_read_b32 v76, a172
    v_accvgpr_read_b32 v77, a173
    v_accvgpr_read_b32 v78, a174
    v_accvgpr_read_b32 v79, a175
    v_accvgpr_read_b32 v80, a184
    v_accvgpr_read_b32 v81, a185
    v_accvgpr_read_b32 v82, a186
    v_accvgpr_read_b32 v83, a187
    v_pk_mul_f32 v[76:77], v[76:77], s[14:15] op_sel:[0,0] op_sel_hi:[1,0]
    v_pk_mul_f32 v[78:79], v[78:79], s[14:15] op_sel:[0,0] op_sel_hi:[1,0]
    v_pk_mul_f32 v[80:81], v[80:81], s[14:15] op_sel:[0,0] op_sel_hi:[1,0]
    v_pk_mul_f32 v[82:83], v[82:83], s[14:15] op_sel:[0,0] op_sel_hi:[1,0]
    v_cvt_pk_bf16_f32 v76, v76, v77
    v_cvt_pk_bf16_f32 v77, v78, v79
    v_cvt_pk_bf16_f32 v78, v80, v81
    v_cvt_pk_bf16_f32 v79, v82, v83
    v_accvgpr_write_b32 a88, v76
    v_accvgpr_write_b32 a89, v77
    v_accvgpr_write_b32 a90, v78
    v_accvgpr_write_b32 a91, v79
    v_accvgpr_read_b32 v84, a176
    v_accvgpr_read_b32 v85, a177
    v_accvgpr_read_b32 v86, a178
    v_accvgpr_read_b32 v87, a179
    v_accvgpr_read_b32 v88, a188
    v_accvgpr_read_b32 v89, a189
    v_accvgpr_read_b32 v90, a190
    v_accvgpr_read_b32 v91, a191
    v_pk_mul_f32 v[84:85], v[84:85], s[14:15] op_sel:[0,0] op_sel_hi:[1,0]
    v_pk_mul_f32 v[86:87], v[86:87], s[14:15] op_sel:[0,0] op_sel_hi:[1,0]
    v_pk_mul_f32 v[88:89], v[88:89], s[14:15] op_sel:[0,0] op_sel_hi:[1,0]
    v_pk_mul_f32 v[90:91], v[90:91], s[14:15] op_sel:[0,0] op_sel_hi:[1,0]
    v_cvt_pk_bf16_f32 v84, v84, v85
    v_cvt_pk_bf16_f32 v85, v86, v87
    v_cvt_pk_bf16_f32 v86, v88, v89
    v_cvt_pk_bf16_f32 v87, v90, v91
    v_accvgpr_write_b32 a92, v84
    v_accvgpr_write_b32 a93, v85
    v_accvgpr_write_b32 a94, v86
    v_accvgpr_write_b32 a95, v87
    v_accvgpr_read_b32 v60, a192
    v_accvgpr_read_b32 v61, a193
    v_accvgpr_read_b32 v62, a194
    v_accvgpr_read_b32 v63, a195
    v_accvgpr_read_b32 v64, a204
    v_accvgpr_read_b32 v65, a205
    v_accvgpr_read_b32 v66, a206
    v_accvgpr_read_b32 v67, a207
    s_xor_b32 s64, s56, 40960
    s_add_u32 m0, s61, 109824
    v_pk_mul_f32 v[60:61], v[60:61], s[14:15] op_sel:[0,0] op_sel_hi:[1,0]
    buffer_load_dwordx4 v1, s[44:47], s64 offen nt lds
    v_pk_mul_f32 v[62:63], v[62:63], s[14:15] op_sel:[0,0] op_sel_hi:[1,0]
    v_pk_mul_f32 v[64:65], v[64:65], s[14:15] op_sel:[0,0] op_sel_hi:[1,0]
    v_pk_mul_f32 v[66:67], v[66:67], s[14:15] op_sel:[0,0] op_sel_hi:[1,0]
    v_cvt_pk_bf16_f32 v60, v60, v61
    v_cvt_pk_bf16_f32 v61, v62, v63
    v_cvt_pk_bf16_f32 v62, v64, v65
    v_cvt_pk_bf16_f32 v63, v66, v67
    v_accvgpr_write_b32 a96, v60
    v_accvgpr_write_b32 a97, v61
    v_accvgpr_write_b32 a98, v62
    v_accvgpr_write_b32 a99, v63
    v_accvgpr_read_b32 v68, a196
    v_accvgpr_read_b32 v69, a197
    v_accvgpr_read_b32 v70, a198
    v_accvgpr_read_b32 v71, a199
    v_accvgpr_read_b32 v72, a208
    v_accvgpr_read_b32 v73, a209
    v_accvgpr_read_b32 v74, a210
    v_accvgpr_read_b32 v75, a211
    v_pk_mul_f32 v[68:69], v[68:69], s[14:15] op_sel:[0,0] op_sel_hi:[1,0]
    v_pk_mul_f32 v[70:71], v[70:71], s[14:15] op_sel:[0,0] op_sel_hi:[1,0]
    v_pk_mul_f32 v[72:73], v[72:73], s[14:15] op_sel:[0,0] op_sel_hi:[1,0]
    v_pk_mul_f32 v[74:75], v[74:75], s[14:15] op_sel:[0,0] op_sel_hi:[1,0]
    v_cvt_pk_bf16_f32 v68, v68, v69
    v_cvt_pk_bf16_f32 v69, v70, v71
    v_cvt_pk_bf16_f32 v70, v72, v73
    v_cvt_pk_bf16_f32 v71, v74, v75
    v_accvgpr_write_b32 a100, v68
    v_accvgpr_write_b32 a101, v69
    v_accvgpr_write_b32 a102, v70
    v_accvgpr_write_b32 a103, v71
    v_accvgpr_read_b32 v76, a200
    v_accvgpr_read_b32 v77, a201
    v_accvgpr_read_b32 v78, a202
    v_accvgpr_read_b32 v79, a203
    v_accvgpr_read_b32 v80, a212
    v_accvgpr_read_b32 v81, a213
    v_accvgpr_read_b32 v82, a214
    v_accvgpr_read_b32 v83, a215
    v_pk_mul_f32 v[76:77], v[76:77], s[14:15] op_sel:[0,0] op_sel_hi:[1,0]
    v_pk_mul_f32 v[78:79], v[78:79], s[14:15] op_sel:[0,0] op_sel_hi:[1,0]
    v_pk_mul_f32 v[80:81], v[80:81], s[14:15] op_sel:[0,0] op_sel_hi:[1,0]
    v_pk_mul_f32 v[82:83], v[82:83], s[14:15] op_sel:[0,0] op_sel_hi:[1,0]
    v_cvt_pk_bf16_f32 v76, v76, v77
    v_cvt_pk_bf16_f32 v77, v78, v79
    v_cvt_pk_bf16_f32 v78, v80, v81
    v_cvt_pk_bf16_f32 v79, v82, v83
    v_accvgpr_write_b32 a104, v76
    v_accvgpr_write_b32 a105, v77
    v_accvgpr_write_b32 a106, v78
    v_accvgpr_write_b32 a107, v79
    v_accvgpr_read_b32 v84, a216
    v_accvgpr_read_b32 v85, a217
    v_accvgpr_read_b32 v86, a218
    v_accvgpr_read_b32 v87, a219
    v_accvgpr_read_b32 v88, a228
    v_accvgpr_read_b32 v89, a229
    v_accvgpr_read_b32 v90, a230
    v_accvgpr_read_b32 v91, a231
    v_pk_mul_f32 v[84:85], v[84:85], s[14:15] op_sel:[0,0] op_sel_hi:[1,0]
    v_pk_mul_f32 v[86:87], v[86:87], s[14:15] op_sel:[0,0] op_sel_hi:[1,0]
    v_pk_mul_f32 v[88:89], v[88:89], s[14:15] op_sel:[0,0] op_sel_hi:[1,0]
    v_pk_mul_f32 v[90:91], v[90:91], s[14:15] op_sel:[0,0] op_sel_hi:[1,0]
    v_cvt_pk_bf16_f32 v84, v84, v85
    v_cvt_pk_bf16_f32 v85, v86, v87
    v_cvt_pk_bf16_f32 v86, v88, v89
    v_cvt_pk_bf16_f32 v87, v90, v91
    v_accvgpr_write_b32 a108, v84
    v_accvgpr_write_b32 a109, v85
    v_accvgpr_write_b32 a110, v86
    v_accvgpr_write_b32 a111, v87
    v_accvgpr_read_b32 v92, a220
    v_accvgpr_read_b32 v93, a221
    v_accvgpr_read_b32 v94, a222
    v_accvgpr_read_b32 v95, a223
    v_accvgpr_read_b32 v96, a232
    v_accvgpr_read_b32 v97, a233
    v_accvgpr_read_b32 v98, a234
    v_accvgpr_read_b32 v99, a235
    s_add_u32 m0, s61, 109856
    v_pk_mul_f32 v[92:93], v[92:93], s[14:15] op_sel:[0,0] op_sel_hi:[1,0]
    buffer_load_dwordx4 v1, s[44:47], s64 offen offset:1024 nt lds
    v_pk_mul_f32 v[94:95], v[94:95], s[14:15] op_sel:[0,0] op_sel_hi:[1,0]
    v_pk_mul_f32 v[96:97], v[96:97], s[14:15] op_sel:[0,0] op_sel_hi:[1,0]
    v_pk_mul_f32 v[98:99], v[98:99], s[14:15] op_sel:[0,0] op_sel_hi:[1,0]
    v_cvt_pk_bf16_f32 v92, v92, v93
    v_cvt_pk_bf16_f32 v93, v94, v95
    v_cvt_pk_bf16_f32 v94, v96, v97
    v_cvt_pk_bf16_f32 v95, v98, v99
    v_accvgpr_write_b32 a112, v92
    v_accvgpr_write_b32 a113, v93
    v_accvgpr_write_b32 a114, v94
    v_accvgpr_write_b32 a115, v95
    v_accvgpr_read_b32 v100, a224
    v_accvgpr_read_b32 v101, a225
    v_accvgpr_read_b32 v102, a226
    v_accvgpr_read_b32 v103, a227
    v_accvgpr_read_b32 v104, a236
    v_accvgpr_read_b32 v105, a237
    v_accvgpr_read_b32 v106, a238
    v_accvgpr_read_b32 v107, a239
    v_pk_mul_f32 v[100:101], v[100:101], s[14:15] op_sel:[0,0] op_sel_hi:[1,0]
    v_pk_mul_f32 v[102:103], v[102:103], s[14:15] op_sel:[0,0] op_sel_hi:[1,0]
    v_pk_mul_f32 v[104:105], v[104:105], s[14:15] op_sel:[0,0] op_sel_hi:[1,0]
    v_pk_mul_f32 v[106:107], v[106:107], s[14:15] op_sel:[0,0] op_sel_hi:[1,0]
    v_cvt_pk_bf16_f32 v100, v100, v101
    v_cvt_pk_bf16_f32 v101, v102, v103
    v_cvt_pk_bf16_f32 v102, v104, v105
    v_cvt_pk_bf16_f32 v103, v106, v107
    v_accvgpr_write_b32 a116, v100
    v_accvgpr_write_b32 a117, v101
    v_accvgpr_write_b32 a118, v102
    v_accvgpr_write_b32 a119, v103
    v_accvgpr_read_b32 v108, a240
    v_accvgpr_read_b32 v109, a241
    v_accvgpr_read_b32 v110, a242
    v_accvgpr_read_b32 v111, a243
    v_accvgpr_read_b32 v112, a252
    v_accvgpr_read_b32 v113, a253
    v_accvgpr_read_b32 v114, a254
    v_accvgpr_read_b32 v115, a255
    v_pk_mul_f32 v[108:109], v[108:109], s[14:15] op_sel:[0,0] op_sel_hi:[1,0]
    v_pk_mul_f32 v[110:111], v[110:111], s[14:15] op_sel:[0,0] op_sel_hi:[1,0]
    v_pk_mul_f32 v[112:113], v[112:113], s[14:15] op_sel:[0,0] op_sel_hi:[1,0]
    v_pk_mul_f32 v[114:115], v[114:115], s[14:15] op_sel:[0,0] op_sel_hi:[1,0]
    v_cvt_pk_bf16_f32 v108, v108, v109
    v_cvt_pk_bf16_f32 v109, v110, v111
    v_cvt_pk_bf16_f32 v110, v112, v113
    v_cvt_pk_bf16_f32 v111, v114, v115
    v_accvgpr_write_b32 a120, v108
    v_accvgpr_write_b32 a121, v109
    v_accvgpr_write_b32 a122, v110
    v_accvgpr_write_b32 a123, v111
    v_accvgpr_read_b32 v116, a244
    v_accvgpr_read_b32 v117, a245
    v_accvgpr_read_b32 v118, a246
    v_accvgpr_read_b32 v119, a247
    v_pk_mul_f32 v[116:117], v[116:117], s[14:15] op_sel:[0,0] op_sel_hi:[1,0]
    v_pk_mul_f32 v[118:119], v[118:119], s[14:15] op_sel:[0,0] op_sel_hi:[1,0]
    v_pk_mul_f32 v[124:125], v[124:125], s[14:15] op_sel:[0,0] op_sel_hi:[1,0]
    v_pk_mul_f32 v[126:127], v[126:127], s[14:15] op_sel:[0,0] op_sel_hi:[1,0]
    v_cvt_pk_bf16_f32 v116, v116, v117
    v_cvt_pk_bf16_f32 v117, v118, v119
    v_cvt_pk_bf16_f32 v118, v124, v125
    v_cvt_pk_bf16_f32 v119, v126, v127
    v_accvgpr_write_b32 a124, v116
    v_accvgpr_write_b32 a125, v117
    v_accvgpr_write_b32 a126, v118
    v_accvgpr_write_b32 a127, v119
    v_accvgpr_read_b32 v60, a248
    v_accvgpr_read_b32 v61, a249
    v_accvgpr_read_b32 v62, a250
    v_accvgpr_read_b32 v63, a251
    v_pk_mul_f32 v[60:61], v[60:61], s[14:15] op_sel:[0,0] op_sel_hi:[1,0]
    v_pk_mul_f32 v[62:63], v[62:63], s[14:15] op_sel:[0,0] op_sel_hi:[1,0]
    v_pk_mul_f32 v[128:129], v[128:129], s[14:15] op_sel:[0,0] op_sel_hi:[1,0]
    v_pk_mul_f32 v[130:131], v[130:131], s[14:15] op_sel:[0,0] op_sel_hi:[1,0]
    v_cvt_pk_bf16_f32 v60, v60, v61
    v_cvt_pk_bf16_f32 v61, v62, v63
    v_cvt_pk_bf16_f32 v62, v128, v129
    v_cvt_pk_bf16_f32 v63, v130, v131
    s_xor_b32 s64, s56, 49152
    s_add_u32 m0, s61, 50688
    v_accvgpr_write_b32 a128, v60
    buffer_load_dwordx4 v1, s[40:43], s64 offen nt lds
    v_accvgpr_write_b32 a129, v61
    v_accvgpr_write_b32 a130, v62
    v_accvgpr_write_b32 a131, v63
    v_pk_mul_f32 v[132:133], v[132:133], s[14:15] op_sel:[0,0] op_sel_hi:[1,0]
    v_pk_mul_f32 v[134:135], v[134:135], s[14:15] op_sel:[0,0] op_sel_hi:[1,0]
    v_pk_mul_f32 v[144:145], v[144:145], s[14:15] op_sel:[0,0] op_sel_hi:[1,0]
    v_pk_mul_f32 v[146:147], v[146:147], s[14:15] op_sel:[0,0] op_sel_hi:[1,0]
    v_cvt_pk_bf16_f32 v132, v132, v133
    v_cvt_pk_bf16_f32 v133, v134, v135
    v_cvt_pk_bf16_f32 v134, v144, v145
    v_cvt_pk_bf16_f32 v135, v146, v147
    v_accvgpr_write_b32 a132, v132
    v_accvgpr_write_b32 a133, v133
    v_accvgpr_write_b32 a134, v134
    v_accvgpr_write_b32 a135, v135
    v_pk_mul_f32 v[136:137], v[136:137], s[14:15] op_sel:[0,0] op_sel_hi:[1,0]
    v_pk_mul_f32 v[138:139], v[138:139], s[14:15] op_sel:[0,0] op_sel_hi:[1,0]
    v_pk_mul_f32 v[148:149], v[148:149], s[14:15] op_sel:[0,0] op_sel_hi:[1,0]
    v_pk_mul_f32 v[150:151], v[150:151], s[14:15] op_sel:[0,0] op_sel_hi:[1,0]
    v_cvt_pk_bf16_f32 v136, v136, v137
    v_cvt_pk_bf16_f32 v137, v138, v139
    v_cvt_pk_bf16_f32 v138, v148, v149
    v_cvt_pk_bf16_f32 v139, v150, v151
    v_accvgpr_write_b32 a136, v136
    v_accvgpr_write_b32 a137, v137
    v_accvgpr_write_b32 a138, v138
    v_accvgpr_write_b32 a139, v139
    v_pk_mul_f32 v[140:141], v[140:141], s[14:15] op_sel:[0,0] op_sel_hi:[1,0]
    v_pk_mul_f32 v[142:143], v[142:143], s[14:15] op_sel:[0,0] op_sel_hi:[1,0]
    v_pk_mul_f32 v[152:153], v[152:153], s[14:15] op_sel:[0,0] op_sel_hi:[1,0]
    v_pk_mul_f32 v[154:155], v[154:155], s[14:15] op_sel:[0,0] op_sel_hi:[1,0]
    v_cvt_pk_bf16_f32 v140, v140, v141
    v_cvt_pk_bf16_f32 v141, v142, v143
    v_cvt_pk_bf16_f32 v142, v152, v153
    v_cvt_pk_bf16_f32 v143, v154, v155
    v_accvgpr_write_b32 a140, v140
    v_accvgpr_write_b32 a141, v141
    v_accvgpr_write_b32 a142, v142
    v_accvgpr_write_b32 a143, v143
    v_pk_mul_f32 v[160:161], v[160:161], s[14:15] op_sel:[0,0] op_sel_hi:[1,0]
    v_pk_mul_f32 v[162:163], v[162:163], s[14:15] op_sel:[0,0] op_sel_hi:[1,0]
    v_pk_mul_f32 v[172:173], v[172:173], s[14:15] op_sel:[0,0] op_sel_hi:[1,0]
    v_pk_mul_f32 v[174:175], v[174:175], s[14:15] op_sel:[0,0] op_sel_hi:[1,0]
    v_cvt_pk_bf16_f32 v12, v160, v161
    v_cvt_pk_bf16_f32 v13, v162, v163
    v_cvt_pk_bf16_f32 v14, v172, v173
    v_cvt_pk_bf16_f32 v15, v174, v175
    v_pk_mul_f32 v[164:165], v[164:165], s[14:15] op_sel:[0,0] op_sel_hi:[1,0]
    v_pk_mul_f32 v[166:167], v[166:167], s[14:15] op_sel:[0,0] op_sel_hi:[1,0]
    v_pk_mul_f32 v[176:177], v[176:177], s[14:15] op_sel:[0,0] op_sel_hi:[1,0]
    v_pk_mul_f32 v[178:179], v[178:179], s[14:15] op_sel:[0,0] op_sel_hi:[1,0]
    v_cvt_pk_bf16_f32 v28, v164, v165
    v_cvt_pk_bf16_f32 v29, v166, v167
    v_cvt_pk_bf16_f32 v30, v176, v177
    v_cvt_pk_bf16_f32 v31, v178, v179
    v_pk_mul_f32 v[168:169], v[168:169], s[14:15] op_sel:[0,0] op_sel_hi:[1,0]
    v_pk_mul_f32 v[170:171], v[170:171], s[14:15] op_sel:[0,0] op_sel_hi:[1,0]
    v_pk_mul_f32 v[180:181], v[180:181], s[14:15] op_sel:[0,0] op_sel_hi:[1,0]
    v_pk_mul_f32 v[182:183], v[182:183], s[14:15] op_sel:[0,0] op_sel_hi:[1,0]
    v_cvt_pk_bf16_f32 v44, v168, v169
    v_cvt_pk_bf16_f32 v45, v170, v171
    v_cvt_pk_bf16_f32 v46, v180, v181
    v_cvt_pk_bf16_f32 v47, v182, v183
    v_pk_mul_f32 v[184:185], v[184:185], s[14:15] op_sel:[0,0] op_sel_hi:[1,0]
    v_pk_mul_f32 v[186:187], v[186:187], s[14:15] op_sel:[0,0] op_sel_hi:[1,0]
    v_pk_mul_f32 v[196:197], v[196:197], s[14:15] op_sel:[0,0] op_sel_hi:[1,0]
    v_pk_mul_f32 v[198:199], v[198:199], s[14:15] op_sel:[0,0] op_sel_hi:[1,0]
    v_cvt_pk_bf16_f32 v16, v184, v185
    v_cvt_pk_bf16_f32 v17, v186, v187
    v_cvt_pk_bf16_f32 v18, v196, v197
    v_cvt_pk_bf16_f32 v19, v198, v199
    v_pk_mul_f32 v[188:189], v[188:189], s[14:15] op_sel:[0,0] op_sel_hi:[1,0]
    v_pk_mul_f32 v[190:191], v[190:191], s[14:15] op_sel:[0,0] op_sel_hi:[1,0]
    v_pk_mul_f32 v[200:201], v[200:201], s[14:15] op_sel:[0,0] op_sel_hi:[1,0]
    v_pk_mul_f32 v[202:203], v[202:203], s[14:15] op_sel:[0,0] op_sel_hi:[1,0]
    v_cvt_pk_bf16_f32 v32, v188, v189
    v_cvt_pk_bf16_f32 v33, v190, v191
    v_cvt_pk_bf16_f32 v34, v200, v201
    v_cvt_pk_bf16_f32 v35, v202, v203
    s_add_u32 m0, s61, 50720
    v_pk_mul_f32 v[192:193], v[192:193], s[14:15] op_sel:[0,0] op_sel_hi:[1,0]
    buffer_load_dwordx4 v1, s[40:43], s64 offen offset:1024 nt lds
    v_pk_mul_f32 v[194:195], v[194:195], s[14:15] op_sel:[0,0] op_sel_hi:[1,0]
    v_pk_mul_f32 v[204:205], v[204:205], s[14:15] op_sel:[0,0] op_sel_hi:[1,0]
    v_pk_mul_f32 v[206:207], v[206:207], s[14:15] op_sel:[0,0] op_sel_hi:[1,0]
    v_cvt_pk_bf16_f32 v48, v192, v193
    v_cvt_pk_bf16_f32 v49, v194, v195
    v_cvt_pk_bf16_f32 v50, v204, v205
    v_cvt_pk_bf16_f32 v51, v206, v207
    v_pk_mul_f32 v[208:209], v[208:209], s[14:15] op_sel:[0,0] op_sel_hi:[1,0]
    v_pk_mul_f32 v[210:211], v[210:211], s[14:15] op_sel:[0,0] op_sel_hi:[1,0]
    v_pk_mul_f32 v[220:221], v[220:221], s[14:15] op_sel:[0,0] op_sel_hi:[1,0]
    v_pk_mul_f32 v[222:223], v[222:223], s[14:15] op_sel:[0,0] op_sel_hi:[1,0]
    v_cvt_pk_bf16_f32 v20, v208, v209
    v_cvt_pk_bf16_f32 v21, v210, v211
    v_cvt_pk_bf16_f32 v22, v220, v221
    v_cvt_pk_bf16_f32 v23, v222, v223
    v_pk_mul_f32 v[212:213], v[212:213], s[14:15] op_sel:[0,0] op_sel_hi:[1,0]
    v_pk_mul_f32 v[214:215], v[214:215], s[14:15] op_sel:[0,0] op_sel_hi:[1,0]
    v_pk_mul_f32 v[224:225], v[224:225], s[14:15] op_sel:[0,0] op_sel_hi:[1,0]
    v_pk_mul_f32 v[226:227], v[226:227], s[14:15] op_sel:[0,0] op_sel_hi:[1,0]
    v_cvt_pk_bf16_f32 v36, v212, v213
    v_cvt_pk_bf16_f32 v37, v214, v215
    v_cvt_pk_bf16_f32 v38, v224, v225
    v_cvt_pk_bf16_f32 v39, v226, v227
    v_pk_mul_f32 v[216:217], v[216:217], s[14:15] op_sel:[0,0] op_sel_hi:[1,0]
    v_pk_mul_f32 v[218:219], v[218:219], s[14:15] op_sel:[0,0] op_sel_hi:[1,0]
    v_pk_mul_f32 v[228:229], v[228:229], s[14:15] op_sel:[0,0] op_sel_hi:[1,0]
    v_pk_mul_f32 v[230:231], v[230:231], s[14:15] op_sel:[0,0] op_sel_hi:[1,0]
    v_cvt_pk_bf16_f32 v52, v216, v217
    v_cvt_pk_bf16_f32 v53, v218, v219
    v_cvt_pk_bf16_f32 v54, v228, v229
    v_cvt_pk_bf16_f32 v55, v230, v231
    v_pk_mul_f32 v[232:233], v[232:233], s[14:15] op_sel:[0,0] op_sel_hi:[1,0]
    v_pk_mul_f32 v[234:235], v[234:235], s[14:15] op_sel:[0,0] op_sel_hi:[1,0]
    v_pk_mul_f32 v[244:245], v[244:245], s[14:15] op_sel:[0,0] op_sel_hi:[1,0]
    v_pk_mul_f32 v[246:247], v[246:247], s[14:15] op_sel:[0,0] op_sel_hi:[1,0]
    v_cvt_pk_bf16_f32 v24, v232, v233
    v_cvt_pk_bf16_f32 v25, v234, v235
    v_cvt_pk_bf16_f32 v26, v244, v245
    v_cvt_pk_bf16_f32 v27, v246, v247
    v_pk_mul_f32 v[236:237], v[236:237], s[14:15] op_sel:[0,0] op_sel_hi:[1,0]
    v_pk_mul_f32 v[238:239], v[238:239], s[14:15] op_sel:[0,0] op_sel_hi:[1,0]
    v_pk_mul_f32 v[248:249], v[248:249], s[14:15] op_sel:[0,0] op_sel_hi:[1,0]
    v_pk_mul_f32 v[250:251], v[250:251], s[14:15] op_sel:[0,0] op_sel_hi:[1,0]
    v_cvt_pk_bf16_f32 v40, v236, v237
    v_cvt_pk_bf16_f32 v41, v238, v239
    v_cvt_pk_bf16_f32 v42, v248, v249
    v_cvt_pk_bf16_f32 v43, v250, v251
    v_pk_mul_f32 v[240:241], v[240:241], s[14:15] op_sel:[0,0] op_sel_hi:[1,0]
    v_pk_mul_f32 v[242:243], v[242:243], s[14:15] op_sel:[0,0] op_sel_hi:[1,0]
    v_pk_mul_f32 v[252:253], v[252:253], s[14:15] op_sel:[0,0] op_sel_hi:[1,0]
    v_pk_mul_f32 v[254:255], v[254:255], s[14:15] op_sel:[0,0] op_sel_hi:[1,0]
    v_cvt_pk_bf16_f32 v56, v240, v241
    v_cvt_pk_bf16_f32 v57, v242, v243
    v_cvt_pk_bf16_f32 v58, v252, v253
    v_cvt_pk_bf16_f32 v59, v254, v255
    v_and_b32 v9, 56, v0
    s_lshl_b32 s66, s60, 1
    v_add_u32 v9, s66, v9
    v_mul_u32_u24 v9, 1280, v9
    v_and_b32 v8, 7, v0
    s_xor_b32 s66, s72, 7
    s_and_b32 s66, s66, 3
    s_lshl_b32 s66, s66, 1
    v_xor_b32 v8, s66, v8
    v_lshl_add_u32 v155, v8, 4, v9
    s_cmp_lg_u32 s60, 0
    s_cbranch_scc1 L_boot_11
    s_lshl_b32 s66, s74, 2
    s_add_u32 s66, s66, 128
    v_mov_b32 v157, s66
    s_getreg_b32 s69, hwreg(HW_REG_XCC_ID, 0, 4)
    s_mul_i32 s70, s69, s69
    s_lshl_b32 s70, s70, 8
    s_add_u32 s70, s70, s69
    s_lshl_b32 s70, s70, 8
    s_add_u32 s24, s70, 1
    v_mov_b32 v158, s24
    s_mov_b64 exec, 1
    global_atomic_add v157, v158, s[18:19]
    s_mov_b64 exec, -1
L_boot_11:
    s_branch L_enter
L_p0end:
.p2align 6
L_gx:
    v_subrev_u32 v154, 344064, v152
    v_subrev_u32 v158, 344064, v153
    s_branch L_gmid0
.p2align 6
L_gl_far:
    v_mfma_f32_16x16x32_bf16 v[72:75], a[192:195], a[144:147], 0
    ds_read_b64_tr_b16 a[224:225], v5 offset:0
    v_mfma_f32_16x16x32_bf16 v[72:75], a[196:199], a[156:159], v[72:75]
    ds_read_b64_tr_b16 a[226:227], v5 offset:256
    v_cvt_pk_bf16_f32 v160, v208, v209
    v_mfma_f32_16x16x32_bf16 v[76:79], a[196:199], a[160:163], 0
    ds_read_b64_tr_b16 a[228:229], v5 offset:512
    v_cvt_pk_bf16_f32 v161, v210, v211
    v_mfma_f32_16x16x32_bf16 v[76:79], a[192:195], a[148:151], v[76:79]
    ds_read_b64_tr_b16 a[230:231], v5 offset:768
    v_cvt_pk_bf16_f32 v162, v212, v213
    v_mfma_f32_16x16x32_bf16 v[80:83], a[192:195], a[152:155], 0
    s_add_u32 s64, s6, 81920
    ds_read_b64_tr_b16 a[232:233], v5 offset:32
    v_cvt_pk_bf16_f32 v163, v214, v215
    v_mfma_f32_16x16x32_bf16 v[80:83], a[196:199], a[164:167], v[80:83]
    s_add_u32 m0, s61, 118272
    ds_read_b64_tr_b16 a[234:235], v5 offset:288
    v_cvt_pk_bf16_f32 v164, v216, v217
    v_mfma_f32_16x16x32_bf16 v[92:95], a[204:207], a[164:167], 0
    buffer_load_dwordx4 v155, s[48:51], s64 offen lds
    v_mfma_f32_16x16x32_bf16 v[92:95], a[200:203], a[152:155], v[92:95]
    ds_read_b64_tr_b16 a[236:237], v5 offset:544
    v_cvt_pk_bf16_f32 v165, v218, v219
    v_mfma_f32_16x16x32_bf16 v[88:91], a[200:203], a[148:151], 0
    ds_read_b64_tr_b16 a[238:239], v5 offset:800
    v_cvt_pk_bf16_f32 v166, v220, v221
    v_mfma_f32_16x16x32_bf16 v[88:91], a[204:207], a[160:163], v[88:91]
    s_add_u32 s64, s6, 83200
    ds_read_b64_tr_b16 a[240:241], v5 offset:64
    v_cvt_pk_bf16_f32 v167, v222, v223
    v_mfma_f32_16x16x32_bf16 v[84:87], a[204:207], a[156:159], 0
    s_add_u32 m0, s61, 119328
    ds_read_b64_tr_b16 a[242:243], v5 offset:320
    v_cvt_pk_bf16_f32 v168, v224, v225
    v_mfma_f32_16x16x32_bf16 v[84:87], a[200:203], a[144:147], v[84:87]
    s_add_u32 s6, s6, s13
    buffer_load_dwordx4 v155, s[48:51], s64 offen lds
    v_mfma_f32_16x16x32_bf16 v[96:99], a[208:211], a[144:147], 0
    ds_read_b64_tr_b16 a[244:245], v5 offset:576
    v_cvt_pk_bf16_f32 v169, v226, v227
    v_mfma_f32_16x16x32_bf16 v[96:99], a[212:215], a[156:159], v[96:99]
    ds_read_b64_tr_b16 a[246:247], v5 offset:832
    v_cvt_pk_bf16_f32 v170, v228, v229
    v_mfma_f32_16x16x32_bf16 v[100:103], a[212:215], a[160:163], 0
    ds_read_b64_tr_b16 a[248:249], v5 offset:96
    v_cvt_pk_bf16_f32 v171, v230, v231
    v_mfma_f32_16x16x32_bf16 v[100:103], a[208:211], a[148:151], v[100:103]
    ds_read_b64_tr_b16 a[250:251], v5 offset:352
    v_cvt_pk_bf16_f32 v172, v232, v233
    v_mfma_f32_16x16x32_bf16 v[104:107], a[208:211], a[152:155], 0
    v_cvt_pk_bf16_f32 v173, v234, v235
    v_cvt_pk_bf16_f32 v174, v236, v237
    v_mfma_f32_16x16x32_bf16 v[104:107], a[212:215], a[164:167], v[104:107]
    ds_read_b64_tr_b16 a[252:253], v5 offset:608
    v_cvt_pk_bf16_f32 v175, v238, v239
    v_mfma_f32_16x16x32_bf16 v[116:119], a[220:223], a[164:167], 0
    ds_read_b64_tr_b16 a[254:255], v5 offset:864
    v_cvt_pk_bf16_f32 v176, v240, v241
    v_mfma_f32_16x16x32_bf16 v[116:119], a[216:219], a[152:155], v[116:119]
    v_cvt_pk_bf16_f32 v177, v242, v243
    v_mfma_f32_16x16x32_bf16 v[112:115], a[216:219], a[148:151], 0
    v_mfma_f32_16x16x32_bf16 v[112:115], a[220:223], a[160:163], v[112:115]
    v_mfma_f32_16x16x32_bf16 v[108:111], a[220:223], a[156:159], 0
    s_waitcnt lgkmcnt(0)
    v_mfma_f32_16x16x32_bf16 v[108:111], a[216:219], a[144:147], v[108:111]
    v_mfma_f32_16x16x32_bf16 v[72:75], a[224:227], a[168:171], v[72:75]
    ds_read_b64_tr_b16 a[192:193], v4 offset:8448
    v_mfma_f32_16x16x32_bf16 v[72:75], a[228:231], a[180:183], v[72:75]
    ds_read_b64_tr_b16 a[194:195], v4 offset:8704
    v_mfma_f32_16x16x32_bf16 v[76:79], a[228:231], a[184:187], v[76:79]
    ds_read_b64_tr_b16 a[196:197], v4 offset:8960
    v_mfma_f32_16x16x32_bf16 v[76:79], a[224:227], a[172:175], v[76:79]
    ds_read_b64_tr_b16 a[198:199], v4 offset:9216
    v_mfma_f32_16x16x32_bf16 v[80:83], a[224:227], a[176:179], v[80:83]
    s_add_u32 s64, s7, 0
    ds_read_b64_tr_b16 a[200:201], v4 offset:8480
    v_mfma_f32_16x16x32_bf16 v[80:83], a[228:231], a[188:191], v[80:83]
    s_add_u32 m0, s61, 59136
    ds_read_b64_tr_b16 a[202:203], v4 offset:8736
    v_mfma_f32_16x16x32_bf16 v[92:95], a[236:239], a[188:191], v[92:95]
    buffer_load_dwordx4 v155, s[48:51], s64 offen lds
    v_mfma_f32_16x16x32_bf16 v[92:95], a[232:235], a[176:179], v[92:95]
    ds_read_b64_tr_b16 a[204:205], v4 offset:8992
    v_mfma_f32_16x16x32_bf16 v[88:91], a[232:235], a[172:175], v[88:91]
    ds_read_b64_tr_b16 a[206:207], v4 offset:9248
    v_mfma_f32_16x16x32_bf16 v[88:91], a[236:239], a[184:187], v[88:91]
    s_add_u32 s64, s7, 1280
    ds_read_b64_tr_b16 a[208:209], v4 offset:8512
    v_mfma_f32_16x16x32_bf16 v[84:87], a[236:239], a[180:183], v[84:87]
    s_add_u32 m0, s61, 60192
    ds_read_b64_tr_b16 a[210:211], v4 offset:8768
    v_mfma_f32_16x16x32_bf16 v[84:87], a[232:235], a[168:171], v[84:87]
    buffer_load_dwordx4 v155, s[48:51], s64 offen lds
    v_mfma_f32_16x16x32_bf16 v[96:99], a[240:243], a[168:171], v[96:99]
    ds_read_b64_tr_b16 a[212:213], v4 offset:9024
    v_mfma_f32_16x16x32_bf16 v[96:99], a[244:247], a[180:183], v[96:99]
    ds_read_b64_tr_b16 a[214:215], v4 offset:9280
    v_mfma_f32_16x16x32_bf16 v[100:103], a[244:247], a[184:187], v[100:103]
    ds_read_b64_tr_b16 a[216:217], v4 offset:8544
    v_mfma_f32_16x16x32_bf16 v[100:103], a[240:243], a[172:175], v[100:103]
    ds_read_b64_tr_b16 a[218:219], v4 offset:8800
    v_mfma_f32_16x16x32_bf16 v[104:107], a[240:243], a[176:179], v[104:107]
    s_waitcnt vmcnt(6)
    v_cmp_gt_u32 vcc, v10, v6
    v_mfma_f32_16x16x32_bf16 v[104:107], a[244:247], a[188:191], v[104:107]
    ds_read_b64_tr_b16 a[220:221], v4 offset:9056
    v_mfma_f32_16x16x32_bf16 v[116:119], a[252:255], a[188:191], v[116:119]
    ds_read_b64_tr_b16 a[222:223], v4 offset:9312
    v_mfma_f32_16x16x32_bf16 v[116:119], a[248:251], a[176:179], v[116:119]
    v_mfma_f32_16x16x32_bf16 v[112:115], a[248:251], a[172:175], v[112:115]
    s_cbranch_vccnz L_sp_93
L_ok_94:
    v_mfma_f32_16x16x32_bf16 v[112:115], a[252:255], a[184:187], v[112:115]
    v_mfma_f32_16x16x32_bf16 v[108:111], a[252:255], a[180:183], v[108:111]
    s_waitcnt vmcnt(16) lgkmcnt(0)
    v_mfma_f32_16x16x32_bf16 v[108:111], a[248:251], a[168:171], v[108:111]
    s_barrier
    v_mfma_f32_16x16x32_bf16 v[72:75], a[192:195], a[96:99], v[72:75]
    ds_read_b64_tr_b16 a[224:225], v5 offset:8448
    v_mfma_f32_16x16x32_bf16 v[72:75], a[196:199], a[108:111], v[72:75]
    ds_read_b64_tr_b16 a[226:227], v5 offset:8704
    v_mfma_f32_16x16x32_bf16 v[76:79], a[196:199], a[112:115], v[76:79]
    ds_read_b64_tr_b16 a[228:229], v5 offset:8960
    v_mfma_f32_16x16x32_bf16 v[76:79], a[192:195], a[100:103], v[76:79]
    ds_read_b64_tr_b16 a[230:231], v5 offset:9216
    v_mfma_f32_16x16x32_bf16 v[80:83], a[192:195], a[104:107], v[80:83]
    ds_read_b64_tr_b16 a[232:233], v5 offset:8480
    v_mfma_f32_16x16x32_bf16 v[80:83], a[196:199], a[116:119], v[80:83]
    ds_read_b64_tr_b16 a[234:235], v5 offset:8736
    v_mfma_f32_16x16x32_bf16 v[92:95], a[204:207], a[116:119], v[92:95]
    buffer_store_dwordx4 v[160:163], v152, s[52:55], s44 offen sc1
    v_mfma_f32_16x16x32_bf16 v[92:95], a[200:203], a[104:107], v[92:95]
    ds_read_b64_tr_b16 a[236:237], v5 offset:8992
    v_mfma_f32_16x16x32_bf16 v[88:91], a[200:203], a[100:103], v[88:91]
    ds_read_b64_tr_b16 a[238:239], v5 offset:9248
    v_mfma_f32_16x16x32_bf16 v[88:91], a[204:207], a[112:115], v[88:91]
    ds_read_b64_tr_b16 a[240:241], v5 offset:8512
    v_mfma_f32_16x16x32_bf16 v[84:87], a[204:207], a[108:111], v[84:87]
    ds_read_b64_tr_b16 a[242:243], v5 offset:8768
    v_mfma_f32_16x16x32_bf16 v[84:87], a[200:203], a[96:99], v[84:87]
    s_mov_b32 s65, 0
    buffer_load_dwordx4 v[186:189], v154, s[32:35], s65 offen sc1
    v_mfma_f32_16x16x32_bf16 v[96:99], a[208:211], a[96:99], v[96:99]
    ds_read_b64_tr_b16 a[244:245], v5 offset:9024
    v_mfma_f32_16x16x32_bf16 v[96:99], a[212:215], a[108:111], v[96:99]
    ds_read_b64_tr_b16 a[246:247], v5 offset:9280
    v_mfma_f32_16x16x32_bf16 v[100:103], a[212:215], a[112:115], v[100:103]
    ds_read_b64_tr_b16 a[248:249], v5 offset:8544
    v_mfma_f32_16x16x32_bf16 v[100:103], a[208:211], a[100:103], v[100:103]
    ds_read_b64_tr_b16 a[250:251], v5 offset:8800
    v_mfma_f32_16x16x32_bf16 v[104:107], a[208:211], a[104:107], v[104:107]
    buffer_store_dwordx2 v[164:165], v153, s[52:55], s44 offen sc1
    v_mfma_f32_16x16x32_bf16 v[104:107], a[212:215], a[116:119], v[104:107]
    ds_read_b64_tr_b16 a[252:253], v5 offset:9056
    v_mfma_f32_16x16x32_bf16 v[116:119], a[220:223], a[116:119], v[116:119]
    ds_read_b64_tr_b16 a[254:255], v5 offset:9312
    v_mfma_f32_16x16x32_bf16 v[116:119], a[216:219], a[104:107], v[116:119]
    buffer_load_dwordx2 v[194:195], v158, s[32:35], s65 offen sc1
    v_mfma_f32_16x16x32_bf16 v[112:115], a[216:219], a[100:103], v[112:115]
    s_mov_b32 s65, 6144
    buffer_load_dwordx4 v[190:193], v154, s[32:35], s65 offen sc1
    v_mfma_f32_16x16x32_bf16 v[112:115], a[220:223], a[112:115], v[112:115]
    buffer_store_dwordx4 v[168:171], v152, s[52:55], s45 offen sc1
    v_mfma_f32_16x16x32_bf16 v[108:111], a[220:223], a[108:111], v[108:111]
    s_waitcnt lgkmcnt(0)
    buffer_load_dwordx2 v[184:185], v158, s[32:35], s65 offen sc1
    v_mfma_f32_16x16x32_bf16 v[108:111], a[216:219], a[96:99], v[108:111]
    ds_bpermute_b32 v124, v11, v124
    v_mfma_f32_16x16x32_bf16 v[72:75], a[224:227], a[120:123], v[72:75]
    ds_read_b64_tr_b16 a[192:193], v4 offset:16896
    v_mfma_f32_16x16x32_bf16 v[72:75], a[228:231], a[132:135], v[72:75]
    ds_read_b64_tr_b16 a[194:195], v4 offset:17152
    v_mfma_f32_16x16x32_bf16 v[76:79], a[228:231], a[136:139], v[76:79]
    ds_read_b64_tr_b16 a[196:197], v4 offset:17408
    v_mfma_f32_16x16x32_bf16 v[76:79], a[224:227], a[124:127], v[76:79]
    ds_read_b64_tr_b16 a[198:199], v4 offset:17664
    v_mfma_f32_16x16x32_bf16 v[80:83], a[224:227], a[128:131], v[80:83]
    ds_read_b64_tr_b16 a[200:201], v4 offset:16928
    v_mfma_f32_16x16x32_bf16 v[80:83], a[228:231], a[140:143], v[80:83]
    ds_read_b64_tr_b16 a[202:203], v4 offset:17184
    v_mfma_f32_16x16x32_bf16 v[92:95], a[236:239], a[140:143], v[92:95]
    buffer_store_dwordx2 v[166:167], v153, s[52:55], s45 offen sc1
    v_mfma_f32_16x16x32_bf16 v[92:95], a[232:235], a[128:131], v[92:95]
    ds_read_b64_tr_b16 a[204:205], v4 offset:17440
    v_mfma_f32_16x16x32_bf16 v[88:91], a[232:235], a[124:127], v[88:91]
    ds_read_b64_tr_b16 a[206:207], v4 offset:17696
    v_mfma_f32_16x16x32_bf16 v[88:91], a[236:239], a[136:139], v[88:91]
    ds_read_b64_tr_b16 a[208:209], v4 offset:16960
    v_mfma_f32_16x16x32_bf16 v[84:87], a[236:239], a[132:135], v[84:87]
    ds_read_b64_tr_b16 a[210:211], v4 offset:17216
    v_mfma_f32_16x16x32_bf16 v[84:87], a[232:235], a[120:123], v[84:87]
    s_mov_b32 s65, 12288
    buffer_load_dwordx4 v[198:201], v154, s[32:35], s65 offen sc1
    v_mfma_f32_16x16x32_bf16 v[96:99], a[240:243], a[120:123], v[96:99]
    ds_read_b64_tr_b16 a[212:213], v4 offset:17472
    v_mfma_f32_16x16x32_bf16 v[96:99], a[244:247], a[132:135], v[96:99]
    ds_read_b64_tr_b16 a[214:215], v4 offset:17728
    v_mfma_f32_16x16x32_bf16 v[100:103], a[244:247], a[136:139], v[100:103]
    ds_read_b64_tr_b16 a[216:217], v4 offset:16992
    v_mfma_f32_16x16x32_bf16 v[100:103], a[240:243], a[124:127], v[100:103]
    ds_read_b64_tr_b16 a[218:219], v4 offset:17248
    v_mfma_f32_16x16x32_bf16 v[104:107], a[240:243], a[128:131], v[104:107]
    buffer_store_dwordx4 v[172:175], v152, s[52:55], s46 offen sc1
    v_mfma_f32_16x16x32_bf16 v[104:107], a[244:247], a[140:143], v[104:107]
    ds_read_b64_tr_b16 a[220:221], v4 offset:17504
    v_mfma_f32_16x16x32_bf16 v[116:119], a[252:255], a[140:143], v[116:119]
    ds_read_b64_tr_b16 a[222:223], v4 offset:17760
    v_mfma_f32_16x16x32_bf16 v[116:119], a[248:251], a[128:131], v[116:119]
    buffer_load_dwordx2 v[206:207], v158, s[32:35], s65 offen sc1
    v_mfma_f32_16x16x32_bf16 v[112:115], a[248:251], a[124:127], v[112:115]
    s_mov_b32 s65, 18432
    buffer_load_dwordx4 v[202:205], v154, s[32:35], s65 offen sc1
    v_mfma_f32_16x16x32_bf16 v[112:115], a[252:255], a[136:139], v[112:115]
    buffer_store_dwordx2 v[176:177], v153, s[52:55], s46 offen sc1
    v_mfma_f32_16x16x32_bf16 v[108:111], a[252:255], a[132:135], v[108:111]
    s_waitcnt lgkmcnt(0)
    buffer_load_dwordx2 v[196:197], v158, s[32:35], s65 offen sc1
    v_mfma_f32_16x16x32_bf16 v[108:111], a[248:251], a[120:123], v[108:111]
    ds_bpermute_b32 v125, v11, v125
    v_mfma_f32_16x16x32_bf16 v[72:75], a[192:195], a[48:51], v[72:75]
    ds_read_b64_tr_b16 a[224:225], v5 offset:16896
    v_mfma_f32_16x16x32_bf16 v[72:75], a[196:199], a[60:63], v[72:75]
    ds_read_b64_tr_b16 a[226:227], v5 offset:17152
    v_mfma_f32_16x16x32_bf16 v[76:79], a[196:199], a[64:67], v[76:79]
    ds_read_b64_tr_b16 a[228:229], v5 offset:17408
    v_mfma_f32_16x16x32_bf16 v[76:79], a[192:195], a[52:55], v[76:79]
    ds_read_b64_tr_b16 a[230:231], v5 offset:17664
    v_mfma_f32_16x16x32_bf16 v[80:83], a[192:195], a[56:59], v[80:83]
    s_add_u32 s64, s7, 81920
    ds_read_b64_tr_b16 a[232:233], v5 offset:16928
    v_mfma_f32_16x16x32_bf16 v[80:83], a[196:199], a[68:71], v[80:83]
    s_add_u32 m0, s61, 126720
    ds_read_b64_tr_b16 a[234:235], v5 offset:17184
    v_mfma_f32_16x16x32_bf16 v[92:95], a[204:207], a[68:71], v[92:95]
    buffer_load_dwordx4 v155, s[48:51], s64 offen lds
    v_mfma_f32_16x16x32_bf16 v[92:95], a[200:203], a[56:59], v[92:95]
    ds_read_b64_tr_b16 a[236:237], v5 offset:17440
    v_mfma_f32_16x16x32_bf16 v[88:91], a[200:203], a[52:55], v[88:91]
    ds_read_b64_tr_b16 a[238:239], v5 offset:17696
    v_mfma_f32_16x16x32_bf16 v[88:91], a[204:207], a[64:67], v[88:91]
    s_add_u32 s64, s7, 83200
    ds_read_b64_tr_b16 a[240:241], v5 offset:16960
    v_mfma_f32_16x16x32_bf16 v[84:87], a[204:207], a[60:63], v[84:87]
    s_add_u32 m0, s61, 127776
    ds_read_b64_tr_b16 a[242:243], v5 offset:17216
    v_mfma_f32_16x16x32_bf16 v[84:87], a[200:203], a[48:51], v[84:87]
    s_add_u32 s7, s7, s13
    buffer_load_dwordx4 v155, s[48:51], s64 offen lds
    v_mfma_f32_16x16x32_bf16 v[96:99], a[208:211], a[48:51], v[96:99]
    s_cmp_eq_u32 s27, 4
    ds_read_b64_tr_b16 a[244:245], v5 offset:17472
    v_mfma_f32_16x16x32_bf16 v[96:99], a[212:215], a[60:63], v[96:99]
    s_cselect_b32 s50, 0, s50
    ds_read_b64_tr_b16 a[246:247], v5 offset:17728
    v_mfma_f32_16x16x32_bf16 v[100:103], a[212:215], a[64:67], v[100:103]
    s_add_u32 s64, s4, 0
    ds_read_b64_tr_b16 a[248:249], v5 offset:16992
    v_mfma_f32_16x16x32_bf16 v[100:103], a[208:211], a[52:55], v[100:103]
    s_add_u32 m0, s61, 0
    ds_read_b64_tr_b16 a[250:251], v5 offset:17248
    v_mfma_f32_16x16x32_bf16 v[104:107], a[208:211], a[56:59], v[104:107]
    buffer_load_dwordx4 v155, s[48:51], s64 offen lds
    v_mfma_f32_16x16x32_bf16 v[104:107], a[212:215], a[68:71], v[104:107]
    s_add_u32 s64, s4, 1280
    ds_read_b64_tr_b16 a[252:253], v5 offset:17504
    v_mfma_f32_16x16x32_bf16 v[116:119], a[220:223], a[68:71], v[116:119]
    s_add_u32 m0, s61, 1056
    ds_read_b64_tr_b16 a[254:255], v5 offset:17760
    v_mfma_f32_16x16x32_bf16 v[116:119], a[216:219], a[56:59], v[116:119]
    buffer_load_dwordx4 v155, s[48:51], s64 offen lds
    v_mfma_f32_16x16x32_bf16 v[112:115], a[216:219], a[52:55], v[112:115]
    v_mfma_f32_16x16x32_bf16 v[112:115], a[220:223], a[64:67], v[112:115]
    v_mfma_f32_16x16x32_bf16 v[108:111], a[220:223], a[60:63], v[108:111]
    s_waitcnt lgkmcnt(0)
    ds_bpermute_b32 v126, v11, v126
    v_mfma_f32_16x16x32_bf16 v[108:111], a[216:219], a[48:51], v[108:111]
    ds_bpermute_b32 v127, v11, v127
    v_mfma_f32_16x16x32_bf16 v[72:75], a[224:227], a[72:75], v[72:75]
    ds_read_b64_tr_b16 a[192:193], v4 offset:25344
    v_mfma_f32_16x16x32_bf16 v[72:75], a[228:231], a[84:87], v[72:75]
    ds_read_b64_tr_b16 a[194:195], v4 offset:25600
    v_mfma_f32_16x16x32_bf16 v[76:79], a[228:231], a[88:91], v[76:79]
    s_waitcnt vmcnt(4)
    ds_read_b64_tr_b16 a[196:197], v4 offset:25856
    v_mfma_f32_16x16x32_bf16 v[76:79], a[224:227], a[76:79], v[76:79]
    ds_read_b64_tr_b16 a[198:199], v4 offset:26112
    v_mfma_f32_16x16x32_bf16 v[80:83], a[224:227], a[80:83], v[80:83]
    ds_read_b64_tr_b16 a[200:201], v4 offset:25376
    v_add_u32 v10, 1, v10
    v_mfma_f32_16x16x32_bf16 v[80:83], a[228:231], a[92:95], v[80:83]
    ds_read_b64_tr_b16 a[202:203], v4 offset:25632
    v_mfma_f32_16x16x32_bf16 v[92:95], a[236:239], a[92:95], v[92:95]
    buffer_store_dword v10, v1, s[8:11], 0 offen sc1
    v_mfma_f32_16x16x32_bf16 v[92:95], a[232:235], a[80:83], v[92:95]
    ds_read_b64_tr_b16 a[204:205], v4 offset:25888
    v_mfma_f32_16x16x32_bf16 v[88:91], a[232:235], a[76:79], v[88:91]
    ds_read_b64_tr_b16 a[206:207], v4 offset:26144
    v_mfma_f32_16x16x32_bf16 v[88:91], a[236:239], a[88:91], v[88:91]
    s_add_u32 s64, s4, 81920
    ds_read_b64_tr_b16 a[208:209], v4 offset:25408
    v_mfma_f32_16x16x32_bf16 v[84:87], a[236:239], a[84:87], v[84:87]
    s_add_u32 m0, s61, 67584
    ds_read_b64_tr_b16 a[210:211], v4 offset:25664
    v_mfma_f32_16x16x32_bf16 v[84:87], a[232:235], a[72:75], v[84:87]
    buffer_load_dwordx4 v155, s[48:51], s64 offen lds
    v_mfma_f32_16x16x32_bf16 v[96:99], a[240:243], a[72:75], v[96:99]
    ds_read_b64_tr_b16 a[212:213], v4 offset:25920
    v_mfma_f32_16x16x32_bf16 v[96:99], a[244:247], a[84:87], v[96:99]
    ds_read_b64_tr_b16 a[214:215], v4 offset:26176
    v_mfma_f32_16x16x32_bf16 v[100:103], a[244:247], a[88:91], v[100:103]
    s_add_u32 s64, s4, 83200
    ds_read_b64_tr_b16 a[216:217], v4 offset:25440
    v_mfma_f32_16x16x32_bf16 v[100:103], a[240:243], a[76:79], v[100:103]
    s_add_u32 m0, s61, 68640
    ds_read_b64_tr_b16 a[218:219], v4 offset:25696
    v_mfma_f32_16x16x32_bf16 v[104:107], a[240:243], a[80:83], v[104:107]
    s_add_u32 s4, s4, s12
    buffer_load_dwordx4 v155, s[48:51], s64 offen lds
    v_mfma_f32_16x16x32_bf16 v[104:107], a[244:247], a[92:95], v[104:107]
    s_add_u32 s64, s5, 0
    ds_read_b64_tr_b16 a[220:221], v4 offset:25952
    v_mfma_f32_16x16x32_bf16 v[116:119], a[252:255], a[92:95], v[116:119]
    s_add_u32 m0, s61, 8448
    ds_read_b64_tr_b16 a[222:223], v4 offset:26208
    v_mfma_f32_16x16x32_bf16 v[116:119], a[248:251], a[80:83], v[116:119]
    buffer_load_dwordx4 v155, s[48:51], s64 offen lds
    v_mfma_f32_16x16x32_bf16 v[112:115], a[248:251], a[76:79], v[112:115]
    s_add_u32 s64, s5, 1280
    v_mfma_f32_16x16x32_bf16 v[112:115], a[252:255], a[88:91], v[112:115]
    s_add_u32 m0, s61, 9504
    v_mfma_f32_16x16x32_bf16 v[108:111], a[252:255], a[84:87], v[108:111]
    s_waitcnt vmcnt(30) lgkmcnt(0)
    buffer_load_dwordx4 v155, s[48:51], s64 offen lds
    v_mfma_f32_16x16x32_bf16 v[108:111], a[248:251], a[72:75], v[108:111]
    s_barrier
    v_mfma_f32_16x16x32_bf16 v[72:75], a[192:195], v[12:15], v[72:75]
    ds_read_b64_tr_b16 a[224:225], v5 offset:25344
    v_mfma_f32_16x16x32_bf16 v[72:75], a[196:199], v[16:19], v[72:75]
    ds_read_b64_tr_b16 a[226:227], v5 offset:25600
    v_mfma_f32_16x16x32_bf16 v[76:79], a[196:199], v[32:35], v[76:79]
    ds_read_b64_tr_b16 a[228:229], v5 offset:25856
    v_mfma_f32_16x16x32_bf16 v[76:79], a[192:195], v[28:31], v[76:79]
    ds_read_b64_tr_b16 a[230:231], v5 offset:26112
    v_mfma_f32_16x16x32_bf16 v[80:83], a[192:195], v[44:47], v[80:83]
    s_add_u32 s64, s5, 81920
    ds_read_b64_tr_b16 a[232:233], v5 offset:25376
    v_mfma_f32_16x16x32_bf16 v[80:83], a[196:199], v[48:51], v[80:83]
    s_add_u32 m0, s61, 76032
    ds_read_b64_tr_b16 a[234:235], v5 offset:25632
    v_mfma_f32_16x16x32_bf16 v[92:95], a[204:207], v[48:51], v[92:95]
    buffer_load_dwordx4 v155, s[48:51], s64 offen lds
    v_mfma_f32_16x16x32_bf16 v[92:95], a[200:203], v[44:47], v[92:95]
    ds_read_b64_tr_b16 a[236:237], v5 offset:25888
    v_mfma_f32_16x16x32_bf16 v[88:91], a[200:203], v[28:31], v[88:91]
    ds_read_b64_tr_b16 a[238:239], v5 offset:26144
    v_mfma_f32_16x16x32_bf16 v[88:91], a[204:207], v[32:35], v[88:91]
    s_add_u32 s64, s5, 83200
    ds_read_b64_tr_b16 a[240:241], v5 offset:25408
    v_mfma_f32_16x16x32_bf16 v[84:87], a[204:207], v[16:19], v[84:87]
    s_add_u32 m0, s61, 77088
    ds_read_b64_tr_b16 a[242:243], v5 offset:25664
    v_mfma_f32_16x16x32_bf16 v[84:87], a[200:203], v[12:15], v[84:87]
    s_add_u32 s5, s5, s12
    buffer_load_dwordx4 v155, s[48:51], s64 offen lds
    v_mfma_f32_16x16x32_bf16 v[96:99], a[208:211], v[12:15], v[96:99]
    ds_read_b64_tr_b16 a[244:245], v5 offset:25920
    v_mfma_f32_16x16x32_bf16 v[96:99], a[212:215], v[16:19], v[96:99]
    ds_read_b64_tr_b16 a[246:247], v5 offset:26176
    v_mfma_f32_16x16x32_bf16 v[100:103], a[212:215], v[32:35], v[100:103]
    ds_read_b64_tr_b16 a[248:249], v5 offset:25440
    v_mfma_f32_16x16x32_bf16 v[100:103], a[208:211], v[28:31], v[100:103]
    ds_read_b64_tr_b16 a[250:251], v5 offset:25696
    v_mfma_f32_16x16x32_bf16 v[104:107], a[208:211], v[44:47], v[104:107]
    s_add_u32 s65, s58, 0
    buffer_store_dwordx2 v[124:125], v159, s[36:39], s65 offen nt
    v_mfma_f32_16x16x32_bf16 v[104:107], a[212:215], v[48:51], v[104:107]
    ds_read_b64_tr_b16 a[252:253], v5 offset:25952
    v_mfma_f32_16x16x32_bf16 v[116:119], a[220:223], v[48:51], v[116:119]
    ds_read_b64_tr_b16 a[254:255], v5 offset:26208
    v_mfma_f32_16x16x32_bf16 v[116:119], a[216:219], v[44:47], v[116:119]
    v_mfma_f32_16x16x32_bf16 v[112:115], a[216:219], v[28:31], v[112:115]
    v_mfma_f32_16x16x32_bf16 v[112:115], a[220:223], v[32:35], v[112:115]
    v_mfma_f32_16x16x32_bf16 v[108:111], a[220:223], v[16:19], v[108:111]
    s_waitcnt lgkmcnt(0)
    ds_bpermute_b32 v128, v11, v128
    v_mfma_f32_16x16x32_bf16 v[108:111], a[216:219], v[12:15], v[108:111]
    ds_bpermute_b32 v129, v11, v129
    v_mfma_f32_16x16x32_bf16 v[60:63], a[0:3], v[184:187], v[244:247]
    v_mfma_f32_16x16x32_bf16 v[64:67], a[0:3], v[188:191], v[248:251]
    v_mfma_f32_16x16x32_bf16 v[68:71], a[0:3], v[192:195], v[252:255]
    v_mfma_f32_16x16x32_bf16 v[60:63], a[0:3], v[196:199], v[60:63]
    v_mfma_f32_16x16x32_bf16 v[64:67], a[0:3], v[200:203], v[64:67]
    v_mfma_f32_16x16x32_bf16 v[68:71], a[0:3], v[204:207], v[68:71]
    v_mfma_f32_16x16x32_bf16 v[72:75], a[224:227], v[20:23], v[72:75]
    ds_read_b64_tr_b16 a[192:193], v4 offset:33792
    v_mfma_f32_16x16x32_bf16 v[72:75], a[228:231], v[24:27], v[72:75]
    ds_read_b64_tr_b16 a[194:195], v4 offset:34048
    v_mfma_f32_16x16x32_bf16 v[76:79], a[228:231], v[40:43], v[76:79]
    ds_read_b64_tr_b16 a[196:197], v4 offset:34304
    v_mfma_f32_16x16x32_bf16 v[76:79], a[224:227], v[36:39], v[76:79]
    ds_read_b64_tr_b16 a[198:199], v4 offset:34560
    v_mfma_f32_16x16x32_bf16 v[80:83], a[224:227], v[52:55], v[80:83]
    ds_read_b64_tr_b16 a[200:201], v4 offset:33824
    v_mfma_f32_16x16x32_bf16 v[80:83], a[228:231], v[56:59], v[80:83]
    ds_read_b64_tr_b16 a[202:203], v4 offset:34080
    v_mfma_f32_16x16x32_bf16 v[92:95], a[236:239], v[56:59], v[92:95]
    buffer_load_dword v6, v2, s[8:11], 0 offen sc1
    v_mfma_f32_16x16x32_bf16 v[92:95], a[232:235], v[52:55], v[92:95]
    ds_read_b64_tr_b16 a[204:205], v4 offset:34336
    v_mfma_f32_16x16x32_bf16 v[88:91], a[232:235], v[36:39], v[88:91]
    ds_read_b64_tr_b16 a[206:207], v4 offset:34592
    v_mfma_f32_16x16x32_bf16 v[88:91], a[236:239], v[40:43], v[88:91]
    s_add_u32 s64, s6, 0
    ds_read_b64_tr_b16 a[208:209], v4 offset:33856
    v_mfma_f32_16x16x32_bf16 v[84:87], a[236:239], v[24:27], v[84:87]
    s_add_u32 m0, s61, 16896
    ds_read_b64_tr_b16 a[210:211], v4 offset:34112
    v_mfma_f32_16x16x32_bf16 v[84:87], a[232:235], v[20:23], v[84:87]
    buffer_load_dwordx4 v155, s[48:51], s64 offen lds
    v_mfma_f32_16x16x32_bf16 v[96:99], a[240:243], v[20:23], v[96:99]
    ds_read_b64_tr_b16 a[212:213], v4 offset:34368
    v_mfma_f32_16x16x32_bf16 v[96:99], a[244:247], v[24:27], v[96:99]
    ds_read_b64_tr_b16 a[214:215], v4 offset:34624
    v_mfma_f32_16x16x32_bf16 v[100:103], a[244:247], v[40:43], v[100:103]
    s_add_u32 s64, s6, 1280
    ds_read_b64_tr_b16 a[216:217], v4 offset:33888
    v_mfma_f32_16x16x32_bf16 v[100:103], a[240:243], v[36:39], v[100:103]
    s_add_u32 m0, s61, 17952
    ds_read_b64_tr_b16 a[218:219], v4 offset:34144
    v_mfma_f32_16x16x32_bf16 v[104:107], a[240:243], v[52:55], v[104:107]
    buffer_load_dwordx4 v155, s[48:51], s64 offen lds
    v_mfma_f32_16x16x32_bf16 v[104:107], a[244:247], v[56:59], v[104:107]
    ds_read_b64_tr_b16 a[220:221], v4 offset:34400
    v_mfma_f32_16x16x32_bf16 v[116:119], a[252:255], v[56:59], v[116:119]
    ds_read_b64_tr_b16 a[222:223], v4 offset:34656
    v_mfma_f32_16x16x32_bf16 v[116:119], a[248:251], v[52:55], v[116:119]
    v_add_u32 v152, 344064, v152
    v_mfma_f32_16x16x32_bf16 v[112:115], a[248:251], v[36:39], v[112:115]
    v_add_u32 v153, 344064, v153
    v_mfma_f32_16x16x32_bf16 v[112:115], a[252:255], v[40:43], v[112:115]
    v_mfma_f32_16x16x32_bf16 v[108:111], a[252:255], v[24:27], v[108:111]
    s_waitcnt lgkmcnt(0)
    v_mfma_f32_16x16x32_bf16 v[108:111], a[248:251], v[20:23], v[108:111]
L_gmid0:
    v_mfma_f32_16x16x32_bf16 v[208:211], a[192:195], a[144:147], 0
    ds_read_b64_tr_b16 a[224:225], v5 offset:33792
    v_mfma_f32_16x16x32_bf16 v[208:211], a[196:199], a[156:159], v[208:211]
    ds_read_b64_tr_b16 a[226:227], v5 offset:34048
    v_cvt_pk_bf16_f32 v160, v72, v73
    v_mfma_f32_16x16x32_bf16 v[212:215], a[196:199], a[160:163], 0
    ds_read_b64_tr_b16 a[228:229], v5 offset:34304
    v_cvt_pk_bf16_f32 v161, v74, v75
    v_mfma_f32_16x16x32_bf16 v[212:215], a[192:195], a[148:151], v[212:215]
    ds_read_b64_tr_b16 a[230:231], v5 offset:34560
    v_cvt_pk_bf16_f32 v162, v76, v77
    v_mfma_f32_16x16x32_bf16 v[216:219], a[192:195], a[152:155], 0
    s_add_u32 s64, s6, 81920
    ds_read_b64_tr_b16 a[232:233], v5 offset:33824
    v_cvt_pk_bf16_f32 v163, v78, v79
    v_mfma_f32_16x16x32_bf16 v[216:219], a[196:199], a[164:167], v[216:219]
    s_add_u32 m0, s61, 84480
    ds_read_b64_tr_b16 a[234:235], v5 offset:34080
    v_cvt_pk_bf16_f32 v164, v80, v81
    v_mfma_f32_16x16x32_bf16 v[228:231], a[204:207], a[164:167], 0
    buffer_load_dwordx4 v155, s[48:51], s64 offen lds
    v_mfma_f32_16x16x32_bf16 v[228:231], a[200:203], a[152:155], v[228:231]
    ds_read_b64_tr_b16 a[236:237], v5 offset:34336
    v_cvt_pk_bf16_f32 v165, v82, v83
    v_mfma_f32_16x16x32_bf16 v[224:227], a[200:203], a[148:151], 0
    ds_read_b64_tr_b16 a[238:239], v5 offset:34592
    v_cvt_pk_bf16_f32 v166, v84, v85
    v_mfma_f32_16x16x32_bf16 v[224:227], a[204:207], a[160:163], v[224:227]
    s_add_u32 s64, s6, 83200
    ds_read_b64_tr_b16 a[240:241], v5 offset:33856
    v_cvt_pk_bf16_f32 v167, v86, v87
    v_mfma_f32_16x16x32_bf16 v[220:223], a[204:207], a[156:159], 0
    s_add_u32 m0, s61, 85536
    ds_read_b64_tr_b16 a[242:243], v5 offset:34112
    v_cvt_pk_bf16_f32 v168, v88, v89
    v_mfma_f32_16x16x32_bf16 v[220:223], a[200:203], a[144:147], v[220:223]
    s_add_u32 s6, s6, s12
    buffer_load_dwordx4 v155, s[48:51], s64 offen lds
    v_mfma_f32_16x16x32_bf16 v[232:235], a[208:211], a[144:147], 0
    ds_read_b64_tr_b16 a[244:245], v5 offset:34368
    v_cvt_pk_bf16_f32 v169, v90, v91
    v_mfma_f32_16x16x32_bf16 v[232:235], a[212:215], a[156:159], v[232:235]
    ds_read_b64_tr_b16 a[246:247], v5 offset:34624
    v_cvt_pk_bf16_f32 v170, v92, v93
    v_mfma_f32_16x16x32_bf16 v[236:239], a[212:215], a[160:163], 0
    ds_read_b64_tr_b16 a[248:249], v5 offset:33888
    v_cvt_pk_bf16_f32 v171, v94, v95
    v_mfma_f32_16x16x32_bf16 v[236:239], a[208:211], a[148:151], v[236:239]
    ds_read_b64_tr_b16 a[250:251], v5 offset:34144
    v_cvt_pk_bf16_f32 v172, v96, v97
    v_mfma_f32_16x16x32_bf16 v[240:243], a[208:211], a[152:155], 0
    s_add_u32 s65, s58, 40960
    buffer_store_dwordx2 v[126:127], v159, s[36:39], s65 offen nt
    v_mfma_f32_16x16x32_bf16 v[240:243], a[212:215], a[164:167], v[240:243]
    ds_read_b64_tr_b16 a[252:253], v5 offset:34400
    v_cvt_pk_bf16_f32 v173, v98, v99
    v_mfma_f32_16x16x32_bf16 v[252:255], a[220:223], a[164:167], 0
    ds_read_b64_tr_b16 a[254:255], v5 offset:34656
    v_cvt_pk_bf16_f32 v174, v100, v101
    v_mfma_f32_16x16x32_bf16 v[252:255], a[216:219], a[152:155], v[252:255]
    v_cvt_pk_bf16_f32 v175, v102, v103
    v_cvt_pk_bf16_f32 v176, v104, v105
    v_mfma_f32_16x16x32_bf16 v[248:251], a[216:219], a[148:151], 0
    v_cvt_pk_bf16_f32 v177, v106, v107
    v_mfma_f32_16x16x32_bf16 v[248:251], a[220:223], a[160:163], v[248:251]
    v_cvt_pk_bf16_f32 v178, v108, v109
    v_mfma_f32_16x16x32_bf16 v[244:247], a[220:223], a[156:159], 0
    s_waitcnt lgkmcnt(0)
    v_cvt_pk_bf16_f32 v179, v110, v111
    v_cvt_pk_bf16_f32 v180, v112, v113
    v_mfma_f32_16x16x32_bf16 v[244:247], a[216:219], a[144:147], v[244:247]
    v_cvt_pk_bf16_f32 v181, v114, v115
    v_mfma_f32_16x16x32_bf16 v[208:211], a[224:227], a[168:171], v[208:211]
    ds_read_b64_tr_b16 a[192:193], v4 offset:42240
    v_cvt_pk_bf16_f32 v182, v116, v117
    v_mfma_f32_16x16x32_bf16 v[208:211], a[228:231], a[180:183], v[208:211]
    ds_read_b64_tr_b16 a[194:195], v4 offset:42496
    v_cvt_pk_bf16_f32 v183, v118, v119
    v_mfma_f32_16x16x32_bf16 v[212:215], a[228:231], a[184:187], v[212:215]
    ds_read_b64_tr_b16 a[196:197], v4 offset:42752
    v_mfma_f32_16x16x32_bf16 v[212:215], a[224:227], a[172:175], v[212:215]
    ds_read_b64_tr_b16 a[198:199], v4 offset:43008
    v_mfma_f32_16x16x32_bf16 v[216:219], a[224:227], a[176:179], v[216:219]
    s_add_u32 s64, s7, 0
    ds_read_b64_tr_b16 a[200:201], v4 offset:42272
    v_mfma_f32_16x16x32_bf16 v[216:219], a[228:231], a[188:191], v[216:219]
    s_add_u32 m0, s61, 25344
    ds_read_b64_tr_b16 a[202:203], v4 offset:42528
    v_mfma_f32_16x16x32_bf16 v[228:231], a[236:239], a[188:191], v[228:231]
    buffer_load_dwordx4 v155, s[48:51], s64 offen lds
    v_mfma_f32_16x16x32_bf16 v[228:231], a[232:235], a[176:179], v[228:231]
    ds_read_b64_tr_b16 a[204:205], v4 offset:42784
    v_mfma_f32_16x16x32_bf16 v[224:227], a[232:235], a[172:175], v[224:227]
    ds_read_b64_tr_b16 a[206:207], v4 offset:43040
    v_mfma_f32_16x16x32_bf16 v[224:227], a[236:239], a[184:187], v[224:227]
    s_add_u32 s64, s7, 1280
    ds_read_b64_tr_b16 a[208:209], v4 offset:42304
    v_mfma_f32_16x16x32_bf16 v[220:223], a[236:239], a[180:183], v[220:223]
    s_add_u32 m0, s61, 26400
    ds_read_b64_tr_b16 a[210:211], v4 offset:42560
    v_mfma_f32_16x16x32_bf16 v[220:223], a[232:235], a[168:171], v[220:223]
    buffer_load_dwordx4 v155, s[48:51], s64 offen lds
    v_mfma_f32_16x16x32_bf16 v[232:235], a[240:243], a[168:171], v[232:235]
    ds_read_b64_tr_b16 a[212:213], v4 offset:42816
    v_mfma_f32_16x16x32_bf16 v[232:235], a[244:247], a[180:183], v[232:235]
    ds_read_b64_tr_b16 a[214:215], v4 offset:43072
    v_mfma_f32_16x16x32_bf16 v[236:239], a[244:247], a[184:187], v[236:239]
    ds_read_b64_tr_b16 a[216:217], v4 offset:42336
    v_mfma_f32_16x16x32_bf16 v[236:239], a[240:243], a[172:175], v[236:239]
    ds_read_b64_tr_b16 a[218:219], v4 offset:42592
    v_mfma_f32_16x16x32_bf16 v[240:243], a[240:243], a[176:179], v[240:243]
    s_waitcnt vmcnt(7)
    v_cmp_gt_u32 vcc, v10, v6
    v_mfma_f32_16x16x32_bf16 v[240:243], a[244:247], a[188:191], v[240:243]
    ds_read_b64_tr_b16 a[220:221], v4 offset:42848
    v_mfma_f32_16x16x32_bf16 v[252:255], a[252:255], a[188:191], v[252:255]
    ds_read_b64_tr_b16 a[222:223], v4 offset:43104
    v_mfma_f32_16x16x32_bf16 v[252:255], a[248:251], a[176:179], v[252:255]
    v_mfma_f32_16x16x32_bf16 v[248:251], a[248:251], a[172:175], v[248:251]
    s_cbranch_vccnz L_sp_95
L_ok_96:
    v_mfma_f32_16x16x32_bf16 v[248:251], a[252:255], a[184:187], v[248:251]
    v_mfma_f32_16x16x32_bf16 v[244:247], a[252:255], a[180:183], v[244:247]
    s_waitcnt vmcnt(17) lgkmcnt(0)
    v_mfma_f32_16x16x32_bf16 v[244:247], a[248:251], a[168:171], v[244:247]
    s_barrier
    v_mfma_f32_16x16x32_bf16 v[208:211], a[192:195], a[96:99], v[208:211]
    ds_read_b64_tr_b16 a[224:225], v5 offset:42240
    v_mfma_f32_16x16x32_bf16 v[208:211], a[196:199], a[108:111], v[208:211]
    ds_read_b64_tr_b16 a[226:227], v5 offset:42496
    v_mfma_f32_16x16x32_bf16 v[212:215], a[196:199], a[112:115], v[212:215]
    ds_read_b64_tr_b16 a[228:229], v5 offset:42752
    v_mfma_f32_16x16x32_bf16 v[212:215], a[192:195], a[100:103], v[212:215]
    ds_read_b64_tr_b16 a[230:231], v5 offset:43008
    v_mfma_f32_16x16x32_bf16 v[216:219], a[192:195], a[104:107], v[216:219]
    ds_read_b64_tr_b16 a[232:233], v5 offset:42272
    v_mfma_f32_16x16x32_bf16 v[216:219], a[196:199], a[116:119], v[216:219]
    ds_read_b64_tr_b16 a[234:235], v5 offset:42528
    v_mfma_f32_16x16x32_bf16 v[228:231], a[204:207], a[116:119], v[228:231]
    buffer_store_dwordx4 v[160:163], v152, s[52:55], s40 offen sc1
    v_mfma_f32_16x16x32_bf16 v[228:231], a[200:203], a[104:107], v[228:231]
    ds_read_b64_tr_b16 a[236:237], v5 offset:42784
    v_mfma_f32_16x16x32_bf16 v[224:227], a[200:203], a[100:103], v[224:227]
    ds_read_b64_tr_b16 a[238:239], v5 offset:43040
    v_mfma_f32_16x16x32_bf16 v[224:227], a[204:207], a[112:115], v[224:227]
    ds_read_b64_tr_b16 a[240:241], v5 offset:42304
    v_mfma_f32_16x16x32_bf16 v[220:223], a[204:207], a[108:111], v[220:223]
    ds_read_b64_tr_b16 a[242:243], v5 offset:42560
    v_mfma_f32_16x16x32_bf16 v[220:223], a[200:203], a[96:99], v[220:223]
    buffer_store_dwordx2 v[164:165], v153, s[52:55], s40 offen sc1
    v_mfma_f32_16x16x32_bf16 v[232:235], a[208:211], a[96:99], v[232:235]
    ds_read_b64_tr_b16 a[244:245], v5 offset:42816
    v_mfma_f32_16x16x32_bf16 v[232:235], a[212:215], a[108:111], v[232:235]
    ds_read_b64_tr_b16 a[246:247], v5 offset:43072
    v_mfma_f32_16x16x32_bf16 v[236:239], a[212:215], a[112:115], v[236:239]
    ds_read_b64_tr_b16 a[248:249], v5 offset:42336
    v_mfma_f32_16x16x32_bf16 v[236:239], a[208:211], a[100:103], v[236:239]
    ds_read_b64_tr_b16 a[250:251], v5 offset:42592
    v_mfma_f32_16x16x32_bf16 v[240:243], a[208:211], a[104:107], v[240:243]
    s_mov_b32 s65, 24576
    buffer_load_dwordx4 v[132:135], v154, s[32:35], s65 offen sc1
    v_mfma_f32_16x16x32_bf16 v[240:243], a[212:215], a[116:119], v[240:243]
    ds_read_b64_tr_b16 a[252:253], v5 offset:42848
    v_mfma_f32_16x16x32_bf16 v[252:255], a[220:223], a[116:119], v[252:255]
    ds_read_b64_tr_b16 a[254:255], v5 offset:43104
    v_mfma_f32_16x16x32_bf16 v[252:255], a[216:219], a[104:107], v[252:255]
    buffer_store_dwordx4 v[168:171], v152, s[52:55], s41 offen sc1
    v_mfma_f32_16x16x32_bf16 v[248:251], a[216:219], a[100:103], v[248:251]
    buffer_load_dwordx2 v[140:141], v158, s[32:35], s65 offen sc1
    v_mfma_f32_16x16x32_bf16 v[248:251], a[220:223], a[112:115], v[248:251]
    buffer_store_dwordx2 v[166:167], v153, s[52:55], s41 offen sc1
    v_mfma_f32_16x16x32_bf16 v[244:247], a[220:223], a[108:111], v[244:247]
    s_mov_b32 s65, 30720
    s_waitcnt lgkmcnt(0)
    buffer_load_dwordx4 v[136:139], v154, s[32:35], s65 offen sc1
    v_mfma_f32_16x16x32_bf16 v[244:247], a[216:219], a[96:99], v[244:247]
    v_mfma_f32_16x16x32_bf16 v[208:211], a[224:227], a[120:123], v[208:211]
    ds_read_b64_tr_b16 a[192:193], v4 offset:50688
    v_mfma_f32_16x16x32_bf16 v[208:211], a[228:231], a[132:135], v[208:211]
    ds_read_b64_tr_b16 a[194:195], v4 offset:50944
    v_mfma_f32_16x16x32_bf16 v[212:215], a[228:231], a[136:139], v[212:215]
    ds_read_b64_tr_b16 a[196:197], v4 offset:51200
    v_mfma_f32_16x16x32_bf16 v[212:215], a[224:227], a[124:127], v[212:215]
    ds_read_b64_tr_b16 a[198:199], v4 offset:51456
    v_mfma_f32_16x16x32_bf16 v[216:219], a[224:227], a[128:131], v[216:219]
    ds_read_b64_tr_b16 a[200:201], v4 offset:50720
    v_mfma_f32_16x16x32_bf16 v[216:219], a[228:231], a[140:143], v[216:219]
    ds_read_b64_tr_b16 a[202:203], v4 offset:50976
    v_mfma_f32_16x16x32_bf16 v[228:231], a[236:239], a[140:143], v[228:231]
    buffer_store_dwordx4 v[172:175], v152, s[52:55], s42 offen sc1
    v_mfma_f32_16x16x32_bf16 v[228:231], a[232:235], a[128:131], v[228:231]
    ds_read_b64_tr_b16 a[204:205], v4 offset:51232
    v_mfma_f32_16x16x32_bf16 v[224:227], a[232:235], a[124:127], v[224:227]
    ds_read_b64_tr_b16 a[206:207], v4 offset:51488
    v_mfma_f32_16x16x32_bf16 v[224:227], a[236:239], a[136:139], v[224:227]
    ds_read_b64_tr_b16 a[208:209], v4 offset:50752
    v_mfma_f32_16x16x32_bf16 v[220:223], a[236:239], a[132:135], v[220:223]
    ds_read_b64_tr_b16 a[210:211], v4 offset:51008
    v_mfma_f32_16x16x32_bf16 v[220:223], a[232:235], a[120:123], v[220:223]
    buffer_store_dwordx2 v[176:177], v153, s[52:55], s42 offen sc1
    v_mfma_f32_16x16x32_bf16 v[232:235], a[240:243], a[120:123], v[232:235]
    ds_read_b64_tr_b16 a[212:213], v4 offset:51264
    v_mfma_f32_16x16x32_bf16 v[232:235], a[244:247], a[132:135], v[232:235]
    ds_read_b64_tr_b16 a[214:215], v4 offset:51520
    v_mfma_f32_16x16x32_bf16 v[236:239], a[244:247], a[136:139], v[236:239]
    ds_read_b64_tr_b16 a[216:217], v4 offset:50784
    v_mfma_f32_16x16x32_bf16 v[236:239], a[240:243], a[124:127], v[236:239]
    ds_read_b64_tr_b16 a[218:219], v4 offset:51040
    v_mfma_f32_16x16x32_bf16 v[240:243], a[240:243], a[128:131], v[240:243]
    buffer_load_dwordx2 v[130:131], v158, s[32:35], s65 offen sc1
    v_mfma_f32_16x16x32_bf16 v[240:243], a[244:247], a[140:143], v[240:243]
    ds_read_b64_tr_b16 a[220:221], v4 offset:51296
    v_mfma_f32_16x16x32_bf16 v[252:255], a[252:255], a[140:143], v[252:255]
    ds_read_b64_tr_b16 a[222:223], v4 offset:51552
    v_mfma_f32_16x16x32_bf16 v[252:255], a[248:251], a[128:131], v[252:255]
    buffer_store_dwordx4 v[180:183], v152, s[52:55], s43 offen sc1
    v_mfma_f32_16x16x32_bf16 v[248:251], a[248:251], a[124:127], v[248:251]
    s_mov_b32 s65, 36864
    buffer_load_dwordx4 v[144:147], v154, s[32:35], s65 offen sc1
    v_mfma_f32_16x16x32_bf16 v[248:251], a[252:255], a[136:139], v[248:251]
    buffer_store_dwordx2 v[178:179], v153, s[52:55], s43 offen sc1
    v_mfma_f32_16x16x32_bf16 v[244:247], a[252:255], a[132:135], v[244:247]
    s_waitcnt lgkmcnt(0)
    buffer_load_dwordx2 v[150:151], v158, s[32:35], s65 offen sc1
    v_mfma_f32_16x16x32_bf16 v[244:247], a[248:251], a[120:123], v[244:247]
    v_mfma_f32_16x16x32_bf16 v[208:211], a[192:195], a[48:51], v[208:211]
    ds_read_b64_tr_b16 a[224:225], v5 offset:50688
    v_mfma_f32_16x16x32_bf16 v[208:211], a[196:199], a[60:63], v[208:211]
    ds_read_b64_tr_b16 a[226:227], v5 offset:50944
    v_mfma_f32_16x16x32_bf16 v[212:215], a[196:199], a[64:67], v[212:215]
    ds_read_b64_tr_b16 a[228:229], v5 offset:51200
    v_mfma_f32_16x16x32_bf16 v[212:215], a[192:195], a[52:55], v[212:215]
    ds_read_b64_tr_b16 a[230:231], v5 offset:51456
    v_mfma_f32_16x16x32_bf16 v[216:219], a[192:195], a[56:59], v[216:219]
    s_add_u32 s64, s7, 81920
    ds_read_b64_tr_b16 a[232:233], v5 offset:50720
    v_mfma_f32_16x16x32_bf16 v[216:219], a[196:199], a[68:71], v[216:219]
    s_add_u32 m0, s61, 92928
    ds_read_b64_tr_b16 a[234:235], v5 offset:50976
    v_mfma_f32_16x16x32_bf16 v[228:231], a[204:207], a[68:71], v[228:231]
    buffer_load_dwordx4 v155, s[48:51], s64 offen lds
    v_mfma_f32_16x16x32_bf16 v[228:231], a[200:203], a[56:59], v[228:231]
    ds_read_b64_tr_b16 a[236:237], v5 offset:51232
    v_mfma_f32_16x16x32_bf16 v[224:227], a[200:203], a[52:55], v[224:227]
    ds_read_b64_tr_b16 a[238:239], v5 offset:51488
    v_mfma_f32_16x16x32_bf16 v[224:227], a[204:207], a[64:67], v[224:227]
    s_add_u32 s64, s7, 83200
    ds_read_b64_tr_b16 a[240:241], v5 offset:50752
    v_mfma_f32_16x16x32_bf16 v[220:223], a[204:207], a[60:63], v[220:223]
    s_add_u32 m0, s61, 93984
    ds_read_b64_tr_b16 a[242:243], v5 offset:51008
    v_mfma_f32_16x16x32_bf16 v[220:223], a[200:203], a[48:51], v[220:223]
    s_add_u32 s7, s7, s12
    buffer_load_dwordx4 v155, s[48:51], s64 offen lds
    v_mfma_f32_16x16x32_bf16 v[232:235], a[208:211], a[48:51], v[232:235]
    ds_read_b64_tr_b16 a[244:245], v5 offset:51264
    v_mfma_f32_16x16x32_bf16 v[232:235], a[212:215], a[60:63], v[232:235]
    ds_read_b64_tr_b16 a[246:247], v5 offset:51520
    v_mfma_f32_16x16x32_bf16 v[236:239], a[212:215], a[64:67], v[236:239]
    s_add_u32 s64, s4, 0
    ds_read_b64_tr_b16 a[248:249], v5 offset:50784
    v_mfma_f32_16x16x32_bf16 v[236:239], a[208:211], a[52:55], v[236:239]
    s_add_u32 m0, s61, 33792
    ds_read_b64_tr_b16 a[250:251], v5 offset:51040
    v_mfma_f32_16x16x32_bf16 v[240:243], a[208:211], a[56:59], v[240:243]
    buffer_load_dwordx4 v155, s[48:51], s64 offen lds
    v_mfma_f32_16x16x32_bf16 v[240:243], a[212:215], a[68:71], v[240:243]
    s_add_u32 s64, s4, 1280
    ds_read_b64_tr_b16 a[252:253], v5 offset:51296
    v_mfma_f32_16x16x32_bf16 v[252:255], a[220:223], a[68:71], v[252:255]
    s_add_u32 m0, s61, 34848
    ds_read_b64_tr_b16 a[254:255], v5 offset:51552
    v_mfma_f32_16x16x32_bf16 v[252:255], a[216:219], a[56:59], v[252:255]
    buffer_load_dwordx4 v155, s[48:51], s64 offen lds
    v_mfma_f32_16x16x32_bf16 v[248:251], a[216:219], a[52:55], v[248:251]
    v_mfma_f32_16x16x32_bf16 v[248:251], a[220:223], a[64:67], v[248:251]
    v_mfma_f32_16x16x32_bf16 v[244:247], a[220:223], a[60:63], v[244:247]
    s_waitcnt lgkmcnt(0)
    v_mfma_f32_16x16x32_bf16 v[244:247], a[216:219], a[48:51], v[244:247]
    v_mfma_f32_16x16x32_bf16 v[208:211], a[224:227], a[72:75], v[208:211]
    ds_read_b64_tr_b16 a[192:193], v4 offset:59136
    v_mfma_f32_16x16x32_bf16 v[208:211], a[228:231], a[84:87], v[208:211]
    ds_read_b64_tr_b16 a[194:195], v4 offset:59392
    v_mfma_f32_16x16x32_bf16 v[212:215], a[228:231], a[88:91], v[212:215]
    s_waitcnt vmcnt(4)
    ds_read_b64_tr_b16 a[196:197], v4 offset:59648
    v_mfma_f32_16x16x32_bf16 v[212:215], a[224:227], a[76:79], v[212:215]
    ds_read_b64_tr_b16 a[198:199], v4 offset:59904
    v_mfma_f32_16x16x32_bf16 v[216:219], a[224:227], a[80:83], v[216:219]
    ds_read_b64_tr_b16 a[200:201], v4 offset:59168
    v_add_u32 v10, 1, v10
    v_mfma_f32_16x16x32_bf16 v[216:219], a[228:231], a[92:95], v[216:219]
    ds_read_b64_tr_b16 a[202:203], v4 offset:59424
    v_mfma_f32_16x16x32_bf16 v[228:231], a[236:239], a[92:95], v[228:231]
    buffer_store_dword v10, v1, s[8:11], 0 offen sc1
    v_mfma_f32_16x16x32_bf16 v[228:231], a[232:235], a[80:83], v[228:231]
    ds_read_b64_tr_b16 a[204:205], v4 offset:59680
    v_mfma_f32_16x16x32_bf16 v[224:227], a[232:235], a[76:79], v[224:227]
    ds_read_b64_tr_b16 a[206:207], v4 offset:59936
    v_mfma_f32_16x16x32_bf16 v[224:227], a[236:239], a[88:91], v[224:227]
    s_add_u32 s64, s4, 81920
    ds_read_b64_tr_b16 a[208:209], v4 offset:59200
    v_mfma_f32_16x16x32_bf16 v[220:223], a[236:239], a[84:87], v[220:223]
    s_add_u32 m0, s61, 101376
    ds_read_b64_tr_b16 a[210:211], v4 offset:59456
    v_mfma_f32_16x16x32_bf16 v[220:223], a[232:235], a[72:75], v[220:223]
    buffer_load_dwordx4 v155, s[48:51], s64 offen lds
    v_mfma_f32_16x16x32_bf16 v[232:235], a[240:243], a[72:75], v[232:235]
    ds_read_b64_tr_b16 a[212:213], v4 offset:59712
    v_mfma_f32_16x16x32_bf16 v[232:235], a[244:247], a[84:87], v[232:235]
    ds_read_b64_tr_b16 a[214:215], v4 offset:59968
    v_mfma_f32_16x16x32_bf16 v[236:239], a[244:247], a[88:91], v[236:239]
    s_add_u32 s64, s4, 83200
    ds_read_b64_tr_b16 a[216:217], v4 offset:59232
    v_mfma_f32_16x16x32_bf16 v[236:239], a[240:243], a[76:79], v[236:239]
    s_add_u32 m0, s61, 102432
    ds_read_b64_tr_b16 a[218:219], v4 offset:59488
    v_mfma_f32_16x16x32_bf16 v[240:243], a[240:243], a[80:83], v[240:243]
    s_add_u32 s4, s4, s13
    buffer_load_dwordx4 v155, s[48:51], s64 offen lds
    v_mfma_f32_16x16x32_bf16 v[240:243], a[244:247], a[92:95], v[240:243]
    s_add_u32 s64, s5, 0
    ds_read_b64_tr_b16 a[220:221], v4 offset:59744
    v_mfma_f32_16x16x32_bf16 v[252:255], a[252:255], a[92:95], v[252:255]
    s_add_u32 m0, s61, 42240
    ds_read_b64_tr_b16 a[222:223], v4 offset:60000
    v_mfma_f32_16x16x32_bf16 v[252:255], a[248:251], a[80:83], v[252:255]
    buffer_load_dwordx4 v155, s[48:51], s64 offen lds
    v_mfma_f32_16x16x32_bf16 v[248:251], a[248:251], a[76:79], v[248:251]
    s_add_u32 s64, s5, 1280
    v_mfma_f32_16x16x32_bf16 v[248:251], a[252:255], a[88:91], v[248:251]
    s_add_u32 m0, s61, 43296
    v_mfma_f32_16x16x32_bf16 v[244:247], a[252:255], a[84:87], v[244:247]
    s_waitcnt vmcnt(31) lgkmcnt(0)
    buffer_load_dwordx4 v155, s[48:51], s64 offen lds
    v_mfma_f32_16x16x32_bf16 v[244:247], a[248:251], a[72:75], v[244:247]
    s_barrier
    v_mfma_f32_16x16x32_bf16 v[208:211], a[192:195], v[12:15], v[208:211]
    ds_read_b64_tr_b16 a[224:225], v5 offset:59136
    v_mfma_f32_16x16x32_bf16 v[208:211], a[196:199], v[16:19], v[208:211]
    ds_read_b64_tr_b16 a[226:227], v5 offset:59392
    v_mfma_f32_16x16x32_bf16 v[212:215], a[196:199], v[32:35], v[212:215]
    ds_read_b64_tr_b16 a[228:229], v5 offset:59648
    v_mfma_f32_16x16x32_bf16 v[212:215], a[192:195], v[28:31], v[212:215]
    ds_read_b64_tr_b16 a[230:231], v5 offset:59904
    v_mfma_f32_16x16x32_bf16 v[216:219], a[192:195], v[44:47], v[216:219]
    s_add_u32 s64, s5, 81920
    ds_read_b64_tr_b16 a[232:233], v5 offset:59168
    v_mfma_f32_16x16x32_bf16 v[216:219], a[196:199], v[48:51], v[216:219]
    s_add_u32 m0, s61, 109824
    ds_read_b64_tr_b16 a[234:235], v5 offset:59424
    v_mfma_f32_16x16x32_bf16 v[228:231], a[204:207], v[48:51], v[228:231]
    buffer_load_dwordx4 v155, s[48:51], s64 offen lds
    v_mfma_f32_16x16x32_bf16 v[228:231], a[200:203], v[44:47], v[228:231]
    ds_read_b64_tr_b16 a[236:237], v5 offset:59680
    v_mfma_f32_16x16x32_bf16 v[224:227], a[200:203], v[28:31], v[224:227]
    ds_read_b64_tr_b16 a[238:239], v5 offset:59936
    v_mfma_f32_16x16x32_bf16 v[224:227], a[204:207], v[32:35], v[224:227]
    s_add_u32 s64, s5, 83200
    ds_read_b64_tr_b16 a[240:241], v5 offset:59200
    v_mfma_f32_16x16x32_bf16 v[220:223], a[204:207], v[16:19], v[220:223]
    s_add_u32 m0, s61, 110880
    ds_read_b64_tr_b16 a[242:243], v5 offset:59456
    v_mfma_f32_16x16x32_bf16 v[220:223], a[200:203], v[12:15], v[220:223]
    s_add_u32 s5, s5, s13
    buffer_load_dwordx4 v155, s[48:51], s64 offen lds
    v_mfma_f32_16x16x32_bf16 v[232:235], a[208:211], v[12:15], v[232:235]
    ds_read_b64_tr_b16 a[244:245], v5 offset:59712
    v_mfma_f32_16x16x32_bf16 v[232:235], a[212:215], v[16:19], v[232:235]
    ds_read_b64_tr_b16 a[246:247], v5 offset:59968
    v_mfma_f32_16x16x32_bf16 v[236:239], a[212:215], v[32:35], v[236:239]
    ds_read_b64_tr_b16 a[248:249], v5 offset:59232
    v_mfma_f32_16x16x32_bf16 v[236:239], a[208:211], v[28:31], v[236:239]
    ds_read_b64_tr_b16 a[250:251], v5 offset:59488
    v_mfma_f32_16x16x32_bf16 v[240:243], a[208:211], v[44:47], v[240:243]
    s_add_u32 s65, s58, 81920
    buffer_store_dwordx2 v[128:129], v159, s[36:39], s65 offen nt
    v_mfma_f32_16x16x32_bf16 v[240:243], a[212:215], v[48:51], v[240:243]
    ds_read_b64_tr_b16 a[252:253], v5 offset:59744
    v_mfma_f32_16x16x32_bf16 v[252:255], a[220:223], v[48:51], v[252:255]
    ds_read_b64_tr_b16 a[254:255], v5 offset:60000
    v_mfma_f32_16x16x32_bf16 v[252:255], a[216:219], v[44:47], v[252:255]
    v_mfma_f32_16x16x32_bf16 v[248:251], a[216:219], v[28:31], v[248:251]
    v_mfma_f32_16x16x32_bf16 v[248:251], a[220:223], v[32:35], v[248:251]
    v_mfma_f32_16x16x32_bf16 v[244:247], a[220:223], v[16:19], v[244:247]
    s_waitcnt lgkmcnt(0)
    v_mfma_f32_16x16x32_bf16 v[244:247], a[216:219], v[12:15], v[244:247]
    v_mfma_f32_16x16x32_bf16 v[60:63], a[0:3], v[130:133], v[60:63]
    v_mfma_f32_16x16x32_bf16 v[64:67], a[0:3], v[134:137], v[64:67]
    v_mfma_f32_16x16x32_bf16 v[68:71], a[0:3], v[138:141], v[68:71]
    v_mfma_f32_16x16x32_bf16 v[60:63], a[0:3], v[142:145], v[60:63]
    v_mfma_f32_16x16x32_bf16 v[64:67], a[0:3], v[146:149], v[64:67]
    v_mfma_f32_16x16x32_bf16 v[68:71], a[0:3], v[148:151], v[68:71]
    v_mfma_f32_16x16x32_bf16 v[208:211], a[224:227], v[20:23], v[208:211]
    s_cmp_ge_u32 s27, 1
    ds_read_b64_tr_b16 a[192:193], v4 offset:0
    v_mfma_f32_16x16x32_bf16 v[208:211], a[228:231], v[24:27], v[208:211]
    s_cselect_b32 s38, 490016, 0
    ds_read_b64_tr_b16 a[194:195], v4 offset:256
    v_mfma_f32_16x16x32_bf16 v[212:215], a[228:231], v[40:43], v[212:215]
    s_add_u32 s58, s58, 256
    ds_read_b64_tr_b16 a[196:197], v4 offset:512
    v_mfma_f32_16x16x32_bf16 v[212:215], a[224:227], v[36:39], v[212:215]
    s_mov_b32 s34, 1763328
    ds_read_b64_tr_b16 a[198:199], v4 offset:768
    v_mfma_f32_16x16x32_bf16 v[216:219], a[224:227], v[52:55], v[216:219]
    ds_read_b64_tr_b16 a[200:201], v4 offset:32
    v_mfma_f32_16x16x32_bf16 v[216:219], a[228:231], v[56:59], v[216:219]
    ds_read_b64_tr_b16 a[202:203], v4 offset:288
    v_mfma_f32_16x16x32_bf16 v[228:231], a[236:239], v[56:59], v[228:231]
    buffer_load_dword v6, v2, s[8:11], 0 offen sc1
    v_mfma_f32_16x16x32_bf16 v[228:231], a[232:235], v[52:55], v[228:231]
    ds_read_b64_tr_b16 a[204:205], v4 offset:544
    v_cvt_pk_bf16_f32 v124, v60, v61
    v_mfma_f32_16x16x32_bf16 v[224:227], a[232:235], v[36:39], v[224:227]
    ds_read_b64_tr_b16 a[206:207], v4 offset:800
    v_cvt_pk_bf16_f32 v125, v62, v63
    v_mfma_f32_16x16x32_bf16 v[224:227], a[236:239], v[40:43], v[224:227]
    s_add_u32 s64, s6, 0
    ds_read_b64_tr_b16 a[208:209], v4 offset:64
    v_cvt_pk_bf16_f32 v126, v64, v65
    v_mfma_f32_16x16x32_bf16 v[220:223], a[236:239], v[24:27], v[220:223]
    s_add_u32 m0, s61, 50688
    ds_read_b64_tr_b16 a[210:211], v4 offset:320
    v_cvt_pk_bf16_f32 v127, v66, v67
    v_mfma_f32_16x16x32_bf16 v[220:223], a[232:235], v[20:23], v[220:223]
    buffer_load_dwordx4 v155, s[48:51], s64 offen lds
    v_mfma_f32_16x16x32_bf16 v[232:235], a[240:243], v[20:23], v[232:235]
    ds_read_b64_tr_b16 a[212:213], v4 offset:576
    v_cvt_pk_bf16_f32 v128, v68, v69
    v_mfma_f32_16x16x32_bf16 v[232:235], a[244:247], v[24:27], v[232:235]
    ds_read_b64_tr_b16 a[214:215], v4 offset:832
    v_cvt_pk_bf16_f32 v129, v70, v71
    v_mfma_f32_16x16x32_bf16 v[236:239], a[244:247], v[40:43], v[236:239]
    s_add_u32 s64, s6, 1280
    ds_read_b64_tr_b16 a[216:217], v4 offset:96
    v_mfma_f32_16x16x32_bf16 v[236:239], a[240:243], v[36:39], v[236:239]
    s_add_u32 m0, s61, 51744
    ds_read_b64_tr_b16 a[218:219], v4 offset:352
    v_mfma_f32_16x16x32_bf16 v[240:243], a[240:243], v[52:55], v[240:243]
    buffer_load_dwordx4 v155, s[48:51], s64 offen lds
    v_mfma_f32_16x16x32_bf16 v[240:243], a[244:247], v[56:59], v[240:243]
    ds_read_b64_tr_b16 a[220:221], v4 offset:608
    v_mfma_f32_16x16x32_bf16 v[252:255], a[252:255], v[56:59], v[252:255]
    s_add_u32 s27, s27, 1
    ds_read_b64_tr_b16 a[222:223], v4 offset:864
    v_mfma_f32_16x16x32_bf16 v[252:255], a[248:251], v[52:55], v[252:255]
    s_cmp_lt_u32 s27, 5
    v_add_u32 v154, 344064, v154
    v_mfma_f32_16x16x32_bf16 v[248:251], a[248:251], v[36:39], v[248:251]
    v_add_u32 v158, 344064, v158
    v_mfma_f32_16x16x32_bf16 v[248:251], a[252:255], v[40:43], v[248:251]
    v_mfma_f32_16x16x32_bf16 v[244:247], a[252:255], v[24:27], v[244:247]
    s_waitcnt lgkmcnt(0)
    v_mfma_f32_16x16x32_bf16 v[244:247], a[248:251], v[20:23], v[244:247]
    s_cbranch_scc1 L_gl_far
    v_cvt_pk_bf16_f32 v160, v208, v209
    v_cvt_pk_bf16_f32 v161, v210, v211
    v_cvt_pk_bf16_f32 v162, v212, v213
    v_cvt_pk_bf16_f32 v163, v214, v215
    v_cvt_pk_bf16_f32 v164, v216, v217
    v_cvt_pk_bf16_f32 v165, v218, v219
    v_cvt_pk_bf16_f32 v166, v220, v221
    v_cvt_pk_bf16_f32 v167, v222, v223
    v_cvt_pk_bf16_f32 v168, v224, v225
    v_cvt_pk_bf16_f32 v169, v226, v227
    v_cvt_pk_bf16_f32 v170, v228, v229
    v_cvt_pk_bf16_f32 v171, v230, v231
    v_cvt_pk_bf16_f32 v172, v232, v233
    v_cvt_pk_bf16_f32 v173, v234, v235
    v_cvt_pk_bf16_f32 v174, v236, v237
    v_cvt_pk_bf16_f32 v175, v238, v239
    v_cvt_pk_bf16_f32 v176, v240, v241
    v_cvt_pk_bf16_f32 v177, v242, v243
    s_waitcnt vmcnt(2)
    v_cmp_gt_u32 vcc, v10, v6
    s_nop 4
    s_cbranch_vccnz L_sp_97
L_ok_98:
    buffer_store_dwordx4 v[160:163], v152, s[52:55], s44 offen sc1
    buffer_store_dwordx2 v[164:165], v153, s[52:55], s44 offen sc1
    buffer_store_dwordx4 v[168:171], v152, s[52:55], s45 offen sc1
    buffer_store_dwordx2 v[166:167], v153, s[52:55], s45 offen sc1
    buffer_store_dwordx4 v[172:175], v152, s[52:55], s46 offen sc1
    buffer_store_dwordx2 v[176:177], v153, s[52:55], s46 offen sc1
    s_mov_b32 s65, 0
    buffer_load_dwordx4 v[186:189], v154, s[32:35], s65 offen sc1
    buffer_load_dwordx2 v[194:195], v158, s[32:35], s65 offen sc1
    s_mov_b32 s65, 6144
    buffer_load_dwordx4 v[190:193], v154, s[32:35], s65 offen sc1
    buffer_load_dwordx2 v[184:185], v158, s[32:35], s65 offen sc1
    s_mov_b32 s65, 12288
    buffer_load_dwordx4 v[198:201], v154, s[32:35], s65 offen sc1
    buffer_load_dwordx2 v[206:207], v158, s[32:35], s65 offen sc1
    s_mov_b32 s65, 18432
    buffer_load_dwordx4 v[202:205], v154, s[32:35], s65 offen sc1
    buffer_load_dwordx2 v[196:197], v158, s[32:35], s65 offen sc1
    ds_bpermute_b32 v124, v11, v124
    ds_bpermute_b32 v125, v11, v125
    ds_bpermute_b32 v126, v11, v126
    ds_bpermute_b32 v127, v11, v127
    ds_bpermute_b32 v128, v11, v128
    ds_bpermute_b32 v129, v11, v129
    s_waitcnt vmcnt(8)
    v_add_u32 v10, 1, v10
    buffer_store_dword v10, v1, s[8:11], 0 offen sc1
    s_waitcnt vmcnt(7)
    s_waitcnt vmcnt(5)
    v_mfma_f32_16x16x32_bf16 v[60:63], a[0:3], v[184:187], v[244:247]
    v_mfma_f32_16x16x32_bf16 v[64:67], a[0:3], v[188:191], v[248:251]
    v_mfma_f32_16x16x32_bf16 v[68:71], a[0:3], v[192:195], v[252:255]
    s_waitcnt vmcnt(3)
    s_waitcnt vmcnt(1)
    v_mfma_f32_16x16x32_bf16 v[60:63], a[0:3], v[196:199], v[60:63]
    v_mfma_f32_16x16x32_bf16 v[64:67], a[0:3], v[200:203], v[64:67]
    v_mfma_f32_16x16x32_bf16 v[68:71], a[0:3], v[204:207], v[68:71]
    buffer_load_dword v6, v2, s[8:11], 0 offen sc1
    s_waitcnt vmcnt(0)
    v_cmp_gt_u32 vcc, v10, v6
    s_nop 4
    s_cbranch_vccnz L_sp_99
L_ok_100:
    s_mov_b32 s65, 24576
    buffer_load_dwordx4 v[132:135], v154, s[32:35], s65 offen sc1
    buffer_load_dwordx2 v[140:141], v158, s[32:35], s65 offen sc1
    s_mov_b32 s65, 30720
    buffer_load_dwordx4 v[136:139], v154, s[32:35], s65 offen sc1
    buffer_load_dwordx2 v[130:131], v158, s[32:35], s65 offen sc1
    s_mov_b32 s65, 36864
    buffer_load_dwordx4 v[144:147], v154, s[32:35], s65 offen sc1
    buffer_load_dwordx2 v[150:151], v158, s[32:35], s65 offen sc1
    s_waitcnt lgkmcnt(0)
    s_add_u32 s65, s58, 0
    buffer_store_dwordx2 v[124:125], v159, s[36:39], s65 offen nt
    s_add_u32 s65, s58, 40960
    buffer_store_dwordx2 v[126:127], v159, s[36:39], s65 offen nt
    s_add_u32 s65, s58, 81920
    buffer_store_dwordx2 v[128:129], v159, s[36:39], s65 offen nt
    s_mov_b32 s58, 1024
    s_waitcnt vmcnt(7)
    s_waitcnt vmcnt(5)
    v_mfma_f32_16x16x32_bf16 v[60:63], a[0:3], v[130:133], v[60:63]
    v_mfma_f32_16x16x32_bf16 v[64:67], a[0:3], v[134:137], v[64:67]
    v_mfma_f32_16x16x32_bf16 v[68:71], a[0:3], v[138:141], v[68:71]
    s_waitcnt vmcnt(3)
    v_mfma_f32_16x16x32_bf16 v[60:63], a[0:3], v[142:145], v[60:63]
    v_mfma_f32_16x16x32_bf16 v[64:67], a[0:3], v[146:149], v[64:67]
    v_mfma_f32_16x16x32_bf16 v[68:71], a[0:3], v[148:151], v[68:71]
    s_nop 5
    v_cvt_pk_bf16_f32 v124, v60, v61
    v_cvt_pk_bf16_f32 v125, v62, v63
    v_cvt_pk_bf16_f32 v126, v64, v65
    v_cvt_pk_bf16_f32 v127, v66, v67
    v_cvt_pk_bf16_f32 v128, v68, v69
    v_cvt_pk_bf16_f32 v129, v70, v71
    ds_bpermute_b32 v124, v11, v124
    ds_bpermute_b32 v125, v11, v125
    ds_bpermute_b32 v126, v11, v126
    ds_bpermute_b32 v127, v11, v127
    ds_bpermute_b32 v128, v11, v128
    ds_bpermute_b32 v129, v11, v129
    s_waitcnt lgkmcnt(0)
    s_add_u32 s65, s58, 0
    buffer_store_dwordx2 v[124:125], v159, s[36:39], s65 offen nt
    s_add_u32 s65, s58, 40960
    buffer_store_dwordx2 v[126:127], v159, s[36:39], s65 offen nt
    s_add_u32 s65, s58, 81920
    buffer_store_dwordx2 v[128:129], v159, s[36:39], s65 offen nt
    s_branch L_fin
L_sp_93:
    s_mov_b32 s70, 0
L_spin_101:
    s_add_u32 s70, s70, 1
    s_cmp_ge_u32 s70, 2000000
    s_cbranch_scc1 L_ok_94
    s_sleep 1
    buffer_load_dword v6, v2, s[8:11], 0 offen sc1
    s_waitcnt vmcnt(0)
    v_cmp_gt_u32 vcc, v10, v6
    s_nop 4
    s_cbranch_vccnz L_spin_101
    s_branch L_ok_94
L_sp_95:
    s_mov_b32 s70, 0
L_spin_102:
    s_add_u32 s70, s70, 1
    s_cmp_ge_u32 s70, 2000000
    s_cbranch_scc1 L_ok_96
    s_sleep 1
    buffer_load_dword v6, v2, s[8:11], 0 offen sc1
    s_waitcnt vmcnt(0)
    v_cmp_gt_u32 vcc, v10, v6
    s_nop 4
    s_cbranch_vccnz L_spin_102
    s_branch L_ok_96
L_sp_97:
    s_mov_b32 s70, 0
L_spin_103:
    s_add_u32 s70, s70, 1
    s_cmp_ge_u32 s70, 2000000
    s_cbranch_scc1 L_ok_98
    s_sleep 1
    buffer_load_dword v6, v2, s[8:11], 0 offen sc1
    s_waitcnt vmcnt(0)
    v_cmp_gt_u32 vcc, v10, v6
    s_nop 4
    s_cbranch_vccnz L_spin_103
    s_branch L_ok_98
L_sp_99:
    s_mov_b32 s70, 0
L_spin_104:
    s_add_u32 s70, s70, 1
    s_cmp_ge_u32 s70, 2000000
    s_cbranch_scc1 L_ok_100
    s_sleep 1
    buffer_load_dword v6, v2, s[8:11], 0 offen sc1
    s_waitcnt vmcnt(0)
    v_cmp_gt_u32 vcc, v10, v6
    s_nop 4
    s_cbranch_vccnz L_spin_104
    s_branch L_ok_100
L_slow:
    s_waitcnt vmcnt(0) lgkmcnt(0)
    s_nop 7
    v_and_b32 v108, 7, v0
    v_lshlrev_b32 v108, 10, v108
    v_bfe_u32 v109, v0, 3, 1
    v_lshl_add_u32 v108, v109, 8, v108
    v_lshrrev_b32 v109, 4, v0
    v_lshl_add_u32 v10, v109, 4, v108
    v_bfe_u32 v108, v0, 4, 1
    v_lshlrev_b32 v108, 12, v108
    v_lshrrev_b32 v109, 5, v0
    v_lshl_add_u32 v108, v109, 8, v108
    v_and_b32 v109, 15, v0
    v_lshl_add_u32 v11, v109, 1, v108
    v_mov_b32 v7, 0xff800000
    v_mov_b32 v8, 0xff800000
    v_mov_b32 v9, 0xff800000
    s_and_b32 s69, s22, 0x60000
    s_xor_b32 s69, s69, s68
    s_add_u32 s70, s69, 131072
L_slow_p1:
    buffer_load_dwordx4 v[120:123], v10, s[40:43], s69 offen offset:0
    buffer_load_dwordx4 v[124:127], v10, s[40:43], s69 offen offset:64
    buffer_load_dwordx4 v[128:131], v10, s[40:43], s69 offen offset:128
    buffer_load_dwordx4 v[132:135], v10, s[40:43], s69 offen offset:192
    buffer_load_dwordx4 v[136:139], v10, s[40:43], s69 offen offset:512
    buffer_load_dwordx4 v[140:143], v10, s[40:43], s69 offen offset:576
    buffer_load_dwordx4 v[144:147], v10, s[40:43], s69 offen offset:640
    buffer_load_dwordx4 v[148:151], v10, s[40:43], s69 offen offset:704
    s_waitcnt vmcnt(7)
    v_mfma_f32_16x16x32_bf16 v[72:75], v[120:123], v[12:15], 0
    s_waitcnt vmcnt(6)
    v_mfma_f32_16x16x32_bf16 v[72:75], v[124:127], v[16:19], v[72:75]
    s_waitcnt vmcnt(5)
    v_mfma_f32_16x16x32_bf16 v[72:75], v[128:131], v[20:23], v[72:75]
    s_waitcnt vmcnt(4)
    v_mfma_f32_16x16x32_bf16 v[72:75], v[132:135], v[24:27], v[72:75]
    v_mfma_f32_16x16x32_bf16 v[76:79], v[120:123], v[28:31], 0
    v_mfma_f32_16x16x32_bf16 v[76:79], v[124:127], v[32:35], v[76:79]
    v_mfma_f32_16x16x32_bf16 v[76:79], v[128:131], v[36:39], v[76:79]
    v_mfma_f32_16x16x32_bf16 v[76:79], v[132:135], v[40:43], v[76:79]
    v_mfma_f32_16x16x32_bf16 v[80:83], v[120:123], v[44:47], 0
    v_mfma_f32_16x16x32_bf16 v[80:83], v[124:127], v[48:51], v[80:83]
    v_mfma_f32_16x16x32_bf16 v[80:83], v[128:131], v[52:55], v[80:83]
    v_mfma_f32_16x16x32_bf16 v[80:83], v[132:135], v[56:59], v[80:83]
    s_waitcnt vmcnt(3)
    v_mfma_f32_16x16x32_bf16 v[84:87], v[136:139], v[12:15], 0
    s_waitcnt vmcnt(2)
    v_mfma_f32_16x16x32_bf16 v[84:87], v[140:143], v[16:19], v[84:87]
    s_waitcnt vmcnt(1)
    v_mfma_f32_16x16x32_bf16 v[84:87], v[144:147], v[20:23], v[84:87]
    s_waitcnt vmcnt(0)
    v_mfma_f32_16x16x32_bf16 v[84:87], v[148:151], v[24:27], v[84:87]
    v_mfma_f32_16x16x32_bf16 v[88:91], v[136:139], v[28:31], 0
    v_mfma_f32_16x16x32_bf16 v[88:91], v[140:143], v[32:35], v[88:91]
    v_mfma_f32_16x16x32_bf16 v[88:91], v[144:147], v[36:39], v[88:91]
    v_mfma_f32_16x16x32_bf16 v[88:91], v[148:151], v[40:43], v[88:91]
    v_mfma_f32_16x16x32_bf16 v[92:95], v[136:139], v[44:47], 0
    v_mfma_f32_16x16x32_bf16 v[92:95], v[140:143], v[48:51], v[92:95]
    v_mfma_f32_16x16x32_bf16 v[92:95], v[144:147], v[52:55], v[92:95]
    v_mfma_f32_16x16x32_bf16 v[92:95], v[148:151], v[56:59], v[92:95]
    v_max3_f32 v7, v7, v72, v73
    v_max3_f32 v7, v7, v74, v75
    v_max3_f32 v7, v7, v84, v85
    v_max3_f32 v7, v7, v86, v87
    v_max3_f32 v8, v8, v76, v77
    v_max3_f32 v8, v8, v78, v79
    v_max3_f32 v8, v8, v88, v89
    v_max3_f32 v8, v8, v90, v91
    v_max3_f32 v9, v9, v80, v81
    v_max3_f32 v9, v9, v82, v83
    v_max3_f32 v9, v9, v92, v93
    v_max3_f32 v9, v9, v94, v95
    s_add_u32 s69, s69, 8192
    s_cmp_lt_u32 s69, s70
    s_cbranch_scc1 L_slow_p1
    v_mov_b32 v60, v7
    v_mov_b32 v64, v8
    v_mov_b32 v68, v9
    v_permlane32_swap_b32 v7, v60
    v_permlane32_swap_b32 v8, v64
    v_permlane32_swap_b32 v9, v68
    v_max_f32 v7, v7, v60
    v_max_f32 v8, v8, v64
    v_max_f32 v9, v9, v68
    v_mov_b32 v60, v7
    v_mov_b32 v64, v8
    v_mov_b32 v68, v9
    v_permlane16_swap_b32 v7, v60
    v_permlane16_swap_b32 v8, v64
    v_permlane16_swap_b32 v9, v68
    v_max_f32 v7, v7, v60
    v_max_f32 v8, v8, v64
    v_max_f32 v9, v9, v68
    v_sub_f32 v60, 0, v7
    v_sub_f32 v61, 0, v7
    v_sub_f32 v62, 0, v7
    v_sub_f32 v63, 0, v7
    v_sub_f32 v64, 0, v8
    v_sub_f32 v65, 0, v8
    v_sub_f32 v66, 0, v8
    v_sub_f32 v67, 0, v8
    v_sub_f32 v68, 0, v9
    v_sub_f32 v69, 0, v9
    v_sub_f32 v70, 0, v9
    v_sub_f32 v71, 0, v9
    v_mov_b32 v160, 0
    v_mov_b32 v161, 0
    v_mov_b32 v162, 0
    v_mov_b32 v163, 0
    v_mov_b32 v164, 0
    v_mov_b32 v165, 0
    v_mov_b32 v166, 0
    v_mov_b32 v167, 0
    v_mov_b32 v168, 0
    v_mov_b32 v169, 0
    v_mov_b32 v170, 0
    v_mov_b32 v171, 0
    v_mov_b32 v172, 0
    v_mov_b32 v173, 0
    v_mov_b32 v174, 0
    v_mov_b32 v175, 0
    v_mov_b32 v176, 0
    v_mov_b32 v177, 0
    v_mov_b32 v178, 0
    v_mov_b32 v179, 0
    v_mov_b32 v180, 0
    v_mov_b32 v181, 0
    v_mov_b32 v182, 0
    v_mov_b32 v183, 0
    v_mov_b32 v184, 0
    v_mov_b32 v185, 0
    v_mov_b32 v186, 0
    v_mov_b32 v187, 0
    v_mov_b32 v188, 0
    v_mov_b32 v189, 0
    v_mov_b32 v190, 0
    v_mov_b32 v191, 0
    v_mov_b32 v192, 0
    v_mov_b32 v193, 0
    v_mov_b32 v194, 0
    v_mov_b32 v195, 0
    v_mov_b32 v196, 0
    v_mov_b32 v197, 0
    v_mov_b32 v198, 0
    v_mov_b32 v199, 0
    v_mov_b32 v200, 0
    v_mov_b32 v201, 0
    v_mov_b32 v202, 0
    v_mov_b32 v203, 0
    v_mov_b32 v204, 0
    v_mov_b32 v205, 0
    v_mov_b32 v206, 0
    v_mov_b32 v207, 0
    v_mov_b32 v208, 0
    v_mov_b32 v209, 0
    v_mov_b32 v210, 0
    v_mov_b32 v211, 0
    v_mov_b32 v212, 0
    v_mov_b32 v213, 0
    v_mov_b32 v214, 0
    v_mov_b32 v215, 0
    v_mov_b32 v216, 0
    v_mov_b32 v217, 0
    v_mov_b32 v218, 0
    v_mov_b32 v219, 0
    v_mov_b32 v220, 0
    v_mov_b32 v221, 0
    v_mov_b32 v222, 0
    v_mov_b32 v223, 0
    v_mov_b32 v224, 0
    v_mov_b32 v225, 0
    v_mov_b32 v226, 0
    v_mov_b32 v227, 0
    v_mov_b32 v228, 0
    v_mov_b32 v229, 0
    v_mov_b32 v230, 0
    v_mov_b32 v231, 0
    v_mov_b32 v232, 0
    v_mov_b32 v233, 0
    v_mov_b32 v234, 0
    v_mov_b32 v235, 0
    v_mov_b32 v236, 0
    v_mov_b32 v237, 0
    v_mov_b32 v238, 0
    v_mov_b32 v239, 0
    v_mov_b32 v240, 0
    v_mov_b32 v241, 0
    v_mov_b32 v242, 0
    v_mov_b32 v243, 0
    v_mov_b32 v244, 0
    v_mov_b32 v245, 0
    v_mov_b32 v246, 0
    v_mov_b32 v247, 0
    v_mov_b32 v248, 0
    v_mov_b32 v249, 0
    v_mov_b32 v250, 0
    v_mov_b32 v251, 0
    v_mov_b32 v252, 0
    v_mov_b32 v253, 0
    v_mov_b32 v254, 0
    v_mov_b32 v255, 0
    v_accvgpr_write_b32 a192, 0
    v_accvgpr_write_b32 a193, 0
    v_accvgpr_write_b32 a194, 0
    v_accvgpr_write_b32 a195, 0
    v_accvgpr_write_b32 a196, 0
    v_accvgpr_write_b32 a197, 0
    v_accvgpr_write_b32 a198, 0
    v_accvgpr_write_b32 a199, 0
    v_accvgpr_write_b32 a200, 0
    v_accvgpr_write_b32 a201, 0
    v_accvgpr_write_b32 a202, 0
    v_accvgpr_write_b32 a203, 0
    s_sub_u32 s69, s70, 131072
L_slow_p2:
    buffer_load_dwordx4 v[120:123], v10, s[40:43], s69 offen offset:0
    buffer_load_dwordx4 v[124:127], v10, s[40:43], s69 offen offset:64
    buffer_load_dwordx4 v[128:131], v10, s[40:43], s69 offen offset:128
    buffer_load_dwordx4 v[132:135], v10, s[40:43], s69 offen offset:192
    buffer_load_dwordx4 v[136:139], v10, s[40:43], s69 offen offset:512
    buffer_load_dwordx4 v[140:143], v10, s[40:43], s69 offen offset:576
    buffer_load_dwordx4 v[144:147], v10, s[40:43], s69 offen offset:640
    buffer_load_dwordx4 v[148:151], v10, s[40:43], s69 offen offset:704
    s_waitcnt vmcnt(7)
    v_mfma_f32_16x16x32_bf16 v[72:75], v[120:123], v[12:15], v[60:63]
    s_waitcnt vmcnt(6)
    v_mfma_f32_16x16x32_bf16 v[72:75], v[124:127], v[16:19], v[72:75]
    s_waitcnt vmcnt(5)
    v_mfma_f32_16x16x32_bf16 v[72:75], v[128:131], v[20:23], v[72:75]
    s_waitcnt vmcnt(4)
    v_mfma_f32_16x16x32_bf16 v[72:75], v[132:135], v[24:27], v[72:75]
    v_mfma_f32_16x16x32_bf16 v[76:79], v[120:123], v[28:31], v[64:67]
    v_mfma_f32_16x16x32_bf16 v[76:79], v[124:127], v[32:35], v[76:79]
    v_mfma_f32_16x16x32_bf16 v[76:79], v[128:131], v[36:39], v[76:79]
    v_mfma_f32_16x16x32_bf16 v[76:79], v[132:135], v[40:43], v[76:79]
    v_mfma_f32_16x16x32_bf16 v[80:83], v[120:123], v[44:47], v[68:71]
    v_mfma_f32_16x16x32_bf16 v[80:83], v[124:127], v[48:51], v[80:83]
    v_mfma_f32_16x16x32_bf16 v[80:83], v[128:131], v[52:55], v[80:83]
    v_mfma_f32_16x16x32_bf16 v[80:83], v[132:135], v[56:59], v[80:83]
    s_waitcnt vmcnt(3)
    v_mfma_f32_16x16x32_bf16 v[84:87], v[136:139], v[12:15], v[60:63]
    s_waitcnt vmcnt(2)
    v_mfma_f32_16x16x32_bf16 v[84:87], v[140:143], v[16:19], v[84:87]
    s_waitcnt vmcnt(1)
    v_mfma_f32_16x16x32_bf16 v[84:87], v[144:147], v[20:23], v[84:87]
    s_waitcnt vmcnt(0)
    v_mfma_f32_16x16x32_bf16 v[84:87], v[148:151], v[24:27], v[84:87]
    v_mfma_f32_16x16x32_bf16 v[88:91], v[136:139], v[28:31], v[64:67]
    v_mfma_f32_16x16x32_bf16 v[88:91], v[140:143], v[32:35], v[88:91]
    v_mfma_f32_16x16x32_bf16 v[88:91], v[144:147], v[36:39], v[88:91]
    v_mfma_f32_16x16x32_bf16 v[88:91], v[148:151], v[40:43], v[88:91]
    v_mfma_f32_16x16x32_bf16 v[92:95], v[136:139], v[44:47], v[68:71]
    v_mfma_f32_16x16x32_bf16 v[92:95], v[140:143], v[48:51], v[92:95]
    v_mfma_f32_16x16x32_bf16 v[92:95], v[144:147], v[52:55], v[92:95]
    v_mfma_f32_16x16x32_bf16 v[92:95], v[148:151], v[56:59], v[92:95]
    v_exp_f32 v72, v72
    v_exp_f32 v73, v73
    v_exp_f32 v74, v74
    v_exp_f32 v75, v75
    v_exp_f32 v76, v76
    v_exp_f32 v77, v77
    v_exp_f32 v78, v78
    v_exp_f32 v79, v79
    v_exp_f32 v80, v80
    v_exp_f32 v81, v81
    v_exp_f32 v82, v82
    v_exp_f32 v83, v83
    v_exp_f32 v84, v84
    v_exp_f32 v85, v85
    v_exp_f32 v86, v86
    v_exp_f32 v87, v87
    v_exp_f32 v88, v88
    v_exp_f32 v89, v89
    v_exp_f32 v90, v90
    v_exp_f32 v91, v91
    v_exp_f32 v92, v92
    v_exp_f32 v93, v93
    v_exp_f32 v94, v94
    v_exp_f32 v95, v95
    v_cvt_pk_bf16_f32 v96, v72, v73
    v_cvt_pk_bf16_f32 v97, v74, v75
    v_cvt_pk_bf16_f32 v100, v76, v77
    v_cvt_pk_bf16_f32 v101, v78, v79
    v_cvt_pk_bf16_f32 v104, v80, v81
    v_cvt_pk_bf16_f32 v105, v82, v83
    v_cvt_pk_bf16_f32 v98, v84, v85
    v_cvt_pk_bf16_f32 v99, v86, v87
    v_cvt_pk_bf16_f32 v102, v88, v89
    v_cvt_pk_bf16_f32 v103, v90, v91
    v_cvt_pk_bf16_f32 v106, v92, v93
    v_cvt_pk_bf16_f32 v107, v94, v95
    buffer_load_ushort v120, v11, s[44:47], s69 offen offset:0
    buffer_load_ushort v121, v11, s[44:47], s69 offen offset:2048
    buffer_load_ushort v122, v11, s[44:47], s69 offen offset:512
    buffer_load_ushort v123, v11, s[44:47], s69 offen offset:2560
    buffer_load_ushort v124, v11, s[44:47], s69 offen offset:32
    buffer_load_ushort v125, v11, s[44:47], s69 offen offset:2080
    buffer_load_ushort v126, v11, s[44:47], s69 offen offset:544
    buffer_load_ushort v127, v11, s[44:47], s69 offen offset:2592
    buffer_load_ushort v128, v11, s[44:47], s69 offen offset:64
    buffer_load_ushort v129, v11, s[44:47], s69 offen offset:2112
    buffer_load_ushort v130, v11, s[44:47], s69 offen offset:576
    buffer_load_ushort v131, v11, s[44:47], s69 offen offset:2624
    buffer_load_ushort v132, v11, s[44:47], s69 offen offset:96
    buffer_load_ushort v133, v11, s[44:47], s69 offen offset:2144
    buffer_load_ushort v134, v11, s[44:47], s69 offen offset:608
    buffer_load_ushort v135, v11, s[44:47], s69 offen offset:2656
    buffer_load_ushort v72, v11, s[44:47], s69 offen offset:1024
    buffer_load_ushort v73, v11, s[44:47], s69 offen offset:3072
    buffer_load_ushort v74, v11, s[44:47], s69 offen offset:1536
    buffer_load_ushort v75, v11, s[44:47], s69 offen offset:3584
    buffer_load_ushort v76, v11, s[44:47], s69 offen offset:1056
    buffer_load_ushort v77, v11, s[44:47], s69 offen offset:3104
    buffer_load_ushort v78, v11, s[44:47], s69 offen offset:1568
    buffer_load_ushort v79, v11, s[44:47], s69 offen offset:3616
    buffer_load_ushort v80, v11, s[44:47], s69 offen offset:1088
    buffer_load_ushort v81, v11, s[44:47], s69 offen offset:3136
    buffer_load_ushort v82, v11, s[44:47], s69 offen offset:1600
    buffer_load_ushort v83, v11, s[44:47], s69 offen offset:3648
    buffer_load_ushort v84, v11, s[44:47], s69 offen offset:1120
    buffer_load_ushort v85, v11, s[44:47], s69 offen offset:3168
    buffer_load_ushort v86, v11, s[44:47], s69 offen offset:1632
    buffer_load_ushort v87, v11, s[44:47], s69 offen offset:3680
    s_waitcnt vmcnt(0)
    v_lshl_or_b32 v120, v72, 16, v120
    v_lshl_or_b32 v121, v73, 16, v121
    v_lshl_or_b32 v122, v74, 16, v122
    v_lshl_or_b32 v123, v75, 16, v123
    v_lshl_or_b32 v124, v76, 16, v124
    v_lshl_or_b32 v125, v77, 16, v125
    v_lshl_or_b32 v126, v78, 16, v126
    v_lshl_or_b32 v127, v79, 16, v127
    v_lshl_or_b32 v128, v80, 16, v128
    v_lshl_or_b32 v129, v81, 16, v129
    v_lshl_or_b32 v130, v82, 16, v130
    v_lshl_or_b32 v131, v83, 16, v131
    v_lshl_or_b32 v132, v84, 16, v132
    v_lshl_or_b32 v133, v85, 16, v133
    v_lshl_or_b32 v134, v86, 16, v134
    v_lshl_or_b32 v135, v87, 16, v135
    buffer_load_ushort v136, v11, s[44:47], s69 offen offset:128
    buffer_load_ushort v137, v11, s[44:47], s69 offen offset:2176
    buffer_load_ushort v138, v11, s[44:47], s69 offen offset:640
    buffer_load_ushort v139, v11, s[44:47], s69 offen offset:2688
    buffer_load_ushort v140, v11, s[44:47], s69 offen offset:160
    buffer_load_ushort v141, v11, s[44:47], s69 offen offset:2208
    buffer_load_ushort v142, v11, s[44:47], s69 offen offset:672
    buffer_load_ushort v143, v11, s[44:47], s69 offen offset:2720
    buffer_load_ushort v144, v11, s[44:47], s69 offen offset:192
    buffer_load_ushort v145, v11, s[44:47], s69 offen offset:2240
    buffer_load_ushort v146, v11, s[44:47], s69 offen offset:704
    buffer_load_ushort v147, v11, s[44:47], s69 offen offset:2752
    buffer_load_ushort v148, v11, s[44:47], s69 offen offset:224
    buffer_load_ushort v149, v11, s[44:47], s69 offen offset:2272
    buffer_load_ushort v150, v11, s[44:47], s69 offen offset:736
    buffer_load_ushort v151, v11, s[44:47], s69 offen offset:2784
    buffer_load_ushort v72, v11, s[44:47], s69 offen offset:1152
    buffer_load_ushort v73, v11, s[44:47], s69 offen offset:3200
    buffer_load_ushort v74, v11, s[44:47], s69 offen offset:1664
    buffer_load_ushort v75, v11, s[44:47], s69 offen offset:3712
    buffer_load_ushort v76, v11, s[44:47], s69 offen offset:1184
    buffer_load_ushort v77, v11, s[44:47], s69 offen offset:3232
    buffer_load_ushort v78, v11, s[44:47], s69 offen offset:1696
    buffer_load_ushort v79, v11, s[44:47], s69 offen offset:3744
    buffer_load_ushort v80, v11, s[44:47], s69 offen offset:1216
    buffer_load_ushort v81, v11, s[44:47], s69 offen offset:3264
    buffer_load_ushort v82, v11, s[44:47], s69 offen offset:1728
    buffer_load_ushort v83, v11, s[44:47], s69 offen offset:3776
    buffer_load_ushort v84, v11, s[44:47], s69 offen offset:1248
    buffer_load_ushort v85, v11, s[44:47], s69 offen offset:3296
    buffer_load_ushort v86, v11, s[44:47], s69 offen offset:1760
    buffer_load_ushort v87, v11, s[44:47], s69 offen offset:3808
    s_waitcnt vmcnt(0)
    v_lshl_or_b32 v136, v72, 16, v136
    v_lshl_or_b32 v137, v73, 16, v137
    v_lshl_or_b32 v138, v74, 16, v138
    v_lshl_or_b32 v139, v75, 16, v139
    v_lshl_or_b32 v140, v76, 16, v140
    v_lshl_or_b32 v141, v77, 16, v141
    v_lshl_or_b32 v142, v78, 16, v142
    v_lshl_or_b32 v143, v79, 16, v143
    v_lshl_or_b32 v144, v80, 16, v144
    v_lshl_or_b32 v145, v81, 16, v145
    v_lshl_or_b32 v146, v82, 16, v146
    v_lshl_or_b32 v147, v83, 16, v147
    v_lshl_or_b32 v148, v84, 16, v148
    v_lshl_or_b32 v149, v85, 16, v149
    v_lshl_or_b32 v150, v86, 16, v150
    v_lshl_or_b32 v151, v87, 16, v151
    v_mfma_f32_16x16x32_bf16 a[200:203], a[204:207], v[104:107], a[200:203]
    v_mfma_f32_16x16x32_bf16 a[196:199], a[204:207], v[100:103], a[196:199]
    v_mfma_f32_16x16x32_bf16 a[192:195], a[204:207], v[96:99], a[192:195]
    v_mfma_f32_16x16x32_bf16 v[160:163], v[120:123], v[96:99], v[160:163]
    v_mfma_f32_16x16x32_bf16 v[164:167], v[120:123], v[100:103], v[164:167]
    v_mfma_f32_16x16x32_bf16 v[168:171], v[120:123], v[104:107], v[168:171]
    v_mfma_f32_16x16x32_bf16 v[180:183], v[124:127], v[104:107], v[180:183]
    v_mfma_f32_16x16x32_bf16 v[176:179], v[124:127], v[100:103], v[176:179]
    v_mfma_f32_16x16x32_bf16 v[172:175], v[124:127], v[96:99], v[172:175]
    v_mfma_f32_16x16x32_bf16 v[184:187], v[128:131], v[96:99], v[184:187]
    v_mfma_f32_16x16x32_bf16 v[188:191], v[128:131], v[100:103], v[188:191]
    v_mfma_f32_16x16x32_bf16 v[192:195], v[128:131], v[104:107], v[192:195]
    v_mfma_f32_16x16x32_bf16 v[204:207], v[132:135], v[104:107], v[204:207]
    v_mfma_f32_16x16x32_bf16 v[200:203], v[132:135], v[100:103], v[200:203]
    v_mfma_f32_16x16x32_bf16 v[196:199], v[132:135], v[96:99], v[196:199]
    v_mfma_f32_16x16x32_bf16 v[208:211], v[136:139], v[96:99], v[208:211]
    v_mfma_f32_16x16x32_bf16 v[212:215], v[136:139], v[100:103], v[212:215]
    v_mfma_f32_16x16x32_bf16 v[216:219], v[136:139], v[104:107], v[216:219]
    v_mfma_f32_16x16x32_bf16 v[228:231], v[140:143], v[104:107], v[228:231]
    v_mfma_f32_16x16x32_bf16 v[224:227], v[140:143], v[100:103], v[224:227]
    v_mfma_f32_16x16x32_bf16 v[220:223], v[140:143], v[96:99], v[220:223]
    v_mfma_f32_16x16x32_bf16 v[232:235], v[144:147], v[96:99], v[232:235]
    v_mfma_f32_16x16x32_bf16 v[236:239], v[144:147], v[100:103], v[236:239]
    v_mfma_f32_16x16x32_bf16 v[240:243], v[144:147], v[104:107], v[240:243]
    v_mfma_f32_16x16x32_bf16 v[252:255], v[148:151], v[104:107], v[252:255]
    v_mfma_f32_16x16x32_bf16 v[248:251], v[148:151], v[100:103], v[248:251]
    v_mfma_f32_16x16x32_bf16 v[244:247], v[148:151], v[96:99], v[244:247]
    s_add_u32 s69, s69, 8192
    s_cmp_lt_u32 s69, s70
    s_nop 7
    s_cbranch_scc1 L_slow_p2
    v_accvgpr_read_b32 v7, a192
    v_accvgpr_read_b32 v8, a196
    v_accvgpr_read_b32 v9, a200
    v_rcp_f32 v7, v7
    v_rcp_f32 v8, v8
    v_rcp_f32 v9, v9
    s_cmp_eq_u32 s67, 3
    s_cbranch_scc1 L_g
    v_mul_f32 v160, v160, v7
    v_mul_f32 v161, v161, v7
    v_mul_f32 v162, v162, v7
    v_mul_f32 v163, v163, v7
    v_mul_f32 v164, v164, v8
    v_mul_f32 v165, v165, v8
    v_mul_f32 v166, v166, v8
    v_mul_f32 v167, v167, v8
    v_mul_f32 v168, v168, v9
    v_mul_f32 v169, v169, v9
    v_mul_f32 v170, v170, v9
    v_mul_f32 v171, v171, v9
    v_mul_f32 v172, v172, v7
    v_mul_f32 v173, v173, v7
    v_mul_f32 v174, v174, v7
    v_mul_f32 v175, v175, v7
    v_mul_f32 v176, v176, v8
    v_mul_f32 v177, v177, v8
    v_mul_f32 v178, v178, v8
    v_mul_f32 v179, v179, v8
    s_branch L_epi
.section .rodata,"a"
.p2align 6
.amdhsa_kernel concat_heads__mha_block_cached__gqa_block_cached__near_ridge_kernel
  .amdhsa_next_free_vgpr 512
  .amdhsa_next_free_sgpr 80
  .amdhsa_accum_offset 256
  .amdhsa_group_segment_fixed_size 0
  .amdhsa_kernarg_size 104
  .amdhsa_user_sgpr_count 2
  .amdhsa_user_sgpr_kernarg_segment_ptr 1
  .amdhsa_system_sgpr_workgroup_id_x 1
  .amdhsa_float_denorm_mode_32 3
.end_amdhsa_kernel
```
